```python
import torch

def _softmax(x, axis=-1):
    return torch.softmax(x, dim=axis)
def _gelu(x):
    return torch.nn.functional.gelu(x, approximate="tanh")
def _silu(x):
    return torch.nn.functional.silu(x)
def _sigmoid(x):
    return torch.sigmoid(x)
def _layernorm(x, axis=-1, eps=1e-5):
    m = x.mean(dim=axis, keepdim=True)
    v = x.var(dim=axis, keepdim=True, unbiased=False)
    return (x - m) / torch.sqrt(v + eps)
def _scatter_add(tgt, idx, src, axis=0):
    return tgt.clone().index_add_(axis, idx, src)
def _segment_sum(src, seg, n):
    out = torch.zeros((n,) + src.shape[1:], dtype=src.dtype)
    return out.index_add_(0, seg, src)
def _pad(x, pw):
    flat = tuple(v for pair in reversed(pw) for v in pair)
    return torch.nn.functional.pad(x, flat)

kernel_name = 'sequential_preLN__compressed_kv_cla__dense_activation_silu__prompt'

def setup_inputs():

    _w = (lambda a: (lambda t: t.to(torch.bfloat16) if t.is_floating_point() else t)(torch.as_tensor(a)))
    def _A_setup():
        B, H, Sq, Sk, D, M = 1, 32, 2048, 2048, 128, 1024
        Dc = 4 * D
        return {
            "x": _w((lambda *s: torch.randn(*s, dtype=torch.bfloat16) * 0.05)(B, Sq, M)),
            "c_kv": _w((lambda *s: torch.randn(*s, dtype=torch.bfloat16) * 0.4)(B, Sk, Dc)),
            "w_q": _w((lambda *s: torch.randn(*s, dtype=torch.bfloat16) * 1.6)(M, H, D) * (M ** -0.5)),
            "w_uk": _w((lambda *s: torch.randn(*s, dtype=torch.bfloat16) * 1.6)(Dc, H, D) * (Dc ** -0.5)),
            "w_uv": _w((lambda *s: torch.randn(*s, dtype=torch.bfloat16) * 0.4)(Dc, H, D) * (Dc ** -0.5)),
            "w_o": _w((lambda *s: torch.randn(*s, dtype=torch.bfloat16) * 0.4)(H, D, M) * ((H * D) ** -0.5)),
        }
    _A_in = _A_setup()

    def _B_setup():
        B, S, D, F = 1, 2048, 1024, 3584
        return {
            "x": _w((lambda *s: torch.randn(*s, dtype=torch.bfloat16) * 0.05)(B, S, D)),
            "w1": _w((lambda *s: torch.randn(*s, dtype=torch.bfloat16) * 0.8)(D, F) * (D ** -0.5)),
            "w2": _w((lambda *s: torch.randn(*s, dtype=torch.bfloat16) * 0.1)(F, D) * (F ** -0.5)),
        }
    _B_in = _B_setup()

    return {
        "A_x": _A_in["x"],
        "A_c_kv": _A_in["c_kv"],
        "A_w_q": _A_in["w_q"],
        "A_w_uk": _A_in["w_uk"],
        "A_w_uv": _A_in["w_uv"],
        "A_w_o": _A_in["w_o"],
        "B_x": _B_in["x"],
        "B_w1": _B_in["w1"],
        "B_w2": _B_in["w2"],
    }

def reference(A_x, A_c_kv, A_w_q, A_w_uk, A_w_uv, A_w_o, B_x, B_w1, B_w2):
    def _A_ref(x, c_kv, w_q, w_uk, w_uv, w_o):
        B, Sq, M = x.shape[0], x.shape[1], x.shape[2]
        Sk = c_kv.shape[1]
        H, D = w_q.shape[1], w_q.shape[2]
        q = torch.einsum("bqm,mhd->bhqd", x, w_q)
        k = torch.einsum("bkc,chd->bhkd", c_kv, w_uk)
        v = torch.einsum("bkc,chd->bhkd", c_kv, w_uv)
        scores = torch.einsum("bhqd,bhkd->bhqk", q, k) * (D ** -0.5)
        off = Sk - Sq
        qi = torch.arange(Sq)[:, None]
        kj = torch.arange(Sk)[None, :]
        cmask = kj <= (qi + off)
        scores = torch.where(cmask[None, None], scores, -1e9)
        p = _softmax(scores, axis=-1)
        ctx = torch.einsum("bhqk,bhkd->bhqd", p, v)
        return torch.einsum("bhqd,hdm->bqm", ctx, w_o)

    def _B_ref(x, w1, w2):
        h = torch.einsum("bsd,df->bsf", x, w1)
        h = _silu(h)
        out = torch.einsum("bsf,fd->bsd", h, w2)
        return out

    x = A_x
    h = x + _A_ref(_layernorm(x, axis=-1), A_c_kv, A_w_q, A_w_uk, A_w_uv, A_w_o)
    h2 = h + _B_ref(_layernorm(h, axis=-1), B_w1, B_w2)
    return h2
```

```asm
; @launch grid=(256,1,1) block=(256,1,1) lds=163840
.amdgcn_target "amdgcn-amd-amdhsa--gfx950"
.macro mm x0, x1, x2, x3
  v_mfma_f32_16x16x32_bf16 \x0, \x1, \x2, \x3
.endm
.macro rt x0, x1, x2
  ds_read_b64_tr_b16 \x0, \x1 offset:\x2
.endm
.macro cv x0, x1, x2
  v_cvt_pk_bf16_f32 \x0, \x1, \x2
.endm
.macro ar x0, x1
  v_accvgpr_read_b32 \x0, \x1
.endm
.macro aw x0, x1
  v_accvgpr_write_b32 \x0, \x1
.endm
.text
.globl sequential_preLN__compressed_kv_cla__dense_activation_silu__prompt_kernel
.type sequential_preLN__compressed_kv_cla__dense_activation_silu__prompt_kernel,@function
.p2align 8
sequential_preLN__compressed_kv_cla__dense_activation_silu__prompt_kernel:
s_cmp_lt_u32 s2, 256
s_cbranch_scc1 L_go
s_endpgm
L_go:
s_load_dwordx16 s[64:79], s[0:1], 0
s_load_dwordx8 s[80:87], s[0:1], 64
v_lshrrev_b32 v2, 6, v0
v_and_b32 v0, 63, v0
v_readfirstlane_b32 s3, v2
v_lshlrev_b32 v1, 4, v0
s_and_b32 s32, s2, 7
s_lshl_b32 s32, s32, 2
s_bfe_u32 s4, s2, 0x20003
s_add_u32 s32, s32, s4
s_lshr_b32 s33, s2, 5
s_bfe_u32 s55, s2, 0x10003
s_bfe_u32 s56, s2, 0x10004
s_lshl_b32 s56, s56, 1
s_and_b32 s4, s32, 28
s_add_u32 s56, s56, s4
s_lshr_b32 s4, s3, 1
s_add_u32 s56, s56, s4
v_lshrrev_b32 v29, 3, v0
s_lshl_b32 s4, s3, 6
v_add_u32 v29, s4, v29
v_lshlrev_b32 v29, 10, v29
v_lshrrev_b32 v30, 4, v0
v_and_b32 v31, 7, v0
v_xor_b32 v30, v30, v31
v_xor_b32 v31, 4, v30
v_lshl_add_u32 v2, v30, 4, v29
v_lshl_add_u32 v3, v31, 4, v29
v_add_u32 v3, 7168, v3
v_lshl_add_u32 v4, v30, 4, v29
v_add_u32 v4, 14336, v4
v_lshl_add_u32 v5, v31, 4, v29
v_add_u32 v5, 21504, v5
v_lshrrev_b32 v29, 4, v0
s_and_b32 s4, s3, 1
s_lshl_b32 s4, s4, 4
v_add_u32 v30, s4, v29
v_lshlrev_b32 v30, 13, v30
v_lshlrev_b32 v29, 1, v29
v_and_b32 v31, 15, v0
v_xor_b32 v29, v29, v31
v_lshl_add_u32 v6, v29, 4, v30
v_lshl_add_u32 v7, v29, 4, v30
v_add_u32 v7, 31744, v7
v_xor_b32 v29, 8, v29
v_lshl_add_u32 v8, v29, 4, v30
v_add_u32 v8, 63488, v8
v_lshl_add_u32 v9, v29, 4, v30
v_add_u32 v9, 95232, v9
s_lshl_b32 s34, s33, 18
s_lshl_b32 s35, s56, 8
s_lshl_b32 s36, s3, 13
s_lshl_b32 s5, s3, 12
s_add_u32 s37, s5, 65536
s_add_u32 s39, s34, 32768
s_mov_b32 s40, 262144
s_lshl_b32 s4, s2, 14
s_add_u32 s4, s4, s5
s_mul_i32 s5, s3, 4160
s_waitcnt lgkmcnt(0)
s_mov_b32 s8, s66
s_and_b32 s9, s67, 0xffff
s_mov_b32 s10, 2097152
s_mov_b32 s11, 0x20000
s_cmp_eq_u32 s55, 1
s_cselect_b32 s12, s72, s70
s_cselect_b32 s13, s73, s71
s_and_b32 s13, s13, 0xffff
s_mov_b32 s14, 4194304
s_mov_b32 s15, 0x20000
s_mov_b32 s16, s64
s_and_b32 s17, s65, 0xffff
s_mov_b32 s18, 4194304
s_mov_b32 s19, 0x20000
s_getpc_b64 s[42:43]
L_pc0:
s_lshr_b32 s53, s2, 3
s_lshl_b32 s53, s53, 2
s_add_u32 s53, s53, s3
s_lshl_b32 s6, s53, 8
v_lshl_add_u32 v99, v0, 2, s6
global_load_dword v97, v99, s[42:43]
s_add_u32 m0, s37, 0
s_nop 0
buffer_load_dwordx4 v6, s[12:15], s35 offen offset:0 lds
buffer_load_dwordx4 v7, s[12:15], s35 offen offset:1024 lds
buffer_load_dwordx4 v8, s[12:15], s35 offen offset:2048 lds
buffer_load_dwordx4 v9, s[12:15], s35 offen offset:3072 lds
s_add_u32 s35, s35, s40
s_add_u32 m0, s36, 0
s_nop 0
buffer_load_dwordx4 v2, s[8:11], s34 offen offset:0 lds
buffer_load_dwordx4 v3, s[8:11], s34 offen offset:1024 lds
buffer_load_dwordx4 v4, s[8:11], s34 offen offset:2048 lds
buffer_load_dwordx4 v5, s[8:11], s34 offen offset:3072 lds
s_add_u32 s34, s34, 128
s_add_u32 m0, s36, 4096
s_nop 0
buffer_load_dwordx4 v2, s[8:11], s39 offen offset:0 lds
buffer_load_dwordx4 v3, s[8:11], s39 offen offset:1024 lds
buffer_load_dwordx4 v4, s[8:11], s39 offen offset:2048 lds
buffer_load_dwordx4 v5, s[8:11], s39 offen offset:3072 lds
s_add_u32 s39, s39, 128
s_mov_b32 s57, s4
s_mov_b32 s58, s5
s_and_b32 s7, s2, 7
s_lshl_b32 s7, s7, 10
s_mov_b32 s60, s66
s_and_b32 s61, s67, 0xffff
s_mov_b32 s62, 2097152
s_mov_b32 s63, 0x20000
s_cmp_ge_u32 s53, 64
s_cselect_b32 s44, s72, s70
s_cselect_b32 s45, s73, s71
s_and_b32 s45, s45, 0xffff
s_mov_b32 s46, 4194304
s_mov_b32 s47, 0x20000
s_and_b32 s6, s53, 63
s_lshl_b32 s6, s6, 13
s_add_u32 s6, s6, s7
s_add_u32 s49, s6, 2097152
v_lshrrev_b32 v100, 3, v0
v_lshlrev_b32 v100, 10, v100
v_and_b32 v101, 7, v0
v_lshl_add_u32 v100, v101, 4, v100
v_add_u32 v101, 8192, v100
s_lshl_b32 s48, s53, 14
s_add_u32 s48, s48, 512
s_mov_b32 s50, 128
s_lshl_b32 s52, s53, 13
s_add_u32 s52, s52, s7
s_lshl_b32 s6, s53, 10
s_add_u32 s6, s6, 32768
v_add_u32 v99, s6, v1
v_min_u32 v99, L_end-L_pc0, v99
v_and_b32 v29, 15, v0
v_lshrrev_b32 v30, 1, v29
v_lshrrev_b32 v31, 4, v0
v_xor_b32 v30, v30, v31
v_lshlrev_b32 v30, 4, v30
v_lshl_add_u32 v29, v29, 7, v30
s_and_b32 s4, s3, 1
s_lshl_b32 s4, s4, 14
v_add_u32 v10, s4, v29
v_xor_b32 v11, 64, v10
v_bfe_u32 v33, v0, 2, 2
v_and_b32 v34, 3, v0
v_lshl_add_u32 v29, v31, 3, v33
v_lshlrev_b32 v29, 8, v29
v_lshl_add_u32 v29, v34, 3, v29
v_and_b32 v30, 1, v31
v_lshl_add_u32 v30, v30, 2, v33
v_lshl_add_u32 v29, v30, 5, v29
s_lshr_b32 s4, s3, 1
s_lshl_b32 s4, s4, 13
s_add_u32 s4, s4, 65536
v_add_u32 v29, s4, v29
v_xor_b32 v12, 0, v29
v_xor_b32 v13, 32, v29
v_xor_b32 v14, 64, v29
v_xor_b32 v15, 96, v29
v_xor_b32 v16, 128, v29
v_xor_b32 v17, 160, v29
v_xor_b32 v18, 192, v29
v_xor_b32 v19, 224, v29
v_lshrrev_b32 v29, 5, v0
s_lshl_b32 s4, s3, 1
v_add_u32 v31, s4, v29
v_mul_u32_u24 v52, 2080, v31
v_and_b32 v30, 31, v0
v_lshl_add_u32 v52, v30, 4, v52
v_add_u32 v52, 131072, v52
v_lshlrev_b32 v53, 3, v31
v_add_u32 v53, 147712, v53
v_and_b32 v30, 7, v0
v_lshlrev_b32 v54, 3, v30
v_add_u32 v54, 147712, v54
v_mul_u32_u24 v55, 2080, v30
v_bfe_u32 v31, v0, 3, 2
v_lshl_add_u32 v55, v31, 3, v55
v_lshl_add_u32 v55, v29, 6, v55
s_lshl_b32 s4, s3, 9
s_add_u32 s4, s4, 131072
v_add_u32 v55, s4, v55
v_lshlrev_b32 v31, 4, v31
v_add_u32 v31, v31, v30
v_lshlrev_b32 v31, 4, v31
v_lshl_add_u32 v31, v29, 10, v31
s_lshr_b32 s4, s2, 1
s_lshl_b32 s4, s4, 15
s_lshl_b32 s5, s3, 13
s_add_u32 s4, s4, s5
s_and_b32 s5, s2, 1
s_lshl_b32 s5, s5, 7
s_add_u32 s4, s4, s5
v_add_u32 v96, s4, v31
v_add_u32 v56, 4096, v96
v_lshlrev_b32 v57, 2, v0
v_and_b32 v29, 3, v0
v_bfe_u32 v30, v0, 2, 1
v_lshl_add_u32 v29, v30, 10, v29
v_lshlrev_b32 v29, 7, v29
s_mul_i32 s4, s2, 384
s_add_u32 s4, s4, 32768
v_add_u32 v29, s4, v29
v_cmp_lt_u32 vcc, 15, v0
s_nop 1
v_cndmask_b32 v57, v57, v29, vcc
v_cmp_lt_u32 vcc, 23, v0
v_mov_b32 v29, 0x1000000
s_nop 0
v_cndmask_b32 v57, v57, v29, vcc
v_mov_b32 v58, 0
v_and_b32 v98, 1, v0
v_lshlrev_b32 v98, 7, v98
s_lshl_b32 s54, s2, 7
s_add_u32 s28, s86, 63963136
s_addc_u32 s29, s87, 0
s_and_b32 s29, s29, 0xffff
s_mov_b32 s30, 294912
s_mov_b32 s31, 0x20000
s_mov_b32 s24, s84
s_and_b32 s25, s85, 0xffff
s_mov_b32 s26, 256
s_mov_b32 s27, 0x20000
s_mov_b32 s20, s86
s_and_b32 s21, s87, 0xffff
s_mov_b32 s22, 4194304
s_mov_b32 s23, 0x20000
s_add_u32 m0, s37, 16384
s_nop 0
buffer_load_dwordx4 v6, s[12:15], s35 offen offset:0 lds
buffer_load_dwordx4 v7, s[12:15], s35 offen offset:1024 lds
buffer_load_dwordx4 v8, s[12:15], s35 offen offset:2048 lds
buffer_load_dwordx4 v9, s[12:15], s35 offen offset:3072 lds
s_add_u32 s35, s35, s40
s_add_u32 m0, s58, 131072
s_nop 0
buffer_load_dwordx4 v1, s[16:19], s57 offen lds
buffer_load_dwordx4 v1, s[16:19], s57 offen offset:1024 lds
s_add_u32 m0, s58, 133152
s_add_u32 s57, s57, 2048
buffer_load_dwordx4 v1, s[16:19], s57 offen lds
buffer_load_dwordx4 v1, s[16:19], s57 offen offset:1024 lds
s_waitcnt vmcnt(8)
s_barrier
ds_read_b128 a[128:131], v10 offset:0
rt a[160:161],v12,0
rt a[162:163],v12,1024
ds_read_b128 a[132:135], v10 offset:2048
rt a[164:165],v13,0
rt a[166:167],v13,1024
ds_read_b128 a[136:139], v10 offset:4096
rt a[168:169],v14,0
rt a[170:171],v14,1024
ds_read_b128 a[140:143], v10 offset:6144
rt a[172:173],v15,0
rt a[174:175],v15,1024
ds_read_b128 a[144:147], v10 offset:8192
rt a[176:177],v16,0
rt a[178:179],v16,1024
ds_read_b128 a[148:151], v10 offset:10240
rt a[180:181],v17,0
rt a[182:183],v17,1024
ds_read_b128 a[152:155], v10 offset:12288
rt a[184:185],v18,0
rt a[186:187],v18,1024
ds_read_b128 a[156:159], v10 offset:14336
rt a[188:189],v19,0
rt a[190:191],v19,1024
s_add_u32 m0, s37, 32768
s_nop 0
buffer_load_dwordx4 v6, s[12:15], s35 offen offset:0 lds
buffer_load_dwordx4 v7, s[12:15], s35 offen offset:1024 lds
buffer_load_dwordx4 v8, s[12:15], s35 offen offset:2048 lds
buffer_load_dwordx4 v9, s[12:15], s35 offen offset:3072 lds
s_add_u32 s35, s35, s40
s_mov_b32 s38, 1
s_waitcnt lgkmcnt(0)
s_cmp_eq_u32 s55, 1
s_cbranch_scc1 L_p1_v
L_p1_k:
mm v[128:131],a[160:163],a[128:131],0
s_add_u32 m0, s36, 32768
mm v[132:135],a[164:167],a[128:131],0
buffer_load_dwordx4 v2, s[8:11], s34 offen offset:0 lds
mm v[136:139],a[168:171],a[128:131],0
mm v[140:143],a[172:175],a[128:131],0
buffer_load_dwordx4 v3, s[8:11], s34 offen offset:1024 lds
mm v[144:147],a[176:179],a[128:131],0
mm v[148:151],a[180:183],a[128:131],0
buffer_load_dwordx4 v4, s[8:11], s34 offen offset:2048 lds
mm v[152:155],a[184:187],a[128:131],0
buffer_load_dwordx4 v5, s[8:11], s34 offen offset:3072 lds
mm v[156:159],a[188:191],a[128:131],0
mm v[160:163],a[160:163],a[132:135],0
s_add_u32 s34, s34, 128
mm v[164:167],a[164:167],a[132:135],0
s_add_u32 m0, s36, 36864
mm v[168:171],a[168:171],a[132:135],0
buffer_load_dwordx4 v2, s[8:11], s39 offen offset:0 lds
mm v[172:175],a[172:175],a[132:135],0
buffer_load_dwordx4 v3, s[8:11], s39 offen offset:1024 lds
mm v[176:179],a[176:179],a[132:135],0
mm v[180:183],a[180:183],a[132:135],0
buffer_load_dwordx4 v4, s[8:11], s39 offen offset:2048 lds
mm v[184:187],a[184:187],a[132:135],0
mm v[188:191],a[188:191],a[132:135],0
buffer_load_dwordx4 v5, s[8:11], s39 offen offset:3072 lds
mm v[192:195],a[160:163],a[136:139],0
mm v[196:199],a[164:167],a[136:139],0
s_add_u32 s39, s39, 128
s_add_u32 m0, s37, 49152
mm v[200:203],a[168:171],a[136:139],0
buffer_load_dwordx4 v6, s[12:15], s35 offen offset:0 lds
buffer_load_dwordx4 v7, s[12:15], s35 offen offset:1024 lds
buffer_load_dwordx4 v8, s[12:15], s35 offen offset:2048 lds
buffer_load_dwordx4 v9, s[12:15], s35 offen offset:3072 lds
s_add_u32 s35, s35, s40
mm v[204:207],a[172:175],a[136:139],0
s_waitcnt vmcnt(16)
s_barrier
mm v[208:211],a[176:179],a[136:139],0
mm v[212:215],a[180:183],a[136:139],0
mm v[216:219],a[184:187],a[136:139],0
mm v[220:223],a[188:191],a[136:139],0
mm v[224:227],a[160:163],a[140:143],0
mm v[228:231],a[164:167],a[140:143],0
mm v[232:235],a[168:171],a[140:143],0
mm v[236:239],a[172:175],a[140:143],0
mm v[240:243],a[176:179],a[140:143],0
buffer_load_dwordx4 v[104:107], v100, s[60:63], s48 offen
mm v[244:247],a[180:183],a[140:143],0
buffer_load_dwordx4 v[104:107], v1, s[44:47], s49 offen
mm v[248:251],a[184:187],a[140:143],0
mm v[252:255],a[188:191],a[140:143],0
ds_read_b128 a[192:195], v11 offset:0
mm a[0:3],a[160:163],a[144:147],0
rt a[224:225],v12,16384
mm a[4:7],a[164:167],a[144:147],0
rt a[226:227],v12,17408
mm a[8:11],a[168:171],a[144:147],0
ds_read_b128 a[196:199], v11 offset:2048
rt a[228:229],v13,16384
mm a[12:15],a[172:175],a[144:147],0
rt a[230:231],v13,17408
mm a[16:19],a[176:179],a[144:147],0
ds_read_b128 a[200:203], v11 offset:4096
mm a[20:23],a[180:183],a[144:147],0
rt a[232:233],v14,16384
mm a[24:27],a[184:187],a[144:147],0
s_add_u32 s49, s49, 524288
mm a[28:31],a[188:191],a[144:147],0
rt a[234:235],v14,17408
mm a[32:35],a[160:163],a[148:151],0
ds_read_b128 a[204:207], v11 offset:6144
rt a[236:237],v15,16384
mm a[36:39],a[164:167],a[148:151],0
rt a[238:239],v15,17408
mm a[40:43],a[168:171],a[148:151],0
s_add_u32 m0, s37, 0
mm a[44:47],a[172:175],a[148:151],0
buffer_load_dwordx4 v6, s[12:15], s35 offen offset:0 lds
mm a[48:51],a[176:179],a[148:151],0
mm a[52:55],a[180:183],a[148:151],0
ds_read_b128 a[208:211], v11 offset:8192
mm a[56:59],a[184:187],a[148:151],0
buffer_load_dwordx4 v7, s[12:15], s35 offen offset:1024 lds
mm a[60:63],a[188:191],a[148:151],0
rt a[240:241],v16,16384
mm a[64:67],a[160:163],a[152:155],0
rt a[242:243],v16,17408
mm a[68:71],a[164:167],a[152:155],0
ds_read_b128 a[212:215], v11 offset:10240
mm a[72:75],a[168:171],a[152:155],0
rt a[244:245],v17,16384
mm a[76:79],a[172:175],a[152:155],0
buffer_load_dwordx4 v8, s[12:15], s35 offen offset:2048 lds
mm a[80:83],a[176:179],a[152:155],0
rt a[246:247],v17,17408
mm a[84:87],a[180:183],a[152:155],0
ds_read_b128 a[216:219], v11 offset:12288
mm a[88:91],a[184:187],a[152:155],0
rt a[248:249],v18,16384
mm a[92:95],a[188:191],a[152:155],0
rt a[250:251],v18,17408
mm a[96:99],a[160:163],a[156:159],0
ds_read_b128 a[220:223], v11 offset:14336
rt a[252:253],v19,16384
rt a[254:255],v19,17408
ds_read_b128 v[36:39], v52 offset:0
ds_read_b128 v[40:43], v52 offset:512
ds_read_b128 v[44:47], v52 offset:1024
ds_read_b128 v[48:51], v52 offset:1536
mm a[100:103],a[164:167],a[156:159],0
mm a[104:107],a[168:171],a[156:159],0
mm a[108:111],a[172:175],a[156:159],0
mm a[112:115],a[176:179],a[156:159],0
mm a[116:119],a[180:183],a[156:159],0
mm a[120:123],a[184:187],a[156:159],0
buffer_load_dwordx4 v9, s[12:15], s35 offen offset:3072 lds
s_add_u32 s35, s35, s40
mm a[124:127],a[188:191],a[156:159],0
s_waitcnt lgkmcnt(0)
mm v[128:131],a[224:227],a[192:195],v[128:131]
v_lshlrev_b32 v64, 16, v36
v_and_b32 v65, 0xffff0000, v36
v_lshlrev_b32 v66, 16, v37
mm v[132:135],a[228:231],a[192:195],v[132:135]
v_and_b32 v67, 0xffff0000, v37
v_lshlrev_b32 v68, 16, v38
mm v[136:139],a[232:235],a[192:195],v[136:139]
v_and_b32 v69, 0xffff0000, v38
v_lshlrev_b32 v70, 16, v39
v_and_b32 v71, 0xffff0000, v39
mm v[140:143],a[236:239],a[192:195],v[140:143]
v_lshlrev_b32 v72, 16, v40
v_and_b32 v73, 0xffff0000, v40
mm v[144:147],a[240:243],a[192:195],v[144:147]
v_lshlrev_b32 v74, 16, v41
v_and_b32 v75, 0xffff0000, v41
v_lshlrev_b32 v76, 16, v42
mm v[148:151],a[244:247],a[192:195],v[148:151]
v_and_b32 v77, 0xffff0000, v42
v_lshlrev_b32 v78, 16, v43
mm v[152:155],a[248:251],a[192:195],v[152:155]
v_and_b32 v79, 0xffff0000, v43
v_lshlrev_b32 v80, 16, v44
v_and_b32 v81, 0xffff0000, v44
mm v[156:159],a[252:255],a[192:195],v[156:159]
v_lshlrev_b32 v82, 16, v45
v_and_b32 v83, 0xffff0000, v45
mm v[160:163],a[224:227],a[196:199],v[160:163]
v_lshlrev_b32 v84, 16, v46
v_and_b32 v85, 0xffff0000, v46
v_lshlrev_b32 v86, 16, v47
mm v[164:167],a[228:231],a[196:199],v[164:167]
v_and_b32 v87, 0xffff0000, v47
v_lshlrev_b32 v88, 16, v48
s_waitcnt vmcnt(10)
s_barrier
mm v[168:171],a[232:235],a[196:199],v[168:171]
s_add_u32 m0, s36, 0
ds_read_b128 a[128:131], v10 offset:32768
v_and_b32 v89, 0xffff0000, v48
v_lshlrev_b32 v90, 16, v49
mm v[172:175],a[236:239],a[196:199],v[172:175]
v_and_b32 v91, 0xffff0000, v49
v_lshlrev_b32 v92, 16, v50
v_and_b32 v93, 0xffff0000, v50
mm v[176:179],a[240:243],a[196:199],v[176:179]
buffer_load_dwordx4 v2, s[8:11], s34 offen offset:0 lds
rt a[160:161],v12,32768
v_lshlrev_b32 v94, 16, v51
v_and_b32 v95, 0xffff0000, v51
mm v[180:183],a[244:247],a[196:199],v[180:183]
v_add_f32 v32, v64, v66
v_add_f32 v33, v65, v67
v_add_f32 v32, v32, v68
mm v[184:187],a[248:251],a[196:199],v[184:187]
rt a[162:163],v12,33792
v_add_f32 v33, v33, v69
v_add_f32 v32, v32, v70
mm v[188:191],a[252:255],a[196:199],v[188:191]
buffer_load_dwordx4 v3, s[8:11], s34 offen offset:1024 lds
v_add_f32 v33, v33, v71
v_add_f32 v32, v32, v72
v_add_f32 v33, v33, v73
mm v[192:195],a[224:227],a[200:203],v[192:195]
ds_read_b128 a[132:135], v10 offset:34816
v_add_f32 v32, v32, v74
v_add_f32 v33, v33, v75
mm v[196:199],a[228:231],a[200:203],v[196:199]
v_add_f32 v32, v32, v76
v_add_f32 v33, v33, v77
v_add_f32 v32, v32, v78
mm v[200:203],a[232:235],a[200:203],v[200:203]
buffer_load_dwordx4 v4, s[8:11], s34 offen offset:2048 lds
rt a[164:165],v13,32768
v_add_f32 v33, v33, v79
v_add_f32 v32, v32, v80
mm v[204:207],a[236:239],a[200:203],v[204:207]
v_add_f32 v33, v33, v81
v_add_f32 v32, v32, v82
mm v[208:211],a[240:243],a[200:203],v[208:211]
buffer_load_dwordx4 v5, s[8:11], s34 offen offset:3072 lds
rt a[166:167],v13,33792
v_add_f32 v33, v33, v83
v_add_f32 v32, v32, v84
v_add_f32 v33, v33, v85
mm v[212:215],a[244:247],a[200:203],v[212:215]
v_add_f32 v32, v32, v86
v_add_f32 v33, v33, v87
mm v[216:219],a[248:251],a[200:203],v[216:219]
ds_read_b128 a[136:139], v10 offset:36864
v_add_f32 v32, v32, v88
v_add_f32 v33, v33, v89
v_add_f32 v32, v32, v90
mm v[220:223],a[252:255],a[200:203],v[220:223]
v_add_f32 v33, v33, v91
v_add_f32 v32, v32, v92
s_add_u32 s34, s34, 128
mm v[224:227],a[224:227],a[204:207],v[224:227]
rt a[168:169],v14,32768
v_add_f32 v33, v33, v93
v_add_f32 v32, v32, v94
v_add_f32 v33, v33, v95
mm v[228:231],a[228:231],a[204:207],v[228:231]
v_add_f32 v36, v32, v33
s_nop 1
v_add_f32 v36, v36, v36 row_ror:8
mm v[232:235],a[232:235],a[204:207],v[232:235]
s_nop 1
v_add_f32 v36, v36, v36 row_ror:4
rt a[170:171],v14,33792
s_add_u32 m0, s36, 4096
s_nop 1
v_add_f32 v36, v36, v36 row_ror:2
s_nop 1
v_add_f32 v36, v36, v36 row_ror:1
mm v[236:239],a[236:239],a[204:207],v[236:239]
v_mov_b32 v34, v36
s_nop 1
v_permlane16_swap_b32 v36, v34
mm v[240:243],a[240:243],a[204:207],v[240:243]
ds_read_b128 a[140:143], v10 offset:38912
v_add_f32 v36, v36, v34
v_mul_f32 v36, 0xba800000, v36
mm v[244:247],a[244:247],a[204:207],v[244:247]
buffer_load_dwordx4 v2, s[8:11], s39 offen offset:0 lds
v_add_f32 v64, v64, v36
mm v[248:251],a[248:251],a[204:207],v[248:251]
v_add_f32 v65, v65, v36
v_add_f32 v66, v66, v36
rt a[172:173],v15,32768
v_add_f32 v67, v67, v36
mm v[252:255],a[252:255],a[204:207],v[252:255]
buffer_load_dwordx4 v3, s[8:11], s39 offen offset:1024 lds
v_add_f32 v68, v68, v36
mm a[0:3],a[224:227],a[208:211],a[0:3]
v_add_f32 v69, v69, v36
v_add_f32 v70, v70, v36
v_add_f32 v71, v71, v36
mm a[4:7],a[228:231],a[208:211],a[4:7]
rt a[174:175],v15,33792
v_add_f32 v72, v72, v36
v_add_f32 v73, v73, v36
v_add_f32 v74, v74, v36
mm a[8:11],a[232:235],a[208:211],a[8:11]
buffer_load_dwordx4 v4, s[8:11], s39 offen offset:2048 lds
v_add_f32 v75, v75, v36
mm a[12:15],a[236:239],a[208:211],a[12:15]
v_add_f32 v76, v76, v36
ds_read_b128 a[144:147], v10 offset:40960
v_add_f32 v77, v77, v36
v_add_f32 v78, v78, v36
mm a[16:19],a[240:243],a[208:211],a[16:19]
v_add_f32 v79, v79, v36
v_add_f32 v80, v80, v36
v_add_f32 v81, v81, v36
mm a[20:23],a[244:247],a[208:211],a[20:23]
rt a[176:177],v16,32768
v_add_f32 v82, v82, v36
v_add_f32 v83, v83, v36
v_add_f32 v84, v84, v36
mm a[24:27],a[248:251],a[208:211],a[24:27]
buffer_load_dwordx4 v5, s[8:11], s39 offen offset:3072 lds
v_add_f32 v85, v85, v36
mm a[28:31],a[252:255],a[208:211],a[28:31]
v_add_f32 v86, v86, v36
rt a[178:179],v16,33792
v_add_f32 v87, v87, v36
mm a[32:35],a[224:227],a[212:215],a[32:35]
v_add_f32 v88, v88, v36
v_add_f32 v89, v89, v36
v_add_f32 v90, v90, v36
ds_read_b128 a[148:151], v10 offset:43008
mm a[36:39],a[228:231],a[212:215],a[36:39]
v_add_f32 v91, v91, v36
s_add_u32 s39, s39, 128
v_add_f32 v92, v92, v36
mm a[40:43],a[232:235],a[212:215],a[40:43]
buffer_load_dwordx4 v[104:107], v101, s[60:63], s48 offen
v_add_f32 v93, v93, v36
v_add_f32 v94, v94, v36
mm a[44:47],a[236:239],a[212:215],a[44:47]
v_add_f32 v95, v95, v36
rt a[180:181],v17,32768
v_mul_f32 v32, v64, v64
mm a[48:51],a[240:243],a[212:215],a[48:51]
v_mul_f32 v33, v65, v65
v_fmac_f32 v32, v66, v66
v_fmac_f32 v33, v67, v67
mm a[52:55],a[244:247],a[212:215],a[52:55]
v_fmac_f32 v32, v68, v68
rt a[182:183],v17,33792
v_fmac_f32 v33, v69, v69
v_fmac_f32 v32, v70, v70
mm a[56:59],a[248:251],a[212:215],a[56:59]
v_fmac_f32 v33, v71, v71
v_fmac_f32 v32, v72, v72
s_add_u32 s48, s48, s50
mm a[60:63],a[252:255],a[212:215],a[60:63]
v_fmac_f32 v33, v73, v73
ds_read_b128 a[152:155], v10 offset:45056
v_fmac_f32 v32, v74, v74
v_fmac_f32 v33, v75, v75
mm a[64:67],a[224:227],a[216:219],a[64:67]
v_fmac_f32 v32, v76, v76
v_fmac_f32 v33, v77, v77
v_fmac_f32 v32, v78, v78
mm a[68:71],a[228:231],a[216:219],a[68:71]
rt a[184:185],v18,32768
v_fmac_f32 v33, v79, v79
s_add_u32 m0, s37, 16384
v_fmac_f32 v32, v80, v80
mm a[72:75],a[232:235],a[216:219],a[72:75]
v_fmac_f32 v33, v81, v81
v_fmac_f32 v32, v82, v82
v_fmac_f32 v33, v83, v83
mm a[76:79],a[236:239],a[216:219],a[76:79]
buffer_load_dwordx4 v6, s[12:15], s35 offen offset:0 lds
rt a[186:187],v18,33792
mm a[80:83],a[240:243],a[216:219],a[80:83]
v_fmac_f32 v32, v84, v84
v_fmac_f32 v33, v85, v85
v_fmac_f32 v32, v86, v86
v_fmac_f32 v33, v87, v87
mm a[84:87],a[244:247],a[216:219],a[84:87]
v_fmac_f32 v32, v88, v88
ds_read_b128 a[156:159], v10 offset:47104
v_fmac_f32 v33, v89, v89
mm a[88:91],a[248:251],a[216:219],a[88:91]
buffer_load_dwordx4 v7, s[12:15], s35 offen offset:1024 lds
v_fmac_f32 v32, v90, v90
v_fmac_f32 v33, v91, v91
mm a[92:95],a[252:255],a[216:219],a[92:95]
v_fmac_f32 v32, v92, v92
v_fmac_f32 v33, v93, v93
rt a[188:189],v19,32768
mm a[96:99],a[224:227],a[220:223],a[96:99]
rt a[190:191],v19,33792
v_fmac_f32 v32, v94, v94
v_fmac_f32 v33, v95, v95
v_add_f32 v28, v32, v33
mm a[100:103],a[228:231],a[220:223],a[100:103]
s_nop 1
v_add_f32 v28, v28, v28 row_ror:8
s_nop 1
v_add_f32 v28, v28, v28 row_ror:4
mm a[104:107],a[232:235],a[220:223],a[104:107]
s_nop 1
v_add_f32 v28, v28, v28 row_ror:2
mm a[108:111],a[236:239],a[220:223],a[108:111]
buffer_load_dwordx4 v8, s[12:15], s35 offen offset:2048 lds
s_nop 1
v_add_f32 v28, v28, v28 row_ror:1
mm a[112:115],a[240:243],a[220:223],a[112:115]
v_mov_b32 v34, v28
s_nop 1
v_permlane16_swap_b32 v28, v34
v_add_f32 v28, v28, v34
v_mov_b32 v34, 0x3727c5ac
v_fmac_f32 v34, 0x3a800000, v28
v_rsq_f32 v37, v34
s_nop 0
v_mul_f32 v37, 0x3e0293ee, v37
ds_write_b64 v53, v[36:37]
mm a[116:119],a[244:247],a[220:223],a[116:119]
mm a[120:123],a[248:251],a[220:223],a[120:123]
buffer_load_dwordx4 v9, s[12:15], s35 offen offset:3072 lds
s_add_u32 s35, s35, s40
mm a[124:127],a[252:255],a[220:223],a[124:127]
s_waitcnt lgkmcnt(0)
mm v[128:131],a[160:163],a[128:131],v[128:131]
mm v[132:135],a[164:167],a[128:131],v[132:135]
mm v[136:139],a[168:171],a[128:131],v[136:139]
mm v[140:143],a[172:175],a[128:131],v[140:143]
s_waitcnt vmcnt(19)
s_barrier
mm v[144:147],a[176:179],a[128:131],v[144:147]
ds_read_b64 v[36:37], v54
ds_read_b64 v[80:81], v55 offset:0
ds_read_b64 v[82:83], v55 offset:32
buffer_load_dwordx4 v[104:107], v100, s[60:63], s48 offen
mm v[148:151],a[180:183],a[128:131],v[148:151]
ds_read_b64 v[84:85], v55 offset:128
ds_read_b64 v[86:87], v55 offset:160
ds_read_b64 v[88:89], v55 offset:256
mm v[152:155],a[184:187],a[128:131],v[152:155]
ds_read_b64 v[90:91], v55 offset:288
ds_read_b64 v[92:93], v55 offset:384
mm v[156:159],a[188:191],a[128:131],v[156:159]
ds_read_b64 v[94:95], v55 offset:416
mm v[160:163],a[160:163],a[132:135],v[160:163]
mm v[164:167],a[164:167],a[132:135],v[164:167]
buffer_load_dwordx4 v[104:107], v1, s[44:47], s49 offen
mm v[168:171],a[168:171],a[132:135],v[168:171]
mm v[172:175],a[172:175],a[132:135],v[172:175]
mm v[176:179],a[176:179],a[132:135],v[176:179]
s_waitcnt lgkmcnt(0)
mm v[180:183],a[180:183],a[132:135],v[180:183]
ds_read_b128 a[192:195], v11 offset:32768
v_lshlrev_b32 v38, 16, v80
v_and_b32 v39, 0xffff0000, v80
mm v[184:187],a[184:187],a[132:135],v[184:187]
v_add_f32 v38, v38, v36
rt a[224:225],v12,49152
mm v[188:191],a[188:191],a[132:135],v[188:191]
v_add_f32 v39, v39, v36
s_add_u32 s49, s49, 524288
mm v[192:195],a[160:163],a[136:139],v[192:195]
v_mul_f32 v38, v38, v37
rt a[226:227],v12,50176
mm v[196:199],a[164:167],a[136:139],v[196:199]
v_mul_f32 v39, v39, v37
mm v[200:203],a[168:171],a[136:139],v[200:203]
cv v64,v38,v39
ds_read_b128 a[196:199], v11 offset:34816
mm v[204:207],a[172:175],a[136:139],v[204:207]
v_lshlrev_b32 v40, 16, v81
v_and_b32 v41, 0xffff0000, v81
mm v[208:211],a[176:179],a[136:139],v[208:211]
rt a[228:229],v13,49152
v_add_f32 v40, v40, v36
mm v[212:215],a[180:183],a[136:139],v[212:215]
s_add_u32 m0, s37, 32768
v_add_f32 v41, v41, v36
mm v[216:219],a[184:187],a[136:139],v[216:219]
rt a[230:231],v13,50176
v_mul_f32 v40, v40, v37
mm v[220:223],a[188:191],a[136:139],v[220:223]
v_mul_f32 v41, v41, v37
mm v[224:227],a[160:163],a[140:143],v[224:227]
cv v65,v40,v41
ds_read_b128 a[200:203], v11 offset:36864
mm v[228:231],a[164:167],a[140:143],v[228:231]
v_lshlrev_b32 v42, 16, v82
v_and_b32 v43, 0xffff0000, v82
mm v[232:235],a[168:171],a[140:143],v[232:235]
rt a[232:233],v14,49152
v_add_f32 v42, v42, v36
mm v[236:239],a[172:175],a[140:143],v[236:239]
buffer_load_dwordx4 v6, s[12:15], s35 offen offset:0 lds
v_add_f32 v43, v43, v36
rt a[234:235],v14,50176
mm v[240:243],a[176:179],a[140:143],v[240:243]
v_mul_f32 v42, v42, v37
mm v[244:247],a[180:183],a[140:143],v[244:247]
v_mul_f32 v43, v43, v37
ds_read_b128 a[204:207], v11 offset:38912
mm v[248:251],a[184:187],a[140:143],v[248:251]
cv v66,v42,v43
mm v[252:255],a[188:191],a[140:143],v[252:255]
v_lshlrev_b32 v44, 16, v83
rt a[236:237],v15,49152
v_and_b32 v45, 0xffff0000, v83
mm a[0:3],a[160:163],a[144:147],a[0:3]
v_add_f32 v44, v44, v36
mm a[4:7],a[164:167],a[144:147],a[4:7]
buffer_load_dwordx4 v7, s[12:15], s35 offen offset:1024 lds
rt a[238:239],v15,50176
v_add_f32 v45, v45, v36
mm a[8:11],a[168:171],a[144:147],a[8:11]
v_mul_f32 v44, v44, v37
mm a[12:15],a[172:175],a[144:147],a[12:15]
v_mul_f32 v45, v45, v37
ds_read_b128 a[208:211], v11 offset:40960
mm a[16:19],a[176:179],a[144:147],a[16:19]
cv v67,v44,v45
mm a[20:23],a[180:183],a[144:147],a[20:23]
buffer_store_dwordx4 v[64:67], v96, s[20:23], 0 offen offset:0 sc1
rt a[240:241],v16,49152
v_lshlrev_b32 v38, 16, v84
mm a[24:27],a[184:187],a[144:147],a[24:27]
buffer_load_dwordx4 v8, s[12:15], s35 offen offset:2048 lds
mm a[28:31],a[188:191],a[144:147],a[28:31]
v_and_b32 v39, 0xffff0000, v84
rt a[242:243],v16,50176
mm a[32:35],a[160:163],a[148:151],a[32:35]
v_add_f32 v38, v38, v36
v_add_f32 v39, v39, v36
mm a[36:39],a[164:167],a[148:151],a[36:39]
ds_read_b128 a[212:215], v11 offset:43008
mm a[40:43],a[168:171],a[148:151],a[40:43]
v_mul_f32 v38, v38, v37
v_mul_f32 v39, v39, v37
mm a[44:47],a[172:175],a[148:151],a[44:47]
rt a[244:245],v17,49152
cv v68,v38,v39
mm a[48:51],a[176:179],a[148:151],a[48:51]
buffer_load_dwordx4 v9, s[12:15], s35 offen offset:3072 lds
mm a[52:55],a[180:183],a[148:151],a[52:55]
v_lshlrev_b32 v40, 16, v85
mm a[56:59],a[184:187],a[148:151],a[56:59]
rt a[246:247],v17,50176
v_and_b32 v41, 0xffff0000, v85
mm a[60:63],a[188:191],a[148:151],a[60:63]
v_add_f32 v40, v40, v36
v_add_f32 v41, v41, v36
mm a[64:67],a[160:163],a[152:155],a[64:67]
ds_read_b128 a[216:219], v11 offset:45056
v_mul_f32 v40, v40, v37
mm a[68:71],a[164:167],a[152:155],a[68:71]
v_mul_f32 v41, v41, v37
rt a[248:249],v18,49152
mm a[72:75],a[168:171],a[152:155],a[72:75]
cv v69,v40,v41
mm a[76:79],a[172:175],a[152:155],a[76:79]
v_lshlrev_b32 v42, 16, v86
rt a[250:251],v18,50176
mm a[80:83],a[176:179],a[152:155],a[80:83]
s_add_u32 s35, s35, s40
v_and_b32 v43, 0xffff0000, v86
mm a[84:87],a[180:183],a[152:155],a[84:87]
v_add_f32 v42, v42, v36
ds_read_b128 a[220:223], v11 offset:47104
mm a[88:91],a[184:187],a[152:155],a[88:91]
v_add_f32 v43, v43, v36
mm a[92:95],a[188:191],a[152:155],a[92:95]
v_mul_f32 v42, v42, v37
rt a[252:253],v19,49152
mm a[96:99],a[160:163],a[156:159],a[96:99]
rt a[254:255],v19,50176
v_mul_f32 v43, v43, v37
mm a[100:103],a[164:167],a[156:159],a[100:103]
cv v70,v42,v43
v_lshlrev_b32 v44, 16, v87
mm a[104:107],a[168:171],a[156:159],a[104:107]
global_load_dword v97, v99, s[42:43]
v_and_b32 v45, 0xffff0000, v87
mm a[108:111],a[172:175],a[156:159],a[108:111]
v_add_f32 v44, v44, v36
mm a[112:115],a[176:179],a[156:159],a[112:115]
v_add_f32 v45, v45, v36
v_mul_f32 v44, v44, v37
mm a[116:119],a[180:183],a[156:159],a[116:119]
v_mul_f32 v45, v45, v37
cv v71,v44,v45
mm a[120:123],a[184:187],a[156:159],a[120:123]
buffer_store_dword v58, v57, s[28:31], s54 offen sc1
buffer_store_dwordx4 v[68:71], v96, s[20:23], 0 offen offset:2048 sc1
mm a[124:127],a[188:191],a[156:159],a[124:127]
s_waitcnt lgkmcnt(0)
mm v[128:131],a[224:227],a[192:195],v[128:131]
v_lshlrev_b32 v38, 16, v88
mm v[132:135],a[228:231],a[192:195],v[132:135]
s_waitcnt vmcnt(15)
s_barrier
mm v[136:139],a[232:235],a[192:195],v[136:139]
v_and_b32 v39, 0xffff0000, v88
s_add_u32 m0, s36, 32768
mm v[140:143],a[236:239],a[192:195],v[140:143]
ds_read_b128 a[128:131], v10 offset:0
v_add_f32 v38, v38, v36
mm v[144:147],a[240:243],a[192:195],v[144:147]
v_add_f32 v39, v39, v36
v_mul_f32 v38, v38, v37
mm v[148:151],a[244:247],a[192:195],v[148:151]
buffer_load_dwordx4 v2, s[8:11], s34 offen offset:0 lds
mm v[152:155],a[248:251],a[192:195],v[152:155]
rt a[160:161],v12,0
v_mul_f32 v39, v39, v37
mm v[156:159],a[252:255],a[192:195],v[156:159]
cv v72,v38,v39
mm v[160:163],a[224:227],a[196:199],v[160:163]
buffer_load_dwordx4 v3, s[8:11], s34 offen offset:1024 lds
mm v[164:167],a[228:231],a[196:199],v[164:167]
rt a[162:163],v12,1024
v_lshlrev_b32 v40, 16, v89
mm v[168:171],a[232:235],a[196:199],v[168:171]
v_and_b32 v41, 0xffff0000, v89
ds_read_b128 a[132:135], v10 offset:2048
mm v[172:175],a[236:239],a[196:199],v[172:175]
buffer_load_dwordx4 v4, s[8:11], s34 offen offset:2048 lds
mm v[176:179],a[240:243],a[196:199],v[176:179]
v_add_f32 v40, v40, v36
v_add_f32 v41, v41, v36
mm v[180:183],a[244:247],a[196:199],v[180:183]
rt a[164:165],v13,0
v_mul_f32 v40, v40, v37
mm v[184:187],a[248:251],a[196:199],v[184:187]
buffer_load_dwordx4 v5, s[8:11], s34 offen offset:3072 lds
mm v[188:191],a[252:255],a[196:199],v[188:191]
v_mul_f32 v41, v41, v37
mm v[192:195],a[224:227],a[200:203],v[192:195]
cv v73,v40,v41
rt a[166:167],v13,1024
mm v[196:199],a[228:231],a[200:203],v[196:199]
v_lshlrev_b32 v42, 16, v90
v_and_b32 v43, 0xffff0000, v90
mm v[200:203],a[232:235],a[200:203],v[200:203]
ds_read_b128 a[136:139], v10 offset:4096
v_add_f32 v42, v42, v36
mm v[204:207],a[236:239],a[200:203],v[204:207]
s_add_u32 s34, s34, 128
v_add_f32 v43, v43, v36
mm v[208:211],a[240:243],a[200:203],v[208:211]
rt a[168:169],v14,0
v_mul_f32 v42, v42, v37
mm v[212:215],a[244:247],a[200:203],v[212:215]
v_mul_f32 v43, v43, v37
mm v[216:219],a[248:251],a[200:203],v[216:219]
rt a[170:171],v14,1024
s_add_u32 m0, s36, 36864
mm v[220:223],a[252:255],a[200:203],v[220:223]
cv v74,v42,v43
v_lshlrev_b32 v44, 16, v91
mm v[224:227],a[224:227],a[204:207],v[224:227]
buffer_load_dwordx4 v2, s[8:11], s39 offen offset:0 lds
mm v[228:231],a[228:231],a[204:207],v[228:231]
ds_read_b128 a[140:143], v10 offset:6144
v_and_b32 v45, 0xffff0000, v91
mm v[232:235],a[232:235],a[204:207],v[232:235]
v_add_f32 v44, v44, v36
v_add_f32 v45, v45, v36
mm v[236:239],a[236:239],a[204:207],v[236:239]
buffer_load_dwordx4 v3, s[8:11], s39 offen offset:1024 lds
mm v[240:243],a[240:243],a[204:207],v[240:243]
rt a[172:173],v15,0
mm v[244:247],a[244:247],a[204:207],v[244:247]
v_mul_f32 v44, v44, v37
v_mul_f32 v45, v45, v37
mm v[248:251],a[248:251],a[204:207],v[248:251]
rt a[174:175],v15,1024
cv v75,v44,v45
mm v[252:255],a[252:255],a[204:207],v[252:255]
buffer_store_dwordx4 v[72:75], v56, s[20:23], 0 offen offset:0 sc1
mm a[0:3],a[224:227],a[208:211],a[0:3]
buffer_load_dwordx4 v4, s[8:11], s39 offen offset:2048 lds
mm a[4:7],a[228:231],a[208:211],a[4:7]
ds_read_b128 a[144:147], v10 offset:8192
v_lshlrev_b32 v38, 16, v92
mm a[8:11],a[232:235],a[208:211],a[8:11]
v_and_b32 v39, 0xffff0000, v92
rt a[176:177],v16,0
mm a[12:15],a[236:239],a[208:211],a[12:15]
buffer_load_dwordx4 v5, s[8:11], s39 offen offset:3072 lds
mm a[16:19],a[240:243],a[208:211],a[16:19]
v_add_f32 v38, v38, v36
mm a[20:23],a[244:247],a[208:211],a[20:23]
v_add_f32 v39, v39, v36
v_mul_f32 v38, v38, v37
mm a[24:27],a[248:251],a[208:211],a[24:27]
rt a[178:179],v16,1024
v_mul_f32 v39, v39, v37
mm a[28:31],a[252:255],a[208:211],a[28:31]
s_add_u32 s39, s39, 128
cv v76,v38,v39
mm a[32:35],a[224:227],a[212:215],a[32:35]
ds_read_b128 a[148:151], v10 offset:10240
v_lshlrev_b32 v40, 16, v93
mm a[36:39],a[228:231],a[212:215],a[36:39]
buffer_load_dwordx4 v[104:107], v101, s[60:63], s48 offen
mm a[40:43],a[232:235],a[212:215],a[40:43]
v_and_b32 v41, 0xffff0000, v93
mm a[44:47],a[236:239],a[212:215],a[44:47]
rt a[180:181],v17,0
v_add_f32 v40, v40, v36
mm a[48:51],a[240:243],a[212:215],a[48:51]
v_add_f32 v41, v41, v36
rt a[182:183],v17,1024
mm a[52:55],a[244:247],a[212:215],a[52:55]
v_mul_f32 v40, v40, v37
s_add_u32 s48, s48, s50
mm a[56:59],a[248:251],a[212:215],a[56:59]
v_mul_f32 v41, v41, v37
cv v77,v40,v41
mm a[60:63],a[252:255],a[212:215],a[60:63]
ds_read_b128 a[152:155], v10 offset:12288
v_lshlrev_b32 v42, 16, v94
mm a[64:67],a[224:227],a[216:219],a[64:67]
s_add_u32 m0, s37, 49152
v_and_b32 v43, 0xffff0000, v94
mm a[68:71],a[228:231],a[216:219],a[68:71]
rt a[184:185],v18,0
mm a[72:75],a[232:235],a[216:219],a[72:75]
buffer_load_dwordx4 v6, s[12:15], s35 offen offset:0 lds
mm a[76:79],a[236:239],a[216:219],a[76:79]
v_add_f32 v42, v42, v36
v_add_f32 v43, v43, v36
mm a[80:83],a[240:243],a[216:219],a[80:83]
rt a[186:187],v18,1024
v_mul_f32 v42, v42, v37
mm a[84:87],a[244:247],a[216:219],a[84:87]
v_mul_f32 v43, v43, v37
ds_read_b128 a[156:159], v10 offset:14336
mm a[88:91],a[248:251],a[216:219],a[88:91]
buffer_load_dwordx4 v7, s[12:15], s35 offen offset:1024 lds
mm a[92:95],a[252:255],a[216:219],a[92:95]
cv v78,v42,v43
v_lshlrev_b32 v44, 16, v95
mm a[96:99],a[224:227],a[220:223],a[96:99]
rt a[188:189],v19,0
rt a[190:191],v19,1024
mm a[100:103],a[228:231],a[220:223],a[100:103]
buffer_load_dwordx4 v8, s[12:15], s35 offen offset:2048 lds
mm a[104:107],a[232:235],a[220:223],a[104:107]
buffer_load_dwordx4 v9, s[12:15], s35 offen offset:3072 lds
mm a[108:111],a[236:239],a[220:223],a[108:111]
v_and_b32 v45, 0xffff0000, v95
mm a[112:115],a[240:243],a[220:223],a[112:115]
v_add_f32 v44, v44, v36
v_add_f32 v45, v45, v36
v_mul_f32 v44, v44, v37
v_mul_f32 v45, v45, v37
cv v79,v44,v45
buffer_store_dwordx4 v[76:79], v56, s[20:23], 0 offen offset:2048 sc1
mm a[116:119],a[244:247],a[220:223],a[116:119]
mm a[120:123],a[248:251],a[220:223],a[120:123]
s_add_u32 s35, s35, s40
mm a[124:127],a[252:255],a[220:223],a[124:127]
s_waitcnt lgkmcnt(0)
.p2align 6
L_p1_kloop:
mm v[128:131],a[160:163],a[128:131],v[128:131]
s_waitcnt vmcnt(19)
s_barrier
mm v[132:135],a[164:167],a[128:131],v[132:135]
ds_read_b128 a[192:195], v11 offset:0
mm v[136:139],a[168:171],a[128:131],v[136:139]
rt a[224:225],v12,16384
mm v[140:143],a[172:175],a[128:131],v[140:143]
mm v[144:147],a[176:179],a[128:131],v[144:147]
buffer_load_dwordx4 v[104:107], v100, s[60:63], s48 offen
mm v[148:151],a[180:183],a[128:131],v[148:151]
mm v[152:155],a[184:187],a[128:131],v[152:155]
rt a[226:227],v12,17408
mm v[156:159],a[188:191],a[128:131],v[156:159]
mm v[160:163],a[160:163],a[132:135],v[160:163]
ds_read_b128 a[196:199], v11 offset:2048
mm v[164:167],a[164:167],a[132:135],v[164:167]
mm v[168:171],a[168:171],a[132:135],v[168:171]
buffer_load_dwordx4 v[104:107], v1, s[44:47], s49 offen
mm v[172:175],a[172:175],a[132:135],v[172:175]
mm v[176:179],a[176:179],a[132:135],v[176:179]
rt a[228:229],v13,16384
mm v[180:183],a[180:183],a[132:135],v[180:183]
rt a[230:231],v13,17408
mm v[184:187],a[184:187],a[132:135],v[184:187]
s_add_u32 s49, s49, 524288
mm v[188:191],a[188:191],a[132:135],v[188:191]
mm v[192:195],a[160:163],a[136:139],v[192:195]
ds_read_b128 a[200:203], v11 offset:4096
mm v[196:199],a[164:167],a[136:139],v[196:199]
rt a[232:233],v14,16384
mm v[200:203],a[168:171],a[136:139],v[200:203]
s_add_u32 m0, s37, 0
mm v[204:207],a[172:175],a[136:139],v[204:207]
mm v[208:211],a[176:179],a[136:139],v[208:211]
rt a[234:235],v14,17408
mm v[212:215],a[180:183],a[136:139],v[212:215]
ds_read_b128 a[204:207], v11 offset:6144
mm v[216:219],a[184:187],a[136:139],v[216:219]
mm v[220:223],a[188:191],a[136:139],v[220:223]
buffer_load_dwordx4 v6, s[12:15], s35 offen offset:0 lds
mm v[224:227],a[160:163],a[140:143],v[224:227]
mm v[228:231],a[164:167],a[140:143],v[228:231]
rt a[236:237],v15,16384
mm v[232:235],a[168:171],a[140:143],v[232:235]
rt a[238:239],v15,17408
mm v[236:239],a[172:175],a[140:143],v[236:239]
mm v[240:243],a[176:179],a[140:143],v[240:243]
buffer_load_dwordx4 v7, s[12:15], s35 offen offset:1024 lds
mm v[244:247],a[180:183],a[140:143],v[244:247]
mm v[248:251],a[184:187],a[140:143],v[248:251]
ds_read_b128 a[208:211], v11 offset:8192
mm v[252:255],a[188:191],a[140:143],v[252:255]
mm a[0:3],a[160:163],a[144:147],a[0:3]
rt a[240:241],v16,16384
mm a[4:7],a[164:167],a[144:147],a[4:7]
mm a[8:11],a[168:171],a[144:147],a[8:11]
buffer_load_dwordx4 v8, s[12:15], s35 offen offset:2048 lds
mm a[12:15],a[172:175],a[144:147],a[12:15]
mm a[16:19],a[176:179],a[144:147],a[16:19]
rt a[242:243],v16,17408
mm a[20:23],a[180:183],a[144:147],a[20:23]
ds_read_b128 a[212:215], v11 offset:10240
mm a[24:27],a[184:187],a[144:147],a[24:27]
mm a[28:31],a[188:191],a[144:147],a[28:31]
buffer_load_dwordx4 v9, s[12:15], s35 offen offset:3072 lds
mm a[32:35],a[160:163],a[148:151],a[32:35]
mm a[36:39],a[164:167],a[148:151],a[36:39]
rt a[244:245],v17,16384
mm a[40:43],a[168:171],a[148:151],a[40:43]
rt a[246:247],v17,17408
mm a[44:47],a[172:175],a[148:151],a[44:47]
mm a[48:51],a[176:179],a[148:151],a[48:51]
s_add_u32 s35, s35, s40
mm a[52:55],a[180:183],a[148:151],a[52:55]
ds_read_b128 a[216:219], v11 offset:12288
mm a[56:59],a[184:187],a[148:151],a[56:59]
rt a[248:249],v18,16384
mm a[60:63],a[188:191],a[148:151],a[60:63]
mm a[64:67],a[160:163],a[152:155],a[64:67]
rt a[250:251],v18,17408
mm a[68:71],a[164:167],a[152:155],a[68:71]
ds_read_b128 a[220:223], v11 offset:14336
mm a[72:75],a[168:171],a[152:155],a[72:75]
rt a[252:253],v19,16384
mm a[76:79],a[172:175],a[152:155],a[76:79]
mm a[80:83],a[176:179],a[152:155],a[80:83]
rt a[254:255],v19,17408
mm a[84:87],a[180:183],a[152:155],a[84:87]
mm a[88:91],a[184:187],a[152:155],a[88:91]
mm a[92:95],a[188:191],a[152:155],a[92:95]
mm a[96:99],a[160:163],a[156:159],a[96:99]
mm a[100:103],a[164:167],a[156:159],a[100:103]
mm a[104:107],a[168:171],a[156:159],a[104:107]
mm a[108:111],a[172:175],a[156:159],a[108:111]
mm a[112:115],a[176:179],a[156:159],a[112:115]
mm a[116:119],a[180:183],a[156:159],a[116:119]
mm a[120:123],a[184:187],a[156:159],a[120:123]
mm a[124:127],a[188:191],a[156:159],a[124:127]
s_waitcnt lgkmcnt(0)
mm v[128:131],a[224:227],a[192:195],v[128:131]
s_waitcnt vmcnt(11)
s_barrier
mm v[132:135],a[228:231],a[192:195],v[132:135]
ds_read_b128 a[128:131], v10 offset:32768
mm v[136:139],a[232:235],a[192:195],v[136:139]
rt a[160:161],v12,32768
mm v[140:143],a[236:239],a[192:195],v[140:143]
s_add_u32 m0, s36, 0
mm v[144:147],a[240:243],a[192:195],v[144:147]
rt a[162:163],v12,33792
mm v[148:151],a[244:247],a[192:195],v[148:151]
ds_read_b128 a[132:135], v10 offset:34816
mm v[152:155],a[248:251],a[192:195],v[152:155]
buffer_load_dwordx4 v2, s[8:11], s34 offen offset:0 lds
mm v[156:159],a[252:255],a[192:195],v[156:159]
rt a[164:165],v13,32768
mm v[160:163],a[224:227],a[196:199],v[160:163]
rt a[166:167],v13,33792
mm v[164:167],a[228:231],a[196:199],v[164:167]
mm v[168:171],a[232:235],a[196:199],v[168:171]
buffer_load_dwordx4 v3, s[8:11], s34 offen offset:1024 lds
mm v[172:175],a[236:239],a[196:199],v[172:175]
ds_read_b128 a[136:139], v10 offset:36864
mm v[176:179],a[240:243],a[196:199],v[176:179]
rt a[168:169],v14,32768
mm v[180:183],a[244:247],a[196:199],v[180:183]
buffer_load_dwordx4 v4, s[8:11], s34 offen offset:2048 lds
mm v[184:187],a[248:251],a[196:199],v[184:187]
mm v[188:191],a[252:255],a[196:199],v[188:191]
rt a[170:171],v14,33792
mm v[192:195],a[224:227],a[200:203],v[192:195]
ds_read_b128 a[140:143], v10 offset:38912
mm v[196:199],a[228:231],a[200:203],v[196:199]
buffer_load_dwordx4 v5, s[8:11], s34 offen offset:3072 lds
mm v[200:203],a[232:235],a[200:203],v[200:203]
rt a[172:173],v15,32768
mm v[204:207],a[236:239],a[200:203],v[204:207]
rt a[174:175],v15,33792
mm v[208:211],a[240:243],a[200:203],v[208:211]
s_add_u32 s34, s34, 128
mm v[212:215],a[244:247],a[200:203],v[212:215]
ds_read_b128 a[144:147], v10 offset:40960
mm v[216:219],a[248:251],a[200:203],v[216:219]
rt a[176:177],v16,32768
mm v[220:223],a[252:255],a[200:203],v[220:223]
s_add_u32 m0, s36, 4096
mm v[224:227],a[224:227],a[204:207],v[224:227]
rt a[178:179],v16,33792
mm v[228:231],a[228:231],a[204:207],v[228:231]
ds_read_b128 a[148:151], v10 offset:43008
mm v[232:235],a[232:235],a[204:207],v[232:235]
buffer_load_dwordx4 v2, s[8:11], s39 offen offset:0 lds
mm v[236:239],a[236:239],a[204:207],v[236:239]
rt a[180:181],v17,32768
mm v[240:243],a[240:243],a[204:207],v[240:243]
rt a[182:183],v17,33792
mm v[244:247],a[244:247],a[204:207],v[244:247]
mm v[248:251],a[248:251],a[204:207],v[248:251]
buffer_load_dwordx4 v3, s[8:11], s39 offen offset:1024 lds
mm v[252:255],a[252:255],a[204:207],v[252:255]
ds_read_b128 a[152:155], v10 offset:45056
mm a[0:3],a[224:227],a[208:211],a[0:3]
rt a[184:185],v18,32768
mm a[4:7],a[228:231],a[208:211],a[4:7]
buffer_load_dwordx4 v4, s[8:11], s39 offen offset:2048 lds
mm a[8:11],a[232:235],a[208:211],a[8:11]
mm a[12:15],a[236:239],a[208:211],a[12:15]
rt a[186:187],v18,33792
mm a[16:19],a[240:243],a[208:211],a[16:19]
ds_read_b128 a[156:159], v10 offset:47104
mm a[20:23],a[244:247],a[208:211],a[20:23]
buffer_load_dwordx4 v5, s[8:11], s39 offen offset:3072 lds
mm a[24:27],a[248:251],a[208:211],a[24:27]
rt a[188:189],v19,32768
mm a[28:31],a[252:255],a[208:211],a[28:31]
rt a[190:191],v19,33792
mm a[32:35],a[224:227],a[212:215],a[32:35]
s_add_u32 s39, s39, 128
mm a[36:39],a[228:231],a[212:215],a[36:39]
mm a[40:43],a[232:235],a[212:215],a[40:43]
buffer_load_dwordx4 v[104:107], v101, s[60:63], s48 offen
mm a[44:47],a[236:239],a[212:215],a[44:47]
s_add_u32 s48, s48, s50
mm a[48:51],a[240:243],a[212:215],a[48:51]
s_add_u32 m0, s37, 16384
mm a[52:55],a[244:247],a[212:215],a[52:55]
buffer_load_dwordx4 v6, s[12:15], s35 offen offset:0 lds
mm a[56:59],a[248:251],a[212:215],a[56:59]
mm a[60:63],a[252:255],a[212:215],a[60:63]
buffer_load_dwordx4 v7, s[12:15], s35 offen offset:1024 lds
mm a[64:67],a[224:227],a[216:219],a[64:67]
mm a[68:71],a[228:231],a[216:219],a[68:71]
buffer_load_dwordx4 v8, s[12:15], s35 offen offset:2048 lds
mm a[72:75],a[232:235],a[216:219],a[72:75]
mm a[76:79],a[236:239],a[216:219],a[76:79]
buffer_load_dwordx4 v9, s[12:15], s35 offen offset:3072 lds
mm a[80:83],a[240:243],a[216:219],a[80:83]
s_add_u32 s35, s35, s40
mm a[84:87],a[244:247],a[216:219],a[84:87]
mm a[88:91],a[248:251],a[216:219],a[88:91]
mm a[92:95],a[252:255],a[216:219],a[92:95]
mm a[96:99],a[224:227],a[220:223],a[96:99]
mm a[100:103],a[228:231],a[220:223],a[100:103]
mm a[104:107],a[232:235],a[220:223],a[104:107]
mm a[108:111],a[236:239],a[220:223],a[108:111]
mm a[112:115],a[240:243],a[220:223],a[112:115]
mm a[116:119],a[244:247],a[220:223],a[116:119]
mm a[120:123],a[248:251],a[220:223],a[120:123]
mm a[124:127],a[252:255],a[220:223],a[124:127]
s_waitcnt lgkmcnt(0)
mm v[128:131],a[160:163],a[128:131],v[128:131]
s_waitcnt vmcnt(19)
s_barrier
mm v[132:135],a[164:167],a[128:131],v[132:135]
ds_read_b128 a[192:195], v11 offset:32768
mm v[136:139],a[168:171],a[128:131],v[136:139]
rt a[224:225],v12,49152
mm v[140:143],a[172:175],a[128:131],v[140:143]
mm v[144:147],a[176:179],a[128:131],v[144:147]
buffer_load_dwordx4 v[104:107], v100, s[60:63], s48 offen
mm v[148:151],a[180:183],a[128:131],v[148:151]
mm v[152:155],a[184:187],a[128:131],v[152:155]
rt a[226:227],v12,50176
mm v[156:159],a[188:191],a[128:131],v[156:159]
mm v[160:163],a[160:163],a[132:135],v[160:163]
ds_read_b128 a[196:199], v11 offset:34816
mm v[164:167],a[164:167],a[132:135],v[164:167]
mm v[168:171],a[168:171],a[132:135],v[168:171]
buffer_load_dwordx4 v[104:107], v1, s[44:47], s49 offen
mm v[172:175],a[172:175],a[132:135],v[172:175]
mm v[176:179],a[176:179],a[132:135],v[176:179]
rt a[228:229],v13,49152
mm v[180:183],a[180:183],a[132:135],v[180:183]
rt a[230:231],v13,50176
mm v[184:187],a[184:187],a[132:135],v[184:187]
s_add_u32 s49, s49, 524288
mm v[188:191],a[188:191],a[132:135],v[188:191]
mm v[192:195],a[160:163],a[136:139],v[192:195]
ds_read_b128 a[200:203], v11 offset:36864
mm v[196:199],a[164:167],a[136:139],v[196:199]
rt a[232:233],v14,49152
mm v[200:203],a[168:171],a[136:139],v[200:203]
s_add_u32 m0, s37, 32768
mm v[204:207],a[172:175],a[136:139],v[204:207]
mm v[208:211],a[176:179],a[136:139],v[208:211]
rt a[234:235],v14,50176
mm v[212:215],a[180:183],a[136:139],v[212:215]
ds_read_b128 a[204:207], v11 offset:38912
mm v[216:219],a[184:187],a[136:139],v[216:219]
mm v[220:223],a[188:191],a[136:139],v[220:223]
buffer_load_dwordx4 v6, s[12:15], s35 offen offset:0 lds
mm v[224:227],a[160:163],a[140:143],v[224:227]
mm v[228:231],a[164:167],a[140:143],v[228:231]
rt a[236:237],v15,49152
mm v[232:235],a[168:171],a[140:143],v[232:235]
rt a[238:239],v15,50176
mm v[236:239],a[172:175],a[140:143],v[236:239]
mm v[240:243],a[176:179],a[140:143],v[240:243]
buffer_load_dwordx4 v7, s[12:15], s35 offen offset:1024 lds
mm v[244:247],a[180:183],a[140:143],v[244:247]
mm v[248:251],a[184:187],a[140:143],v[248:251]
ds_read_b128 a[208:211], v11 offset:40960
mm v[252:255],a[188:191],a[140:143],v[252:255]
mm a[0:3],a[160:163],a[144:147],a[0:3]
rt a[240:241],v16,49152
mm a[4:7],a[164:167],a[144:147],a[4:7]
mm a[8:11],a[168:171],a[144:147],a[8:11]
buffer_load_dwordx4 v8, s[12:15], s35 offen offset:2048 lds
mm a[12:15],a[172:175],a[144:147],a[12:15]
mm a[16:19],a[176:179],a[144:147],a[16:19]
rt a[242:243],v16,50176
mm a[20:23],a[180:183],a[144:147],a[20:23]
ds_read_b128 a[212:215], v11 offset:43008
mm a[24:27],a[184:187],a[144:147],a[24:27]
mm a[28:31],a[188:191],a[144:147],a[28:31]
buffer_load_dwordx4 v9, s[12:15], s35 offen offset:3072 lds
mm a[32:35],a[160:163],a[148:151],a[32:35]
mm a[36:39],a[164:167],a[148:151],a[36:39]
rt a[244:245],v17,49152
mm a[40:43],a[168:171],a[148:151],a[40:43]
rt a[246:247],v17,50176
mm a[44:47],a[172:175],a[148:151],a[44:47]
mm a[48:51],a[176:179],a[148:151],a[48:51]
s_add_u32 s35, s35, s40
mm a[52:55],a[180:183],a[148:151],a[52:55]
ds_read_b128 a[216:219], v11 offset:45056
mm a[56:59],a[184:187],a[148:151],a[56:59]
rt a[248:249],v18,49152
mm a[60:63],a[188:191],a[148:151],a[60:63]
mm a[64:67],a[160:163],a[152:155],a[64:67]
rt a[250:251],v18,50176
mm a[68:71],a[164:167],a[152:155],a[68:71]
ds_read_b128 a[220:223], v11 offset:47104
mm a[72:75],a[168:171],a[152:155],a[72:75]
rt a[252:253],v19,49152
mm a[76:79],a[172:175],a[152:155],a[76:79]
mm a[80:83],a[176:179],a[152:155],a[80:83]
rt a[254:255],v19,50176
mm a[84:87],a[180:183],a[152:155],a[84:87]
mm a[88:91],a[184:187],a[152:155],a[88:91]
mm a[92:95],a[188:191],a[152:155],a[92:95]
mm a[96:99],a[160:163],a[156:159],a[96:99]
mm a[100:103],a[164:167],a[156:159],a[100:103]
mm a[104:107],a[168:171],a[156:159],a[104:107]
mm a[108:111],a[172:175],a[156:159],a[108:111]
mm a[112:115],a[176:179],a[156:159],a[112:115]
mm a[116:119],a[180:183],a[156:159],a[116:119]
mm a[120:123],a[184:187],a[156:159],a[120:123]
mm a[124:127],a[188:191],a[156:159],a[124:127]
s_waitcnt lgkmcnt(0)
mm v[128:131],a[224:227],a[192:195],v[128:131]
s_waitcnt vmcnt(11)
s_barrier
mm v[132:135],a[228:231],a[192:195],v[132:135]
ds_read_b128 a[128:131], v10 offset:0
mm v[136:139],a[232:235],a[192:195],v[136:139]
rt a[160:161],v12,0
mm v[140:143],a[236:239],a[192:195],v[140:143]
s_add_u32 m0, s36, 32768
mm v[144:147],a[240:243],a[192:195],v[144:147]
rt a[162:163],v12,1024
mm v[148:151],a[244:247],a[192:195],v[148:151]
ds_read_b128 a[132:135], v10 offset:2048
mm v[152:155],a[248:251],a[192:195],v[152:155]
buffer_load_dwordx4 v2, s[8:11], s34 offen offset:0 lds
mm v[156:159],a[252:255],a[192:195],v[156:159]
rt a[164:165],v13,0
mm v[160:163],a[224:227],a[196:199],v[160:163]
rt a[166:167],v13,1024
mm v[164:167],a[228:231],a[196:199],v[164:167]
mm v[168:171],a[232:235],a[196:199],v[168:171]
buffer_load_dwordx4 v3, s[8:11], s34 offen offset:1024 lds
mm v[172:175],a[236:239],a[196:199],v[172:175]
ds_read_b128 a[136:139], v10 offset:4096
mm v[176:179],a[240:243],a[196:199],v[176:179]
rt a[168:169],v14,0
mm v[180:183],a[244:247],a[196:199],v[180:183]
buffer_load_dwordx4 v4, s[8:11], s34 offen offset:2048 lds
mm v[184:187],a[248:251],a[196:199],v[184:187]
mm v[188:191],a[252:255],a[196:199],v[188:191]
rt a[170:171],v14,1024
mm v[192:195],a[224:227],a[200:203],v[192:195]
ds_read_b128 a[140:143], v10 offset:6144
mm v[196:199],a[228:231],a[200:203],v[196:199]
buffer_load_dwordx4 v5, s[8:11], s34 offen offset:3072 lds
mm v[200:203],a[232:235],a[200:203],v[200:203]
rt a[172:173],v15,0
mm v[204:207],a[236:239],a[200:203],v[204:207]
rt a[174:175],v15,1024
mm v[208:211],a[240:243],a[200:203],v[208:211]
s_add_u32 s34, s34, 128
mm v[212:215],a[244:247],a[200:203],v[212:215]
ds_read_b128 a[144:147], v10 offset:8192
mm v[216:219],a[248:251],a[200:203],v[216:219]
rt a[176:177],v16,0
mm v[220:223],a[252:255],a[200:203],v[220:223]
s_add_u32 m0, s36, 36864
mm v[224:227],a[224:227],a[204:207],v[224:227]
rt a[178:179],v16,1024
mm v[228:231],a[228:231],a[204:207],v[228:231]
ds_read_b128 a[148:151], v10 offset:10240
mm v[232:235],a[232:235],a[204:207],v[232:235]
buffer_load_dwordx4 v2, s[8:11], s39 offen offset:0 lds
mm v[236:239],a[236:239],a[204:207],v[236:239]
rt a[180:181],v17,0
mm v[240:243],a[240:243],a[204:207],v[240:243]
rt a[182:183],v17,1024
mm v[244:247],a[244:247],a[204:207],v[244:247]
mm v[248:251],a[248:251],a[204:207],v[248:251]
buffer_load_dwordx4 v3, s[8:11], s39 offen offset:1024 lds
mm v[252:255],a[252:255],a[204:207],v[252:255]
ds_read_b128 a[152:155], v10 offset:12288
mm a[0:3],a[224:227],a[208:211],a[0:3]
rt a[184:185],v18,0
mm a[4:7],a[228:231],a[208:211],a[4:7]
buffer_load_dwordx4 v4, s[8:11], s39 offen offset:2048 lds
mm a[8:11],a[232:235],a[208:211],a[8:11]
mm a[12:15],a[236:239],a[208:211],a[12:15]
rt a[186:187],v18,1024
mm a[16:19],a[240:243],a[208:211],a[16:19]
ds_read_b128 a[156:159], v10 offset:14336
mm a[20:23],a[244:247],a[208:211],a[20:23]
buffer_load_dwordx4 v5, s[8:11], s39 offen offset:3072 lds
mm a[24:27],a[248:251],a[208:211],a[24:27]
rt a[188:189],v19,0
mm a[28:31],a[252:255],a[208:211],a[28:31]
rt a[190:191],v19,1024
mm a[32:35],a[224:227],a[212:215],a[32:35]
s_add_u32 s39, s39, 128
mm a[36:39],a[228:231],a[212:215],a[36:39]
mm a[40:43],a[232:235],a[212:215],a[40:43]
buffer_load_dwordx4 v[104:107], v101, s[60:63], s48 offen
mm a[44:47],a[236:239],a[212:215],a[44:47]
s_add_u32 s48, s48, s50
mm a[48:51],a[240:243],a[212:215],a[48:51]
s_add_u32 m0, s37, 49152
mm a[52:55],a[244:247],a[212:215],a[52:55]
buffer_load_dwordx4 v6, s[12:15], s35 offen offset:0 lds
mm a[56:59],a[248:251],a[212:215],a[56:59]
mm a[60:63],a[252:255],a[212:215],a[60:63]
buffer_load_dwordx4 v7, s[12:15], s35 offen offset:1024 lds
mm a[64:67],a[224:227],a[216:219],a[64:67]
mm a[68:71],a[228:231],a[216:219],a[68:71]
buffer_load_dwordx4 v8, s[12:15], s35 offen offset:2048 lds
mm a[72:75],a[232:235],a[216:219],a[72:75]
mm a[76:79],a[236:239],a[216:219],a[76:79]
buffer_load_dwordx4 v9, s[12:15], s35 offen offset:3072 lds
mm a[80:83],a[240:243],a[216:219],a[80:83]
s_add_u32 s35, s35, s40
mm a[84:87],a[244:247],a[216:219],a[84:87]
mm a[88:91],a[248:251],a[216:219],a[88:91]
mm a[92:95],a[252:255],a[216:219],a[92:95]
mm a[96:99],a[224:227],a[220:223],a[96:99]
mm a[100:103],a[228:231],a[220:223],a[100:103]
mm a[104:107],a[232:235],a[220:223],a[104:107]
mm a[108:111],a[236:239],a[220:223],a[108:111]
mm a[112:115],a[240:243],a[220:223],a[112:115]
mm a[116:119],a[244:247],a[220:223],a[116:119]
mm a[120:123],a[248:251],a[220:223],a[120:123]
mm a[124:127],a[252:255],a[220:223],a[124:127]
s_waitcnt lgkmcnt(0)
s_add_u32 s38, s38, 1
s_cmp_eq_u32 s38, 4
s_cbranch_scc1 L_p1_done
s_call_b64 s[42:43], L_p1_trip
s_branch L_p1_kloop
L_p1_v:
mm v[128:131],a[128:131],a[160:163],0
s_add_u32 m0, s36, 32768
mm v[132:135],a[132:135],a[160:163],0
buffer_load_dwordx4 v2, s[8:11], s34 offen offset:0 lds
mm v[192:195],a[136:139],a[160:163],0
mm v[196:199],a[140:143],a[160:163],0
buffer_load_dwordx4 v3, s[8:11], s34 offen offset:1024 lds
mm a[0:3],a[144:147],a[160:163],0
mm a[4:7],a[148:151],a[160:163],0
buffer_load_dwordx4 v4, s[8:11], s34 offen offset:2048 lds
mm a[64:67],a[152:155],a[160:163],0
buffer_load_dwordx4 v5, s[8:11], s34 offen offset:3072 lds
mm a[68:71],a[156:159],a[160:163],0
mm v[136:139],a[128:131],a[164:167],0
s_add_u32 s34, s34, 128
mm v[140:143],a[132:135],a[164:167],0
s_add_u32 m0, s36, 36864
mm v[200:203],a[136:139],a[164:167],0
buffer_load_dwordx4 v2, s[8:11], s39 offen offset:0 lds
mm v[204:207],a[140:143],a[164:167],0
buffer_load_dwordx4 v3, s[8:11], s39 offen offset:1024 lds
mm a[8:11],a[144:147],a[164:167],0
mm a[12:15],a[148:151],a[164:167],0
buffer_load_dwordx4 v4, s[8:11], s39 offen offset:2048 lds
mm a[72:75],a[152:155],a[164:167],0
mm a[76:79],a[156:159],a[164:167],0
buffer_load_dwordx4 v5, s[8:11], s39 offen offset:3072 lds
mm v[144:147],a[128:131],a[168:171],0
mm v[148:151],a[132:135],a[168:171],0
s_add_u32 s39, s39, 128
s_add_u32 m0, s37, 49152
mm v[208:211],a[136:139],a[168:171],0
buffer_load_dwordx4 v6, s[12:15], s35 offen offset:0 lds
buffer_load_dwordx4 v7, s[12:15], s35 offen offset:1024 lds
buffer_load_dwordx4 v8, s[12:15], s35 offen offset:2048 lds
buffer_load_dwordx4 v9, s[12:15], s35 offen offset:3072 lds
s_add_u32 s35, s35, s40
mm v[212:215],a[140:143],a[168:171],0
s_waitcnt vmcnt(16)
s_barrier
mm a[16:19],a[144:147],a[168:171],0
mm a[20:23],a[148:151],a[168:171],0
mm a[80:83],a[152:155],a[168:171],0
mm a[84:87],a[156:159],a[168:171],0
mm v[152:155],a[128:131],a[172:175],0
mm v[156:159],a[132:135],a[172:175],0
mm v[216:219],a[136:139],a[172:175],0
mm v[220:223],a[140:143],a[172:175],0
mm a[24:27],a[144:147],a[172:175],0
buffer_load_dwordx4 v[104:107], v100, s[60:63], s48 offen
mm a[28:31],a[148:151],a[172:175],0
buffer_load_dwordx4 v[104:107], v1, s[44:47], s49 offen
mm a[88:91],a[152:155],a[172:175],0
mm a[92:95],a[156:159],a[172:175],0
ds_read_b128 a[192:195], v11 offset:0
mm v[160:163],a[128:131],a[176:179],0
rt a[224:225],v12,16384
mm v[164:167],a[132:135],a[176:179],0
rt a[226:227],v12,17408
mm v[224:227],a[136:139],a[176:179],0
ds_read_b128 a[196:199], v11 offset:2048
rt a[228:229],v13,16384
mm v[228:231],a[140:143],a[176:179],0
rt a[230:231],v13,17408
mm a[32:35],a[144:147],a[176:179],0
ds_read_b128 a[200:203], v11 offset:4096
mm a[36:39],a[148:151],a[176:179],0
rt a[232:233],v14,16384
mm a[96:99],a[152:155],a[176:179],0
s_add_u32 s49, s49, 524288
mm a[100:103],a[156:159],a[176:179],0
rt a[234:235],v14,17408
mm v[168:171],a[128:131],a[180:183],0
ds_read_b128 a[204:207], v11 offset:6144
rt a[236:237],v15,16384
mm v[172:175],a[132:135],a[180:183],0
rt a[238:239],v15,17408
mm v[232:235],a[136:139],a[180:183],0
s_add_u32 m0, s37, 0
mm v[236:239],a[140:143],a[180:183],0
buffer_load_dwordx4 v6, s[12:15], s35 offen offset:0 lds
mm a[40:43],a[144:147],a[180:183],0
mm a[44:47],a[148:151],a[180:183],0
ds_read_b128 a[208:211], v11 offset:8192
mm a[104:107],a[152:155],a[180:183],0
buffer_load_dwordx4 v7, s[12:15], s35 offen offset:1024 lds
mm a[108:111],a[156:159],a[180:183],0
rt a[240:241],v16,16384
mm v[176:179],a[128:131],a[184:187],0
rt a[242:243],v16,17408
mm v[180:183],a[132:135],a[184:187],0
ds_read_b128 a[212:215], v11 offset:10240
mm v[240:243],a[136:139],a[184:187],0
rt a[244:245],v17,16384
mm v[244:247],a[140:143],a[184:187],0
buffer_load_dwordx4 v8, s[12:15], s35 offen offset:2048 lds
mm a[48:51],a[144:147],a[184:187],0
rt a[246:247],v17,17408
mm a[52:55],a[148:151],a[184:187],0
ds_read_b128 a[216:219], v11 offset:12288
mm a[112:115],a[152:155],a[184:187],0
rt a[248:249],v18,16384
mm a[116:119],a[156:159],a[184:187],0
rt a[250:251],v18,17408
mm v[184:187],a[128:131],a[188:191],0
ds_read_b128 a[220:223], v11 offset:14336
rt a[252:253],v19,16384
rt a[254:255],v19,17408
ds_read_b128 v[36:39], v52 offset:0
ds_read_b128 v[40:43], v52 offset:512
ds_read_b128 v[44:47], v52 offset:1024
ds_read_b128 v[48:51], v52 offset:1536
mm v[188:191],a[132:135],a[188:191],0
mm v[248:251],a[136:139],a[188:191],0
mm v[252:255],a[140:143],a[188:191],0
mm a[56:59],a[144:147],a[188:191],0
mm a[60:63],a[148:151],a[188:191],0
mm a[120:123],a[152:155],a[188:191],0
buffer_load_dwordx4 v9, s[12:15], s35 offen offset:3072 lds
s_add_u32 s35, s35, s40
mm a[124:127],a[156:159],a[188:191],0
s_waitcnt lgkmcnt(0)
mm v[128:131],a[192:195],a[224:227],v[128:131]
v_lshlrev_b32 v64, 16, v36
v_and_b32 v65, 0xffff0000, v36
v_lshlrev_b32 v66, 16, v37
mm v[132:135],a[196:199],a[224:227],v[132:135]
v_and_b32 v67, 0xffff0000, v37
v_lshlrev_b32 v68, 16, v38
mm v[192:195],a[200:203],a[224:227],v[192:195]
v_and_b32 v69, 0xffff0000, v38
v_lshlrev_b32 v70, 16, v39
v_and_b32 v71, 0xffff0000, v39
mm v[196:199],a[204:207],a[224:227],v[196:199]
v_lshlrev_b32 v72, 16, v40
v_and_b32 v73, 0xffff0000, v40
mm a[0:3],a[208:211],a[224:227],a[0:3]
v_lshlrev_b32 v74, 16, v41
v_and_b32 v75, 0xffff0000, v41
v_lshlrev_b32 v76, 16, v42
mm a[4:7],a[212:215],a[224:227],a[4:7]
v_and_b32 v77, 0xffff0000, v42
v_lshlrev_b32 v78, 16, v43
mm a[64:67],a[216:219],a[224:227],a[64:67]
v_and_b32 v79, 0xffff0000, v43
v_lshlrev_b32 v80, 16, v44
v_and_b32 v81, 0xffff0000, v44
mm a[68:71],a[220:223],a[224:227],a[68:71]
v_lshlrev_b32 v82, 16, v45
v_and_b32 v83, 0xffff0000, v45
mm v[136:139],a[192:195],a[228:231],v[136:139]
v_lshlrev_b32 v84, 16, v46
v_and_b32 v85, 0xffff0000, v46
v_lshlrev_b32 v86, 16, v47
mm v[140:143],a[196:199],a[228:231],v[140:143]
v_and_b32 v87, 0xffff0000, v47
v_lshlrev_b32 v88, 16, v48
s_waitcnt vmcnt(10)
s_barrier
mm v[200:203],a[200:203],a[228:231],v[200:203]
s_add_u32 m0, s36, 0
ds_read_b128 a[128:131], v10 offset:32768
v_and_b32 v89, 0xffff0000, v48
v_lshlrev_b32 v90, 16, v49
mm v[204:207],a[204:207],a[228:231],v[204:207]
v_and_b32 v91, 0xffff0000, v49
v_lshlrev_b32 v92, 16, v50
v_and_b32 v93, 0xffff0000, v50
mm a[8:11],a[208:211],a[228:231],a[8:11]
buffer_load_dwordx4 v2, s[8:11], s34 offen offset:0 lds
rt a[160:161],v12,32768
v_lshlrev_b32 v94, 16, v51
v_and_b32 v95, 0xffff0000, v51
mm a[12:15],a[212:215],a[228:231],a[12:15]
v_add_f32 v32, v64, v66
v_add_f32 v33, v65, v67
v_add_f32 v32, v32, v68
mm a[72:75],a[216:219],a[228:231],a[72:75]
rt a[162:163],v12,33792
v_add_f32 v33, v33, v69
v_add_f32 v32, v32, v70
mm a[76:79],a[220:223],a[228:231],a[76:79]
buffer_load_dwordx4 v3, s[8:11], s34 offen offset:1024 lds
v_add_f32 v33, v33, v71
v_add_f32 v32, v32, v72
v_add_f32 v33, v33, v73
mm v[144:147],a[192:195],a[232:235],v[144:147]
ds_read_b128 a[132:135], v10 offset:34816
v_add_f32 v32, v32, v74
v_add_f32 v33, v33, v75
mm v[148:151],a[196:199],a[232:235],v[148:151]
v_add_f32 v32, v32, v76
v_add_f32 v33, v33, v77
v_add_f32 v32, v32, v78
mm v[208:211],a[200:203],a[232:235],v[208:211]
buffer_load_dwordx4 v4, s[8:11], s34 offen offset:2048 lds
rt a[164:165],v13,32768
v_add_f32 v33, v33, v79
v_add_f32 v32, v32, v80
mm v[212:215],a[204:207],a[232:235],v[212:215]
v_add_f32 v33, v33, v81
v_add_f32 v32, v32, v82
mm a[16:19],a[208:211],a[232:235],a[16:19]
buffer_load_dwordx4 v5, s[8:11], s34 offen offset:3072 lds
rt a[166:167],v13,33792
v_add_f32 v33, v33, v83
v_add_f32 v32, v32, v84
v_add_f32 v33, v33, v85
mm a[20:23],a[212:215],a[232:235],a[20:23]
v_add_f32 v32, v32, v86
v_add_f32 v33, v33, v87
mm a[80:83],a[216:219],a[232:235],a[80:83]
ds_read_b128 a[136:139], v10 offset:36864
v_add_f32 v32, v32, v88
v_add_f32 v33, v33, v89
v_add_f32 v32, v32, v90
mm a[84:87],a[220:223],a[232:235],a[84:87]
v_add_f32 v33, v33, v91
v_add_f32 v32, v32, v92
s_add_u32 s34, s34, 128
mm v[152:155],a[192:195],a[236:239],v[152:155]
rt a[168:169],v14,32768
v_add_f32 v33, v33, v93
v_add_f32 v32, v32, v94
v_add_f32 v33, v33, v95
mm v[156:159],a[196:199],a[236:239],v[156:159]
v_add_f32 v36, v32, v33
s_nop 1
v_add_f32 v36, v36, v36 row_ror:8
mm v[216:219],a[200:203],a[236:239],v[216:219]
s_nop 1
v_add_f32 v36, v36, v36 row_ror:4
rt a[170:171],v14,33792
s_add_u32 m0, s36, 4096
s_nop 1
v_add_f32 v36, v36, v36 row_ror:2
s_nop 1
v_add_f32 v36, v36, v36 row_ror:1
mm v[220:223],a[204:207],a[236:239],v[220:223]
v_mov_b32 v34, v36
s_nop 1
v_permlane16_swap_b32 v36, v34
mm a[24:27],a[208:211],a[236:239],a[24:27]
ds_read_b128 a[140:143], v10 offset:38912
v_add_f32 v36, v36, v34
v_mul_f32 v36, 0xba800000, v36
mm a[28:31],a[212:215],a[236:239],a[28:31]
buffer_load_dwordx4 v2, s[8:11], s39 offen offset:0 lds
v_add_f32 v64, v64, v36
mm a[88:91],a[216:219],a[236:239],a[88:91]
v_add_f32 v65, v65, v36
v_add_f32 v66, v66, v36
rt a[172:173],v15,32768
v_add_f32 v67, v67, v36
mm a[92:95],a[220:223],a[236:239],a[92:95]
buffer_load_dwordx4 v3, s[8:11], s39 offen offset:1024 lds
v_add_f32 v68, v68, v36
mm v[160:163],a[192:195],a[240:243],v[160:163]
v_add_f32 v69, v69, v36
v_add_f32 v70, v70, v36
v_add_f32 v71, v71, v36
mm v[164:167],a[196:199],a[240:243],v[164:167]
rt a[174:175],v15,33792
v_add_f32 v72, v72, v36
v_add_f32 v73, v73, v36
v_add_f32 v74, v74, v36
mm v[224:227],a[200:203],a[240:243],v[224:227]
buffer_load_dwordx4 v4, s[8:11], s39 offen offset:2048 lds
v_add_f32 v75, v75, v36
mm v[228:231],a[204:207],a[240:243],v[228:231]
v_add_f32 v76, v76, v36
ds_read_b128 a[144:147], v10 offset:40960
v_add_f32 v77, v77, v36
v_add_f32 v78, v78, v36
mm a[32:35],a[208:211],a[240:243],a[32:35]
v_add_f32 v79, v79, v36
v_add_f32 v80, v80, v36
v_add_f32 v81, v81, v36
mm a[36:39],a[212:215],a[240:243],a[36:39]
rt a[176:177],v16,32768
v_add_f32 v82, v82, v36
v_add_f32 v83, v83, v36
v_add_f32 v84, v84, v36
mm a[96:99],a[216:219],a[240:243],a[96:99]
buffer_load_dwordx4 v5, s[8:11], s39 offen offset:3072 lds
v_add_f32 v85, v85, v36
mm a[100:103],a[220:223],a[240:243],a[100:103]
v_add_f32 v86, v86, v36
rt a[178:179],v16,33792
v_add_f32 v87, v87, v36
mm v[168:171],a[192:195],a[244:247],v[168:171]
v_add_f32 v88, v88, v36
v_add_f32 v89, v89, v36
v_add_f32 v90, v90, v36
ds_read_b128 a[148:151], v10 offset:43008
mm v[172:175],a[196:199],a[244:247],v[172:175]
v_add_f32 v91, v91, v36
s_add_u32 s39, s39, 128
v_add_f32 v92, v92, v36
mm v[232:235],a[200:203],a[244:247],v[232:235]
buffer_load_dwordx4 v[104:107], v101, s[60:63], s48 offen
v_add_f32 v93, v93, v36
v_add_f32 v94, v94, v36
mm v[236:239],a[204:207],a[244:247],v[236:239]
v_add_f32 v95, v95, v36
rt a[180:181],v17,32768
v_mul_f32 v32, v64, v64
mm a[40:43],a[208:211],a[244:247],a[40:43]
v_mul_f32 v33, v65, v65
v_fmac_f32 v32, v66, v66
v_fmac_f32 v33, v67, v67
mm a[44:47],a[212:215],a[244:247],a[44:47]
v_fmac_f32 v32, v68, v68
rt a[182:183],v17,33792
v_fmac_f32 v33, v69, v69
v_fmac_f32 v32, v70, v70
mm a[104:107],a[216:219],a[244:247],a[104:107]
v_fmac_f32 v33, v71, v71
v_fmac_f32 v32, v72, v72
s_add_u32 s48, s48, s50
mm a[108:111],a[220:223],a[244:247],a[108:111]
v_fmac_f32 v33, v73, v73
ds_read_b128 a[152:155], v10 offset:45056
v_fmac_f32 v32, v74, v74
v_fmac_f32 v33, v75, v75
mm v[176:179],a[192:195],a[248:251],v[176:179]
v_fmac_f32 v32, v76, v76
v_fmac_f32 v33, v77, v77
v_fmac_f32 v32, v78, v78
mm v[180:183],a[196:199],a[248:251],v[180:183]
rt a[184:185],v18,32768
v_fmac_f32 v33, v79, v79
s_add_u32 m0, s37, 16384
v_fmac_f32 v32, v80, v80
mm v[240:243],a[200:203],a[248:251],v[240:243]
v_fmac_f32 v33, v81, v81
v_fmac_f32 v32, v82, v82
v_fmac_f32 v33, v83, v83
mm v[244:247],a[204:207],a[248:251],v[244:247]
buffer_load_dwordx4 v6, s[12:15], s35 offen offset:0 lds
rt a[186:187],v18,33792
mm a[48:51],a[208:211],a[248:251],a[48:51]
v_fmac_f32 v32, v84, v84
v_fmac_f32 v33, v85, v85
v_fmac_f32 v32, v86, v86
v_fmac_f32 v33, v87, v87
mm a[52:55],a[212:215],a[248:251],a[52:55]
v_fmac_f32 v32, v88, v88
ds_read_b128 a[156:159], v10 offset:47104
v_fmac_f32 v33, v89, v89
mm a[112:115],a[216:219],a[248:251],a[112:115]
buffer_load_dwordx4 v7, s[12:15], s35 offen offset:1024 lds
v_fmac_f32 v32, v90, v90
v_fmac_f32 v33, v91, v91
mm a[116:119],a[220:223],a[248:251],a[116:119]
v_fmac_f32 v32, v92, v92
v_fmac_f32 v33, v93, v93
rt a[188:189],v19,32768
mm v[184:187],a[192:195],a[252:255],v[184:187]
rt a[190:191],v19,33792
v_fmac_f32 v32, v94, v94
v_fmac_f32 v33, v95, v95
v_add_f32 v28, v32, v33
mm v[188:191],a[196:199],a[252:255],v[188:191]
s_nop 1
v_add_f32 v28, v28, v28 row_ror:8
s_nop 1
v_add_f32 v28, v28, v28 row_ror:4
mm v[248:251],a[200:203],a[252:255],v[248:251]
s_nop 1
v_add_f32 v28, v28, v28 row_ror:2
mm v[252:255],a[204:207],a[252:255],v[252:255]
buffer_load_dwordx4 v8, s[12:15], s35 offen offset:2048 lds
s_nop 1
v_add_f32 v28, v28, v28 row_ror:1
mm a[56:59],a[208:211],a[252:255],a[56:59]
v_mov_b32 v34, v28
s_nop 1
v_permlane16_swap_b32 v28, v34
v_add_f32 v28, v28, v34
v_mov_b32 v34, 0x3727c5ac
v_fmac_f32 v34, 0x3a800000, v28
v_rsq_f32 v37, v34
s_nop 0
v_mul_f32 v37, 0x3e0293ee, v37
ds_write_b64 v53, v[36:37]
mm a[60:63],a[212:215],a[252:255],a[60:63]
mm a[120:123],a[216:219],a[252:255],a[120:123]
buffer_load_dwordx4 v9, s[12:15], s35 offen offset:3072 lds
s_add_u32 s35, s35, s40
mm a[124:127],a[220:223],a[252:255],a[124:127]
s_waitcnt lgkmcnt(0)
mm v[128:131],a[128:131],a[160:163],v[128:131]
mm v[132:135],a[132:135],a[160:163],v[132:135]
mm v[192:195],a[136:139],a[160:163],v[192:195]
mm v[196:199],a[140:143],a[160:163],v[196:199]
s_waitcnt vmcnt(19)
s_barrier
mm a[0:3],a[144:147],a[160:163],a[0:3]
ds_read_b64 v[36:37], v54
ds_read_b64 v[80:81], v55 offset:0
ds_read_b64 v[82:83], v55 offset:32
buffer_load_dwordx4 v[104:107], v100, s[60:63], s48 offen
mm a[4:7],a[148:151],a[160:163],a[4:7]
ds_read_b64 v[84:85], v55 offset:128
ds_read_b64 v[86:87], v55 offset:160
ds_read_b64 v[88:89], v55 offset:256
mm a[64:67],a[152:155],a[160:163],a[64:67]
ds_read_b64 v[90:91], v55 offset:288
ds_read_b64 v[92:93], v55 offset:384
mm a[68:71],a[156:159],a[160:163],a[68:71]
ds_read_b64 v[94:95], v55 offset:416
mm v[136:139],a[128:131],a[164:167],v[136:139]
mm v[140:143],a[132:135],a[164:167],v[140:143]
buffer_load_dwordx4 v[104:107], v1, s[44:47], s49 offen
mm v[200:203],a[136:139],a[164:167],v[200:203]
mm v[204:207],a[140:143],a[164:167],v[204:207]
mm a[8:11],a[144:147],a[164:167],a[8:11]
s_waitcnt lgkmcnt(0)
mm a[12:15],a[148:151],a[164:167],a[12:15]
ds_read_b128 a[192:195], v11 offset:32768
v_lshlrev_b32 v38, 16, v80
v_and_b32 v39, 0xffff0000, v80
mm a[72:75],a[152:155],a[164:167],a[72:75]
v_add_f32 v38, v38, v36
rt a[224:225],v12,49152
mm a[76:79],a[156:159],a[164:167],a[76:79]
v_add_f32 v39, v39, v36
s_add_u32 s49, s49, 524288
mm v[144:147],a[128:131],a[168:171],v[144:147]
v_mul_f32 v38, v38, v37
rt a[226:227],v12,50176
mm v[148:151],a[132:135],a[168:171],v[148:151]
v_mul_f32 v39, v39, v37
mm v[208:211],a[136:139],a[168:171],v[208:211]
cv v64,v38,v39
ds_read_b128 a[196:199], v11 offset:34816
mm v[212:215],a[140:143],a[168:171],v[212:215]
v_lshlrev_b32 v40, 16, v81
v_and_b32 v41, 0xffff0000, v81
mm a[16:19],a[144:147],a[168:171],a[16:19]
rt a[228:229],v13,49152
v_add_f32 v40, v40, v36
mm a[20:23],a[148:151],a[168:171],a[20:23]
s_add_u32 m0, s37, 32768
v_add_f32 v41, v41, v36
mm a[80:83],a[152:155],a[168:171],a[80:83]
rt a[230:231],v13,50176
v_mul_f32 v40, v40, v37
mm a[84:87],a[156:159],a[168:171],a[84:87]
v_mul_f32 v41, v41, v37
mm v[152:155],a[128:131],a[172:175],v[152:155]
cv v65,v40,v41
ds_read_b128 a[200:203], v11 offset:36864
mm v[156:159],a[132:135],a[172:175],v[156:159]
v_lshlrev_b32 v42, 16, v82
v_and_b32 v43, 0xffff0000, v82
mm v[216:219],a[136:139],a[172:175],v[216:219]
rt a[232:233],v14,49152
v_add_f32 v42, v42, v36
mm v[220:223],a[140:143],a[172:175],v[220:223]
buffer_load_dwordx4 v6, s[12:15], s35 offen offset:0 lds
v_add_f32 v43, v43, v36
rt a[234:235],v14,50176
mm a[24:27],a[144:147],a[172:175],a[24:27]
v_mul_f32 v42, v42, v37
mm a[28:31],a[148:151],a[172:175],a[28:31]
v_mul_f32 v43, v43, v37
ds_read_b128 a[204:207], v11 offset:38912
mm a[88:91],a[152:155],a[172:175],a[88:91]
cv v66,v42,v43
mm a[92:95],a[156:159],a[172:175],a[92:95]
v_lshlrev_b32 v44, 16, v83
rt a[236:237],v15,49152
v_and_b32 v45, 0xffff0000, v83
mm v[160:163],a[128:131],a[176:179],v[160:163]
v_add_f32 v44, v44, v36
mm v[164:167],a[132:135],a[176:179],v[164:167]
buffer_load_dwordx4 v7, s[12:15], s35 offen offset:1024 lds
rt a[238:239],v15,50176
v_add_f32 v45, v45, v36
mm v[224:227],a[136:139],a[176:179],v[224:227]
v_mul_f32 v44, v44, v37
mm v[228:231],a[140:143],a[176:179],v[228:231]
v_mul_f32 v45, v45, v37
ds_read_b128 a[208:211], v11 offset:40960
mm a[32:35],a[144:147],a[176:179],a[32:35]
cv v67,v44,v45
mm a[36:39],a[148:151],a[176:179],a[36:39]
buffer_store_dwordx4 v[64:67], v96, s[20:23], 0 offen offset:0 sc1
rt a[240:241],v16,49152
v_lshlrev_b32 v38, 16, v84
mm a[96:99],a[152:155],a[176:179],a[96:99]
buffer_load_dwordx4 v8, s[12:15], s35 offen offset:2048 lds
mm a[100:103],a[156:159],a[176:179],a[100:103]
v_and_b32 v39, 0xffff0000, v84
rt a[242:243],v16,50176
mm v[168:171],a[128:131],a[180:183],v[168:171]
v_add_f32 v38, v38, v36
v_add_f32 v39, v39, v36
mm v[172:175],a[132:135],a[180:183],v[172:175]
ds_read_b128 a[212:215], v11 offset:43008
mm v[232:235],a[136:139],a[180:183],v[232:235]
v_mul_f32 v38, v38, v37
v_mul_f32 v39, v39, v37
mm v[236:239],a[140:143],a[180:183],v[236:239]
rt a[244:245],v17,49152
cv v68,v38,v39
mm a[40:43],a[144:147],a[180:183],a[40:43]
buffer_load_dwordx4 v9, s[12:15], s35 offen offset:3072 lds
mm a[44:47],a[148:151],a[180:183],a[44:47]
v_lshlrev_b32 v40, 16, v85
mm a[104:107],a[152:155],a[180:183],a[104:107]
rt a[246:247],v17,50176
v_and_b32 v41, 0xffff0000, v85
mm a[108:111],a[156:159],a[180:183],a[108:111]
v_add_f32 v40, v40, v36
v_add_f32 v41, v41, v36
mm v[176:179],a[128:131],a[184:187],v[176:179]
ds_read_b128 a[216:219], v11 offset:45056
v_mul_f32 v40, v40, v37
mm v[180:183],a[132:135],a[184:187],v[180:183]
v_mul_f32 v41, v41, v37
rt a[248:249],v18,49152
mm v[240:243],a[136:139],a[184:187],v[240:243]
cv v69,v40,v41
mm v[244:247],a[140:143],a[184:187],v[244:247]
v_lshlrev_b32 v42, 16, v86
rt a[250:251],v18,50176
mm a[48:51],a[144:147],a[184:187],a[48:51]
s_add_u32 s35, s35, s40
v_and_b32 v43, 0xffff0000, v86
mm a[52:55],a[148:151],a[184:187],a[52:55]
v_add_f32 v42, v42, v36
ds_read_b128 a[220:223], v11 offset:47104
mm a[112:115],a[152:155],a[184:187],a[112:115]
v_add_f32 v43, v43, v36
mm a[116:119],a[156:159],a[184:187],a[116:119]
v_mul_f32 v42, v42, v37
rt a[252:253],v19,49152
mm v[184:187],a[128:131],a[188:191],v[184:187]
rt a[254:255],v19,50176
v_mul_f32 v43, v43, v37
mm v[188:191],a[132:135],a[188:191],v[188:191]
cv v70,v42,v43
v_lshlrev_b32 v44, 16, v87
mm v[248:251],a[136:139],a[188:191],v[248:251]
global_load_dword v97, v99, s[42:43]
v_and_b32 v45, 0xffff0000, v87
mm v[252:255],a[140:143],a[188:191],v[252:255]
v_add_f32 v44, v44, v36
mm a[56:59],a[144:147],a[188:191],a[56:59]
v_add_f32 v45, v45, v36
v_mul_f32 v44, v44, v37
mm a[60:63],a[148:151],a[188:191],a[60:63]
v_mul_f32 v45, v45, v37
cv v71,v44,v45
mm a[120:123],a[152:155],a[188:191],a[120:123]
buffer_store_dword v58, v57, s[28:31], s54 offen sc1
buffer_store_dwordx4 v[68:71], v96, s[20:23], 0 offen offset:2048 sc1
mm a[124:127],a[156:159],a[188:191],a[124:127]
s_waitcnt lgkmcnt(0)
mm v[128:131],a[192:195],a[224:227],v[128:131]
v_lshlrev_b32 v38, 16, v88
mm v[132:135],a[196:199],a[224:227],v[132:135]
s_waitcnt vmcnt(15)
s_barrier
mm v[192:195],a[200:203],a[224:227],v[192:195]
v_and_b32 v39, 0xffff0000, v88
s_add_u32 m0, s36, 32768
mm v[196:199],a[204:207],a[224:227],v[196:199]
ds_read_b128 a[128:131], v10 offset:0
v_add_f32 v38, v38, v36
mm a[0:3],a[208:211],a[224:227],a[0:3]
v_add_f32 v39, v39, v36
v_mul_f32 v38, v38, v37
mm a[4:7],a[212:215],a[224:227],a[4:7]
buffer_load_dwordx4 v2, s[8:11], s34 offen offset:0 lds
mm a[64:67],a[216:219],a[224:227],a[64:67]
rt a[160:161],v12,0
v_mul_f32 v39, v39, v37
mm a[68:71],a[220:223],a[224:227],a[68:71]
cv v72,v38,v39
mm v[136:139],a[192:195],a[228:231],v[136:139]
buffer_load_dwordx4 v3, s[8:11], s34 offen offset:1024 lds
mm v[140:143],a[196:199],a[228:231],v[140:143]
rt a[162:163],v12,1024
v_lshlrev_b32 v40, 16, v89
mm v[200:203],a[200:203],a[228:231],v[200:203]
v_and_b32 v41, 0xffff0000, v89
ds_read_b128 a[132:135], v10 offset:2048
mm v[204:207],a[204:207],a[228:231],v[204:207]
buffer_load_dwordx4 v4, s[8:11], s34 offen offset:2048 lds
mm a[8:11],a[208:211],a[228:231],a[8:11]
v_add_f32 v40, v40, v36
v_add_f32 v41, v41, v36
mm a[12:15],a[212:215],a[228:231],a[12:15]
rt a[164:165],v13,0
v_mul_f32 v40, v40, v37
mm a[72:75],a[216:219],a[228:231],a[72:75]
buffer_load_dwordx4 v5, s[8:11], s34 offen offset:3072 lds
mm a[76:79],a[220:223],a[228:231],a[76:79]
v_mul_f32 v41, v41, v37
mm v[144:147],a[192:195],a[232:235],v[144:147]
cv v73,v40,v41
rt a[166:167],v13,1024
mm v[148:151],a[196:199],a[232:235],v[148:151]
v_lshlrev_b32 v42, 16, v90
v_and_b32 v43, 0xffff0000, v90
mm v[208:211],a[200:203],a[232:235],v[208:211]
ds_read_b128 a[136:139], v10 offset:4096
v_add_f32 v42, v42, v36
mm v[212:215],a[204:207],a[232:235],v[212:215]
s_add_u32 s34, s34, 128
v_add_f32 v43, v43, v36
mm a[16:19],a[208:211],a[232:235],a[16:19]
rt a[168:169],v14,0
v_mul_f32 v42, v42, v37
mm a[20:23],a[212:215],a[232:235],a[20:23]
v_mul_f32 v43, v43, v37
mm a[80:83],a[216:219],a[232:235],a[80:83]
rt a[170:171],v14,1024
s_add_u32 m0, s36, 36864
mm a[84:87],a[220:223],a[232:235],a[84:87]
cv v74,v42,v43
v_lshlrev_b32 v44, 16, v91
mm v[152:155],a[192:195],a[236:239],v[152:155]
buffer_load_dwordx4 v2, s[8:11], s39 offen offset:0 lds
mm v[156:159],a[196:199],a[236:239],v[156:159]
ds_read_b128 a[140:143], v10 offset:6144
v_and_b32 v45, 0xffff0000, v91
mm v[216:219],a[200:203],a[236:239],v[216:219]
v_add_f32 v44, v44, v36
v_add_f32 v45, v45, v36
mm v[220:223],a[204:207],a[236:239],v[220:223]
buffer_load_dwordx4 v3, s[8:11], s39 offen offset:1024 lds
mm a[24:27],a[208:211],a[236:239],a[24:27]
rt a[172:173],v15,0
mm a[28:31],a[212:215],a[236:239],a[28:31]
v_mul_f32 v44, v44, v37
v_mul_f32 v45, v45, v37
mm a[88:91],a[216:219],a[236:239],a[88:91]
rt a[174:175],v15,1024
cv v75,v44,v45
mm a[92:95],a[220:223],a[236:239],a[92:95]
buffer_store_dwordx4 v[72:75], v56, s[20:23], 0 offen offset:0 sc1
mm v[160:163],a[192:195],a[240:243],v[160:163]
buffer_load_dwordx4 v4, s[8:11], s39 offen offset:2048 lds
mm v[164:167],a[196:199],a[240:243],v[164:167]
ds_read_b128 a[144:147], v10 offset:8192
v_lshlrev_b32 v38, 16, v92
mm v[224:227],a[200:203],a[240:243],v[224:227]
v_and_b32 v39, 0xffff0000, v92
rt a[176:177],v16,0
mm v[228:231],a[204:207],a[240:243],v[228:231]
buffer_load_dwordx4 v5, s[8:11], s39 offen offset:3072 lds
mm a[32:35],a[208:211],a[240:243],a[32:35]
v_add_f32 v38, v38, v36
mm a[36:39],a[212:215],a[240:243],a[36:39]
v_add_f32 v39, v39, v36
v_mul_f32 v38, v38, v37
mm a[96:99],a[216:219],a[240:243],a[96:99]
rt a[178:179],v16,1024
v_mul_f32 v39, v39, v37
mm a[100:103],a[220:223],a[240:243],a[100:103]
s_add_u32 s39, s39, 128
cv v76,v38,v39
mm v[168:171],a[192:195],a[244:247],v[168:171]
ds_read_b128 a[148:151], v10 offset:10240
v_lshlrev_b32 v40, 16, v93
mm v[172:175],a[196:199],a[244:247],v[172:175]
buffer_load_dwordx4 v[104:107], v101, s[60:63], s48 offen
mm v[232:235],a[200:203],a[244:247],v[232:235]
v_and_b32 v41, 0xffff0000, v93
mm v[236:239],a[204:207],a[244:247],v[236:239]
rt a[180:181],v17,0
v_add_f32 v40, v40, v36
mm a[40:43],a[208:211],a[244:247],a[40:43]
v_add_f32 v41, v41, v36
rt a[182:183],v17,1024
mm a[44:47],a[212:215],a[244:247],a[44:47]
v_mul_f32 v40, v40, v37
s_add_u32 s48, s48, s50
mm a[104:107],a[216:219],a[244:247],a[104:107]
v_mul_f32 v41, v41, v37
cv v77,v40,v41
mm a[108:111],a[220:223],a[244:247],a[108:111]
ds_read_b128 a[152:155], v10 offset:12288
v_lshlrev_b32 v42, 16, v94
mm v[176:179],a[192:195],a[248:251],v[176:179]
s_add_u32 m0, s37, 49152
v_and_b32 v43, 0xffff0000, v94
mm v[180:183],a[196:199],a[248:251],v[180:183]
rt a[184:185],v18,0
mm v[240:243],a[200:203],a[248:251],v[240:243]
buffer_load_dwordx4 v6, s[12:15], s35 offen offset:0 lds
mm v[244:247],a[204:207],a[248:251],v[244:247]
v_add_f32 v42, v42, v36
v_add_f32 v43, v43, v36
mm a[48:51],a[208:211],a[248:251],a[48:51]
rt a[186:187],v18,1024
v_mul_f32 v42, v42, v37
mm a[52:55],a[212:215],a[248:251],a[52:55]
v_mul_f32 v43, v43, v37
ds_read_b128 a[156:159], v10 offset:14336
mm a[112:115],a[216:219],a[248:251],a[112:115]
buffer_load_dwordx4 v7, s[12:15], s35 offen offset:1024 lds
mm a[116:119],a[220:223],a[248:251],a[116:119]
cv v78,v42,v43
v_lshlrev_b32 v44, 16, v95
mm v[184:187],a[192:195],a[252:255],v[184:187]
rt a[188:189],v19,0
rt a[190:191],v19,1024
mm v[188:191],a[196:199],a[252:255],v[188:191]
buffer_load_dwordx4 v8, s[12:15], s35 offen offset:2048 lds
mm v[248:251],a[200:203],a[252:255],v[248:251]
buffer_load_dwordx4 v9, s[12:15], s35 offen offset:3072 lds
mm v[252:255],a[204:207],a[252:255],v[252:255]
v_and_b32 v45, 0xffff0000, v95
mm a[56:59],a[208:211],a[252:255],a[56:59]
v_add_f32 v44, v44, v36
v_add_f32 v45, v45, v36
v_mul_f32 v44, v44, v37
v_mul_f32 v45, v45, v37
cv v79,v44,v45
buffer_store_dwordx4 v[76:79], v56, s[20:23], 0 offen offset:2048 sc1
mm a[60:63],a[212:215],a[252:255],a[60:63]
mm a[120:123],a[216:219],a[252:255],a[120:123]
s_add_u32 s35, s35, s40
mm a[124:127],a[220:223],a[252:255],a[124:127]
s_waitcnt lgkmcnt(0)
.p2align 6
L_p1_vloop:
mm v[128:131],a[128:131],a[160:163],v[128:131]
s_waitcnt vmcnt(19)
s_barrier
mm v[132:135],a[132:135],a[160:163],v[132:135]
ds_read_b128 a[192:195], v11 offset:0
mm v[192:195],a[136:139],a[160:163],v[192:195]
rt a[224:225],v12,16384
mm v[196:199],a[140:143],a[160:163],v[196:199]
mm a[0:3],a[144:147],a[160:163],a[0:3]
buffer_load_dwordx4 v[104:107], v100, s[60:63], s48 offen
mm a[4:7],a[148:151],a[160:163],a[4:7]
mm a[64:67],a[152:155],a[160:163],a[64:67]
rt a[226:227],v12,17408
mm a[68:71],a[156:159],a[160:163],a[68:71]
mm v[136:139],a[128:131],a[164:167],v[136:139]
ds_read_b128 a[196:199], v11 offset:2048
mm v[140:143],a[132:135],a[164:167],v[140:143]
mm v[200:203],a[136:139],a[164:167],v[200:203]
buffer_load_dwordx4 v[104:107], v1, s[44:47], s49 offen
mm v[204:207],a[140:143],a[164:167],v[204:207]
mm a[8:11],a[144:147],a[164:167],a[8:11]
rt a[228:229],v13,16384
mm a[12:15],a[148:151],a[164:167],a[12:15]
rt a[230:231],v13,17408
mm a[72:75],a[152:155],a[164:167],a[72:75]
s_add_u32 s49, s49, 524288
mm a[76:79],a[156:159],a[164:167],a[76:79]
mm v[144:147],a[128:131],a[168:171],v[144:147]
ds_read_b128 a[200:203], v11 offset:4096
mm v[148:151],a[132:135],a[168:171],v[148:151]
rt a[232:233],v14,16384
mm v[208:211],a[136:139],a[168:171],v[208:211]
s_add_u32 m0, s37, 0
mm v[212:215],a[140:143],a[168:171],v[212:215]
mm a[16:19],a[144:147],a[168:171],a[16:19]
rt a[234:235],v14,17408
mm a[20:23],a[148:151],a[168:171],a[20:23]
ds_read_b128 a[204:207], v11 offset:6144
mm a[80:83],a[152:155],a[168:171],a[80:83]
mm a[84:87],a[156:159],a[168:171],a[84:87]
buffer_load_dwordx4 v6, s[12:15], s35 offen offset:0 lds
mm v[152:155],a[128:131],a[172:175],v[152:155]
mm v[156:159],a[132:135],a[172:175],v[156:159]
rt a[236:237],v15,16384
mm v[216:219],a[136:139],a[172:175],v[216:219]
rt a[238:239],v15,17408
mm v[220:223],a[140:143],a[172:175],v[220:223]
mm a[24:27],a[144:147],a[172:175],a[24:27]
buffer_load_dwordx4 v7, s[12:15], s35 offen offset:1024 lds
mm a[28:31],a[148:151],a[172:175],a[28:31]
mm a[88:91],a[152:155],a[172:175],a[88:91]
ds_read_b128 a[208:211], v11 offset:8192
mm a[92:95],a[156:159],a[172:175],a[92:95]
mm v[160:163],a[128:131],a[176:179],v[160:163]
rt a[240:241],v16,16384
mm v[164:167],a[132:135],a[176:179],v[164:167]
mm v[224:227],a[136:139],a[176:179],v[224:227]
buffer_load_dwordx4 v8, s[12:15], s35 offen offset:2048 lds
mm v[228:231],a[140:143],a[176:179],v[228:231]
mm a[32:35],a[144:147],a[176:179],a[32:35]
rt a[242:243],v16,17408
mm a[36:39],a[148:151],a[176:179],a[36:39]
ds_read_b128 a[212:215], v11 offset:10240
mm a[96:99],a[152:155],a[176:179],a[96:99]
mm a[100:103],a[156:159],a[176:179],a[100:103]
buffer_load_dwordx4 v9, s[12:15], s35 offen offset:3072 lds
mm v[168:171],a[128:131],a[180:183],v[168:171]
mm v[172:175],a[132:135],a[180:183],v[172:175]
rt a[244:245],v17,16384
mm v[232:235],a[136:139],a[180:183],v[232:235]
rt a[246:247],v17,17408
mm v[236:239],a[140:143],a[180:183],v[236:239]
mm a[40:43],a[144:147],a[180:183],a[40:43]
s_add_u32 s35, s35, s40
mm a[44:47],a[148:151],a[180:183],a[44:47]
ds_read_b128 a[216:219], v11 offset:12288
mm a[104:107],a[152:155],a[180:183],a[104:107]
rt a[248:249],v18,16384
mm a[108:111],a[156:159],a[180:183],a[108:111]
mm v[176:179],a[128:131],a[184:187],v[176:179]
rt a[250:251],v18,17408
mm v[180:183],a[132:135],a[184:187],v[180:183]
ds_read_b128 a[220:223], v11 offset:14336
mm v[240:243],a[136:139],a[184:187],v[240:243]
rt a[252:253],v19,16384
mm v[244:247],a[140:143],a[184:187],v[244:247]
mm a[48:51],a[144:147],a[184:187],a[48:51]
rt a[254:255],v19,17408
mm a[52:55],a[148:151],a[184:187],a[52:55]
mm a[112:115],a[152:155],a[184:187],a[112:115]
mm a[116:119],a[156:159],a[184:187],a[116:119]
mm v[184:187],a[128:131],a[188:191],v[184:187]
mm v[188:191],a[132:135],a[188:191],v[188:191]
mm v[248:251],a[136:139],a[188:191],v[248:251]
mm v[252:255],a[140:143],a[188:191],v[252:255]
mm a[56:59],a[144:147],a[188:191],a[56:59]
mm a[60:63],a[148:151],a[188:191],a[60:63]
mm a[120:123],a[152:155],a[188:191],a[120:123]
mm a[124:127],a[156:159],a[188:191],a[124:127]
s_waitcnt lgkmcnt(0)
mm v[128:131],a[192:195],a[224:227],v[128:131]
s_waitcnt vmcnt(11)
s_barrier
mm v[132:135],a[196:199],a[224:227],v[132:135]
ds_read_b128 a[128:131], v10 offset:32768
mm v[192:195],a[200:203],a[224:227],v[192:195]
rt a[160:161],v12,32768
mm v[196:199],a[204:207],a[224:227],v[196:199]
s_add_u32 m0, s36, 0
mm a[0:3],a[208:211],a[224:227],a[0:3]
rt a[162:163],v12,33792
mm a[4:7],a[212:215],a[224:227],a[4:7]
ds_read_b128 a[132:135], v10 offset:34816
mm a[64:67],a[216:219],a[224:227],a[64:67]
buffer_load_dwordx4 v2, s[8:11], s34 offen offset:0 lds
mm a[68:71],a[220:223],a[224:227],a[68:71]
rt a[164:165],v13,32768
mm v[136:139],a[192:195],a[228:231],v[136:139]
rt a[166:167],v13,33792
mm v[140:143],a[196:199],a[228:231],v[140:143]
mm v[200:203],a[200:203],a[228:231],v[200:203]
buffer_load_dwordx4 v3, s[8:11], s34 offen offset:1024 lds
mm v[204:207],a[204:207],a[228:231],v[204:207]
ds_read_b128 a[136:139], v10 offset:36864
mm a[8:11],a[208:211],a[228:231],a[8:11]
rt a[168:169],v14,32768
mm a[12:15],a[212:215],a[228:231],a[12:15]
buffer_load_dwordx4 v4, s[8:11], s34 offen offset:2048 lds
mm a[72:75],a[216:219],a[228:231],a[72:75]
mm a[76:79],a[220:223],a[228:231],a[76:79]
rt a[170:171],v14,33792
mm v[144:147],a[192:195],a[232:235],v[144:147]
ds_read_b128 a[140:143], v10 offset:38912
mm v[148:151],a[196:199],a[232:235],v[148:151]
buffer_load_dwordx4 v5, s[8:11], s34 offen offset:3072 lds
mm v[208:211],a[200:203],a[232:235],v[208:211]
rt a[172:173],v15,32768
mm v[212:215],a[204:207],a[232:235],v[212:215]
rt a[174:175],v15,33792
mm a[16:19],a[208:211],a[232:235],a[16:19]
s_add_u32 s34, s34, 128
mm a[20:23],a[212:215],a[232:235],a[20:23]
ds_read_b128 a[144:147], v10 offset:40960
mm a[80:83],a[216:219],a[232:235],a[80:83]
rt a[176:177],v16,32768
mm a[84:87],a[220:223],a[232:235],a[84:87]
s_add_u32 m0, s36, 4096
mm v[152:155],a[192:195],a[236:239],v[152:155]
rt a[178:179],v16,33792
mm v[156:159],a[196:199],a[236:239],v[156:159]
ds_read_b128 a[148:151], v10 offset:43008
mm v[216:219],a[200:203],a[236:239],v[216:219]
buffer_load_dwordx4 v2, s[8:11], s39 offen offset:0 lds
mm v[220:223],a[204:207],a[236:239],v[220:223]
rt a[180:181],v17,32768
mm a[24:27],a[208:211],a[236:239],a[24:27]
rt a[182:183],v17,33792
mm a[28:31],a[212:215],a[236:239],a[28:31]
mm a[88:91],a[216:219],a[236:239],a[88:91]
buffer_load_dwordx4 v3, s[8:11], s39 offen offset:1024 lds
mm a[92:95],a[220:223],a[236:239],a[92:95]
ds_read_b128 a[152:155], v10 offset:45056
mm v[160:163],a[192:195],a[240:243],v[160:163]
rt a[184:185],v18,32768
mm v[164:167],a[196:199],a[240:243],v[164:167]
buffer_load_dwordx4 v4, s[8:11], s39 offen offset:2048 lds
mm v[224:227],a[200:203],a[240:243],v[224:227]
mm v[228:231],a[204:207],a[240:243],v[228:231]
rt a[186:187],v18,33792
mm a[32:35],a[208:211],a[240:243],a[32:35]
ds_read_b128 a[156:159], v10 offset:47104
mm a[36:39],a[212:215],a[240:243],a[36:39]
buffer_load_dwordx4 v5, s[8:11], s39 offen offset:3072 lds
mm a[96:99],a[216:219],a[240:243],a[96:99]
rt a[188:189],v19,32768
mm a[100:103],a[220:223],a[240:243],a[100:103]
rt a[190:191],v19,33792
mm v[168:171],a[192:195],a[244:247],v[168:171]
s_add_u32 s39, s39, 128
mm v[172:175],a[196:199],a[244:247],v[172:175]
mm v[232:235],a[200:203],a[244:247],v[232:235]
buffer_load_dwordx4 v[104:107], v101, s[60:63], s48 offen
mm v[236:239],a[204:207],a[244:247],v[236:239]
s_add_u32 s48, s48, s50
mm a[40:43],a[208:211],a[244:247],a[40:43]
s_add_u32 m0, s37, 16384
mm a[44:47],a[212:215],a[244:247],a[44:47]
buffer_load_dwordx4 v6, s[12:15], s35 offen offset:0 lds
mm a[104:107],a[216:219],a[244:247],a[104:107]
mm a[108:111],a[220:223],a[244:247],a[108:111]
buffer_load_dwordx4 v7, s[12:15], s35 offen offset:1024 lds
mm v[176:179],a[192:195],a[248:251],v[176:179]
mm v[180:183],a[196:199],a[248:251],v[180:183]
buffer_load_dwordx4 v8, s[12:15], s35 offen offset:2048 lds
mm v[240:243],a[200:203],a[248:251],v[240:243]
mm v[244:247],a[204:207],a[248:251],v[244:247]
buffer_load_dwordx4 v9, s[12:15], s35 offen offset:3072 lds
mm a[48:51],a[208:211],a[248:251],a[48:51]
s_add_u32 s35, s35, s40
mm a[52:55],a[212:215],a[248:251],a[52:55]
mm a[112:115],a[216:219],a[248:251],a[112:115]
mm a[116:119],a[220:223],a[248:251],a[116:119]
mm v[184:187],a[192:195],a[252:255],v[184:187]
mm v[188:191],a[196:199],a[252:255],v[188:191]
mm v[248:251],a[200:203],a[252:255],v[248:251]
mm v[252:255],a[204:207],a[252:255],v[252:255]
mm a[56:59],a[208:211],a[252:255],a[56:59]
mm a[60:63],a[212:215],a[252:255],a[60:63]
mm a[120:123],a[216:219],a[252:255],a[120:123]
mm a[124:127],a[220:223],a[252:255],a[124:127]
s_waitcnt lgkmcnt(0)
mm v[128:131],a[128:131],a[160:163],v[128:131]
s_waitcnt vmcnt(19)
s_barrier
mm v[132:135],a[132:135],a[160:163],v[132:135]
ds_read_b128 a[192:195], v11 offset:32768
mm v[192:195],a[136:139],a[160:163],v[192:195]
rt a[224:225],v12,49152
mm v[196:199],a[140:143],a[160:163],v[196:199]
mm a[0:3],a[144:147],a[160:163],a[0:3]
buffer_load_dwordx4 v[104:107], v100, s[60:63], s48 offen
mm a[4:7],a[148:151],a[160:163],a[4:7]
mm a[64:67],a[152:155],a[160:163],a[64:67]
rt a[226:227],v12,50176
mm a[68:71],a[156:159],a[160:163],a[68:71]
mm v[136:139],a[128:131],a[164:167],v[136:139]
ds_read_b128 a[196:199], v11 offset:34816
mm v[140:143],a[132:135],a[164:167],v[140:143]
mm v[200:203],a[136:139],a[164:167],v[200:203]
buffer_load_dwordx4 v[104:107], v1, s[44:47], s49 offen
mm v[204:207],a[140:143],a[164:167],v[204:207]
mm a[8:11],a[144:147],a[164:167],a[8:11]
rt a[228:229],v13,49152
mm a[12:15],a[148:151],a[164:167],a[12:15]
rt a[230:231],v13,50176
mm a[72:75],a[152:155],a[164:167],a[72:75]
s_add_u32 s49, s49, 524288
mm a[76:79],a[156:159],a[164:167],a[76:79]
mm v[144:147],a[128:131],a[168:171],v[144:147]
ds_read_b128 a[200:203], v11 offset:36864
mm v[148:151],a[132:135],a[168:171],v[148:151]
rt a[232:233],v14,49152
mm v[208:211],a[136:139],a[168:171],v[208:211]
s_add_u32 m0, s37, 32768
mm v[212:215],a[140:143],a[168:171],v[212:215]
mm a[16:19],a[144:147],a[168:171],a[16:19]
rt a[234:235],v14,50176
mm a[20:23],a[148:151],a[168:171],a[20:23]
ds_read_b128 a[204:207], v11 offset:38912
mm a[80:83],a[152:155],a[168:171],a[80:83]
mm a[84:87],a[156:159],a[168:171],a[84:87]
buffer_load_dwordx4 v6, s[12:15], s35 offen offset:0 lds
mm v[152:155],a[128:131],a[172:175],v[152:155]
mm v[156:159],a[132:135],a[172:175],v[156:159]
rt a[236:237],v15,49152
mm v[216:219],a[136:139],a[172:175],v[216:219]
rt a[238:239],v15,50176
mm v[220:223],a[140:143],a[172:175],v[220:223]
mm a[24:27],a[144:147],a[172:175],a[24:27]
buffer_load_dwordx4 v7, s[12:15], s35 offen offset:1024 lds
mm a[28:31],a[148:151],a[172:175],a[28:31]
mm a[88:91],a[152:155],a[172:175],a[88:91]
ds_read_b128 a[208:211], v11 offset:40960
mm a[92:95],a[156:159],a[172:175],a[92:95]
mm v[160:163],a[128:131],a[176:179],v[160:163]
rt a[240:241],v16,49152
mm v[164:167],a[132:135],a[176:179],v[164:167]
mm v[224:227],a[136:139],a[176:179],v[224:227]
buffer_load_dwordx4 v8, s[12:15], s35 offen offset:2048 lds
mm v[228:231],a[140:143],a[176:179],v[228:231]
mm a[32:35],a[144:147],a[176:179],a[32:35]
rt a[242:243],v16,50176
mm a[36:39],a[148:151],a[176:179],a[36:39]
ds_read_b128 a[212:215], v11 offset:43008
mm a[96:99],a[152:155],a[176:179],a[96:99]
mm a[100:103],a[156:159],a[176:179],a[100:103]
buffer_load_dwordx4 v9, s[12:15], s35 offen offset:3072 lds
mm v[168:171],a[128:131],a[180:183],v[168:171]
mm v[172:175],a[132:135],a[180:183],v[172:175]
rt a[244:245],v17,49152
mm v[232:235],a[136:139],a[180:183],v[232:235]
rt a[246:247],v17,50176
mm v[236:239],a[140:143],a[180:183],v[236:239]
mm a[40:43],a[144:147],a[180:183],a[40:43]
s_add_u32 s35, s35, s40
mm a[44:47],a[148:151],a[180:183],a[44:47]
ds_read_b128 a[216:219], v11 offset:45056
mm a[104:107],a[152:155],a[180:183],a[104:107]
rt a[248:249],v18,49152
mm a[108:111],a[156:159],a[180:183],a[108:111]
mm v[176:179],a[128:131],a[184:187],v[176:179]
rt a[250:251],v18,50176
mm v[180:183],a[132:135],a[184:187],v[180:183]
ds_read_b128 a[220:223], v11 offset:47104
mm v[240:243],a[136:139],a[184:187],v[240:243]
rt a[252:253],v19,49152
mm v[244:247],a[140:143],a[184:187],v[244:247]
mm a[48:51],a[144:147],a[184:187],a[48:51]
rt a[254:255],v19,50176
mm a[52:55],a[148:151],a[184:187],a[52:55]
mm a[112:115],a[152:155],a[184:187],a[112:115]
mm a[116:119],a[156:159],a[184:187],a[116:119]
mm v[184:187],a[128:131],a[188:191],v[184:187]
mm v[188:191],a[132:135],a[188:191],v[188:191]
mm v[248:251],a[136:139],a[188:191],v[248:251]
mm v[252:255],a[140:143],a[188:191],v[252:255]
mm a[56:59],a[144:147],a[188:191],a[56:59]
mm a[60:63],a[148:151],a[188:191],a[60:63]
mm a[120:123],a[152:155],a[188:191],a[120:123]
mm a[124:127],a[156:159],a[188:191],a[124:127]
s_waitcnt lgkmcnt(0)
mm v[128:131],a[192:195],a[224:227],v[128:131]
s_waitcnt vmcnt(11)
s_barrier
mm v[132:135],a[196:199],a[224:227],v[132:135]
ds_read_b128 a[128:131], v10 offset:0
mm v[192:195],a[200:203],a[224:227],v[192:195]
rt a[160:161],v12,0
mm v[196:199],a[204:207],a[224:227],v[196:199]
s_add_u32 m0, s36, 32768
mm a[0:3],a[208:211],a[224:227],a[0:3]
rt a[162:163],v12,1024
mm a[4:7],a[212:215],a[224:227],a[4:7]
ds_read_b128 a[132:135], v10 offset:2048
mm a[64:67],a[216:219],a[224:227],a[64:67]
buffer_load_dwordx4 v2, s[8:11], s34 offen offset:0 lds
mm a[68:71],a[220:223],a[224:227],a[68:71]
rt a[164:165],v13,0
mm v[136:139],a[192:195],a[228:231],v[136:139]
rt a[166:167],v13,1024
mm v[140:143],a[196:199],a[228:231],v[140:143]
mm v[200:203],a[200:203],a[228:231],v[200:203]
buffer_load_dwordx4 v3, s[8:11], s34 offen offset:1024 lds
mm v[204:207],a[204:207],a[228:231],v[204:207]
ds_read_b128 a[136:139], v10 offset:4096
mm a[8:11],a[208:211],a[228:231],a[8:11]
rt a[168:169],v14,0
mm a[12:15],a[212:215],a[228:231],a[12:15]
buffer_load_dwordx4 v4, s[8:11], s34 offen offset:2048 lds
mm a[72:75],a[216:219],a[228:231],a[72:75]
mm a[76:79],a[220:223],a[228:231],a[76:79]
rt a[170:171],v14,1024
mm v[144:147],a[192:195],a[232:235],v[144:147]
ds_read_b128 a[140:143], v10 offset:6144
mm v[148:151],a[196:199],a[232:235],v[148:151]
buffer_load_dwordx4 v5, s[8:11], s34 offen offset:3072 lds
mm v[208:211],a[200:203],a[232:235],v[208:211]
rt a[172:173],v15,0
mm v[212:215],a[204:207],a[232:235],v[212:215]
rt a[174:175],v15,1024
mm a[16:19],a[208:211],a[232:235],a[16:19]
s_add_u32 s34, s34, 128
mm a[20:23],a[212:215],a[232:235],a[20:23]
ds_read_b128 a[144:147], v10 offset:8192
mm a[80:83],a[216:219],a[232:235],a[80:83]
rt a[176:177],v16,0
mm a[84:87],a[220:223],a[232:235],a[84:87]
s_add_u32 m0, s36, 36864
mm v[152:155],a[192:195],a[236:239],v[152:155]
rt a[178:179],v16,1024
mm v[156:159],a[196:199],a[236:239],v[156:159]
ds_read_b128 a[148:151], v10 offset:10240
mm v[216:219],a[200:203],a[236:239],v[216:219]
buffer_load_dwordx4 v2, s[8:11], s39 offen offset:0 lds
mm v[220:223],a[204:207],a[236:239],v[220:223]
rt a[180:181],v17,0
mm a[24:27],a[208:211],a[236:239],a[24:27]
rt a[182:183],v17,1024
mm a[28:31],a[212:215],a[236:239],a[28:31]
mm a[88:91],a[216:219],a[236:239],a[88:91]
buffer_load_dwordx4 v3, s[8:11], s39 offen offset:1024 lds
mm a[92:95],a[220:223],a[236:239],a[92:95]
ds_read_b128 a[152:155], v10 offset:12288
mm v[160:163],a[192:195],a[240:243],v[160:163]
rt a[184:185],v18,0
mm v[164:167],a[196:199],a[240:243],v[164:167]
buffer_load_dwordx4 v4, s[8:11], s39 offen offset:2048 lds
mm v[224:227],a[200:203],a[240:243],v[224:227]
mm v[228:231],a[204:207],a[240:243],v[228:231]
rt a[186:187],v18,1024
mm a[32:35],a[208:211],a[240:243],a[32:35]
ds_read_b128 a[156:159], v10 offset:14336
mm a[36:39],a[212:215],a[240:243],a[36:39]
buffer_load_dwordx4 v5, s[8:11], s39 offen offset:3072 lds
mm a[96:99],a[216:219],a[240:243],a[96:99]
rt a[188:189],v19,0
mm a[100:103],a[220:223],a[240:243],a[100:103]
rt a[190:191],v19,1024
mm v[168:171],a[192:195],a[244:247],v[168:171]
s_add_u32 s39, s39, 128
mm v[172:175],a[196:199],a[244:247],v[172:175]
mm v[232:235],a[200:203],a[244:247],v[232:235]
buffer_load_dwordx4 v[104:107], v101, s[60:63], s48 offen
mm v[236:239],a[204:207],a[244:247],v[236:239]
s_add_u32 s48, s48, s50
mm a[40:43],a[208:211],a[244:247],a[40:43]
s_add_u32 m0, s37, 49152
mm a[44:47],a[212:215],a[244:247],a[44:47]
buffer_load_dwordx4 v6, s[12:15], s35 offen offset:0 lds
mm a[104:107],a[216:219],a[244:247],a[104:107]
mm a[108:111],a[220:223],a[244:247],a[108:111]
buffer_load_dwordx4 v7, s[12:15], s35 offen offset:1024 lds
mm v[176:179],a[192:195],a[248:251],v[176:179]
mm v[180:183],a[196:199],a[248:251],v[180:183]
buffer_load_dwordx4 v8, s[12:15], s35 offen offset:2048 lds
mm v[240:243],a[200:203],a[248:251],v[240:243]
mm v[244:247],a[204:207],a[248:251],v[244:247]
buffer_load_dwordx4 v9, s[12:15], s35 offen offset:3072 lds
mm a[48:51],a[208:211],a[248:251],a[48:51]
s_add_u32 s35, s35, s40
mm a[52:55],a[212:215],a[248:251],a[52:55]
mm a[112:115],a[216:219],a[248:251],a[112:115]
mm a[116:119],a[220:223],a[248:251],a[116:119]
mm v[184:187],a[192:195],a[252:255],v[184:187]
mm v[188:191],a[196:199],a[252:255],v[188:191]
mm v[248:251],a[200:203],a[252:255],v[248:251]
mm v[252:255],a[204:207],a[252:255],v[252:255]
mm a[56:59],a[208:211],a[252:255],a[56:59]
mm a[60:63],a[212:215],a[252:255],a[60:63]
mm a[120:123],a[216:219],a[252:255],a[120:123]
mm a[124:127],a[220:223],a[252:255],a[124:127]
s_waitcnt lgkmcnt(0)
s_add_u32 s38, s38, 1
s_cmp_eq_u32 s38, 4
s_cbranch_scc1 L_p1_done
s_call_b64 s[42:43], L_p1_trip
s_branch L_p1_vloop
L_p1_trip:
s_cmp_eq_u32 s38, 3
s_cbranch_scc1 L_p1_trip3
s_mov_b32 s60, s68
s_and_b32 s61, s69, 0xffff
s_mov_b32 s62, 8388608
s_mov_b32 s63, 0x20000
s_mov_b32 s46, 0
v_mov_b32 v100, v1
v_add_u32 v101, 1048576, v1
s_mov_b32 s48, s52
s_mov_b32 s50, 2097152
s_and_b32 s4, s2, 16
s_lshl_b32 s4, s4, 3
s_cmp_lg_u32 s3, 0
s_cbranch_scc1 L_sg1
v_mov_b32 v29, 1
s_mov_b64 exec, 1
buffer_atomic_add v29, off, s[24:27], s4 sc1
s_mov_b64 exec, -1
L_sg1:
s_setpc_b64 s[42:43]
L_p1_trip3:
s_mov_b32 s10, 0
buffer_load_dword v97, v98, s[24:27], 0 offen sc1
v_lshrrev_b32 v29, 4, v0
s_lshl_b32 s4, s3, 4
v_add_u32 v30, s4, v29
v_lshlrev_b32 v30, 13, v30
v_lshlrev_b32 v29, 1, v29
v_and_b32 v31, 15, v0
v_xor_b32 v29, v29, v31
v_xor_b32 v31, 8, v29
v_lshl_add_u32 v6, v29, 4, v30
v_lshl_add_u32 v7, v31, 4, v30
v_add_u32 v7, 31744, v7
v_lshl_add_u32 v8, v29, 4, v30
v_add_u32 v8, 63488, v8
v_lshl_add_u32 v9, v31, 4, v30
v_add_u32 v9, 95232, v9
s_mov_b32 s12, s68
s_and_b32 s13, s69, 0xffff
s_mov_b32 s14, 8388608
s_mov_b32 s15, 0x20000
s_lshl_b32 s35, s32, 8
s_mov_b32 s40, 524288
s_setpc_b64 s[42:43]
L_p1_done:
s_mov_b32 s7, 0x100000
s_branch L_spc2
L_sp2:
buffer_load_dword v97, v98, s[24:27], 0 offen sc1
s_waitcnt vmcnt(0)
L_spc2:
v_cmp_gt_u32 vcc, 128, v97
s_sub_u32 s7, s7, 1
s_cbranch_vccz L_spd2
s_cmp_lg_u32 s7, 0
s_cbranch_scc1 L_sp2
L_spd2:
s_bfe_u32 s38, s32, 0x10001
s_lshl_b32 s38, s38, 4
s_and_b32 s4, s2, 7
s_add_u32 s38, s38, s4
s_lshl_b32 s38, s38, 7
s_and_b32 s41, s3, 1
s_lshr_b32 s44, s3, 1
s_mov_b32 s16, s86
s_and_b32 s17, s87, 0xffff
s_mov_b32 s18, 4194304
s_mov_b32 s19, 0x20000
s_sub_u32 s4, 15, s33
s_cmp_eq_u32 s44, 0
s_cselect_b32 s4, s4, s33
s_lshl_b32 s4, s4, 3
s_lshl_b32 s5, s41, 2
s_add_u32 s4, s4, s5
s_lshl_b32 s34, s4, 15
v_mov_b32 v28, v1
v_add_u32 v29, 32768, v1
v_add_u32 v30, 65536, v1
v_add_u32 v31, 98304, v1
buffer_load_dwordx4 a[128:131], v28, s[16:19], s34 offen sc1
buffer_load_dwordx4 a[132:135], v29, s[16:19], s34 offen sc1
buffer_load_dwordx4 a[136:139], v30, s[16:19], s34 offen sc1
buffer_load_dwordx4 a[140:143], v31, s[16:19], s34 offen sc1
s_add_u32 s34, s34, 1024
buffer_load_dwordx4 a[144:147], v28, s[16:19], s34 offen sc1
buffer_load_dwordx4 a[148:151], v29, s[16:19], s34 offen sc1
buffer_load_dwordx4 a[152:155], v30, s[16:19], s34 offen sc1
buffer_load_dwordx4 a[156:159], v31, s[16:19], s34 offen sc1
s_add_u32 s34, s34, 1024
s_cmp_eq_u32 s55, 1
s_mov_b32 s4, 8388608
s_mov_b32 s5, 25165824
s_cselect_b32 s4, s5, s4
s_add_u32 s20, s86, s4
s_addc_u32 s21, s87, 0
s_and_b32 s21, s21, 0xffff
s_mov_b32 s22, 16777216
s_mov_b32 s23, 0x20000
s_lshl_b32 s37, s56, 19
s_lshl_b32 s5, s33, 16
s_add_u32 s37, s37, s5
s_lshl_b32 s5, s41, 15
s_add_u32 s37, s37, s5
s_lshl_b32 s36, s3, 12
s_add_u32 s36, s36, 65536
v_lshrrev_b32 v44, 4, v0
v_bfe_u32 v45, v0, 2, 2
v_and_b32 v46, 3, v0
v_lshl_add_u32 v40, v44, 2, v45
v_and_b32 v41, 7, v40
v_lshlrev_b32 v40, 8, v40
v_lshl_add_u32 v40, v46, 3, v40
v_lshl_add_u32 v40, v41, 5, v40
v_add_u32 v40, 65536, v40
v_xor_b32 v32, 0, v40
v_xor_b32 v33, 32, v40
v_xor_b32 v34, 64, v40
v_xor_b32 v35, 96, v40
v_xor_b32 v36, 128, v40
v_xor_b32 v37, 160, v40
v_xor_b32 v38, 192, v40
v_xor_b32 v39, 224, v40
cv v128,v128,v129
cv v129,v130,v131
cv v130,v132,v133
cv v131,v134,v135
cv v132,v136,v137
cv v133,v138,v139
cv v134,v140,v141
cv v135,v142,v143
buffer_load_dwordx4 a[160:163], v28, s[16:19], s34 offen sc1
cv v136,v144,v145
cv v137,v146,v147
cv v138,v148,v149
cv v139,v150,v151
cv v140,v152,v153
cv v141,v154,v155
cv v142,v156,v157
buffer_load_dwordx4 a[164:167], v29, s[16:19], s34 offen sc1
cv v143,v158,v159
cv v144,v160,v161
cv v145,v162,v163
cv v146,v164,v165
cv v147,v166,v167
cv v148,v168,v169
cv v149,v170,v171
buffer_load_dwordx4 a[168:171], v30, s[16:19], s34 offen sc1
cv v150,v172,v173
cv v151,v174,v175
cv v152,v176,v177
cv v153,v178,v179
cv v154,v180,v181
cv v155,v182,v183
cv v156,v184,v185
buffer_load_dwordx4 a[172:175], v31, s[16:19], s34 offen sc1
cv v157,v186,v187
cv v158,v188,v189
cv v159,v190,v191
cv v160,v192,v193
cv v161,v194,v195
cv v162,v196,v197
cv v163,v198,v199
cv v164,v200,v201
s_add_u32 s34, s34, 1024
buffer_load_dwordx4 a[176:179], v28, s[16:19], s34 offen sc1
cv v165,v202,v203
cv v166,v204,v205
cv v167,v206,v207
cv v168,v208,v209
cv v169,v210,v211
cv v170,v212,v213
cv v171,v214,v215
buffer_load_dwordx4 a[180:183], v29, s[16:19], s34 offen sc1
cv v172,v216,v217
cv v173,v218,v219
cv v174,v220,v221
cv v175,v222,v223
cv v176,v224,v225
cv v177,v226,v227
cv v178,v228,v229
buffer_load_dwordx4 a[184:187], v30, s[16:19], s34 offen sc1
cv v179,v230,v231
cv v180,v232,v233
cv v181,v234,v235
cv v182,v236,v237
cv v183,v238,v239
cv v184,v240,v241
cv v185,v242,v243
buffer_load_dwordx4 a[188:191], v31, s[16:19], s34 offen sc1
cv v186,v244,v245
cv v187,v246,v247
cv v188,v248,v249
cv v189,v250,v251
cv v190,v252,v253
cv v191,v254,v255
ar v64,a0
ar v65,a1
s_add_u32 s34, s34, 1024
buffer_load_dwordx4 a[192:195], v28, s[16:19], s34 offen sc1
ar v66,a2
ar v67,a3
ar v68,a4
ar v69,a5
ar v70,a6
ar v71,a7
cv v192,v64,v65
buffer_load_dwordx4 a[196:199], v29, s[16:19], s34 offen sc1
cv v193,v66,v67
cv v194,v68,v69
cv v195,v70,v71
ar v72,a8
ar v73,a9
ar v74,a10
ar v75,a11
buffer_load_dwordx4 a[200:203], v30, s[16:19], s34 offen sc1
ar v76,a12
ar v77,a13
ar v78,a14
ar v79,a15
cv v196,v72,v73
cv v197,v74,v75
cv v198,v76,v77
buffer_load_dwordx4 a[204:207], v31, s[16:19], s34 offen sc1
cv v199,v78,v79
ar v80,a16
ar v81,a17
ar v82,a18
ar v83,a19
ar v84,a20
ar v85,a21
ar v86,a22
s_add_u32 s34, s34, 1024
buffer_load_dwordx4 a[208:211], v28, s[16:19], s34 offen sc1
ar v87,a23
cv v200,v80,v81
cv v201,v82,v83
cv v202,v84,v85
cv v203,v86,v87
ar v88,a24
ar v89,a25
buffer_load_dwordx4 a[212:215], v29, s[16:19], s34 offen sc1
ar v90,a26
ar v91,a27
ar v92,a28
ar v93,a29
ar v94,a30
ar v95,a31
cv v204,v88,v89
buffer_load_dwordx4 a[216:219], v30, s[16:19], s34 offen sc1
cv v205,v90,v91
cv v206,v92,v93
cv v207,v94,v95
ar v64,a32
ar v65,a33
ar v66,a34
ar v67,a35
buffer_load_dwordx4 a[220:223], v31, s[16:19], s34 offen sc1
ar v68,a36
ar v69,a37
ar v70,a38
ar v71,a39
cv v208,v64,v65
cv v209,v66,v67
cv v210,v68,v69
cv v211,v70,v71
s_add_u32 s34, s34, 1024
buffer_load_dwordx4 a[224:227], v28, s[16:19], s34 offen sc1
ar v72,a40
ar v73,a41
ar v74,a42
ar v75,a43
ar v76,a44
ar v77,a45
ar v78,a46
buffer_load_dwordx4 a[228:231], v29, s[16:19], s34 offen sc1
ar v79,a47
cv v212,v72,v73
cv v213,v74,v75
cv v214,v76,v77
cv v215,v78,v79
ar v80,a48
ar v81,a49
buffer_load_dwordx4 a[232:235], v30, s[16:19], s34 offen sc1
ar v82,a50
ar v83,a51
ar v84,a52
ar v85,a53
ar v86,a54
ar v87,a55
cv v216,v80,v81
buffer_load_dwordx4 a[236:239], v31, s[16:19], s34 offen sc1
cv v217,v82,v83
cv v218,v84,v85
cv v219,v86,v87
ar v88,a56
ar v89,a57
ar v90,a58
ar v91,a59
s_add_u32 s34, s34, 1024
ar v92,a60
ar v93,a61
ar v94,a62
ar v95,a63
cv v220,v88,v89
cv v221,v90,v91
cv v222,v92,v93
cv v223,v94,v95
s_waitcnt vmcnt(40)
s_barrier
rt a[0:1],v32,0
rt a[2:3],v32,4096
rt a[32:33],v32,8192
rt a[34:35],v32,12288
rt a[4:5],v33,0
rt a[6:7],v33,4096
rt a[36:37],v33,8192
rt a[38:39],v33,12288
rt a[8:9],v34,0
rt a[10:11],v34,4096
rt a[40:41],v34,8192
rt a[42:43],v34,12288
rt a[12:13],v35,0
rt a[14:15],v35,4096
rt a[44:45],v35,8192
rt a[46:47],v35,12288
rt a[16:17],v36,0
rt a[18:19],v36,4096
rt a[48:49],v36,8192
rt a[50:51],v36,12288
rt a[20:21],v37,0
rt a[22:23],v37,4096
rt a[52:53],v37,8192
rt a[54:55],v37,12288
rt a[24:25],v38,0
rt a[26:27],v38,4096
rt a[56:57],v38,8192
rt a[58:59],v38,12288
ar v64,a64
ar v65,a65
ar v66,a66
ar v67,a67
ar v68,a68
ar v69,a69
ar v70,a70
ar v71,a71
cv v224,v64,v65
cv v225,v66,v67
cv v226,v68,v69
cv v227,v70,v71
ar v72,a72
ar v73,a73
ar v74,a74
ar v75,a75
ar v76,a76
ar v77,a77
ar v78,a78
ar v79,a79
cv v228,v72,v73
cv v229,v74,v75
cv v230,v76,v77
cv v231,v78,v79
ar v80,a80
ar v81,a81
ar v82,a82
ar v83,a83
ar v84,a84
ar v85,a85
ar v86,a86
ar v87,a87
cv v232,v80,v81
cv v233,v82,v83
cv v234,v84,v85
cv v235,v86,v87
ar v88,a88
ar v89,a89
ar v90,a90
ar v91,a91
ar v92,a92
ar v93,a93
ar v94,a94
ar v95,a95
cv v236,v88,v89
cv v237,v90,v91
cv v238,v92,v93
cv v239,v94,v95
ar v64,a96
ar v65,a97
ar v66,a98
ar v67,a99
ar v68,a100
ar v69,a101
ar v70,a102
ar v71,a103
cv v240,v64,v65
cv v241,v66,v67
cv v242,v68,v69
cv v243,v70,v71
ar v72,a104
ar v73,a105
ar v74,a106
ar v75,a107
ar v76,a108
ar v77,a109
ar v78,a110
ar v79,a111
cv v244,v72,v73
cv v245,v74,v75
cv v246,v76,v77
cv v247,v78,v79
ar v80,a112
ar v81,a113
ar v82,a114
ar v83,a115
ar v84,a116
ar v85,a117
ar v86,a118
ar v87,a119
cv v248,v80,v81
cv v249,v82,v83
cv v250,v84,v85
cv v251,v86,v87
ar v88,a120
ar v89,a121
ar v90,a122
ar v91,a123
ar v92,a124
ar v93,a125
ar v94,a126
ar v95,a127
cv v252,v88,v89
cv v253,v90,v91
cv v254,v92,v93
cv v255,v94,v95
s_waitcnt lgkmcnt(0)
s_waitcnt vmcnt(20) lgkmcnt(8)
mm v[64:67],a[0:3],a[128:131],0
mm v[64:67],a[32:35],a[144:147],v[64:67]
rt a[28:29],v39,0
mm v[96:99],a[0:3],a[132:135],0
rt a[30:31],v39,4096
mm v[96:99],a[32:35],a[148:151],v[96:99]
rt a[60:61],v39,8192
mm a[64:67],a[0:3],a[136:139],0
mm a[64:67],a[32:35],a[152:155],a[64:67]
rt a[62:63],v39,12288
mm a[96:99],a[0:3],a[140:143],0
mm a[96:99],a[32:35],a[156:159],a[96:99]
mm v[68:71],a[4:7],a[128:131],0
mm v[68:71],a[36:39],a[144:147],v[68:71]
mm v[100:103],a[4:7],a[132:135],0
s_waitcnt vmcnt(36) lgkmcnt(0)
s_barrier
mm v[100:103],a[36:39],a[148:151],v[100:103]
buffer_load_dwordx4 a[240:243], v28, s[16:19], s34 offen sc1
rt a[0:1],v32,16384
mm a[68:71],a[4:7],a[136:139],0
rt a[2:3],v32,20480
mm a[68:71],a[36:39],a[152:155],a[68:71]
rt a[32:33],v32,24576
mm a[100:103],a[4:7],a[140:143],0
buffer_load_dwordx4 a[244:247], v29, s[16:19], s34 offen sc1
mm a[100:103],a[36:39],a[156:159],a[100:103]
rt a[34:35],v32,28672
mm v[72:75],a[8:11],a[128:131],0
mm v[72:75],a[40:43],a[144:147],v[72:75]
rt a[4:5],v33,16384
mm v[104:107],a[8:11],a[132:135],0
buffer_load_dwordx4 a[248:251], v30, s[16:19], s34 offen sc1
mm v[104:107],a[40:43],a[148:151],v[104:107]
rt a[6:7],v33,20480
mm a[72:75],a[8:11],a[136:139],0
mm a[72:75],a[40:43],a[152:155],a[72:75]
rt a[36:37],v33,24576
mm a[104:107],a[8:11],a[140:143],0
buffer_load_dwordx4 a[252:255], v31, s[16:19], s34 offen sc1
mm a[104:107],a[40:43],a[156:159],a[104:107]
rt a[38:39],v33,28672
mm v[76:79],a[12:15],a[128:131],0
mm v[76:79],a[44:47],a[144:147],v[76:79]
rt a[8:9],v34,16384
mm v[108:111],a[12:15],a[132:135],0
s_add_u32 s34, s34, 1024
mm v[108:111],a[44:47],a[148:151],v[108:111]
rt a[10:11],v34,20480
mm a[76:79],a[12:15],a[136:139],0
mm a[76:79],a[44:47],a[152:155],a[76:79]
rt a[40:41],v34,24576
mm a[108:111],a[12:15],a[140:143],0
s_add_u32 m0, s36, 0
mm a[108:111],a[44:47],a[156:159],a[108:111]
rt a[42:43],v34,28672
mm v[80:83],a[16:19],a[128:131],0
mm v[80:83],a[48:51],a[144:147],v[80:83]
rt a[12:13],v35,16384
mm v[112:115],a[16:19],a[132:135],0
buffer_load_dwordx4 v6, s[12:15], s35 offen offset:0 lds
mm v[112:115],a[48:51],a[148:151],v[112:115]
rt a[14:15],v35,20480
mm a[80:83],a[16:19],a[136:139],0
mm a[80:83],a[48:51],a[152:155],a[80:83]
rt a[44:45],v35,24576
mm a[112:115],a[16:19],a[140:143],0
buffer_load_dwordx4 v7, s[12:15], s35 offen offset:1024 lds
mm a[112:115],a[48:51],a[156:159],a[112:115]
rt a[46:47],v35,28672
mm v[84:87],a[20:23],a[128:131],0
mm v[84:87],a[52:55],a[144:147],v[84:87]
rt a[16:17],v36,16384
mm v[116:119],a[20:23],a[132:135],0
buffer_load_dwordx4 v8, s[12:15], s35 offen offset:2048 lds
mm v[116:119],a[52:55],a[148:151],v[116:119]
rt a[18:19],v36,20480
mm a[84:87],a[20:23],a[136:139],0
mm a[84:87],a[52:55],a[152:155],a[84:87]
rt a[48:49],v36,24576
mm a[116:119],a[20:23],a[140:143],0
buffer_load_dwordx4 v9, s[12:15], s35 offen offset:3072 lds
mm a[116:119],a[52:55],a[156:159],a[116:119]
rt a[50:51],v36,28672
mm v[88:91],a[24:27],a[128:131],0
mm v[88:91],a[56:59],a[144:147],v[88:91]
rt a[20:21],v37,16384
mm v[120:123],a[24:27],a[132:135],0
s_add_u32 s35, s35, 524288
mm v[120:123],a[56:59],a[148:151],v[120:123]
rt a[22:23],v37,20480
mm a[88:91],a[24:27],a[136:139],0
mm a[88:91],a[56:59],a[152:155],a[88:91]
rt a[52:53],v37,24576
mm a[120:123],a[24:27],a[140:143],0
buffer_store_dwordx4 v[128:131], v1, s[20:23], s37 offen offset:0 sc1
mm a[120:123],a[56:59],a[156:159],a[120:123]
rt a[54:55],v37,28672
mm v[92:95],a[28:31],a[128:131],0
mm v[92:95],a[60:63],a[144:147],v[92:95]
rt a[24:25],v38,16384
mm v[124:127],a[28:31],a[132:135],0
buffer_store_dwordx4 v[132:135], v1, s[20:23], s37 offen offset:1024 sc1
mm v[124:127],a[60:63],a[148:151],v[124:127]
rt a[26:27],v38,20480
mm a[92:95],a[28:31],a[136:139],0
mm a[92:95],a[60:63],a[152:155],a[92:95]
rt a[56:57],v38,24576
mm a[124:127],a[28:31],a[140:143],0
buffer_store_dwordx4 v[136:139], v1, s[20:23], s37 offen offset:2048 sc1
mm a[124:127],a[60:63],a[156:159],a[124:127]
rt a[58:59],v38,28672
s_waitcnt vmcnt(23) lgkmcnt(8)
mm v[64:67],a[0:3],a[160:163],v[64:67]
buffer_load_dwordx4 a[128:131], v28, s[16:19], s34 offen sc1
mm v[64:67],a[32:35],a[176:179],v[64:67]
mm v[96:99],a[0:3],a[164:167],v[96:99]
buffer_load_dwordx4 a[132:135], v29, s[16:19], s34 offen sc1
mm v[96:99],a[32:35],a[180:183],v[96:99]
mm a[64:67],a[0:3],a[168:171],a[64:67]
buffer_load_dwordx4 a[136:139], v30, s[16:19], s34 offen sc1
mm a[64:67],a[32:35],a[184:187],a[64:67]
rt a[28:29],v39,16384
rt a[30:31],v39,20480
rt a[60:61],v39,24576
rt a[62:63],v39,28672
mm a[96:99],a[0:3],a[172:175],a[96:99]
mm a[96:99],a[32:35],a[188:191],a[96:99]
mm v[68:71],a[4:7],a[160:163],v[68:71]
mm v[68:71],a[36:39],a[176:179],v[68:71]
buffer_load_dwordx4 a[140:143], v31, s[16:19], s34 offen sc1
s_add_u32 s34, s34, 1024
mm v[100:103],a[4:7],a[164:167],v[100:103]
s_waitcnt vmcnt(47) lgkmcnt(0)
s_barrier
mm v[100:103],a[36:39],a[180:183],v[100:103]
mm a[68:71],a[4:7],a[168:171],a[68:71]
mm a[68:71],a[36:39],a[184:187],a[68:71]
mm a[100:103],a[4:7],a[172:175],a[100:103]
buffer_load_dwordx4 a[144:147], v28, s[16:19], s34 offen sc1
mm a[100:103],a[36:39],a[188:191],a[100:103]
rt a[0:1],v32,32768
rt a[2:3],v32,36864
rt a[32:33],v32,40960
rt a[34:35],v32,45056
mm v[72:75],a[8:11],a[160:163],v[72:75]
mm v[72:75],a[40:43],a[176:179],v[72:75]
mm v[104:107],a[8:11],a[164:167],v[104:107]
mm v[104:107],a[40:43],a[180:183],v[104:107]
mm a[72:75],a[8:11],a[168:171],a[72:75]
buffer_load_dwordx4 a[148:151], v29, s[16:19], s34 offen sc1
mm a[72:75],a[40:43],a[184:187],a[72:75]
mm a[104:107],a[8:11],a[172:175],a[104:107]
buffer_load_dwordx4 a[152:155], v30, s[16:19], s34 offen sc1
mm a[104:107],a[40:43],a[188:191],a[104:107]
rt a[4:5],v33,32768
rt a[6:7],v33,36864
rt a[36:37],v33,40960
rt a[38:39],v33,45056
mm v[76:79],a[12:15],a[160:163],v[76:79]
mm v[76:79],a[44:47],a[176:179],v[76:79]
mm v[108:111],a[12:15],a[164:167],v[108:111]
mm v[108:111],a[44:47],a[180:183],v[108:111]
buffer_load_dwordx4 a[156:159], v31, s[16:19], s34 offen sc1
mm a[76:79],a[12:15],a[168:171],a[76:79]
mm a[76:79],a[44:47],a[184:187],a[76:79]
rt a[8:9],v34,32768
mm a[108:111],a[12:15],a[172:175],a[108:111]
s_add_u32 s34, s34, 1024
mm a[108:111],a[44:47],a[188:191],a[108:111]
rt a[10:11],v34,36864
rt a[40:41],v34,40960
rt a[42:43],v34,45056
mm v[80:83],a[16:19],a[160:163],v[80:83]
mm v[80:83],a[48:51],a[176:179],v[80:83]
mm v[112:115],a[16:19],a[164:167],v[112:115]
s_add_u32 m0, s36, 16384
mm v[112:115],a[48:51],a[180:183],v[112:115]
buffer_load_dwordx4 v6, s[12:15], s35 offen offset:0 lds
mm a[80:83],a[16:19],a[168:171],a[80:83]
mm a[80:83],a[48:51],a[184:187],a[80:83]
buffer_load_dwordx4 v7, s[12:15], s35 offen offset:1024 lds
mm a[112:115],a[16:19],a[172:175],a[112:115]
rt a[12:13],v35,32768
mm a[112:115],a[48:51],a[188:191],a[112:115]
rt a[14:15],v35,36864
rt a[44:45],v35,40960
rt a[46:47],v35,45056
mm v[84:87],a[20:23],a[160:163],v[84:87]
mm v[84:87],a[52:55],a[176:179],v[84:87]
mm v[116:119],a[20:23],a[164:167],v[116:119]
buffer_load_dwordx4 v8, s[12:15], s35 offen offset:2048 lds
mm v[116:119],a[52:55],a[180:183],v[116:119]
mm a[84:87],a[20:23],a[168:171],a[84:87]
buffer_load_dwordx4 v9, s[12:15], s35 offen offset:3072 lds
mm a[84:87],a[52:55],a[184:187],a[84:87]
mm a[116:119],a[20:23],a[172:175],a[116:119]
rt a[16:17],v36,32768
mm a[116:119],a[52:55],a[188:191],a[116:119]
rt a[18:19],v36,36864
rt a[48:49],v36,40960
rt a[50:51],v36,45056
mm v[88:91],a[24:27],a[160:163],v[88:91]
mm v[88:91],a[56:59],a[176:179],v[88:91]
mm v[120:123],a[24:27],a[164:167],v[120:123]
s_add_u32 s35, s35, 524288
mm v[120:123],a[56:59],a[180:183],v[120:123]
buffer_store_dwordx4 v[140:143], v1, s[20:23], s37 offen offset:3072 sc1
mm a[88:91],a[24:27],a[168:171],a[88:91]
rt a[20:21],v37,32768
mm a[88:91],a[56:59],a[184:187],a[88:91]
rt a[22:23],v37,36864
mm a[120:123],a[24:27],a[172:175],a[120:123]
rt a[52:53],v37,40960
mm a[120:123],a[56:59],a[188:191],a[120:123]
rt a[54:55],v37,45056
mm v[92:95],a[28:31],a[160:163],v[92:95]
s_add_u32 s37, s37, 4096
mm v[92:95],a[60:63],a[176:179],v[92:95]
rt a[24:25],v38,32768
mm v[124:127],a[28:31],a[164:167],v[124:127]
buffer_store_dwordx4 v[144:147], v1, s[20:23], s37 offen offset:0 sc1
mm v[124:127],a[60:63],a[180:183],v[124:127]
mm a[92:95],a[28:31],a[168:171],a[92:95]
rt a[26:27],v38,36864
mm a[92:95],a[60:63],a[184:187],a[92:95]
rt a[56:57],v38,40960
mm a[124:127],a[28:31],a[172:175],a[124:127]
buffer_store_dwordx4 v[148:151], v1, s[20:23], s37 offen offset:1024 sc1
mm a[124:127],a[60:63],a[188:191],a[124:127]
rt a[58:59],v38,45056
s_waitcnt vmcnt(30) lgkmcnt(8)
mm v[64:67],a[0:3],a[192:195],v[64:67]
buffer_load_dwordx4 a[160:163], v28, s[16:19], s34 offen sc1
mm v[64:67],a[32:35],a[208:211],v[64:67]
mm v[96:99],a[0:3],a[196:199],v[96:99]
buffer_load_dwordx4 a[164:167], v29, s[16:19], s34 offen sc1
mm v[96:99],a[32:35],a[212:215],v[96:99]
mm a[64:67],a[0:3],a[200:203],a[64:67]
buffer_load_dwordx4 a[168:171], v30, s[16:19], s34 offen sc1
mm a[64:67],a[32:35],a[216:219],a[64:67]
rt a[28:29],v39,32768
rt a[30:31],v39,36864
rt a[60:61],v39,40960
rt a[62:63],v39,45056
mm a[96:99],a[0:3],a[204:207],a[96:99]
mm a[96:99],a[32:35],a[220:223],a[96:99]
mm v[68:71],a[4:7],a[192:195],v[68:71]
mm v[68:71],a[36:39],a[208:211],v[68:71]
buffer_load_dwordx4 a[172:175], v31, s[16:19], s34 offen sc1
s_add_u32 s34, s34, 1024
mm v[100:103],a[4:7],a[196:199],v[100:103]
s_waitcnt vmcnt(58) lgkmcnt(0)
s_barrier
mm v[100:103],a[36:39],a[212:215],v[100:103]
mm a[68:71],a[4:7],a[200:203],a[68:71]
mm a[68:71],a[36:39],a[216:219],a[68:71]
mm a[100:103],a[4:7],a[204:207],a[100:103]
buffer_load_dwordx4 a[176:179], v28, s[16:19], s34 offen sc1
mm a[100:103],a[36:39],a[220:223],a[100:103]
rt a[0:1],v32,49152
rt a[2:3],v32,53248
rt a[32:33],v32,57344
rt a[34:35],v32,61440
mm v[72:75],a[8:11],a[192:195],v[72:75]
mm v[72:75],a[40:43],a[208:211],v[72:75]
mm v[104:107],a[8:11],a[196:199],v[104:107]
mm v[104:107],a[40:43],a[212:215],v[104:107]
mm a[72:75],a[8:11],a[200:203],a[72:75]
buffer_load_dwordx4 a[180:183], v29, s[16:19], s34 offen sc1
mm a[72:75],a[40:43],a[216:219],a[72:75]
mm a[104:107],a[8:11],a[204:207],a[104:107]
buffer_load_dwordx4 a[184:187], v30, s[16:19], s34 offen sc1
mm a[104:107],a[40:43],a[220:223],a[104:107]
rt a[4:5],v33,49152
rt a[6:7],v33,53248
rt a[36:37],v33,57344
rt a[38:39],v33,61440
mm v[76:79],a[12:15],a[192:195],v[76:79]
mm v[76:79],a[44:47],a[208:211],v[76:79]
mm v[108:111],a[12:15],a[196:199],v[108:111]
mm v[108:111],a[44:47],a[212:215],v[108:111]
buffer_load_dwordx4 a[188:191], v31, s[16:19], s34 offen sc1
mm a[76:79],a[12:15],a[200:203],a[76:79]
mm a[76:79],a[44:47],a[216:219],a[76:79]
rt a[8:9],v34,49152
mm a[108:111],a[12:15],a[204:207],a[108:111]
s_add_u32 s34, s34, 1024
mm a[108:111],a[44:47],a[220:223],a[108:111]
rt a[10:11],v34,53248
rt a[40:41],v34,57344
rt a[42:43],v34,61440
mm v[80:83],a[16:19],a[192:195],v[80:83]
mm v[80:83],a[48:51],a[208:211],v[80:83]
mm v[112:115],a[16:19],a[196:199],v[112:115]
s_add_u32 m0, s36, 32768
mm v[112:115],a[48:51],a[212:215],v[112:115]
buffer_load_dwordx4 v6, s[12:15], s35 offen offset:0 lds
mm a[80:83],a[16:19],a[200:203],a[80:83]
mm a[80:83],a[48:51],a[216:219],a[80:83]
buffer_load_dwordx4 v7, s[12:15], s35 offen offset:1024 lds
mm a[112:115],a[16:19],a[204:207],a[112:115]
rt a[12:13],v35,49152
mm a[112:115],a[48:51],a[220:223],a[112:115]
rt a[14:15],v35,53248
rt a[44:45],v35,57344
rt a[46:47],v35,61440
mm v[84:87],a[20:23],a[192:195],v[84:87]
mm v[84:87],a[52:55],a[208:211],v[84:87]
mm v[116:119],a[20:23],a[196:199],v[116:119]
buffer_load_dwordx4 v8, s[12:15], s35 offen offset:2048 lds
mm v[116:119],a[52:55],a[212:215],v[116:119]
mm a[84:87],a[20:23],a[200:203],a[84:87]
buffer_load_dwordx4 v9, s[12:15], s35 offen offset:3072 lds
mm a[84:87],a[52:55],a[216:219],a[84:87]
mm a[116:119],a[20:23],a[204:207],a[116:119]
rt a[16:17],v36,49152
mm a[116:119],a[52:55],a[220:223],a[116:119]
rt a[18:19],v36,53248
rt a[48:49],v36,57344
rt a[50:51],v36,61440
mm v[88:91],a[24:27],a[192:195],v[88:91]
mm v[88:91],a[56:59],a[208:211],v[88:91]
mm v[120:123],a[24:27],a[196:199],v[120:123]
s_add_u32 s35, s35, 524288
mm v[120:123],a[56:59],a[212:215],v[120:123]
buffer_store_dwordx4 v[152:155], v1, s[20:23], s37 offen offset:2048 sc1
mm a[88:91],a[24:27],a[200:203],a[88:91]
rt a[20:21],v37,49152
mm a[88:91],a[56:59],a[216:219],a[88:91]
rt a[22:23],v37,53248
mm a[120:123],a[24:27],a[204:207],a[120:123]
buffer_store_dwordx4 v[156:159], v1, s[20:23], s37 offen offset:3072 sc1
mm a[120:123],a[56:59],a[220:223],a[120:123]
rt a[52:53],v37,57344
rt a[54:55],v37,61440
mm v[92:95],a[28:31],a[192:195],v[92:95]
mm v[92:95],a[60:63],a[208:211],v[92:95]
mm v[124:127],a[28:31],a[196:199],v[124:127]
rt a[24:25],v38,49152
mm v[124:127],a[60:63],a[212:215],v[124:127]
s_add_u32 s37, s37, 4096
mm a[92:95],a[28:31],a[200:203],a[92:95]
rt a[26:27],v38,53248
mm a[92:95],a[60:63],a[216:219],a[92:95]
rt a[56:57],v38,57344
mm a[124:127],a[28:31],a[204:207],a[124:127]
buffer_store_dwordx4 v[160:163], v1, s[20:23], s37 offen offset:0 sc1
mm a[124:127],a[60:63],a[220:223],a[124:127]
rt a[58:59],v38,61440
s_waitcnt vmcnt(37) lgkmcnt(8)
mm v[64:67],a[0:3],a[224:227],v[64:67]
buffer_load_dwordx4 a[192:195], v28, s[16:19], s34 offen sc1
mm v[64:67],a[32:35],a[240:243],v[64:67]
mm v[96:99],a[0:3],a[228:231],v[96:99]
buffer_load_dwordx4 a[196:199], v29, s[16:19], s34 offen sc1
mm v[96:99],a[32:35],a[244:247],v[96:99]
mm a[64:67],a[0:3],a[232:235],a[64:67]
buffer_load_dwordx4 a[200:203], v30, s[16:19], s34 offen sc1
mm a[64:67],a[32:35],a[248:251],a[64:67]
rt a[28:29],v39,49152
rt a[30:31],v39,53248
rt a[60:61],v39,57344
rt a[62:63],v39,61440
mm a[96:99],a[0:3],a[236:239],a[96:99]
mm a[96:99],a[32:35],a[252:255],a[96:99]
mm v[68:71],a[4:7],a[224:227],v[68:71]
mm v[68:71],a[36:39],a[240:243],v[68:71]
buffer_load_dwordx4 a[204:207], v31, s[16:19], s34 offen sc1
s_add_u32 s34, s34, 1024
mm v[100:103],a[4:7],a[228:231],v[100:103]
s_waitcnt vmcnt(37) lgkmcnt(0)
s_barrier
mm v[100:103],a[36:39],a[244:247],v[100:103]
mm a[68:71],a[4:7],a[232:235],a[68:71]
mm a[68:71],a[36:39],a[248:251],a[68:71]
mm a[100:103],a[4:7],a[236:239],a[100:103]
buffer_load_dwordx4 a[208:211], v28, s[16:19], s34 offen sc1
mm a[100:103],a[36:39],a[252:255],a[100:103]
rt a[0:1],v32,0
rt a[2:3],v32,4096
rt a[32:33],v32,8192
rt a[34:35],v32,12288
mm v[72:75],a[8:11],a[224:227],v[72:75]
mm v[72:75],a[40:43],a[240:243],v[72:75]
mm v[104:107],a[8:11],a[228:231],v[104:107]
mm v[104:107],a[40:43],a[244:247],v[104:107]
mm a[72:75],a[8:11],a[232:235],a[72:75]
buffer_load_dwordx4 a[212:215], v29, s[16:19], s34 offen sc1
mm a[72:75],a[40:43],a[248:251],a[72:75]
mm a[104:107],a[8:11],a[236:239],a[104:107]
buffer_load_dwordx4 a[216:219], v30, s[16:19], s34 offen sc1
mm a[104:107],a[40:43],a[252:255],a[104:107]
rt a[4:5],v33,0
rt a[6:7],v33,4096
rt a[36:37],v33,8192
rt a[38:39],v33,12288
mm v[76:79],a[12:15],a[224:227],v[76:79]
mm v[76:79],a[44:47],a[240:243],v[76:79]
mm v[108:111],a[12:15],a[228:231],v[108:111]
mm v[108:111],a[44:47],a[244:247],v[108:111]
buffer_load_dwordx4 a[220:223], v31, s[16:19], s34 offen sc1
mm a[76:79],a[12:15],a[232:235],a[76:79]
mm a[76:79],a[44:47],a[248:251],a[76:79]
rt a[8:9],v34,0
mm a[108:111],a[12:15],a[236:239],a[108:111]
s_add_u32 s34, s34, 1024
mm a[108:111],a[44:47],a[252:255],a[108:111]
rt a[10:11],v34,4096
rt a[40:41],v34,8192
rt a[42:43],v34,12288
mm v[80:83],a[16:19],a[224:227],v[80:83]
mm v[80:83],a[48:51],a[240:243],v[80:83]
mm v[112:115],a[16:19],a[228:231],v[112:115]
s_add_u32 m0, s36, 49152
mm v[112:115],a[48:51],a[244:247],v[112:115]
buffer_load_dwordx4 v6, s[12:15], s35 offen offset:0 lds
mm a[80:83],a[16:19],a[232:235],a[80:83]
mm a[80:83],a[48:51],a[248:251],a[80:83]
buffer_load_dwordx4 v7, s[12:15], s35 offen offset:1024 lds
mm a[112:115],a[16:19],a[236:239],a[112:115]
rt a[12:13],v35,0
mm a[112:115],a[48:51],a[252:255],a[112:115]
rt a[14:15],v35,4096
rt a[44:45],v35,8192
rt a[46:47],v35,12288
mm v[84:87],a[20:23],a[224:227],v[84:87]
mm v[84:87],a[52:55],a[240:243],v[84:87]
mm v[116:119],a[20:23],a[228:231],v[116:119]
buffer_load_dwordx4 v8, s[12:15], s35 offen offset:2048 lds
mm v[116:119],a[52:55],a[244:247],v[116:119]
mm a[84:87],a[20:23],a[232:235],a[84:87]
buffer_load_dwordx4 v9, s[12:15], s35 offen offset:3072 lds
mm a[84:87],a[52:55],a[248:251],a[84:87]
mm a[116:119],a[20:23],a[236:239],a[116:119]
rt a[16:17],v36,0
mm a[116:119],a[52:55],a[252:255],a[116:119]
rt a[18:19],v36,4096
rt a[48:49],v36,8192
rt a[50:51],v36,12288
mm v[88:91],a[24:27],a[224:227],v[88:91]
mm v[88:91],a[56:59],a[240:243],v[88:91]
mm v[120:123],a[24:27],a[228:231],v[120:123]
s_add_u32 s35, s35, 524288
mm v[120:123],a[56:59],a[244:247],v[120:123]
buffer_store_dwordx4 v[164:167], v1, s[20:23], s37 offen offset:1024 sc1
mm a[88:91],a[24:27],a[232:235],a[88:91]
rt a[20:21],v37,0
mm a[88:91],a[56:59],a[248:251],a[88:91]
rt a[22:23],v37,4096
mm a[120:123],a[24:27],a[236:239],a[120:123]
buffer_store_dwordx4 v[168:171], v1, s[20:23], s37 offen offset:2048 sc1
mm a[120:123],a[56:59],a[252:255],a[120:123]
rt a[52:53],v37,8192
rt a[54:55],v37,12288
mm v[92:95],a[28:31],a[224:227],v[92:95]
mm v[92:95],a[60:63],a[240:243],v[92:95]
mm v[124:127],a[28:31],a[228:231],v[124:127]
buffer_store_dwordx4 v[172:175], v1, s[20:23], s37 offen offset:3072 sc1
mm v[124:127],a[60:63],a[244:247],v[124:127]
mm a[92:95],a[28:31],a[232:235],a[92:95]
rt a[24:25],v38,0
mm a[92:95],a[60:63],a[248:251],a[92:95]
rt a[26:27],v38,4096
mm a[124:127],a[28:31],a[236:239],a[124:127]
s_add_u32 s37, s37, 4096
mm a[124:127],a[60:63],a[252:255],a[124:127]
rt a[56:57],v38,8192
rt a[58:59],v38,12288
s_waitcnt vmcnt(37) lgkmcnt(8)
mm v[64:67],a[0:3],a[128:131],v[64:67]
buffer_load_dwordx4 a[224:227], v28, s[16:19], s34 offen sc1
mm v[64:67],a[32:35],a[144:147],v[64:67]
mm v[96:99],a[0:3],a[132:135],v[96:99]
buffer_load_dwordx4 a[228:231], v29, s[16:19], s34 offen sc1
mm v[96:99],a[32:35],a[148:151],v[96:99]
mm a[64:67],a[0:3],a[136:139],a[64:67]
buffer_load_dwordx4 a[232:235], v30, s[16:19], s34 offen sc1
mm a[64:67],a[32:35],a[152:155],a[64:67]
rt a[28:29],v39,0
rt a[30:31],v39,4096
rt a[60:61],v39,8192
rt a[62:63],v39,12288
mm a[96:99],a[0:3],a[140:143],a[96:99]
mm a[96:99],a[32:35],a[156:159],a[96:99]
mm v[68:71],a[4:7],a[128:131],v[68:71]
mm v[68:71],a[36:39],a[144:147],v[68:71]
buffer_load_dwordx4 a[236:239], v31, s[16:19], s34 offen sc1
s_add_u32 s34, s34, 1024
mm v[100:103],a[4:7],a[132:135],v[100:103]
s_waitcnt vmcnt(37) lgkmcnt(0)
s_barrier
mm v[100:103],a[36:39],a[148:151],v[100:103]
mm a[68:71],a[4:7],a[136:139],a[68:71]
mm a[68:71],a[36:39],a[152:155],a[68:71]
mm a[100:103],a[4:7],a[140:143],a[100:103]
mm a[100:103],a[36:39],a[156:159],a[100:103]
rt a[0:1],v32,16384
rt a[2:3],v32,20480
rt a[32:33],v32,24576
rt a[34:35],v32,28672
mm v[72:75],a[8:11],a[128:131],v[72:75]
mm v[72:75],a[40:43],a[144:147],v[72:75]
mm v[104:107],a[8:11],a[132:135],v[104:107]
buffer_load_dwordx4 a[240:243], v28, s[16:19], s34 offen sc1
mm v[104:107],a[40:43],a[148:151],v[104:107]
mm a[72:75],a[8:11],a[136:139],a[72:75]
buffer_load_dwordx4 a[244:247], v29, s[16:19], s34 offen sc1
mm a[72:75],a[40:43],a[152:155],a[72:75]
mm a[104:107],a[8:11],a[140:143],a[104:107]
buffer_load_dwordx4 a[248:251], v30, s[16:19], s34 offen sc1
mm a[104:107],a[40:43],a[156:159],a[104:107]
rt a[4:5],v33,16384
rt a[6:7],v33,20480
rt a[36:37],v33,24576
rt a[38:39],v33,28672
mm v[76:79],a[12:15],a[128:131],v[76:79]
mm v[76:79],a[44:47],a[144:147],v[76:79]
mm v[108:111],a[12:15],a[132:135],v[108:111]
mm v[108:111],a[44:47],a[148:151],v[108:111]
mm a[76:79],a[12:15],a[136:139],a[76:79]
buffer_load_dwordx4 a[252:255], v31, s[16:19], s34 offen sc1
mm a[76:79],a[44:47],a[152:155],a[76:79]
mm a[108:111],a[12:15],a[140:143],a[108:111]
rt a[8:9],v34,16384
mm a[108:111],a[44:47],a[156:159],a[108:111]
rt a[10:11],v34,20480
rt a[40:41],v34,24576
rt a[42:43],v34,28672
mm v[80:83],a[16:19],a[128:131],v[80:83]
mm v[80:83],a[48:51],a[144:147],v[80:83]
s_add_u32 s34, s34, 1024
mm v[112:115],a[16:19],a[132:135],v[112:115]
s_add_u32 m0, s36, 0
mm v[112:115],a[48:51],a[148:151],v[112:115]
buffer_load_dwordx4 v6, s[12:15], s35 offen offset:0 lds
mm a[80:83],a[16:19],a[136:139],a[80:83]
mm a[80:83],a[48:51],a[152:155],a[80:83]
rt a[12:13],v35,16384
mm a[112:115],a[16:19],a[140:143],a[112:115]
buffer_load_dwordx4 v7, s[12:15], s35 offen offset:1024 lds
mm a[112:115],a[48:51],a[156:159],a[112:115]
rt a[14:15],v35,20480
rt a[44:45],v35,24576
rt a[46:47],v35,28672
mm v[84:87],a[20:23],a[128:131],v[84:87]
mm v[84:87],a[52:55],a[144:147],v[84:87]
mm v[116:119],a[20:23],a[132:135],v[116:119]
mm v[116:119],a[52:55],a[148:151],v[116:119]
buffer_load_dwordx4 v8, s[12:15], s35 offen offset:2048 lds
mm a[84:87],a[20:23],a[136:139],a[84:87]
mm a[84:87],a[52:55],a[152:155],a[84:87]
rt a[16:17],v36,16384
mm a[116:119],a[20:23],a[140:143],a[116:119]
buffer_load_dwordx4 v9, s[12:15], s35 offen offset:3072 lds
mm a[116:119],a[52:55],a[156:159],a[116:119]
rt a[18:19],v36,20480
rt a[48:49],v36,24576
rt a[50:51],v36,28672
mm v[88:91],a[24:27],a[128:131],v[88:91]
mm v[88:91],a[56:59],a[144:147],v[88:91]
mm v[120:123],a[24:27],a[132:135],v[120:123]
rt a[20:21],v37,16384
mm v[120:123],a[56:59],a[148:151],v[120:123]
s_add_u32 s35, s35, 524288
mm a[88:91],a[24:27],a[136:139],a[88:91]
rt a[22:23],v37,20480
mm a[88:91],a[56:59],a[152:155],a[88:91]
rt a[52:53],v37,24576
mm a[120:123],a[24:27],a[140:143],a[120:123]
buffer_store_dwordx4 v[176:179], v1, s[20:23], s37 offen offset:0 sc1
mm a[120:123],a[56:59],a[156:159],a[120:123]
rt a[54:55],v37,28672
mm v[92:95],a[28:31],a[128:131],v[92:95]
mm v[92:95],a[60:63],a[144:147],v[92:95]
rt a[24:25],v38,16384
mm v[124:127],a[28:31],a[132:135],v[124:127]
buffer_store_dwordx4 v[180:183], v1, s[20:23], s37 offen offset:1024 sc1
mm v[124:127],a[60:63],a[148:151],v[124:127]
mm a[92:95],a[28:31],a[136:139],a[92:95]
rt a[26:27],v38,20480
mm a[92:95],a[60:63],a[152:155],a[92:95]
rt a[56:57],v38,24576
mm a[124:127],a[28:31],a[140:143],a[124:127]
buffer_store_dwordx4 v[184:187], v1, s[20:23], s37 offen offset:2048 sc1
mm a[124:127],a[60:63],a[156:159],a[124:127]
rt a[58:59],v38,28672
s_waitcnt vmcnt(37) lgkmcnt(8)
mm v[64:67],a[0:3],a[160:163],v[64:67]
buffer_load_dwordx4 a[128:131], v28, s[16:19], s34 offen sc1
mm v[64:67],a[32:35],a[176:179],v[64:67]
mm v[96:99],a[0:3],a[164:167],v[96:99]
buffer_load_dwordx4 a[132:135], v29, s[16:19], s34 offen sc1
mm v[96:99],a[32:35],a[180:183],v[96:99]
mm a[64:67],a[0:3],a[168:171],a[64:67]
buffer_load_dwordx4 a[136:139], v30, s[16:19], s34 offen sc1
mm a[64:67],a[32:35],a[184:187],a[64:67]
rt a[28:29],v39,16384
rt a[30:31],v39,20480
rt a[60:61],v39,24576
rt a[62:63],v39,28672
mm a[96:99],a[0:3],a[172:175],a[96:99]
mm a[96:99],a[32:35],a[188:191],a[96:99]
mm v[68:71],a[4:7],a[160:163],v[68:71]
mm v[68:71],a[36:39],a[176:179],v[68:71]
buffer_load_dwordx4 a[140:143], v31, s[16:19], s34 offen sc1
s_add_u32 s34, s34, 1024
mm v[100:103],a[4:7],a[164:167],v[100:103]
s_waitcnt vmcnt(37) lgkmcnt(0)
s_barrier
mm v[100:103],a[36:39],a[180:183],v[100:103]
mm a[68:71],a[4:7],a[168:171],a[68:71]
mm a[68:71],a[36:39],a[184:187],a[68:71]
mm a[100:103],a[4:7],a[172:175],a[100:103]
buffer_load_dwordx4 a[144:147], v28, s[16:19], s34 offen sc1
mm a[100:103],a[36:39],a[188:191],a[100:103]
rt a[0:1],v32,32768
rt a[2:3],v32,36864
rt a[32:33],v32,40960
rt a[34:35],v32,45056
mm v[72:75],a[8:11],a[160:163],v[72:75]
mm v[72:75],a[40:43],a[176:179],v[72:75]
mm v[104:107],a[8:11],a[164:167],v[104:107]
mm v[104:107],a[40:43],a[180:183],v[104:107]
mm a[72:75],a[8:11],a[168:171],a[72:75]
buffer_load_dwordx4 a[148:151], v29, s[16:19], s34 offen sc1
mm a[72:75],a[40:43],a[184:187],a[72:75]
mm a[104:107],a[8:11],a[172:175],a[104:107]
buffer_load_dwordx4 a[152:155], v30, s[16:19], s34 offen sc1
mm a[104:107],a[40:43],a[188:191],a[104:107]
rt a[4:5],v33,32768
rt a[6:7],v33,36864
rt a[36:37],v33,40960
rt a[38:39],v33,45056
mm v[76:79],a[12:15],a[160:163],v[76:79]
mm v[76:79],a[44:47],a[176:179],v[76:79]
mm v[108:111],a[12:15],a[164:167],v[108:111]
mm v[108:111],a[44:47],a[180:183],v[108:111]
buffer_load_dwordx4 a[156:159], v31, s[16:19], s34 offen sc1
mm a[76:79],a[12:15],a[168:171],a[76:79]
mm a[76:79],a[44:47],a[184:187],a[76:79]
rt a[8:9],v34,32768
mm a[108:111],a[12:15],a[172:175],a[108:111]
s_add_u32 s34, s34, 1024
mm a[108:111],a[44:47],a[188:191],a[108:111]
rt a[10:11],v34,36864
rt a[40:41],v34,40960
rt a[42:43],v34,45056
mm v[80:83],a[16:19],a[160:163],v[80:83]
mm v[80:83],a[48:51],a[176:179],v[80:83]
mm v[112:115],a[16:19],a[164:167],v[112:115]
s_add_u32 m0, s36, 16384
mm v[112:115],a[48:51],a[180:183],v[112:115]
buffer_load_dwordx4 v6, s[12:15], s35 offen offset:0 lds
mm a[80:83],a[16:19],a[168:171],a[80:83]
mm a[80:83],a[48:51],a[184:187],a[80:83]
buffer_load_dwordx4 v7, s[12:15], s35 offen offset:1024 lds
mm a[112:115],a[16:19],a[172:175],a[112:115]
rt a[12:13],v35,32768
mm a[112:115],a[48:51],a[188:191],a[112:115]
rt a[14:15],v35,36864
rt a[44:45],v35,40960
rt a[46:47],v35,45056
mm v[84:87],a[20:23],a[160:163],v[84:87]
mm v[84:87],a[52:55],a[176:179],v[84:87]
mm v[116:119],a[20:23],a[164:167],v[116:119]
buffer_load_dwordx4 v8, s[12:15], s35 offen offset:2048 lds
mm v[116:119],a[52:55],a[180:183],v[116:119]
mm a[84:87],a[20:23],a[168:171],a[84:87]
buffer_load_dwordx4 v9, s[12:15], s35 offen offset:3072 lds
mm a[84:87],a[52:55],a[184:187],a[84:87]
mm a[116:119],a[20:23],a[172:175],a[116:119]
rt a[16:17],v36,32768
mm a[116:119],a[52:55],a[188:191],a[116:119]
rt a[18:19],v36,36864
rt a[48:49],v36,40960
rt a[50:51],v36,45056
mm v[88:91],a[24:27],a[160:163],v[88:91]
mm v[88:91],a[56:59],a[176:179],v[88:91]
mm v[120:123],a[24:27],a[164:167],v[120:123]
s_add_u32 s35, s35, 524288
mm v[120:123],a[56:59],a[180:183],v[120:123]
buffer_store_dwordx4 v[188:191], v1, s[20:23], s37 offen offset:3072 sc1
mm a[88:91],a[24:27],a[168:171],a[88:91]
rt a[20:21],v37,32768
mm a[88:91],a[56:59],a[184:187],a[88:91]
rt a[22:23],v37,36864
mm a[120:123],a[24:27],a[172:175],a[120:123]
rt a[52:53],v37,40960
mm a[120:123],a[56:59],a[188:191],a[120:123]
rt a[54:55],v37,45056
mm v[92:95],a[28:31],a[160:163],v[92:95]
s_add_u32 s37, s37, 4096
mm v[92:95],a[60:63],a[176:179],v[92:95]
rt a[24:25],v38,32768
mm v[124:127],a[28:31],a[164:167],v[124:127]
buffer_store_dwordx4 v[192:195], v1, s[20:23], s37 offen offset:0 sc1
mm v[124:127],a[60:63],a[180:183],v[124:127]
mm a[92:95],a[28:31],a[168:171],a[92:95]
rt a[26:27],v38,36864
mm a[92:95],a[60:63],a[184:187],a[92:95]
rt a[56:57],v38,40960
mm a[124:127],a[28:31],a[172:175],a[124:127]
buffer_store_dwordx4 v[196:199], v1, s[20:23], s37 offen offset:1024 sc1
mm a[124:127],a[60:63],a[188:191],a[124:127]
rt a[58:59],v38,45056
s_waitcnt vmcnt(37) lgkmcnt(8)
mm v[64:67],a[0:3],a[192:195],v[64:67]
buffer_load_dwordx4 a[160:163], v28, s[16:19], s34 offen sc1
mm v[64:67],a[32:35],a[208:211],v[64:67]
mm v[96:99],a[0:3],a[196:199],v[96:99]
buffer_load_dwordx4 a[164:167], v29, s[16:19], s34 offen sc1
mm v[96:99],a[32:35],a[212:215],v[96:99]
mm a[64:67],a[0:3],a[200:203],a[64:67]
buffer_load_dwordx4 a[168:171], v30, s[16:19], s34 offen sc1
mm a[64:67],a[32:35],a[216:219],a[64:67]
rt a[28:29],v39,32768
rt a[30:31],v39,36864
rt a[60:61],v39,40960
rt a[62:63],v39,45056
mm a[96:99],a[0:3],a[204:207],a[96:99]
mm a[96:99],a[32:35],a[220:223],a[96:99]
mm v[68:71],a[4:7],a[192:195],v[68:71]
mm v[68:71],a[36:39],a[208:211],v[68:71]
buffer_load_dwordx4 a[172:175], v31, s[16:19], s34 offen sc1
s_add_u32 s34, s34, 1024
mm v[100:103],a[4:7],a[196:199],v[100:103]
s_waitcnt vmcnt(37) lgkmcnt(0)
s_barrier
mm v[100:103],a[36:39],a[212:215],v[100:103]
mm a[68:71],a[4:7],a[200:203],a[68:71]
mm a[68:71],a[36:39],a[216:219],a[68:71]
mm a[100:103],a[4:7],a[204:207],a[100:103]
buffer_load_dwordx4 a[176:179], v28, s[16:19], s34 offen sc1
mm a[100:103],a[36:39],a[220:223],a[100:103]
rt a[0:1],v32,49152
rt a[2:3],v32,53248
rt a[32:33],v32,57344
rt a[34:35],v32,61440
mm v[72:75],a[8:11],a[192:195],v[72:75]
mm v[72:75],a[40:43],a[208:211],v[72:75]
mm v[104:107],a[8:11],a[196:199],v[104:107]
mm v[104:107],a[40:43],a[212:215],v[104:107]
mm a[72:75],a[8:11],a[200:203],a[72:75]
buffer_load_dwordx4 a[180:183], v29, s[16:19], s34 offen sc1
mm a[72:75],a[40:43],a[216:219],a[72:75]
mm a[104:107],a[8:11],a[204:207],a[104:107]
buffer_load_dwordx4 a[184:187], v30, s[16:19], s34 offen sc1
mm a[104:107],a[40:43],a[220:223],a[104:107]
rt a[4:5],v33,49152
rt a[6:7],v33,53248
rt a[36:37],v33,57344
rt a[38:39],v33,61440
mm v[76:79],a[12:15],a[192:195],v[76:79]
mm v[76:79],a[44:47],a[208:211],v[76:79]
mm v[108:111],a[12:15],a[196:199],v[108:111]
mm v[108:111],a[44:47],a[212:215],v[108:111]
buffer_load_dwordx4 a[188:191], v31, s[16:19], s34 offen sc1
mm a[76:79],a[12:15],a[200:203],a[76:79]
mm a[76:79],a[44:47],a[216:219],a[76:79]
rt a[8:9],v34,49152
mm a[108:111],a[12:15],a[204:207],a[108:111]
s_add_u32 s34, s34, 1024
mm a[108:111],a[44:47],a[220:223],a[108:111]
rt a[10:11],v34,53248
rt a[40:41],v34,57344
rt a[42:43],v34,61440
mm v[80:83],a[16:19],a[192:195],v[80:83]
mm v[80:83],a[48:51],a[208:211],v[80:83]
mm v[112:115],a[16:19],a[196:199],v[112:115]
s_add_u32 m0, s36, 32768
mm v[112:115],a[48:51],a[212:215],v[112:115]
buffer_load_dwordx4 v6, s[12:15], s35 offen offset:0 lds
mm a[80:83],a[16:19],a[200:203],a[80:83]
mm a[80:83],a[48:51],a[216:219],a[80:83]
buffer_load_dwordx4 v7, s[12:15], s35 offen offset:1024 lds
mm a[112:115],a[16:19],a[204:207],a[112:115]
rt a[12:13],v35,49152
mm a[112:115],a[48:51],a[220:223],a[112:115]
rt a[14:15],v35,53248
rt a[44:45],v35,57344
rt a[46:47],v35,61440
mm v[84:87],a[20:23],a[192:195],v[84:87]
mm v[84:87],a[52:55],a[208:211],v[84:87]
mm v[116:119],a[20:23],a[196:199],v[116:119]
buffer_load_dwordx4 v8, s[12:15], s35 offen offset:2048 lds
mm v[116:119],a[52:55],a[212:215],v[116:119]
mm a[84:87],a[20:23],a[200:203],a[84:87]
buffer_load_dwordx4 v9, s[12:15], s35 offen offset:3072 lds
mm a[84:87],a[52:55],a[216:219],a[84:87]
mm a[116:119],a[20:23],a[204:207],a[116:119]
rt a[16:17],v36,49152
mm a[116:119],a[52:55],a[220:223],a[116:119]
rt a[18:19],v36,53248
rt a[48:49],v36,57344
rt a[50:51],v36,61440
mm v[88:91],a[24:27],a[192:195],v[88:91]
mm v[88:91],a[56:59],a[208:211],v[88:91]
mm v[120:123],a[24:27],a[196:199],v[120:123]
s_add_u32 s35, s35, 524288
mm v[120:123],a[56:59],a[212:215],v[120:123]
buffer_store_dwordx4 v[200:203], v1, s[20:23], s37 offen offset:2048 sc1
mm a[88:91],a[24:27],a[200:203],a[88:91]
rt a[20:21],v37,49152
mm a[88:91],a[56:59],a[216:219],a[88:91]
rt a[22:23],v37,53248
mm a[120:123],a[24:27],a[204:207],a[120:123]
buffer_store_dwordx4 v[204:207], v1, s[20:23], s37 offen offset:3072 sc1
mm a[120:123],a[56:59],a[220:223],a[120:123]
rt a[52:53],v37,57344
rt a[54:55],v37,61440
mm v[92:95],a[28:31],a[192:195],v[92:95]
mm v[92:95],a[60:63],a[208:211],v[92:95]
mm v[124:127],a[28:31],a[196:199],v[124:127]
rt a[24:25],v38,49152
mm v[124:127],a[60:63],a[212:215],v[124:127]
s_add_u32 s37, s37, 4096
mm a[92:95],a[28:31],a[200:203],a[92:95]
rt a[26:27],v38,53248
mm a[92:95],a[60:63],a[216:219],a[92:95]
rt a[56:57],v38,57344
mm a[124:127],a[28:31],a[204:207],a[124:127]
buffer_store_dwordx4 v[208:211], v1, s[20:23], s37 offen offset:0 sc1
mm a[124:127],a[60:63],a[220:223],a[124:127]
rt a[58:59],v38,61440
s_waitcnt vmcnt(37) lgkmcnt(8)
mm v[64:67],a[0:3],a[224:227],v[64:67]
buffer_load_dwordx4 a[192:195], v28, s[16:19], s34 offen sc1
mm v[64:67],a[32:35],a[240:243],v[64:67]
mm v[96:99],a[0:3],a[228:231],v[96:99]
buffer_load_dwordx4 a[196:199], v29, s[16:19], s34 offen sc1
mm v[96:99],a[32:35],a[244:247],v[96:99]
mm a[64:67],a[0:3],a[232:235],a[64:67]
buffer_load_dwordx4 a[200:203], v30, s[16:19], s34 offen sc1
mm a[64:67],a[32:35],a[248:251],a[64:67]
rt a[28:29],v39,49152
rt a[30:31],v39,53248
rt a[60:61],v39,57344
rt a[62:63],v39,61440
mm a[96:99],a[0:3],a[236:239],a[96:99]
mm a[96:99],a[32:35],a[252:255],a[96:99]
mm v[68:71],a[4:7],a[224:227],v[68:71]
mm v[68:71],a[36:39],a[240:243],v[68:71]
buffer_load_dwordx4 a[204:207], v31, s[16:19], s34 offen sc1
s_add_u32 s34, s34, 1024
mm v[100:103],a[4:7],a[228:231],v[100:103]
s_waitcnt vmcnt(37) lgkmcnt(0)
s_barrier
mm v[100:103],a[36:39],a[244:247],v[100:103]
mm a[68:71],a[4:7],a[232:235],a[68:71]
mm a[68:71],a[36:39],a[248:251],a[68:71]
mm a[100:103],a[4:7],a[236:239],a[100:103]
buffer_load_dwordx4 a[208:211], v28, s[16:19], s34 offen sc1
mm a[100:103],a[36:39],a[252:255],a[100:103]
rt a[0:1],v32,0
rt a[2:3],v32,4096
rt a[32:33],v32,8192
rt a[34:35],v32,12288
mm v[72:75],a[8:11],a[224:227],v[72:75]
mm v[72:75],a[40:43],a[240:243],v[72:75]
mm v[104:107],a[8:11],a[228:231],v[104:107]
mm v[104:107],a[40:43],a[244:247],v[104:107]
mm a[72:75],a[8:11],a[232:235],a[72:75]
buffer_load_dwordx4 a[212:215], v29, s[16:19], s34 offen sc1
mm a[72:75],a[40:43],a[248:251],a[72:75]
mm a[104:107],a[8:11],a[236:239],a[104:107]
buffer_load_dwordx4 a[216:219], v30, s[16:19], s34 offen sc1
mm a[104:107],a[40:43],a[252:255],a[104:107]
rt a[4:5],v33,0
rt a[6:7],v33,4096
rt a[36:37],v33,8192
rt a[38:39],v33,12288
mm v[76:79],a[12:15],a[224:227],v[76:79]
mm v[76:79],a[44:47],a[240:243],v[76:79]
mm v[108:111],a[12:15],a[228:231],v[108:111]
mm v[108:111],a[44:47],a[244:247],v[108:111]
buffer_load_dwordx4 a[220:223], v31, s[16:19], s34 offen sc1
mm a[76:79],a[12:15],a[232:235],a[76:79]
mm a[76:79],a[44:47],a[248:251],a[76:79]
rt a[8:9],v34,0
mm a[108:111],a[12:15],a[236:239],a[108:111]
s_add_u32 s34, s34, 1024
mm a[108:111],a[44:47],a[252:255],a[108:111]
rt a[10:11],v34,4096
rt a[40:41],v34,8192
rt a[42:43],v34,12288
mm v[80:83],a[16:19],a[224:227],v[80:83]
mm v[80:83],a[48:51],a[240:243],v[80:83]
mm v[112:115],a[16:19],a[228:231],v[112:115]
s_add_u32 m0, s36, 49152
mm v[112:115],a[48:51],a[244:247],v[112:115]
buffer_load_dwordx4 v6, s[12:15], s35 offen offset:0 lds
mm a[80:83],a[16:19],a[232:235],a[80:83]
mm a[80:83],a[48:51],a[248:251],a[80:83]
buffer_load_dwordx4 v7, s[12:15], s35 offen offset:1024 lds
mm a[112:115],a[16:19],a[236:239],a[112:115]
rt a[12:13],v35,0
mm a[112:115],a[48:51],a[252:255],a[112:115]
rt a[14:15],v35,4096
rt a[44:45],v35,8192
rt a[46:47],v35,12288
mm v[84:87],a[20:23],a[224:227],v[84:87]
mm v[84:87],a[52:55],a[240:243],v[84:87]
mm v[116:119],a[20:23],a[228:231],v[116:119]
buffer_load_dwordx4 v8, s[12:15], s35 offen offset:2048 lds
mm v[116:119],a[52:55],a[244:247],v[116:119]
mm a[84:87],a[20:23],a[232:235],a[84:87]
buffer_load_dwordx4 v9, s[12:15], s35 offen offset:3072 lds
mm a[84:87],a[52:55],a[248:251],a[84:87]
mm a[116:119],a[20:23],a[236:239],a[116:119]
rt a[16:17],v36,0
mm a[116:119],a[52:55],a[252:255],a[116:119]
rt a[18:19],v36,4096
rt a[48:49],v36,8192
rt a[50:51],v36,12288
mm v[88:91],a[24:27],a[224:227],v[88:91]
mm v[88:91],a[56:59],a[240:243],v[88:91]
mm v[120:123],a[24:27],a[228:231],v[120:123]
s_add_u32 s35, s35, 524288
mm v[120:123],a[56:59],a[244:247],v[120:123]
buffer_store_dwordx4 v[212:215], v1, s[20:23], s37 offen offset:1024 sc1
mm a[88:91],a[24:27],a[232:235],a[88:91]
rt a[20:21],v37,0
mm a[88:91],a[56:59],a[248:251],a[88:91]
rt a[22:23],v37,4096
mm a[120:123],a[24:27],a[236:239],a[120:123]
buffer_store_dwordx4 v[216:219], v1, s[20:23], s37 offen offset:2048 sc1
mm a[120:123],a[56:59],a[252:255],a[120:123]
rt a[52:53],v37,8192
rt a[54:55],v37,12288
mm v[92:95],a[28:31],a[224:227],v[92:95]
mm v[92:95],a[60:63],a[240:243],v[92:95]
mm v[124:127],a[28:31],a[228:231],v[124:127]
buffer_store_dwordx4 v[220:223], v1, s[20:23], s37 offen offset:3072 sc1
mm v[124:127],a[60:63],a[244:247],v[124:127]
mm a[92:95],a[28:31],a[232:235],a[92:95]
rt a[24:25],v38,0
mm a[92:95],a[60:63],a[248:251],a[92:95]
rt a[26:27],v38,4096
mm a[124:127],a[28:31],a[236:239],a[124:127]
s_add_u32 s37, s37, 4096
mm a[124:127],a[60:63],a[252:255],a[124:127]
rt a[56:57],v38,8192
rt a[58:59],v38,12288
s_waitcnt vmcnt(37) lgkmcnt(8)
mm v[64:67],a[0:3],a[128:131],v[64:67]
buffer_load_dwordx4 a[224:227], v28, s[16:19], s34 offen sc1
mm v[64:67],a[32:35],a[144:147],v[64:67]
mm v[96:99],a[0:3],a[132:135],v[96:99]
buffer_load_dwordx4 a[228:231], v29, s[16:19], s34 offen sc1
mm v[96:99],a[32:35],a[148:151],v[96:99]
mm a[64:67],a[0:3],a[136:139],a[64:67]
buffer_load_dwordx4 a[232:235], v30, s[16:19], s34 offen sc1
mm a[64:67],a[32:35],a[152:155],a[64:67]
rt a[28:29],v39,0
rt a[30:31],v39,4096
rt a[60:61],v39,8192
rt a[62:63],v39,12288
mm a[96:99],a[0:3],a[140:143],a[96:99]
mm a[96:99],a[32:35],a[156:159],a[96:99]
mm v[68:71],a[4:7],a[128:131],v[68:71]
mm v[68:71],a[36:39],a[144:147],v[68:71]
buffer_load_dwordx4 a[236:239], v31, s[16:19], s34 offen sc1
s_add_u32 s34, s34, 1024
mm v[100:103],a[4:7],a[132:135],v[100:103]
s_waitcnt vmcnt(37) lgkmcnt(0)
s_barrier
mm v[100:103],a[36:39],a[148:151],v[100:103]
mm a[68:71],a[4:7],a[136:139],a[68:71]
mm a[68:71],a[36:39],a[152:155],a[68:71]
mm a[100:103],a[4:7],a[140:143],a[100:103]
mm a[100:103],a[36:39],a[156:159],a[100:103]
rt a[0:1],v32,16384
rt a[2:3],v32,20480
rt a[32:33],v32,24576
rt a[34:35],v32,28672
mm v[72:75],a[8:11],a[128:131],v[72:75]
mm v[72:75],a[40:43],a[144:147],v[72:75]
mm v[104:107],a[8:11],a[132:135],v[104:107]
buffer_load_dwordx4 a[240:243], v28, s[16:19], s34 offen sc1
mm v[104:107],a[40:43],a[148:151],v[104:107]
mm a[72:75],a[8:11],a[136:139],a[72:75]
buffer_load_dwordx4 a[244:247], v29, s[16:19], s34 offen sc1
mm a[72:75],a[40:43],a[152:155],a[72:75]
mm a[104:107],a[8:11],a[140:143],a[104:107]
buffer_load_dwordx4 a[248:251], v30, s[16:19], s34 offen sc1
mm a[104:107],a[40:43],a[156:159],a[104:107]
rt a[4:5],v33,16384
rt a[6:7],v33,20480
rt a[36:37],v33,24576
rt a[38:39],v33,28672
mm v[76:79],a[12:15],a[128:131],v[76:79]
mm v[76:79],a[44:47],a[144:147],v[76:79]
mm v[108:111],a[12:15],a[132:135],v[108:111]
mm v[108:111],a[44:47],a[148:151],v[108:111]
mm a[76:79],a[12:15],a[136:139],a[76:79]
buffer_load_dwordx4 a[252:255], v31, s[16:19], s34 offen sc1
mm a[76:79],a[44:47],a[152:155],a[76:79]
mm a[108:111],a[12:15],a[140:143],a[108:111]
rt a[8:9],v34,16384
mm a[108:111],a[44:47],a[156:159],a[108:111]
rt a[10:11],v34,20480
rt a[40:41],v34,24576
rt a[42:43],v34,28672
mm v[80:83],a[16:19],a[128:131],v[80:83]
mm v[80:83],a[48:51],a[144:147],v[80:83]
s_add_u32 s34, s34, 1024
mm v[112:115],a[16:19],a[132:135],v[112:115]
s_add_u32 m0, s36, 0
mm v[112:115],a[48:51],a[148:151],v[112:115]
buffer_load_dwordx4 v6, s[12:15], s35 offen offset:0 lds
mm a[80:83],a[16:19],a[136:139],a[80:83]
mm a[80:83],a[48:51],a[152:155],a[80:83]
rt a[12:13],v35,16384
mm a[112:115],a[16:19],a[140:143],a[112:115]
buffer_load_dwordx4 v7, s[12:15], s35 offen offset:1024 lds
mm a[112:115],a[48:51],a[156:159],a[112:115]
rt a[14:15],v35,20480
rt a[44:45],v35,24576
rt a[46:47],v35,28672
mm v[84:87],a[20:23],a[128:131],v[84:87]
mm v[84:87],a[52:55],a[144:147],v[84:87]
mm v[116:119],a[20:23],a[132:135],v[116:119]
mm v[116:119],a[52:55],a[148:151],v[116:119]
buffer_load_dwordx4 v8, s[12:15], s35 offen offset:2048 lds
mm a[84:87],a[20:23],a[136:139],a[84:87]
mm a[84:87],a[52:55],a[152:155],a[84:87]
rt a[16:17],v36,16384
mm a[116:119],a[20:23],a[140:143],a[116:119]
buffer_load_dwordx4 v9, s[12:15], s35 offen offset:3072 lds
mm a[116:119],a[52:55],a[156:159],a[116:119]
rt a[18:19],v36,20480
rt a[48:49],v36,24576
rt a[50:51],v36,28672
mm v[88:91],a[24:27],a[128:131],v[88:91]
mm v[88:91],a[56:59],a[144:147],v[88:91]
mm v[120:123],a[24:27],a[132:135],v[120:123]
rt a[20:21],v37,16384
mm v[120:123],a[56:59],a[148:151],v[120:123]
s_add_u32 s35, s35, 524288
mm a[88:91],a[24:27],a[136:139],a[88:91]
rt a[22:23],v37,20480
mm a[88:91],a[56:59],a[152:155],a[88:91]
rt a[52:53],v37,24576
mm a[120:123],a[24:27],a[140:143],a[120:123]
buffer_store_dwordx4 v[224:227], v1, s[20:23], s37 offen offset:0 sc1
mm a[120:123],a[56:59],a[156:159],a[120:123]
rt a[54:55],v37,28672
mm v[92:95],a[28:31],a[128:131],v[92:95]
mm v[92:95],a[60:63],a[144:147],v[92:95]
rt a[24:25],v38,16384
mm v[124:127],a[28:31],a[132:135],v[124:127]
buffer_store_dwordx4 v[228:231], v1, s[20:23], s37 offen offset:1024 sc1
mm v[124:127],a[60:63],a[148:151],v[124:127]
mm a[92:95],a[28:31],a[136:139],a[92:95]
rt a[26:27],v38,20480
mm a[92:95],a[60:63],a[152:155],a[92:95]
rt a[56:57],v38,24576
mm a[124:127],a[28:31],a[140:143],a[124:127]
buffer_store_dwordx4 v[232:235], v1, s[20:23], s37 offen offset:2048 sc1
mm a[124:127],a[60:63],a[156:159],a[124:127]
rt a[58:59],v38,28672
s_waitcnt vmcnt(37) lgkmcnt(8)
mm v[64:67],a[0:3],a[160:163],v[64:67]
buffer_load_dwordx4 a[128:131], v28, s[16:19], s34 offen sc1
mm v[64:67],a[32:35],a[176:179],v[64:67]
mm v[96:99],a[0:3],a[164:167],v[96:99]
buffer_load_dwordx4 a[132:135], v29, s[16:19], s34 offen sc1
mm v[96:99],a[32:35],a[180:183],v[96:99]
mm a[64:67],a[0:3],a[168:171],a[64:67]
buffer_load_dwordx4 a[136:139], v30, s[16:19], s34 offen sc1
mm a[64:67],a[32:35],a[184:187],a[64:67]
rt a[28:29],v39,16384
rt a[30:31],v39,20480
rt a[60:61],v39,24576
rt a[62:63],v39,28672
mm a[96:99],a[0:3],a[172:175],a[96:99]
mm a[96:99],a[32:35],a[188:191],a[96:99]
mm v[68:71],a[4:7],a[160:163],v[68:71]
mm v[68:71],a[36:39],a[176:179],v[68:71]
buffer_load_dwordx4 a[140:143], v31, s[16:19], s34 offen sc1
s_add_u32 s34, s34, 1024
mm v[100:103],a[4:7],a[164:167],v[100:103]
s_waitcnt vmcnt(37) lgkmcnt(0)
s_barrier
mm v[100:103],a[36:39],a[180:183],v[100:103]
mm a[68:71],a[4:7],a[168:171],a[68:71]
mm a[68:71],a[36:39],a[184:187],a[68:71]
mm a[100:103],a[4:7],a[172:175],a[100:103]
buffer_load_dwordx4 a[144:147], v28, s[16:19], s34 offen sc1
mm a[100:103],a[36:39],a[188:191],a[100:103]
rt a[0:1],v32,32768
rt a[2:3],v32,36864
rt a[32:33],v32,40960
rt a[34:35],v32,45056
mm v[72:75],a[8:11],a[160:163],v[72:75]
mm v[72:75],a[40:43],a[176:179],v[72:75]
mm v[104:107],a[8:11],a[164:167],v[104:107]
mm v[104:107],a[40:43],a[180:183],v[104:107]
mm a[72:75],a[8:11],a[168:171],a[72:75]
buffer_load_dwordx4 a[148:151], v29, s[16:19], s34 offen sc1
mm a[72:75],a[40:43],a[184:187],a[72:75]
mm a[104:107],a[8:11],a[172:175],a[104:107]
buffer_load_dwordx4 a[152:155], v30, s[16:19], s34 offen sc1
mm a[104:107],a[40:43],a[188:191],a[104:107]
rt a[4:5],v33,32768
rt a[6:7],v33,36864
rt a[36:37],v33,40960
rt a[38:39],v33,45056
mm v[76:79],a[12:15],a[160:163],v[76:79]
mm v[76:79],a[44:47],a[176:179],v[76:79]
mm v[108:111],a[12:15],a[164:167],v[108:111]
mm v[108:111],a[44:47],a[180:183],v[108:111]
buffer_load_dwordx4 a[156:159], v31, s[16:19], s34 offen sc1
mm a[76:79],a[12:15],a[168:171],a[76:79]
mm a[76:79],a[44:47],a[184:187],a[76:79]
rt a[8:9],v34,32768
mm a[108:111],a[12:15],a[172:175],a[108:111]
s_add_u32 s34, s34, 1024
mm a[108:111],a[44:47],a[188:191],a[108:111]
rt a[10:11],v34,36864
rt a[40:41],v34,40960
rt a[42:43],v34,45056
mm v[80:83],a[16:19],a[160:163],v[80:83]
mm v[80:83],a[48:51],a[176:179],v[80:83]
mm v[112:115],a[16:19],a[164:167],v[112:115]
s_add_u32 m0, s36, 16384
mm v[112:115],a[48:51],a[180:183],v[112:115]
buffer_load_dwordx4 v6, s[12:15], s35 offen offset:0 lds
mm a[80:83],a[16:19],a[168:171],a[80:83]
mm a[80:83],a[48:51],a[184:187],a[80:83]
buffer_load_dwordx4 v7, s[12:15], s35 offen offset:1024 lds
mm a[112:115],a[16:19],a[172:175],a[112:115]
rt a[12:13],v35,32768
mm a[112:115],a[48:51],a[188:191],a[112:115]
rt a[14:15],v35,36864
rt a[44:45],v35,40960
rt a[46:47],v35,45056
mm v[84:87],a[20:23],a[160:163],v[84:87]
mm v[84:87],a[52:55],a[176:179],v[84:87]
mm v[116:119],a[20:23],a[164:167],v[116:119]
buffer_load_dwordx4 v8, s[12:15], s35 offen offset:2048 lds
mm v[116:119],a[52:55],a[180:183],v[116:119]
mm a[84:87],a[20:23],a[168:171],a[84:87]
buffer_load_dwordx4 v9, s[12:15], s35 offen offset:3072 lds
mm a[84:87],a[52:55],a[184:187],a[84:87]
mm a[116:119],a[20:23],a[172:175],a[116:119]
rt a[16:17],v36,32768
mm a[116:119],a[52:55],a[188:191],a[116:119]
rt a[18:19],v36,36864
rt a[48:49],v36,40960
rt a[50:51],v36,45056
mm v[88:91],a[24:27],a[160:163],v[88:91]
mm v[88:91],a[56:59],a[176:179],v[88:91]
mm v[120:123],a[24:27],a[164:167],v[120:123]
s_add_u32 s35, s35, 524288
mm v[120:123],a[56:59],a[180:183],v[120:123]
buffer_store_dwordx4 v[236:239], v1, s[20:23], s37 offen offset:3072 sc1
mm a[88:91],a[24:27],a[168:171],a[88:91]
rt a[20:21],v37,32768
mm a[88:91],a[56:59],a[184:187],a[88:91]
rt a[22:23],v37,36864
mm a[120:123],a[24:27],a[172:175],a[120:123]
rt a[52:53],v37,40960
mm a[120:123],a[56:59],a[188:191],a[120:123]
rt a[54:55],v37,45056
mm v[92:95],a[28:31],a[160:163],v[92:95]
s_add_u32 s37, s37, 4096
mm v[92:95],a[60:63],a[176:179],v[92:95]
rt a[24:25],v38,32768
mm v[124:127],a[28:31],a[164:167],v[124:127]
buffer_store_dwordx4 v[240:243], v1, s[20:23], s37 offen offset:0 sc1
mm v[124:127],a[60:63],a[180:183],v[124:127]
mm a[92:95],a[28:31],a[168:171],a[92:95]
rt a[26:27],v38,36864
mm a[92:95],a[60:63],a[184:187],a[92:95]
rt a[56:57],v38,40960
mm a[124:127],a[28:31],a[172:175],a[124:127]
buffer_store_dwordx4 v[244:247], v1, s[20:23], s37 offen offset:1024 sc1
mm a[124:127],a[60:63],a[188:191],a[124:127]
rt a[58:59],v38,45056
s_waitcnt vmcnt(37) lgkmcnt(8)
mm v[64:67],a[0:3],a[192:195],v[64:67]
buffer_load_dwordx4 a[160:163], v28, s[16:19], s34 offen sc1
mm v[64:67],a[32:35],a[208:211],v[64:67]
mm v[96:99],a[0:3],a[196:199],v[96:99]
buffer_load_dwordx4 a[164:167], v29, s[16:19], s34 offen sc1
mm v[96:99],a[32:35],a[212:215],v[96:99]
mm a[64:67],a[0:3],a[200:203],a[64:67]
buffer_load_dwordx4 a[168:171], v30, s[16:19], s34 offen sc1
mm a[64:67],a[32:35],a[216:219],a[64:67]
rt a[28:29],v39,32768
rt a[30:31],v39,36864
rt a[60:61],v39,40960
rt a[62:63],v39,45056
mm a[96:99],a[0:3],a[204:207],a[96:99]
mm a[96:99],a[32:35],a[220:223],a[96:99]
mm v[68:71],a[4:7],a[192:195],v[68:71]
mm v[68:71],a[36:39],a[208:211],v[68:71]
buffer_load_dwordx4 a[172:175], v31, s[16:19], s34 offen sc1
s_add_u32 s34, s34, 1024
mm v[100:103],a[4:7],a[196:199],v[100:103]
s_waitcnt vmcnt(37) lgkmcnt(0)
s_barrier
mm v[100:103],a[36:39],a[212:215],v[100:103]
mm a[68:71],a[4:7],a[200:203],a[68:71]
mm a[68:71],a[36:39],a[216:219],a[68:71]
mm a[100:103],a[4:7],a[204:207],a[100:103]
mm a[100:103],a[36:39],a[220:223],a[100:103]
rt a[0:1],v32,49152
rt a[2:3],v32,53248
rt a[32:33],v32,57344
rt a[34:35],v32,61440
mm v[72:75],a[8:11],a[192:195],v[72:75]
mm v[72:75],a[40:43],a[208:211],v[72:75]
mm v[104:107],a[8:11],a[196:199],v[104:107]
mm v[104:107],a[40:43],a[212:215],v[104:107]
buffer_load_dwordx4 a[176:179], v28, s[16:19], s34 offen sc1
mm a[72:75],a[8:11],a[200:203],a[72:75]
mm a[72:75],a[40:43],a[216:219],a[72:75]
buffer_load_dwordx4 a[180:183], v29, s[16:19], s34 offen sc1
mm a[104:107],a[8:11],a[204:207],a[104:107]
buffer_load_dwordx4 a[184:187], v30, s[16:19], s34 offen sc1
mm a[104:107],a[40:43],a[220:223],a[104:107]
rt a[4:5],v33,49152
rt a[6:7],v33,53248
rt a[36:37],v33,57344
rt a[38:39],v33,61440
mm v[76:79],a[12:15],a[192:195],v[76:79]
mm v[76:79],a[44:47],a[208:211],v[76:79]
mm v[108:111],a[12:15],a[196:199],v[108:111]
mm v[108:111],a[44:47],a[212:215],v[108:111]
mm a[76:79],a[12:15],a[200:203],a[76:79]
buffer_load_dwordx4 a[188:191], v31, s[16:19], s34 offen sc1
mm a[76:79],a[44:47],a[216:219],a[76:79]
mm a[108:111],a[12:15],a[204:207],a[108:111]
rt a[8:9],v34,49152
mm a[108:111],a[44:47],a[220:223],a[108:111]
rt a[10:11],v34,53248
rt a[40:41],v34,57344
rt a[42:43],v34,61440
mm v[80:83],a[16:19],a[192:195],v[80:83]
mm v[80:83],a[48:51],a[208:211],v[80:83]
mm v[112:115],a[16:19],a[196:199],v[112:115]
s_add_u32 s34, s34, 1024
mm v[112:115],a[48:51],a[212:215],v[112:115]
s_add_u32 m0, s36, 32768
mm a[80:83],a[16:19],a[200:203],a[80:83]
buffer_load_dwordx4 v6, s[12:15], s35 offen offset:0 lds
mm a[80:83],a[48:51],a[216:219],a[80:83]
mm a[112:115],a[16:19],a[204:207],a[112:115]
buffer_load_dwordx4 v7, s[12:15], s35 offen offset:1024 lds
mm a[112:115],a[48:51],a[220:223],a[112:115]
rt a[12:13],v35,49152
rt a[14:15],v35,53248
rt a[44:45],v35,57344
rt a[46:47],v35,61440
mm v[84:87],a[20:23],a[192:195],v[84:87]
mm v[84:87],a[52:55],a[208:211],v[84:87]
mm v[116:119],a[20:23],a[196:199],v[116:119]
mm v[116:119],a[52:55],a[212:215],v[116:119]
buffer_load_dwordx4 v8, s[12:15], s35 offen offset:2048 lds
mm a[84:87],a[20:23],a[200:203],a[84:87]
mm a[84:87],a[52:55],a[216:219],a[84:87]
rt a[16:17],v36,49152
mm a[116:119],a[20:23],a[204:207],a[116:119]
buffer_load_dwordx4 v9, s[12:15], s35 offen offset:3072 lds
mm a[116:119],a[52:55],a[220:223],a[116:119]
rt a[18:19],v36,53248
rt a[48:49],v36,57344
rt a[50:51],v36,61440
mm v[88:91],a[24:27],a[192:195],v[88:91]
mm v[88:91],a[56:59],a[208:211],v[88:91]
mm v[120:123],a[24:27],a[196:199],v[120:123]
mm v[120:123],a[56:59],a[212:215],v[120:123]
rt a[20:21],v37,49152
mm a[88:91],a[24:27],a[200:203],a[88:91]
s_add_u32 s35, s35, 524288
mm a[88:91],a[56:59],a[216:219],a[88:91]
rt a[22:23],v37,53248
mm a[120:123],a[24:27],a[204:207],a[120:123]
buffer_store_dwordx4 v[248:251], v1, s[20:23], s37 offen offset:2048 sc1
mm a[120:123],a[56:59],a[220:223],a[120:123]
rt a[52:53],v37,57344
rt a[54:55],v37,61440
mm v[92:95],a[28:31],a[192:195],v[92:95]
mm v[92:95],a[60:63],a[208:211],v[92:95]
mm v[124:127],a[28:31],a[196:199],v[124:127]
buffer_store_dwordx4 v[252:255], v1, s[20:23], s37 offen offset:3072 sc1
mm v[124:127],a[60:63],a[212:215],v[124:127]
mm a[92:95],a[28:31],a[200:203],a[92:95]
rt a[24:25],v38,49152
mm a[92:95],a[60:63],a[216:219],a[92:95]
rt a[26:27],v38,53248
mm a[124:127],a[28:31],a[204:207],a[124:127]
s_add_u32 s37, s37, 4096
mm a[124:127],a[60:63],a[220:223],a[124:127]
rt a[56:57],v38,57344
rt a[58:59],v38,61440
s_waitcnt vmcnt(36) lgkmcnt(8)
mm v[64:67],a[0:3],a[224:227],v[64:67]
mm v[64:67],a[32:35],a[240:243],v[64:67]
buffer_load_dwordx4 a[192:195], v28, s[16:19], s34 offen sc1
mm v[96:99],a[0:3],a[228:231],v[96:99]
mm v[96:99],a[32:35],a[244:247],v[96:99]
buffer_load_dwordx4 a[196:199], v29, s[16:19], s34 offen sc1
mm a[64:67],a[0:3],a[232:235],a[64:67]
mm a[64:67],a[32:35],a[248:251],a[64:67]
rt a[28:29],v39,49152
rt a[30:31],v39,53248
rt a[60:61],v39,57344
rt a[62:63],v39,61440
mm a[96:99],a[0:3],a[236:239],a[96:99]
mm a[96:99],a[32:35],a[252:255],a[96:99]
mm v[68:71],a[4:7],a[224:227],v[68:71]
mm v[68:71],a[36:39],a[240:243],v[68:71]
buffer_load_dwordx4 a[200:203], v30, s[16:19], s34 offen sc1
buffer_load_dwordx4 a[204:207], v31, s[16:19], s34 offen sc1
s_add_u32 s34, s34, 1024
mm v[100:103],a[4:7],a[228:231],v[100:103]
s_waitcnt vmcnt(36) lgkmcnt(0)
s_barrier
mm v[100:103],a[36:39],a[244:247],v[100:103]
mm a[68:71],a[4:7],a[232:235],a[68:71]
mm a[68:71],a[36:39],a[248:251],a[68:71]
mm a[100:103],a[4:7],a[236:239],a[100:103]
mm a[100:103],a[36:39],a[252:255],a[100:103]
rt a[0:1],v32,0
rt a[2:3],v32,4096
rt a[32:33],v32,8192
rt a[34:35],v32,12288
mm v[72:75],a[8:11],a[224:227],v[72:75]
mm v[72:75],a[40:43],a[240:243],v[72:75]
mm v[104:107],a[8:11],a[228:231],v[104:107]
mm v[104:107],a[40:43],a[244:247],v[104:107]
mm a[72:75],a[8:11],a[232:235],a[72:75]
buffer_load_dwordx4 a[208:211], v28, s[16:19], s34 offen sc1
mm a[72:75],a[40:43],a[248:251],a[72:75]
mm a[104:107],a[8:11],a[236:239],a[104:107]
buffer_load_dwordx4 a[212:215], v29, s[16:19], s34 offen sc1
mm a[104:107],a[40:43],a[252:255],a[104:107]
rt a[4:5],v33,0
rt a[6:7],v33,4096
rt a[36:37],v33,8192
rt a[38:39],v33,12288
mm v[76:79],a[12:15],a[224:227],v[76:79]
mm v[76:79],a[44:47],a[240:243],v[76:79]
mm v[108:111],a[12:15],a[228:231],v[108:111]
mm v[108:111],a[44:47],a[244:247],v[108:111]
mm a[76:79],a[12:15],a[232:235],a[76:79]
buffer_load_dwordx4 a[216:219], v30, s[16:19], s34 offen sc1
mm a[76:79],a[44:47],a[248:251],a[76:79]
mm a[108:111],a[12:15],a[236:239],a[108:111]
buffer_load_dwordx4 a[220:223], v31, s[16:19], s34 offen sc1
mm a[108:111],a[44:47],a[252:255],a[108:111]
rt a[8:9],v34,0
rt a[10:11],v34,4096
rt a[40:41],v34,8192
rt a[42:43],v34,12288
mm v[80:83],a[16:19],a[224:227],v[80:83]
mm v[80:83],a[48:51],a[240:243],v[80:83]
mm v[112:115],a[16:19],a[228:231],v[112:115]
mm v[112:115],a[48:51],a[244:247],v[112:115]
mm a[80:83],a[16:19],a[232:235],a[80:83]
mm a[80:83],a[48:51],a[248:251],a[80:83]
s_add_u32 s34, s34, 1024
mm a[112:115],a[16:19],a[236:239],a[112:115]
rt a[12:13],v35,0
mm a[112:115],a[48:51],a[252:255],a[112:115]
rt a[14:15],v35,4096
rt a[44:45],v35,8192
rt a[46:47],v35,12288
mm v[84:87],a[20:23],a[224:227],v[84:87]
mm v[84:87],a[52:55],a[240:243],v[84:87]
mm v[116:119],a[20:23],a[228:231],v[116:119]
s_add_u32 m0, s36, 49152
mm v[116:119],a[52:55],a[244:247],v[116:119]
buffer_load_dwordx4 v6, s[12:15], s35 offen offset:0 lds
mm a[84:87],a[20:23],a[232:235],a[84:87]
mm a[84:87],a[52:55],a[248:251],a[84:87]
rt a[16:17],v36,0
mm a[116:119],a[20:23],a[236:239],a[116:119]
buffer_load_dwordx4 v7, s[12:15], s35 offen offset:1024 lds
mm a[116:119],a[52:55],a[252:255],a[116:119]
rt a[18:19],v36,4096
rt a[48:49],v36,8192
rt a[50:51],v36,12288
mm v[88:91],a[24:27],a[224:227],v[88:91]
mm v[88:91],a[56:59],a[240:243],v[88:91]
mm v[120:123],a[24:27],a[228:231],v[120:123]
mm v[120:123],a[56:59],a[244:247],v[120:123]
buffer_load_dwordx4 v8, s[12:15], s35 offen offset:2048 lds
mm a[88:91],a[24:27],a[232:235],a[88:91]
mm a[88:91],a[56:59],a[248:251],a[88:91]
rt a[20:21],v37,0
mm a[120:123],a[24:27],a[236:239],a[120:123]
rt a[22:23],v37,4096
mm a[120:123],a[56:59],a[252:255],a[120:123]
rt a[52:53],v37,8192
rt a[54:55],v37,12288
mm v[92:95],a[28:31],a[224:227],v[92:95]
mm v[92:95],a[60:63],a[240:243],v[92:95]
buffer_load_dwordx4 v9, s[12:15], s35 offen offset:3072 lds
mm v[124:127],a[28:31],a[228:231],v[124:127]
mm v[124:127],a[60:63],a[244:247],v[124:127]
rt a[24:25],v38,0
mm a[92:95],a[28:31],a[232:235],a[92:95]
rt a[26:27],v38,4096
mm a[92:95],a[60:63],a[248:251],a[92:95]
rt a[56:57],v38,8192
mm a[124:127],a[28:31],a[236:239],a[124:127]
s_add_u32 s35, s35, 524288
mm a[124:127],a[60:63],a[252:255],a[124:127]
rt a[58:59],v38,12288
s_waitcnt vmcnt(33) lgkmcnt(8)
mm v[64:67],a[0:3],a[128:131],v[64:67]
mm v[64:67],a[32:35],a[144:147],v[64:67]
buffer_load_dwordx4 a[224:227], v28, s[16:19], s34 offen sc1
mm v[96:99],a[0:3],a[132:135],v[96:99]
mm v[96:99],a[32:35],a[148:151],v[96:99]
buffer_load_dwordx4 a[228:231], v29, s[16:19], s34 offen sc1
mm a[64:67],a[0:3],a[136:139],a[64:67]
mm a[64:67],a[32:35],a[152:155],a[64:67]
rt a[28:29],v39,0
rt a[30:31],v39,4096
rt a[60:61],v39,8192
rt a[62:63],v39,12288
mm a[96:99],a[0:3],a[140:143],a[96:99]
mm a[96:99],a[32:35],a[156:159],a[96:99]
mm v[68:71],a[4:7],a[128:131],v[68:71]
mm v[68:71],a[36:39],a[144:147],v[68:71]
buffer_load_dwordx4 a[232:235], v30, s[16:19], s34 offen sc1
buffer_load_dwordx4 a[236:239], v31, s[16:19], s34 offen sc1
s_add_u32 s34, s34, 1024
mm v[100:103],a[4:7],a[132:135],v[100:103]
s_waitcnt vmcnt(16) lgkmcnt(0)
s_barrier
s_lshl_b32 s4, s2, 7
s_cmp_lg_u32 s3, 0
s_cbranch_scc1 L_sg3
v_mov_b32 v40, 1
s_mov_b64 exec, 1
buffer_store_dword v40, off, s[28:31], s4 offset:0 sc1
s_mov_b64 exec, -1
L_sg3:
mm v[100:103],a[36:39],a[148:151],v[100:103]
mm a[68:71],a[4:7],a[136:139],a[68:71]
mm a[68:71],a[36:39],a[152:155],a[68:71]
mm a[100:103],a[4:7],a[140:143],a[100:103]
mm a[100:103],a[36:39],a[156:159],a[100:103]
rt a[0:1],v32,16384
rt a[2:3],v32,20480
rt a[32:33],v32,24576
rt a[34:35],v32,28672
mm v[72:75],a[8:11],a[128:131],v[72:75]
mm v[72:75],a[40:43],a[144:147],v[72:75]
mm v[104:107],a[8:11],a[132:135],v[104:107]
mm v[104:107],a[40:43],a[148:151],v[104:107]
mm a[72:75],a[8:11],a[136:139],a[72:75]
mm a[72:75],a[40:43],a[152:155],a[72:75]
mm a[104:107],a[8:11],a[140:143],a[104:107]
mm a[104:107],a[40:43],a[156:159],a[104:107]
rt a[4:5],v33,16384
rt a[6:7],v33,20480
rt a[36:37],v33,24576
rt a[38:39],v33,28672
mm v[76:79],a[12:15],a[128:131],v[76:79]
mm v[76:79],a[44:47],a[144:147],v[76:79]
mm v[108:111],a[12:15],a[132:135],v[108:111]
mm v[108:111],a[44:47],a[148:151],v[108:111]
mm a[76:79],a[12:15],a[136:139],a[76:79]
mm a[76:79],a[44:47],a[152:155],a[76:79]
mm a[108:111],a[12:15],a[140:143],a[108:111]
mm a[108:111],a[44:47],a[156:159],a[108:111]
rt a[8:9],v34,16384
rt a[10:11],v34,20480
rt a[40:41],v34,24576
rt a[42:43],v34,28672
mm v[80:83],a[16:19],a[128:131],v[80:83]
mm v[80:83],a[48:51],a[144:147],v[80:83]
mm v[112:115],a[16:19],a[132:135],v[112:115]
mm v[112:115],a[48:51],a[148:151],v[112:115]
mm a[80:83],a[16:19],a[136:139],a[80:83]
mm a[80:83],a[48:51],a[152:155],a[80:83]
mm a[112:115],a[16:19],a[140:143],a[112:115]
buffer_load_dwordx4 a[240:243], v28, s[16:19], s34 offen sc1
mm a[112:115],a[48:51],a[156:159],a[112:115]
rt a[12:13],v35,16384
rt a[14:15],v35,20480
rt a[44:45],v35,24576
rt a[46:47],v35,28672
mm v[84:87],a[20:23],a[128:131],v[84:87]
mm v[84:87],a[52:55],a[144:147],v[84:87]
mm v[116:119],a[20:23],a[132:135],v[116:119]
mm v[116:119],a[52:55],a[148:151],v[116:119]
mm a[84:87],a[20:23],a[136:139],a[84:87]
buffer_load_dwordx4 a[244:247], v29, s[16:19], s34 offen sc1
mm a[84:87],a[52:55],a[152:155],a[84:87]
mm a[116:119],a[20:23],a[140:143],a[116:119]
buffer_load_dwordx4 a[248:251], v30, s[16:19], s34 offen sc1
mm a[116:119],a[52:55],a[156:159],a[116:119]
rt a[16:17],v36,16384
rt a[18:19],v36,20480
rt a[48:49],v36,24576
rt a[50:51],v36,28672
mm v[88:91],a[24:27],a[128:131],v[88:91]
mm v[88:91],a[56:59],a[144:147],v[88:91]
mm v[120:123],a[24:27],a[132:135],v[120:123]
mm v[120:123],a[56:59],a[148:151],v[120:123]
mm a[88:91],a[24:27],a[136:139],a[88:91]
mm a[88:91],a[56:59],a[152:155],a[88:91]
buffer_load_dwordx4 a[252:255], v31, s[16:19], s34 offen sc1
mm a[120:123],a[24:27],a[140:143],a[120:123]
mm a[120:123],a[56:59],a[156:159],a[120:123]
rt a[20:21],v37,16384
rt a[22:23],v37,20480
rt a[52:53],v37,24576
rt a[54:55],v37,28672
mm v[92:95],a[28:31],a[128:131],v[92:95]
mm v[92:95],a[60:63],a[144:147],v[92:95]
mm v[124:127],a[28:31],a[132:135],v[124:127]
mm v[124:127],a[60:63],a[148:151],v[124:127]
rt a[24:25],v38,16384
mm a[92:95],a[28:31],a[136:139],a[92:95]
rt a[26:27],v38,20480
mm a[92:95],a[60:63],a[152:155],a[92:95]
rt a[56:57],v38,24576
mm a[124:127],a[28:31],a[140:143],a[124:127]
s_add_u32 s34, s34, 1024
mm a[124:127],a[60:63],a[156:159],a[124:127]
rt a[58:59],v38,28672
s_waitcnt vmcnt(26) lgkmcnt(8)
mm v[64:67],a[0:3],a[160:163],v[64:67]
rt a[28:29],v39,16384
mm v[64:67],a[32:35],a[176:179],v[64:67]
rt a[30:31],v39,20480
mm v[96:99],a[0:3],a[164:167],v[96:99]
mm v[96:99],a[32:35],a[180:183],v[96:99]
rt a[60:61],v39,24576
mm a[64:67],a[0:3],a[168:171],a[64:67]
mm a[64:67],a[32:35],a[184:187],a[64:67]
rt a[62:63],v39,28672
mm a[96:99],a[0:3],a[172:175],a[96:99]
mm a[96:99],a[32:35],a[188:191],a[96:99]
mm v[68:71],a[4:7],a[160:163],v[68:71]
mm v[68:71],a[36:39],a[176:179],v[68:71]
mm v[100:103],a[4:7],a[164:167],v[100:103]
s_waitcnt vmcnt(22) lgkmcnt(0)
s_barrier
mm v[100:103],a[36:39],a[180:183],v[100:103]
rt a[0:1],v32,32768
mm a[68:71],a[4:7],a[168:171],a[68:71]
s_lshl_b32 s4, s44, 14
v_add_u32 v2, s4, v1
rt a[2:3],v32,36864
mm a[68:71],a[36:39],a[184:187],a[68:71]
rt a[32:33],v32,40960
mm a[100:103],a[4:7],a[172:175],a[100:103]
mm a[100:103],a[36:39],a[188:191],a[100:103]
rt a[34:35],v32,45056
s_lshl_b32 s5, s44, 12
s_add_u32 s6, s5, 65536
v_add_u32 v3, s6, v2
mm v[72:75],a[8:11],a[160:163],v[72:75]
mm v[72:75],a[40:43],a[176:179],v[72:75]
rt a[4:5],v33,32768
mm v[104:107],a[8:11],a[164:167],v[104:107]
s_sub_u32 s6, 65536, s5
v_add_u32 v4, s6, v2
mm v[104:107],a[40:43],a[180:183],v[104:107]
rt a[6:7],v33,36864
mm a[72:75],a[8:11],a[168:171],a[72:75]
mm a[72:75],a[40:43],a[184:187],a[72:75]
s_lshl_b32 s49, s3, 13
v_add_u32 v5, s49, v1
rt a[36:37],v33,40960
mm a[104:107],a[8:11],a[172:175],a[104:107]
mm a[104:107],a[40:43],a[188:191],a[104:107]
rt a[38:39],v33,45056
mm v[76:79],a[12:15],a[160:163],v[76:79]
v_add_u32 v10, 4096, v5
mm v[76:79],a[44:47],a[176:179],v[76:79]
rt a[8:9],v34,32768
mm v[108:111],a[12:15],a[164:167],v[108:111]
mm v[108:111],a[44:47],a[180:183],v[108:111]
v_mov_b32 v11, 0xff800000
rt a[10:11],v34,36864
mm a[76:79],a[12:15],a[168:171],a[76:79]
mm a[76:79],a[44:47],a[184:187],a[76:79]
rt a[40:41],v34,40960
mm a[108:111],a[12:15],a[172:175],a[108:111]
s_sub_i32 s4, s41, s44
s_lshl_b32 s4, s4, 6
v_and_b32 v41, 15, v0
mm a[108:111],a[44:47],a[188:191],a[108:111]
rt a[42:43],v34,45056
mm v[80:83],a[16:19],a[160:163],v[80:83]
mm v[80:83],a[48:51],a[176:179],v[80:83]
v_lshlrev_b32 v42, 2, v44
rt a[12:13],v35,32768
mm v[112:115],a[16:19],a[164:167],v[112:115]
mm v[112:115],a[48:51],a[180:183],v[112:115]
rt a[14:15],v35,36864
mm a[80:83],a[16:19],a[168:171],a[80:83]
v_sub_u32 v42, v42, v41
mm a[80:83],a[48:51],a[184:187],a[80:83]
rt a[44:45],v35,40960
mm a[112:115],a[16:19],a[172:175],a[112:115]
mm a[112:115],a[48:51],a[188:191],a[112:115]
rt a[46:47],v35,45056
v_subrev_u32 v42, s4, v42
mm v[84:87],a[20:23],a[160:163],v[84:87]
mm v[84:87],a[52:55],a[176:179],v[84:87]
rt a[16:17],v36,32768
mm v[116:119],a[20:23],a[164:167],v[116:119]
v_cmp_ge_i32 s[54:55], 0, v42
mm v[116:119],a[52:55],a[180:183],v[116:119]
rt a[18:19],v36,36864
mm a[84:87],a[20:23],a[168:171],a[84:87]
mm a[84:87],a[52:55],a[184:187],a[84:87]
v_cmp_ge_i32 s[56:57], -1, v42
rt a[48:49],v36,40960
mm a[116:119],a[20:23],a[172:175],a[116:119]
mm a[116:119],a[52:55],a[188:191],a[116:119]
rt a[50:51],v36,45056
mm v[88:91],a[24:27],a[160:163],v[88:91]
v_cmp_ge_i32 s[58:59], -2, v42
mm v[88:91],a[56:59],a[176:179],v[88:91]
rt a[20:21],v37,32768
mm v[120:123],a[24:27],a[164:167],v[120:123]
mm v[120:123],a[56:59],a[180:183],v[120:123]
v_cmp_ge_i32 s[60:61], -3, v42
rt a[22:23],v37,36864
mm a[88:91],a[24:27],a[168:171],a[88:91]
mm a[88:91],a[56:59],a[184:187],a[88:91]
rt a[52:53],v37,40960
mm a[120:123],a[24:27],a[172:175],a[120:123]
v_cmp_ge_i32 s[52:53], 16, v42
mm a[120:123],a[56:59],a[188:191],a[120:123]
rt a[54:55],v37,45056
mm v[92:95],a[28:31],a[160:163],v[92:95]
mm v[92:95],a[60:63],a[176:179],v[92:95]
v_cmp_gt_i32 s[62:63], -16, v42
rt a[24:25],v38,32768
mm v[124:127],a[28:31],a[164:167],v[124:127]
mm v[124:127],a[60:63],a[180:183],v[124:127]
rt a[26:27],v38,36864
mm a[92:95],a[28:31],a[168:171],a[92:95]
s_lshl_b32 s4, s32, 19
s_add_u32 s5, s4, 8388608
s_add_u32 s8, s86, s5
s_addc_u32 s9, s87, 0
s_and_b32 s9, s9, 0xffff
s_mov_b32 s10, 524288
s_mov_b32 s11, 0x20000
s_mov_b32 s47, 0
mm a[92:95],a[60:63],a[184:187],a[92:95]
mm a[124:127],a[28:31],a[172:175],a[124:127]
mm a[124:127],a[60:63],a[188:191],a[124:127]
rt a[56:57],v38,40960
rt a[58:59],v38,45056
s_waitcnt vmcnt(12) lgkmcnt(8)
mm v[64:67],a[0:3],a[192:195],v[64:67]
mm v[64:67],a[32:35],a[208:211],v[64:67]
rt a[28:29],v39,32768
mm v[96:99],a[0:3],a[196:199],v[96:99]
mm v[96:99],a[32:35],a[212:215],v[96:99]
rt a[30:31],v39,36864
mm a[64:67],a[0:3],a[200:203],a[64:67]
rt a[60:61],v39,40960
mm a[64:67],a[32:35],a[216:219],a[64:67]
rt a[62:63],v39,45056
mm a[96:99],a[0:3],a[204:207],a[96:99]
mm a[96:99],a[32:35],a[220:223],a[96:99]
mm v[68:71],a[4:7],a[192:195],v[68:71]
mm v[68:71],a[36:39],a[208:211],v[68:71]
mm v[100:103],a[4:7],a[196:199],v[100:103]
s_waitcnt vmcnt(8) lgkmcnt(0)
s_barrier
s_cmp_lg_u32 s3, 0
s_cbranch_scc1 L_p2_np
v_bfe_u32 v50, v0, 1, 3
v_lshlrev_b32 v50, 12, v50
v_and_b32 v49, 1, v0
v_lshl_add_u32 v50, v49, 10, v50
buffer_load_dword v51, v50, s[28:31], s38 offen sc1
L_p2_np:
mm v[100:103],a[36:39],a[212:215],v[100:103]
mm a[68:71],a[4:7],a[200:203],a[68:71]
mm a[68:71],a[36:39],a[216:219],a[68:71]
mm a[100:103],a[4:7],a[204:207],a[100:103]
mm a[100:103],a[36:39],a[220:223],a[100:103]
rt a[0:1],v32,49152
rt a[2:3],v32,53248
rt a[32:33],v32,57344
rt a[34:35],v32,61440
mm v[72:75],a[8:11],a[192:195],v[72:75]
mm v[72:75],a[40:43],a[208:211],v[72:75]
mm v[104:107],a[8:11],a[196:199],v[104:107]
mm v[104:107],a[40:43],a[212:215],v[104:107]
mm a[72:75],a[8:11],a[200:203],a[72:75]
mm a[72:75],a[40:43],a[216:219],a[72:75]
mm a[104:107],a[8:11],a[204:207],a[104:107]
mm a[104:107],a[40:43],a[220:223],a[104:107]
rt a[4:5],v33,49152
rt a[6:7],v33,53248
rt a[36:37],v33,57344
rt a[38:39],v33,61440
mm v[76:79],a[12:15],a[192:195],v[76:79]
mm v[76:79],a[44:47],a[208:211],v[76:79]
mm v[108:111],a[12:15],a[196:199],v[108:111]
mm v[108:111],a[44:47],a[212:215],v[108:111]
mm a[76:79],a[12:15],a[200:203],a[76:79]
mm a[76:79],a[44:47],a[216:219],a[76:79]
mm a[108:111],a[12:15],a[204:207],a[108:111]
mm a[108:111],a[44:47],a[220:223],a[108:111]
rt a[8:9],v34,49152
rt a[10:11],v34,53248
rt a[40:41],v34,57344
rt a[42:43],v34,61440
mm v[80:83],a[16:19],a[192:195],v[80:83]
mm v[80:83],a[48:51],a[208:211],v[80:83]
mm v[112:115],a[16:19],a[196:199],v[112:115]
mm v[112:115],a[48:51],a[212:215],v[112:115]
mm a[80:83],a[16:19],a[200:203],a[80:83]
mm a[80:83],a[48:51],a[216:219],a[80:83]
mm a[112:115],a[16:19],a[204:207],a[112:115]
mm a[112:115],a[48:51],a[220:223],a[112:115]
rt a[12:13],v35,49152
rt a[14:15],v35,53248
rt a[44:45],v35,57344
rt a[46:47],v35,61440
mm v[84:87],a[20:23],a[192:195],v[84:87]
mm v[84:87],a[52:55],a[208:211],v[84:87]
mm v[116:119],a[20:23],a[196:199],v[116:119]
mm v[116:119],a[52:55],a[212:215],v[116:119]
mm a[84:87],a[20:23],a[200:203],a[84:87]
mm a[84:87],a[52:55],a[216:219],a[84:87]
mm a[116:119],a[20:23],a[204:207],a[116:119]
mm a[116:119],a[52:55],a[220:223],a[116:119]
rt a[16:17],v36,49152
rt a[18:19],v36,53248
rt a[48:49],v36,57344
rt a[50:51],v36,61440
mm v[88:91],a[24:27],a[192:195],v[88:91]
mm v[88:91],a[56:59],a[208:211],v[88:91]
mm v[120:123],a[24:27],a[196:199],v[120:123]
mm v[120:123],a[56:59],a[212:215],v[120:123]
mm a[88:91],a[24:27],a[200:203],a[88:91]
mm a[88:91],a[56:59],a[216:219],a[88:91]
rt a[20:21],v37,49152
mm a[120:123],a[24:27],a[204:207],a[120:123]
rt a[22:23],v37,53248
mm a[120:123],a[56:59],a[220:223],a[120:123]
rt a[52:53],v37,57344
rt a[54:55],v37,61440
mm v[92:95],a[28:31],a[192:195],v[92:95]
mm v[92:95],a[60:63],a[208:211],v[92:95]
mm v[124:127],a[28:31],a[196:199],v[124:127]
mm v[124:127],a[60:63],a[212:215],v[124:127]
rt a[24:25],v38,49152
mm a[92:95],a[28:31],a[200:203],a[92:95]
rt a[26:27],v38,53248
mm a[92:95],a[60:63],a[216:219],a[92:95]
mm a[124:127],a[28:31],a[204:207],a[124:127]
rt a[56:57],v38,57344
mm a[124:127],a[60:63],a[220:223],a[124:127]
rt a[58:59],v38,61440
s_waitcnt vmcnt(0) lgkmcnt(8)
mm v[64:67],a[0:3],a[224:227],v[64:67]
mm v[64:67],a[32:35],a[240:243],v[64:67]
rt a[28:29],v39,49152
mm v[96:99],a[0:3],a[228:231],v[96:99]
rt a[30:31],v39,53248
mm v[96:99],a[32:35],a[244:247],v[96:99]
rt a[60:61],v39,57344
mm a[64:67],a[0:3],a[232:235],a[64:67]
mm a[64:67],a[32:35],a[248:251],a[64:67]
rt a[62:63],v39,61440
mm a[96:99],a[0:3],a[236:239],a[96:99]
mm a[96:99],a[32:35],a[252:255],a[96:99]
mm v[68:71],a[4:7],a[224:227],v[68:71]
mm v[68:71],a[36:39],a[240:243],v[68:71]
mm v[100:103],a[4:7],a[228:231],v[100:103]
s_cmp_lg_u32 s3, 0
s_cbranch_scc1 L_p2_ni
s_waitcnt vmcnt(0)
s_mov_b32 s7, 0x100000
s_branch L_spc4
L_sp4:
buffer_load_dword v51, v50, s[28:31], s38 offen sc1
s_waitcnt vmcnt(0)
L_spc4:
v_cmp_gt_u32 vcc, 1, v51
s_sub_u32 s7, s7, 1
s_cbranch_vccz L_spd4
s_cmp_lg_u32 s7, 0
s_cbranch_scc1 L_sp4
L_spd4:
L_p2_ni:
s_waitcnt vmcnt(0) lgkmcnt(0)
s_barrier
mm v[100:103],a[36:39],a[244:247],v[100:103]
mm a[68:71],a[4:7],a[232:235],a[68:71]
mm a[68:71],a[36:39],a[248:251],a[68:71]
mm a[100:103],a[4:7],a[236:239],a[100:103]
mm a[100:103],a[36:39],a[252:255],a[100:103]
mm v[72:75],a[8:11],a[224:227],v[72:75]
mm v[72:75],a[40:43],a[240:243],v[72:75]
mm v[104:107],a[8:11],a[228:231],v[104:107]
mm v[104:107],a[40:43],a[244:247],v[104:107]
mm a[72:75],a[8:11],a[232:235],a[72:75]
mm a[72:75],a[40:43],a[248:251],a[72:75]
mm a[104:107],a[8:11],a[236:239],a[104:107]
mm a[104:107],a[40:43],a[252:255],a[104:107]
mm v[76:79],a[12:15],a[224:227],v[76:79]
s_add_u32 m0, s49, 0
mm v[76:79],a[44:47],a[240:243],v[76:79]
buffer_load_dwordx4 v5, s[8:11], s47 offen offset:0 sc1 lds
mm v[108:111],a[12:15],a[228:231],v[108:111]
mm v[108:111],a[44:47],a[244:247],v[108:111]
buffer_load_dwordx4 v5, s[8:11], s47 offen offset:1024 sc1 lds
mm a[76:79],a[12:15],a[232:235],a[76:79]
mm a[76:79],a[44:47],a[248:251],a[76:79]
buffer_load_dwordx4 v5, s[8:11], s47 offen offset:2048 sc1 lds
mm a[108:111],a[12:15],a[236:239],a[108:111]
mm a[108:111],a[44:47],a[252:255],a[108:111]
mm v[80:83],a[16:19],a[224:227],v[80:83]
buffer_load_dwordx4 v5, s[8:11], s47 offen offset:3072 sc1 lds
mm v[80:83],a[48:51],a[240:243],v[80:83]
mm v[112:115],a[16:19],a[228:231],v[112:115]
s_add_u32 m0, s49, 4096
mm v[112:115],a[48:51],a[244:247],v[112:115]
buffer_load_dwordx4 v10, s[8:11], s47 offen offset:0 sc1 lds
mm a[80:83],a[16:19],a[232:235],a[80:83]
mm a[80:83],a[48:51],a[248:251],a[80:83]
buffer_load_dwordx4 v10, s[8:11], s47 offen offset:1024 sc1 lds
mm a[112:115],a[16:19],a[236:239],a[112:115]
mm a[112:115],a[48:51],a[252:255],a[112:115]
buffer_load_dwordx4 v10, s[8:11], s47 offen offset:2048 sc1 lds
mm v[84:87],a[20:23],a[224:227],v[84:87]
mm v[84:87],a[52:55],a[240:243],v[84:87]
buffer_load_dwordx4 v10, s[8:11], s47 offen offset:3072 sc1 lds
mm v[116:119],a[20:23],a[228:231],v[116:119]
mm v[116:119],a[52:55],a[244:247],v[116:119]
s_add_u32 s47, s47, 32768
mm a[84:87],a[20:23],a[232:235],a[84:87]
s_add_u32 m0, s49, 32768
mm a[84:87],a[52:55],a[248:251],a[84:87]
buffer_load_dwordx4 v5, s[8:11], s47 offen offset:0 sc1 lds
mm a[116:119],a[20:23],a[236:239],a[116:119]
mm a[116:119],a[52:55],a[252:255],a[116:119]
mm v[88:91],a[24:27],a[224:227],v[88:91]
buffer_load_dwordx4 v5, s[8:11], s47 offen offset:1024 sc1 lds
mm v[88:91],a[56:59],a[240:243],v[88:91]
mm v[120:123],a[24:27],a[228:231],v[120:123]
buffer_load_dwordx4 v5, s[8:11], s47 offen offset:2048 sc1 lds
mm v[120:123],a[56:59],a[244:247],v[120:123]
mm a[88:91],a[24:27],a[232:235],a[88:91]
buffer_load_dwordx4 v5, s[8:11], s47 offen offset:3072 sc1 lds
mm a[88:91],a[56:59],a[248:251],a[88:91]
mm a[120:123],a[24:27],a[236:239],a[120:123]
s_add_u32 m0, s49, 36864
mm a[120:123],a[56:59],a[252:255],a[120:123]
buffer_load_dwordx4 v10, s[8:11], s47 offen offset:0 sc1 lds
mm v[92:95],a[28:31],a[224:227],v[92:95]
mm v[92:95],a[60:63],a[240:243],v[92:95]
buffer_load_dwordx4 v10, s[8:11], s47 offen offset:1024 sc1 lds
mm v[124:127],a[28:31],a[228:231],v[124:127]
mm v[124:127],a[60:63],a[244:247],v[124:127]
buffer_load_dwordx4 v10, s[8:11], s47 offen offset:2048 sc1 lds
mm a[92:95],a[28:31],a[232:235],a[92:95]
mm a[92:95],a[60:63],a[248:251],a[92:95]
buffer_load_dwordx4 v10, s[8:11], s47 offen offset:3072 sc1 lds
mm a[124:127],a[28:31],a[236:239],a[124:127]
s_add_u32 s47, s47, 32768
mm a[124:127],a[60:63],a[252:255],a[124:127]
s_mov_b64 s[24:25], s[74:75]
s_mov_b32 s26, 8388608
s_cmp_ge_u32 s2, 96
s_cselect_b64 s[24:25], s[78:79], s[24:25]
s_cselect_b32 s6, 96, 0
s_cselect_b32 s26, 7340032, s26
s_cmp_ge_u32 s2, 176
s_cselect_b64 s[24:25], s[80:81], s[24:25]
s_cselect_b32 s6, 176, s6
s_and_b32 s25, s25, 0xffff
s_mov_b32 s27, 0x20000
s_sub_u32 s4, s2, s6
s_lshl_b32 s4, s4, 2
s_add_u32 s4, s4, s3
s_mul_i32 s39, s4, 24576
v_lshlrev_b32 v19, 5, v0
s_cmp_eq_u32 s44, 0
s_mov_b32 s4, 98304
s_mov_b32 s5, 131072
s_cselect_b32 s4, s4, s5
s_lshl_b32 s5, s41, 14
s_add_u32 s4, s4, s5
v_add_u32 v41, s4, v1
s_add_u32 s4, s5, 98304
v_add_u32 v42, s4, v1
s_add_u32 s4, s5, 131072
v_add_u32 v13, s4, v1
cv v128,v64,v65
cv v129,v66,v67
cv v130,v68,v69
cv v131,v70,v71
ds_write_b128 v41, v[128:131] offset:0
cv v132,v72,v73
cv v133,v74,v75
cv v134,v76,v77
cv v135,v78,v79
ds_write_b128 v41, v[132:135] offset:1024
cv v136,v80,v81
cv v137,v82,v83
cv v138,v84,v85
cv v139,v86,v87
ds_write_b128 v41, v[136:139] offset:2048
cv v140,v88,v89
cv v141,v90,v91
cv v142,v92,v93
cv v143,v94,v95
ds_write_b128 v41, v[140:143] offset:3072
cv v144,v96,v97
cv v145,v98,v99
cv v146,v100,v101
cv v147,v102,v103
ds_write_b128 v41, v[144:147] offset:4096
cv v148,v104,v105
cv v149,v106,v107
cv v150,v108,v109
cv v151,v110,v111
ds_write_b128 v41, v[148:151] offset:5120
cv v152,v112,v113
cv v153,v114,v115
cv v154,v116,v117
cv v155,v118,v119
ds_write_b128 v41, v[152:155] offset:6144
cv v156,v120,v121
cv v157,v122,v123
cv v158,v124,v125
cv v159,v126,v127
ds_write_b128 v41, v[156:159] offset:7168
ar v192,a64
ar v193,a65
ar v194,a66
ar v195,a67
ar v196,a68
ar v197,a69
ar v198,a70
ar v199,a71
cv v160,v192,v193
cv v161,v194,v195
cv v162,v196,v197
cv v163,v198,v199
ds_write_b128 v41, v[160:163] offset:8192
ar v200,a72
ar v201,a73
ar v202,a74
ar v203,a75
ar v204,a76
ar v205,a77
ar v206,a78
ar v207,a79
cv v164,v200,v201
cv v165,v202,v203
cv v166,v204,v205
cv v167,v206,v207
ds_write_b128 v41, v[164:167] offset:9216
ar v208,a80
ar v209,a81
ar v210,a82
ar v211,a83
ar v212,a84
ar v213,a85
ar v214,a86
ar v215,a87
cv v168,v208,v209
cv v169,v210,v211
cv v170,v212,v213
cv v171,v214,v215
ds_write_b128 v41, v[168:171] offset:10240
ar v216,a88
ar v217,a89
ar v218,a90
ar v219,a91
ar v220,a92
ar v221,a93
ar v222,a94
ar v223,a95
cv v172,v216,v217
cv v173,v218,v219
cv v174,v220,v221
cv v175,v222,v223
ds_write_b128 v41, v[172:175] offset:11264
ar v192,a96
ar v193,a97
ar v194,a98
ar v195,a99
ar v196,a100
ar v197,a101
ar v198,a102
ar v199,a103
cv v176,v192,v193
cv v177,v194,v195
cv v178,v196,v197
cv v179,v198,v199
ds_write_b128 v41, v[176:179] offset:12288
ar v200,a104
ar v201,a105
ar v202,a106
ar v203,a107
ar v204,a108
ar v205,a109
ar v206,a110
ar v207,a111
cv v180,v200,v201
cv v181,v202,v203
cv v182,v204,v205
cv v183,v206,v207
ds_write_b128 v41, v[180:183] offset:13312
ar v208,a112
ar v209,a113
ar v210,a114
ar v211,a115
ar v212,a116
ar v213,a117
ar v214,a118
ar v215,a119
cv v184,v208,v209
cv v185,v210,v211
cv v186,v212,v213
cv v187,v214,v215
ds_write_b128 v41, v[184:187] offset:14336
ar v216,a120
ar v217,a121
ar v218,a122
ar v219,a123
ar v220,a124
ar v221,a125
ar v222,a126
ar v223,a127
cv v188,v216,v217
cv v189,v218,v219
cv v190,v220,v221
cv v191,v222,v223
ds_write_b128 v41, v[188:191] offset:15360
s_lshl_b32 s4, s32, 19
s_add_u32 s4, s4, 25165824
s_add_u32 s16, s86, s4
s_addc_u32 s17, s87, 0
s_and_b32 s17, s17, 0xffff
s_mov_b32 s18, 524288
s_mov_b32 s19, 0x20000
s_add_u32 s20, s86, 41943040
s_addc_u32 s21, s87, 0
s_and_b32 s21, s21, 0xffff
s_mov_b32 s22, 16777216
s_mov_b32 s23, 0x20000
v_mov_b32 v28, 0x3f803f80
v_mov_b32 v29, 0x3f803f80
v_mov_b32 v30, 0x3f803f80
v_mov_b32 v31, 0x3f803f80
s_sub_u32 s50, 15, s33
s_mov_b32 s51, 0
s_waitcnt lgkmcnt(0)
s_barrier
ds_read_b128 a[128:131], v42 offset:0
ds_read_b128 a[132:135], v42 offset:1024
ds_read_b128 a[136:139], v42 offset:2048
ds_read_b128 a[140:143], v42 offset:3072
ds_read_b128 a[144:147], v42 offset:4096
ds_read_b128 a[148:151], v42 offset:5120
ds_read_b128 a[152:155], v42 offset:6144
ds_read_b128 a[156:159], v42 offset:7168
ds_read_b128 a[160:163], v42 offset:8192
ds_read_b128 a[164:167], v42 offset:9216
ds_read_b128 a[168:171], v42 offset:10240
ds_read_b128 a[172:175], v42 offset:11264
ds_read_b128 a[176:179], v42 offset:12288
ds_read_b128 a[180:183], v42 offset:13312
ds_read_b128 a[184:187], v42 offset:14336
ds_read_b128 a[188:191], v42 offset:15360
s_sub_u32 s45, 15, s33
s_add_u32 s34, s45, 1
s_lshl_b32 s34, s34, 15
s_add_u32 s35, s33, 1
s_lshl_b32 s35, s35, 15
s_mov_b32 s48, 0
s_mov_b32 s36, 0
s_cmp_eq_u32 s33, 0
s_cselect_b64 s[84:85], s[52:53], -1
s_cselect_b64 s[66:67], s[54:55], -1
s_cselect_b64 s[68:69], s[56:57], -1
s_cselect_b64 s[70:71], s[58:59], -1
s_cselect_b64 s[72:73], s[60:61], -1
s_waitcnt vmcnt(0) lgkmcnt(0)
s_barrier
ds_read_b128 a[192:195], v2 offset:0
ds_read_b128 a[196:199], v2 offset:1024
ds_read_b128 a[200:203], v2 offset:2048
ds_read_b128 a[204:207], v2 offset:3072
ds_read_b128 a[208:211], v2 offset:4096
ds_read_b128 a[212:215], v2 offset:5120
ds_read_b128 a[216:219], v2 offset:6144
ds_read_b128 a[220:223], v2 offset:7168
aw a0,0
aw a1,0
aw a2,0
aw a3,0
aw a4,0
aw a5,0
aw a6,0
aw a7,0
aw a8,0
aw a9,0
aw a10,0
aw a11,0
s_waitcnt lgkmcnt(4)
mm v[128:131],a[192:195],a[128:131],0
ds_read_b128 a[224:227], v2 offset:8192
aw a12,0
mm v[128:131],a[196:199],a[132:135],v[128:131]
aw a13,0
aw a14,0
mm v[128:131],a[200:203],a[136:139],v[128:131]
aw a15,0
aw a16,0
mm v[128:131],a[204:207],a[140:143],v[128:131]
aw a17,0
aw a18,0
mm v[132:135],a[192:195],a[144:147],0
aw a19,0
ds_read_b128 a[228:231], v2 offset:9216
mm v[132:135],a[196:199],a[148:151],v[132:135]
aw a20,0
aw a21,0
mm v[132:135],a[200:203],a[152:155],v[132:135]
aw a22,0
aw a23,0
mm v[132:135],a[204:207],a[156:159],v[132:135]
aw a24,0
aw a25,0
mm v[136:139],a[192:195],a[160:163],0
aw a26,0
ds_read_b128 a[232:235], v2 offset:10240
mm v[136:139],a[196:199],a[164:167],v[136:139]
aw a27,0
aw a28,0
mm v[136:139],a[200:203],a[168:171],v[136:139]
aw a29,0
aw a30,0
mm v[136:139],a[204:207],a[172:175],v[136:139]
aw a31,0
aw a32,0
mm v[140:143],a[192:195],a[176:179],0
ds_read_b128 a[236:239], v2 offset:11264
aw a33,0
mm v[140:143],a[196:199],a[180:183],v[140:143]
aw a34,0
aw a35,0
mm v[140:143],a[200:203],a[184:187],v[140:143]
aw a36,0
aw a37,0
mm v[140:143],a[204:207],a[188:191],v[140:143]
aw a38,0
aw a39,0
aw a40,0
aw a41,0
aw a42,0
aw a43,0
aw a44,0
aw a45,0
aw a46,0
aw a47,0
aw a48,0
aw a49,0
v_max3_f32 v33, v128, v129, v130
v_max3_f32 v37, v132, v133, v134
v_max3_f32 v41, v136, v137, v138
v_max3_f32 v45, v140, v141, v142
v_max_f32 v33, v131, v33
v_max_f32 v37, v135, v37
v_max_f32 v41, v139, v41
v_max_f32 v45, v143, v45
v_mov_b32 v34, v33
v_mov_b32 v38, v37
v_mov_b32 v42, v41
v_mov_b32 v46, v45
v_permlane16_swap_b32 v33, v34
v_permlane16_swap_b32 v37, v38
v_permlane16_swap_b32 v41, v42
v_permlane16_swap_b32 v45, v46
v_max_f32 v33, v33, v34
v_max_f32 v37, v37, v38
v_max_f32 v41, v41, v42
v_max_f32 v45, v45, v46
v_mov_b32 v34, v33
v_mov_b32 v38, v37
v_mov_b32 v42, v41
v_mov_b32 v46, v45
v_permlane32_swap_b32 v33, v34
v_permlane32_swap_b32 v37, v38
v_permlane32_swap_b32 v41, v42
v_permlane32_swap_b32 v45, v46
v_max_f32 v33, v33, v34
v_max_f32 v37, v37, v38
v_max_f32 v41, v41, v42
v_max_f32 v45, v45, v46
v_max_f32 v33, 0xf149f2ca, v33
v_max_f32 v37, 0xf149f2ca, v37
v_max_f32 v41, 0xf149f2ca, v41
v_max_f32 v45, 0xf149f2ca, v45
v_sub_f32 v32, 0xc1c00000, v33
v_sub_f32 v36, 0xc1c00000, v37
v_sub_f32 v40, 0xc1c00000, v41
v_sub_f32 v44, 0xc1c00000, v45
v_mov_b32 v33, v32
v_mov_b32 v34, v32
v_mov_b32 v35, v32
v_mov_b32 v37, v36
v_mov_b32 v38, v36
v_mov_b32 v39, v36
v_mov_b32 v41, v40
v_mov_b32 v42, v40
v_mov_b32 v43, v40
v_mov_b32 v45, v44
v_mov_b32 v46, v44
v_mov_b32 v47, v44
s_waitcnt lgkmcnt(4)
mm v[144:147],a[208:211],a[128:131],v[32:35]
ds_read_b128 a[240:243], v2 offset:12288
v_add_f32 v128, v128, v32
v_add_f32 v129, v129, v32
mm v[144:147],a[212:215],a[132:135],v[144:147]
v_add_f32 v130, v130, v32
v_add_f32 v131, v131, v32
v_add_f32 v132, v132, v36
mm v[144:147],a[216:219],a[136:139],v[144:147]
v_add_f32 v133, v133, v36
v_add_f32 v134, v134, v36
v_add_f32 v135, v135, v36
mm v[144:147],a[220:223],a[140:143],v[144:147]
ds_read_b128 a[244:247], v2 offset:13312
v_add_f32 v136, v136, v40
v_add_f32 v137, v137, v40
mm v[148:151],a[208:211],a[144:147],v[36:39]
v_add_f32 v138, v138, v40
v_add_f32 v139, v139, v40
v_add_f32 v140, v140, v44
mm v[148:151],a[212:215],a[148:151],v[148:151]
v_add_f32 v141, v141, v44
v_add_f32 v142, v142, v44
v_add_f32 v143, v143, v44
mm v[148:151],a[216:219],a[152:155],v[148:151]
ds_read_b128 a[248:251], v2 offset:14336
aw a50,0
aw a51,0
mm v[148:151],a[220:223],a[156:159],v[148:151]
aw a52,0
aw a53,0
aw a54,0
mm v[152:155],a[208:211],a[160:163],v[40:43]
aw a55,0
aw a56,0
aw a57,0
mm v[152:155],a[212:215],a[164:167],v[152:155]
aw a58,0
aw a59,0
aw a60,0
mm v[152:155],a[216:219],a[168:171],v[152:155]
ds_read_b128 a[252:255], v2 offset:15360
aw a61,0
aw a62,0
mm v[152:155],a[220:223],a[172:175],v[152:155]
aw a63,0
aw a64,0
aw a65,0
mm v[156:159],a[208:211],a[176:179],v[44:47]
aw a66,0
aw a67,0
aw a68,0
mm v[156:159],a[212:215],a[180:183],v[156:159]
aw a69,0
aw a70,0
aw a71,0
mm v[156:159],a[216:219],a[184:187],v[156:159]
aw a72,0
aw a73,0
mm v[156:159],a[220:223],a[188:191],v[156:159]
aw a74,0
aw a75,0
s_waitcnt lgkmcnt(4)
mm v[160:163],a[224:227],a[128:131],v[32:35]
aw a76,0
aw a77,0
aw a78,0
mm v[160:163],a[228:231],a[132:135],v[160:163]
aw a79,0
aw a80,0
mm v[160:163],a[232:235],a[136:139],v[160:163]
aw a81,0
aw a82,0
mm v[160:163],a[236:239],a[140:143],v[160:163]
aw a83,0
aw a84,0
aw a85,0
mm v[164:167],a[224:227],a[144:147],v[36:39]
aw a86,0
aw a87,0
mm v[164:167],a[228:231],a[148:151],v[164:167]
aw a88,0
aw a89,0
mm v[164:167],a[232:235],a[152:155],v[164:167]
aw a90,0
aw a91,0
mm v[164:167],a[236:239],a[156:159],v[164:167]
aw a92,0
aw a93,0
aw a94,0
mm v[168:171],a[224:227],a[160:163],v[40:43]
aw a95,0
aw a96,0
mm v[168:171],a[228:231],a[164:167],v[168:171]
aw a97,0
aw a98,0
mm v[168:171],a[232:235],a[168:171],v[168:171]
aw a99,0
aw a100,0
aw a101,0
mm v[168:171],a[236:239],a[172:175],v[168:171]
aw a102,0
aw a103,0
mm v[172:175],a[224:227],a[176:179],v[44:47]
aw a104,0
aw a105,0
mm v[172:175],a[228:231],a[180:183],v[172:175]
aw a106,0
aw a107,0
aw a108,0
mm v[172:175],a[232:235],a[184:187],v[172:175]
aw a109,0
aw a110,0
mm v[172:175],a[236:239],a[188:191],v[172:175]
aw a111,0
aw a112,0
s_waitcnt vmcnt(0) lgkmcnt(0)
s_barrier
mm v[176:179],a[240:243],a[128:131],v[32:35]
ds_read_b128 a[192:195], v2 offset:32768
s_add_u32 m0, s49, 0
aw a113,0
aw a114,0
aw a115,0
mm v[176:179],a[244:247],a[132:135],v[176:179]
buffer_load_dwordx4 v5, s[8:11], s47 offen offset:0 sc1 lds
aw a116,0
aw a117,0
mm v[176:179],a[248:251],a[136:139],v[176:179]
buffer_load_dwordx4 v5, s[8:11], s47 offen offset:1024 sc1 lds
ds_read_b128 a[196:199], v2 offset:33792
aw a118,0
aw a119,0
mm v[176:179],a[252:255],a[140:143],v[176:179]
aw a120,0
aw a121,0
aw a122,0
mm v[180:183],a[240:243],a[144:147],v[36:39]
buffer_load_dwordx4 v5, s[8:11], s47 offen offset:2048 sc1 lds
ds_read_b128 a[200:203], v2 offset:34816
aw a123,0
aw a124,0
mm v[180:183],a[244:247],a[148:151],v[180:183]
buffer_load_dwordx4 v5, s[8:11], s47 offen offset:3072 sc1 lds
aw a125,0
aw a126,0
mm v[180:183],a[248:251],a[152:155],v[180:183]
ds_read_b128 a[204:207], v2 offset:35840
s_add_u32 m0, s49, 4096
aw a127,0
v_mov_b32 v48, 0
v_mov_b32 v49, 0
mm v[180:183],a[252:255],a[156:159],v[180:183]
v_mov_b32 v50, 0
v_mov_b32 v51, 0
mm v[184:187],a[240:243],a[160:163],v[40:43]
buffer_load_dwordx4 v10, s[8:11], s47 offen offset:0 sc1 lds
ds_read_b128 a[208:211], v2 offset:36864
v_mov_b32 v52, 0
v_mov_b32 v53, 0
mm v[184:187],a[244:247],a[164:167],v[184:187]
buffer_load_dwordx4 v10, s[8:11], s47 offen offset:1024 sc1 lds
v_mov_b32 v54, 0
v_mov_b32 v55, 0
mm v[184:187],a[248:251],a[168:171],v[184:187]
buffer_load_dwordx4 v10, s[8:11], s47 offen offset:2048 sc1 lds
ds_read_b128 a[212:215], v2 offset:37888
mm v[184:187],a[252:255],a[172:175],v[184:187]
v_mov_b32 v56, 0
v_mov_b32 v57, 0
v_mov_b32 v58, 0
mm v[188:191],a[240:243],a[176:179],v[44:47]
buffer_load_dwordx4 v10, s[8:11], s47 offen offset:3072 sc1 lds
ds_read_b128 a[216:219], v2 offset:38912
mm v[188:191],a[244:247],a[180:183],v[188:191]
v_mov_b32 v59, 0
s_add_u32 s47, s47, 32768
v_mov_b32 v60, 0
mm v[188:191],a[248:251],a[184:187],v[188:191]
ds_read_b128 a[220:223], v2 offset:39936
v_mov_b32 v61, 0
v_mov_b32 v62, 0
mm v[188:191],a[252:255],a[188:191],v[188:191]
s_cmp_eq_u32 s47, s34
s_cselect_b32 s47, 0, s47
s_cselect_b32 s10, s35, s10
v_mov_b32 v63, 0
s_waitcnt lgkmcnt(4)
mm v[192:195],a[192:195],a[128:131],v[32:35]
v_exp_f32 v20, v128
ds_read_b128 a[224:227], v2 offset:40960
mm v[192:195],a[196:199],a[132:135],v[192:195]
v_exp_f32 v21, v129
s_add_u32 m0, s49, 65536
s_nop 0
buffer_load_dwordx4 v5, s[16:19], s48 offen offset:0 sc1 lds
mm v[192:195],a[200:203],a[136:139],v[192:195]
v_exp_f32 v22, v130
cv v64,v20,v21
mm v[192:195],a[204:207],a[140:143],v[192:195]
buffer_load_dwordx4 v5, s[16:19], s48 offen offset:1024 sc1 lds
v_exp_f32 v23, v131
mm v[196:199],a[192:195],a[144:147],v[36:39]
v_exp_f32 v24, v144
cv v65,v22,v23
mm v[196:199],a[196:199],a[148:151],v[196:199]
buffer_load_dwordx4 v5, s[16:19], s48 offen offset:2048 sc1 lds
ds_read_b128 a[228:231], v2 offset:41984
v_exp_f32 v25, v145
mm v[196:199],a[200:203],a[152:155],v[196:199]
buffer_load_dwordx4 v5, s[16:19], s48 offen offset:3072 sc1 lds
v_or_b32 v12, v64, v65
mm v[196:199],a[204:207],a[156:159],v[196:199]
v_exp_f32 v26, v146
cv v66,v24,v25
v_exp_f32 v27, v147
mm v[200:203],a[192:195],a[160:163],v[40:43]
v_exp_f32 v20, v132
mm v[200:203],a[196:199],a[164:167],v[200:203]
v_exp_f32 v21, v133
s_add_u32 m0, s49, 69632
cv v67,v26,v27
mm v[200:203],a[200:203],a[168:171],v[200:203]
buffer_load_dwordx4 v10, s[16:19], s48 offen offset:0 sc1 lds
ds_read_b128 a[232:235], v2 offset:43008
buffer_load_dwordx4 v10, s[16:19], s48 offen offset:1024 sc1 lds
mm v[200:203],a[204:207],a[172:175],v[200:203]
v_exp_f32 v22, v134
v_or3_b32 v12, v66, v67, v12
mm v[204:207],a[192:195],a[176:179],v[44:47]
ds_read_b128 a[236:239], v2 offset:44032
cv v68,v20,v21
v_exp_f32 v23, v135
mm v[204:207],a[196:199],a[180:183],v[204:207]
buffer_load_dwordx4 v10, s[16:19], s48 offen offset:2048 sc1 lds
cv v69,v22,v23
mm v[204:207],a[200:203],a[184:187],v[204:207]
buffer_load_dwordx4 v10, s[16:19], s48 offen offset:3072 sc1 lds
s_add_u32 s48, s48, 32768
s_cmp_eq_u32 s48, s34
s_cselect_b32 s48, 0, s48
mm v[204:207],a[204:207],a[188:191],v[204:207]
v_exp_f32 v24, v148
s_waitcnt lgkmcnt(4)
mm v[208:211],a[208:211],a[128:131],v[32:35]
v_exp_f32 v25, v149
v_or3_b32 v12, v68, v69, v12
cv v70,v24,v25
mm v[208:211],a[212:215],a[132:135],v[208:211]
v_exp_f32 v26, v150
v_exp_f32 v27, v151
mm v[208:211],a[216:219],a[136:139],v[208:211]
v_exp_f32 v20, v136
cv v71,v26,v27
mm v[208:211],a[220:223],a[140:143],v[208:211]
v_exp_f32 v21, v137
ds_read_b128 a[240:243], v2 offset:45056
v_or3_b32 v12, v70, v71, v12
mm v[212:215],a[208:211],a[144:147],v[36:39]
v_exp_f32 v22, v138
cv v72,v20,v21
v_exp_f32 v23, v139
mm v[212:215],a[212:215],a[148:151],v[212:215]
v_exp_f32 v24, v152
mm v[212:215],a[216:219],a[152:155],v[212:215]
v_exp_f32 v25, v153
cv v73,v22,v23
v_or3_b32 v12, v72, v73, v12
mm v[212:215],a[220:223],a[156:159],v[212:215]
v_exp_f32 v26, v154
cv v74,v24,v25
ds_read_b128 a[244:247], v2 offset:46080
mm v[216:219],a[208:211],a[160:163],v[40:43]
v_exp_f32 v27, v155
v_exp_f32 v20, v140
mm v[216:219],a[212:215],a[164:167],v[216:219]
v_exp_f32 v21, v141
cv v75,v26,v27
mm v[216:219],a[216:219],a[168:171],v[216:219]
v_exp_f32 v22, v142
v_or3_b32 v12, v74, v75, v12
cv v76,v20,v21
mm v[216:219],a[220:223],a[172:175],v[216:219]
v_exp_f32 v23, v143
ds_read_b128 a[248:251], v2 offset:47104
cv v77,v22,v23
mm v[220:223],a[208:211],a[176:179],v[44:47]
ds_read_b128 a[252:255], v2 offset:48128
v_exp_f32 v24, v156
v_exp_f32 v25, v157
mm v[220:223],a[212:215],a[180:183],v[220:223]
v_exp_f32 v26, v158
mm v[220:223],a[216:219],a[184:187],v[220:223]
v_exp_f32 v27, v159
v_or3_b32 v12, v76, v77, v12
cv v78,v24,v25
mm v[220:223],a[220:223],a[188:191],v[220:223]
cv v79,v26,v27
v_exp_f32 v20, v160
s_waitcnt lgkmcnt(4)
mm v[224:227],a[224:227],a[128:131],v[32:35]
v_exp_f32 v21, v161
v_or3_b32 v12, v78, v79, v12
cv v80,v20,v21
mm v[224:227],a[228:231],a[132:135],v[224:227]
v_exp_f32 v22, v162
v_exp_f32 v23, v163
mm v[224:227],a[232:235],a[136:139],v[224:227]
v_exp_f32 v24, v176
cv v81,v22,v23
mm v[224:227],a[236:239],a[140:143],v[224:227]
v_exp_f32 v25, v177
v_or3_b32 v12, v80, v81, v12
cv v82,v24,v25
mm v[228:231],a[224:227],a[144:147],v[36:39]
v_exp_f32 v26, v178
v_exp_f32 v27, v179
mm v[228:231],a[228:231],a[148:151],v[228:231]
v_exp_f32 v20, v164
cv v83,v26,v27
v_exp_f32 v21, v165
mm v[228:231],a[232:235],a[152:155],v[228:231]
v_exp_f32 v22, v166
mm v[228:231],a[236:239],a[156:159],v[228:231]
v_exp_f32 v23, v167
v_or3_b32 v12, v82, v83, v12
cv v84,v20,v21
mm v[232:235],a[224:227],a[160:163],v[40:43]
v_exp_f32 v24, v180
cv v85,v22,v23
v_exp_f32 v25, v181
mm v[232:235],a[228:231],a[164:167],v[232:235]
v_exp_f32 v26, v182
v_or3_b32 v12, v84, v85, v12
mm v[232:235],a[232:235],a[168:171],v[232:235]
v_exp_f32 v27, v183
cv v86,v24,v25
mm v[232:235],a[236:239],a[172:175],v[232:235]
v_exp_f32 v20, v168
cv v87,v26,v27
v_exp_f32 v21, v169
mm v[236:239],a[224:227],a[176:179],v[44:47]
v_exp_f32 v22, v170
v_or3_b32 v12, v86, v87, v12
mm v[236:239],a[228:231],a[180:183],v[236:239]
v_exp_f32 v23, v171
cv v88,v20,v21
cv v89,v22,v23
mm v[236:239],a[232:235],a[184:187],v[236:239]
v_exp_f32 v24, v184
v_exp_f32 v25, v185
mm v[236:239],a[236:239],a[188:191],v[236:239]
v_or3_b32 v12, v88, v89, v12
s_waitcnt vmcnt(0) lgkmcnt(0)
s_barrier
mm v[240:243],a[240:243],a[128:131],v[32:35]
v_exp_f32 v26, v186
ds_read_b128 a[192:195], v2 offset:0
s_add_u32 m0, s49, 32768
mm v[240:243],a[244:247],a[132:135],v[240:243]
buffer_load_dwordx4 v5, s[8:11], s47 offen offset:0 sc1 lds
cv v90,v24,v25
v_exp_f32 v27, v187
mm v[240:243],a[248:251],a[136:139],v[240:243]
buffer_load_dwordx4 v5, s[8:11], s47 offen offset:1024 sc1 lds
ds_read_b128 a[196:199], v2 offset:1024
mm v[240:243],a[252:255],a[140:143],v[240:243]
v_exp_f32 v20, v172
cv v91,v26,v27
mm v[244:247],a[240:243],a[144:147],v[36:39]
v_exp_f32 v21, v173
ds_read_b128 a[200:203], v2 offset:2048
buffer_load_dwordx4 v5, s[8:11], s47 offen offset:2048 sc1 lds
mm v[244:247],a[244:247],a[148:151],v[244:247]
v_exp_f32 v22, v174
v_or3_b32 v12, v90, v91, v12
mm v[244:247],a[248:251],a[152:155],v[244:247]
buffer_load_dwordx4 v5, s[8:11], s47 offen offset:3072 sc1 lds
cv v92,v20,v21
v_exp_f32 v23, v175
mm v[244:247],a[252:255],a[156:159],v[244:247]
v_exp_f32 v24, v188
mm v[248:251],a[240:243],a[160:163],v[40:43]
v_exp_f32 v25, v189
ds_read_b128 a[204:207], v2 offset:3072
cv v93,v22,v23
mm v[248:251],a[244:247],a[164:167],v[248:251]
v_exp_f32 v26, v190
s_add_u32 m0, s49, 36864
ds_read_b128 a[208:211], v2 offset:4096
mm v[248:251],a[248:251],a[168:171],v[248:251]
buffer_load_dwordx4 v10, s[8:11], s47 offen offset:0 sc1 lds
v_or3_b32 v12, v92, v93, v12
cv v94,v24,v25
mm v[248:251],a[252:255],a[172:175],v[248:251]
v_exp_f32 v27, v191
buffer_load_dwordx4 v10, s[8:11], s47 offen offset:1024 sc1 lds
mm v[252:255],a[240:243],a[176:179],v[44:47]
buffer_load_dwordx4 v10, s[8:11], s47 offen offset:2048 sc1 lds
cv v95,v26,v27
mm v[252:255],a[244:247],a[180:183],v[252:255]
buffer_load_dwordx4 v10, s[8:11], s47 offen offset:3072 sc1 lds
ds_read_b128 a[212:215], v2 offset:5120
v_or3_b32 v12, v94, v95, v12
mm v[252:255],a[248:251],a[184:187],v[252:255]
ds_read_b128 a[216:219], v2 offset:6144
ds_read_b128 a[220:223], v2 offset:7168
v_and_b32 v12, 0x40004000, v12
s_add_u32 s47, s47, 32768
mm v[252:255],a[252:255],a[188:191],v[252:255]
s_cmp_eq_u32 s47, s34
s_cselect_b32 s47, 0, s47
s_cselect_b32 s10, s35, s10
v_cmp_ne_u32 vcc, 0, v12
s_nop 0
s_cbranch_vccz L_ok_first
s_call_b64 s[42:43], L_rare0
L_ok_first:
s_mov_b32 s46, 1
.p2align 6
L_top1:
s_cmp_eq_u32 s46, s45
s_cbranch_scc1 L_evt1
L_mid1:
s_waitcnt lgkmcnt(4)
mm v[128:131],a[192:195],a[128:131],v[32:35]
v_exp_f32 v20, v192
mm v[128:131],a[196:199],a[132:135],v[128:131]
ds_read_b128 a[224:227], v2 offset:8192
s_add_u32 m0, s49, 98304
mm v[128:131],a[200:203],a[136:139],v[128:131]
v_exp_f32 v21, v193
mm v[128:131],a[204:207],a[140:143],v[128:131]
v_exp_f32 v22, v194
mm v[132:135],a[192:195],a[144:147],v[36:39]
buffer_load_dwordx4 v5, s[16:19], s48 offen offset:0 sc1 lds
mm v[132:135],a[196:199],a[148:151],v[132:135]
cv v96,v20,v21
ds_read_b128 a[228:231], v2 offset:9216
mm v[132:135],a[200:203],a[152:155],v[132:135]
v_exp_f32 v23, v195
mm v[132:135],a[204:207],a[156:159],v[132:135]
v_exp_f32 v24, v208
mm v[136:139],a[192:195],a[160:163],v[40:43]
cv v97,v22,v23
ds_read_b128 a[232:235], v2 offset:10240
mm v[136:139],a[196:199],a[164:167],v[136:139]
v_exp_f32 v25, v209
mm v[136:139],a[200:203],a[168:171],v[136:139]
buffer_load_dwordx4 v5, s[16:19], s48 offen offset:1024 sc1 lds
mm v[136:139],a[204:207],a[172:175],v[136:139]
v_exp_f32 v26, v210
mm v[140:143],a[192:195],a[176:179],v[44:47]
ds_read_b128 a[236:239], v2 offset:11264
v_or_b32 v12, v96, v97
mm v[140:143],a[196:199],a[180:183],v[140:143]
v_exp_f32 v27, v211
mm v[140:143],a[200:203],a[184:187],v[140:143]
buffer_load_dwordx4 v5, s[16:19], s48 offen offset:2048 sc1 lds
mm v[140:143],a[204:207],a[188:191],v[140:143]
cv v98,v24,v25
s_waitcnt lgkmcnt(4)
mm v[144:147],a[208:211],a[128:131],v[32:35]
v_exp_f32 v20, v196
mm v[144:147],a[212:215],a[132:135],v[144:147]
cv v99,v26,v27
ds_read_b128 a[240:243], v2 offset:12288
mm v[144:147],a[216:219],a[136:139],v[144:147]
v_exp_f32 v21, v197
mm v[144:147],a[220:223],a[140:143],v[144:147]
v_exp_f32 v22, v198
mm v[148:151],a[208:211],a[144:147],v[36:39]
buffer_load_dwordx4 v5, s[16:19], s48 offen offset:3072 sc1 lds
mm v[148:151],a[212:215],a[148:151],v[148:151]
v_or3_b32 v12, v98, v99, v12
cv v100,v20,v21
mm v[148:151],a[216:219],a[152:155],v[148:151]
v_exp_f32 v23, v199
mm v[148:151],a[220:223],a[156:159],v[148:151]
v_exp_f32 v24, v212
mm v[152:155],a[208:211],a[160:163],v[40:43]
ds_read_b128 a[244:247], v2 offset:13312
cv v101,v22,v23
mm v[152:155],a[212:215],a[164:167],v[152:155]
v_exp_f32 v25, v213
mm v[152:155],a[216:219],a[168:171],v[152:155]
ds_read_b128 a[248:251], v2 offset:14336
s_add_u32 m0, s49, 102400
mm v[152:155],a[220:223],a[172:175],v[152:155]
v_exp_f32 v26, v214
mm v[156:159],a[208:211],a[176:179],v[44:47]
ds_read_b128 a[252:255], v2 offset:15360
v_or3_b32 v12, v100, v101, v12
mm v[156:159],a[212:215],a[180:183],v[156:159]
v_exp_f32 v27, v215
mm v[156:159],a[216:219],a[184:187],v[156:159]
buffer_load_dwordx4 v10, s[16:19], s48 offen offset:0 sc1 lds
mm v[156:159],a[220:223],a[188:191],v[156:159]
cv v102,v24,v25
s_waitcnt lgkmcnt(4)
mm v[160:163],a[224:227],a[128:131],v[32:35]
v_exp_f32 v20, v200
mm v[160:163],a[228:231],a[132:135],v[160:163]
cv v103,v26,v27
ds_read_b128 a[192:195], v3 offset:0
mm v[160:163],a[232:235],a[136:139],v[160:163]
v_exp_f32 v21, v201
mm v[160:163],a[236:239],a[140:143],v[160:163]
buffer_load_dwordx4 v10, s[16:19], s48 offen offset:1024 sc1 lds
mm v[164:167],a[224:227],a[144:147],v[36:39]
v_exp_f32 v22, v202
mm v[164:167],a[228:231],a[148:151],v[164:167]
v_or3_b32 v12, v102, v103, v12
cv v104,v20,v21
mm v[164:167],a[232:235],a[152:155],v[164:167]
v_exp_f32 v23, v203
mm v[164:167],a[236:239],a[156:159],v[164:167]
v_exp_f32 v24, v216
mm v[168:171],a[224:227],a[160:163],v[40:43]
buffer_load_dwordx4 v10, s[16:19], s48 offen offset:2048 sc1 lds
mm v[168:171],a[228:231],a[164:167],v[168:171]
ds_read_b128 a[196:199], v3 offset:8192
cv v105,v22,v23
mm v[168:171],a[232:235],a[168:171],v[168:171]
v_exp_f32 v25, v217
mm v[168:171],a[236:239],a[172:175],v[168:171]
v_exp_f32 v26, v218
mm v[172:175],a[224:227],a[176:179],v[44:47]
ds_read_b128 a[200:203], v3 offset:1024
ds_read_b128 a[204:207], v3 offset:9216
mm v[172:175],a[228:231],a[180:183],v[172:175]
buffer_load_dwordx4 v10, s[16:19], s48 offen offset:3072 sc1 lds
mm v[172:175],a[232:235],a[184:187],v[172:175]
v_or3_b32 v12, v104, v105, v12
cv v106,v24,v25
mm v[172:175],a[236:239],a[188:191],v[172:175]
v_exp_f32 v27, v219
s_waitcnt lgkmcnt(4)
mm v[176:179],a[240:243],a[128:131],v[32:35]
v_exp_f32 v20, v204
mm v[176:179],a[244:247],a[132:135],v[176:179]
cv v107,v26,v27
ds_read_b128 a[208:211], v3 offset:2048
mm v[176:179],a[248:251],a[136:139],v[176:179]
v_exp_f32 v21, v205
mm v[176:179],a[252:255],a[140:143],v[176:179]
v_exp_f32 v22, v206
mm v[180:183],a[240:243],a[144:147],v[36:39]
s_add_u32 s48, s48, 32768
v_or3_b32 v12, v106, v107, v12
mm v[180:183],a[244:247],a[148:151],v[180:183]
cv v108,v20,v21
ds_read_b128 a[212:215], v3 offset:10240
mm v[180:183],a[248:251],a[152:155],v[180:183]
v_exp_f32 v23, v207
mm v[180:183],a[252:255],a[156:159],v[180:183]
s_cmp_eq_u32 s48, s34
s_cselect_b32 s48, 0, s48
mm v[184:187],a[240:243],a[160:163],v[40:43]
v_exp_f32 v24, v220
mm v[184:187],a[244:247],a[164:167],v[184:187]
cv v109,v22,v23
ds_read_b128 a[216:219], v3 offset:3072
mm v[184:187],a[248:251],a[168:171],v[184:187]
v_exp_f32 v25, v221
mm v[184:187],a[252:255],a[172:175],v[184:187]
v_exp_f32 v26, v222
mm v[188:191],a[240:243],a[176:179],v[44:47]
ds_read_b128 a[220:223], v3 offset:11264
v_or3_b32 v12, v108, v109, v12
mm v[188:191],a[244:247],a[180:183],v[188:191]
buffer_load_dword v18, v19, s[24:27], s39 offen
mm v[188:191],a[248:251],a[184:187],v[188:191]
v_exp_f32 v27, v223
mm v[188:191],a[252:255],a[188:191],v[188:191]
cv v110,v24,v25
s_waitcnt lgkmcnt(4)
mm a[0:3],a[192:195],v[64:67],a[0:3]
s_add_u32 s39, s39, 2048
cv v111,v26,v27
mm a[0:3],a[196:199],v[80:83],a[0:3]
v_exp_f32 v20, v224
mm a[4:7],a[192:195],v[68:71],a[4:7]
v_exp_f32 v21, v225
mm a[4:7],a[196:199],v[84:87],a[4:7]
v_exp_f32 v22, v226
mm a[8:11],a[192:195],v[72:75],a[8:11]
ds_read_b128 a[224:227], v4 offset:4096
v_or3_b32 v12, v110, v111, v12
mm a[8:11],a[196:199],v[88:91],a[8:11]
v_exp_f32 v23, v227
mm a[12:15],a[192:195],v[76:79],a[12:15]
cv v112,v20,v21
ds_read_b128 a[228:231], v4 offset:12288
mm a[12:15],a[196:199],v[92:95],a[12:15]
v_exp_f32 v24, v240
mm a[16:19],a[200:203],v[64:67],a[16:19]
v_exp_f32 v25, v241
mm a[16:19],a[204:207],v[80:83],a[16:19]
cv v113,v22,v23
ds_read_b128 a[232:235], v4 offset:5120
mm a[20:23],a[200:203],v[68:71],a[20:23]
v_exp_f32 v26, v242
mm a[20:23],a[204:207],v[84:87],a[20:23]
v_or3_b32 v12, v112, v113, v12
cv v114,v24,v25
mm a[24:27],a[200:203],v[72:75],a[24:27]
ds_read_b128 a[236:239], v4 offset:13312
v_exp_f32 v27, v243
mm a[24:27],a[204:207],v[88:91],a[24:27]
v_exp_f32 v20, v228
mm a[28:31],a[200:203],v[76:79],a[28:31]
v_exp_f32 v21, v229
mm a[28:31],a[204:207],v[92:95],a[28:31]
cv v115,v26,v27
v_or3_b32 v12, v114, v115, v12
mm v[48:51],v[28:31],v[64:67],v[48:51]
v_exp_f32 v22, v230
mm v[48:51],v[28:31],v[80:83],v[48:51]
cv v116,v20,v21
s_waitcnt lgkmcnt(4)
mm a[32:35],a[208:211],v[64:67],a[32:35]
v_exp_f32 v23, v231
mm a[32:35],a[212:215],v[80:83],a[32:35]
ds_read_b128 a[240:243], v4 offset:6144
cv v117,v22,v23
mm a[36:39],a[208:211],v[68:71],a[36:39]
v_exp_f32 v24, v244
mm a[36:39],a[212:215],v[84:87],a[36:39]
ds_read_b128 a[244:247], v4 offset:14336
v_or3_b32 v12, v116, v117, v12
mm a[40:43],a[208:211],v[72:75],a[40:43]
v_exp_f32 v25, v245
mm a[40:43],a[212:215],v[88:91],a[40:43]
v_exp_f32 v26, v246
mm a[44:47],a[208:211],v[76:79],a[44:47]
ds_read_b128 a[248:251], v4 offset:7168
cv v118,v24,v25
mm a[44:47],a[212:215],v[92:95],a[44:47]
v_exp_f32 v27, v247
mm a[48:51],a[216:219],v[64:67],a[48:51]
v_exp_f32 v20, v232
mm a[48:51],a[220:223],v[80:83],a[48:51]
v_exp_f32 v21, v233
mm a[52:55],a[216:219],v[68:71],a[52:55]
ds_read_b128 a[252:255], v4 offset:15360
cv v119,v26,v27
mm a[52:55],a[220:223],v[84:87],a[52:55]
v_exp_f32 v22, v234
mm a[56:59],a[216:219],v[72:75],a[56:59]
v_or3_b32 v12, v118, v119, v12
cv v120,v20,v21
mm a[56:59],a[220:223],v[88:91],a[56:59]
v_exp_f32 v23, v235
mm a[60:63],a[216:219],v[76:79],a[60:63]
v_exp_f32 v24, v248
mm a[60:63],a[220:223],v[92:95],a[60:63]
v_exp_f32 v25, v249
mm v[52:55],v[28:31],v[68:71],v[52:55]
v_exp_f32 v26, v250
mm v[52:55],v[28:31],v[84:87],v[52:55]
s_waitcnt vmcnt(1) lgkmcnt(0)
s_barrier
mm a[64:67],a[224:227],v[64:67],a[64:67]
ds_read_b128 a[192:195], v2 offset:32768
s_add_u32 m0, s49, 0
mm a[64:67],a[228:231],v[80:83],a[64:67]
cv v121,v22,v23
v_or3_b32 v12, v120, v121, v12
mm a[68:71],a[224:227],v[68:71],a[68:71]
buffer_load_dwordx4 v5, s[8:11], s47 offen offset:0 sc1 lds
mm a[68:71],a[228:231],v[84:87],a[68:71]
v_exp_f32 v27, v251
mm a[72:75],a[224:227],v[72:75],a[72:75]
ds_read_b128 a[196:199], v2 offset:33792
cv v122,v24,v25
mm a[72:75],a[228:231],v[88:91],a[72:75]
buffer_load_dwordx4 v5, s[8:11], s47 offen offset:1024 sc1 lds
mm a[76:79],a[224:227],v[76:79],a[76:79]
v_exp_f32 v20, v236
mm a[76:79],a[228:231],v[92:95],a[76:79]
v_exp_f32 v21, v237
mm a[80:83],a[232:235],v[64:67],a[80:83]
buffer_load_dwordx4 v5, s[8:11], s47 offen offset:2048 sc1 lds
mm a[80:83],a[236:239],v[80:83],a[80:83]
ds_read_b128 a[200:203], v2 offset:34816
cv v123,v26,v27
mm a[84:87],a[232:235],v[68:71],a[84:87]
v_exp_f32 v22, v238
mm a[84:87],a[236:239],v[84:87],a[84:87]
buffer_load_dwordx4 v5, s[8:11], s47 offen offset:3072 sc1 lds
mm a[88:91],a[232:235],v[72:75],a[88:91]
v_or3_b32 v12, v122, v123, v12
cv v124,v20,v21
mm a[88:91],a[236:239],v[88:91],a[88:91]
v_exp_f32 v23, v239
mm a[92:95],a[232:235],v[76:79],a[92:95]
ds_read_b128 a[204:207], v2 offset:35840
s_add_u32 m0, s49, 4096
mm a[92:95],a[236:239],v[92:95],a[92:95]
v_exp_f32 v24, v252
mm v[56:59],v[28:31],v[72:75],v[56:59]
cv v125,v22,v23
v_or3_b32 v12, v124, v125, v12
mm v[56:59],v[28:31],v[88:91],v[56:59]
buffer_load_dwordx4 v10, s[8:11], s47 offen offset:0 sc1 lds
mm a[96:99],a[240:243],v[64:67],a[96:99]
v_exp_f32 v25, v253
mm a[96:99],a[244:247],v[80:83],a[96:99]
ds_read_b128 a[208:211], v2 offset:36864
cv v126,v24,v25
mm a[100:103],a[240:243],v[68:71],a[100:103]
buffer_load_dwordx4 v10, s[8:11], s47 offen offset:1024 sc1 lds
mm a[100:103],a[244:247],v[84:87],a[100:103]
v_exp_f32 v26, v254
mm a[104:107],a[240:243],v[72:75],a[104:107]
v_exp_f32 v27, v255
mm a[104:107],a[244:247],v[88:91],a[104:107]
buffer_load_dwordx4 v10, s[8:11], s47 offen offset:2048 sc1 lds
mm a[108:111],a[240:243],v[76:79],a[108:111]
ds_read_b128 a[212:215], v2 offset:37888
cv v127,v26,v27
mm a[108:111],a[244:247],v[92:95],a[108:111]
v_or3_b32 v12, v126, v127, v12
v_and_b32 v12, 0x40004000, v12
mm a[112:115],a[248:251],v[64:67],a[112:115]
buffer_load_dwordx4 v10, s[8:11], s47 offen offset:3072 sc1 lds
mm a[112:115],a[252:255],v[80:83],a[112:115]
ds_read_b128 a[216:219], v2 offset:38912
v_cmp_ne_u32 vcc, 0, v12
mm a[116:119],a[248:251],v[68:71],a[116:119]
mm a[116:119],a[252:255],v[84:87],a[116:119]
s_add_u32 s47, s47, 32768
mm a[120:123],a[248:251],v[72:75],a[120:123]
mm a[120:123],a[252:255],v[88:91],a[120:123]
mm a[124:127],a[248:251],v[76:79],a[124:127]
ds_read_b128 a[220:223], v2 offset:39936
s_cmp_eq_u32 s47, s34
s_cselect_b32 s47, 0, s47
s_cselect_b32 s10, s35, s10
mm a[124:127],a[252:255],v[92:95],a[124:127]
mm v[60:63],v[28:31],v[76:79],v[60:63]
mm v[60:63],v[28:31],v[92:95],v[60:63]
s_add_u32 s46, s46, 1
s_cbranch_vccz L_ok_mid1
s_call_b64 s[42:43], L_rare1
L_ok_mid1:
L_top0:
s_cmp_eq_u32 s46, s45
s_cbranch_scc1 L_evt0
L_mid0:
s_waitcnt lgkmcnt(4)
mm v[192:195],a[192:195],a[128:131],v[32:35]
v_exp_f32 v20, v128
mm v[192:195],a[196:199],a[132:135],v[192:195]
ds_read_b128 a[224:227], v2 offset:40960
s_add_u32 m0, s49, 65536
mm v[192:195],a[200:203],a[136:139],v[192:195]
v_exp_f32 v21, v129
mm v[192:195],a[204:207],a[140:143],v[192:195]
v_exp_f32 v22, v130
mm v[196:199],a[192:195],a[144:147],v[36:39]
buffer_load_dwordx4 v5, s[16:19], s48 offen offset:0 sc1 lds
mm v[196:199],a[196:199],a[148:151],v[196:199]
cv v64,v20,v21
ds_read_b128 a[228:231], v2 offset:41984
mm v[196:199],a[200:203],a[152:155],v[196:199]
v_exp_f32 v23, v131
mm v[196:199],a[204:207],a[156:159],v[196:199]
v_exp_f32 v24, v144
mm v[200:203],a[192:195],a[160:163],v[40:43]
cv v65,v22,v23
ds_read_b128 a[232:235], v2 offset:43008
mm v[200:203],a[196:199],a[164:167],v[200:203]
v_exp_f32 v25, v145
mm v[200:203],a[200:203],a[168:171],v[200:203]
buffer_load_dwordx4 v5, s[16:19], s48 offen offset:1024 sc1 lds
mm v[200:203],a[204:207],a[172:175],v[200:203]
v_exp_f32 v26, v146
mm v[204:207],a[192:195],a[176:179],v[44:47]
ds_read_b128 a[236:239], v2 offset:44032
v_or_b32 v12, v64, v65
mm v[204:207],a[196:199],a[180:183],v[204:207]
v_exp_f32 v27, v147
mm v[204:207],a[200:203],a[184:187],v[204:207]
buffer_load_dwordx4 v5, s[16:19], s48 offen offset:2048 sc1 lds
mm v[204:207],a[204:207],a[188:191],v[204:207]
cv v66,v24,v25
s_waitcnt lgkmcnt(4)
mm v[208:211],a[208:211],a[128:131],v[32:35]
v_exp_f32 v20, v132
mm v[208:211],a[212:215],a[132:135],v[208:211]
cv v67,v26,v27
ds_read_b128 a[240:243], v2 offset:45056
mm v[208:211],a[216:219],a[136:139],v[208:211]
v_exp_f32 v21, v133
mm v[208:211],a[220:223],a[140:143],v[208:211]
v_exp_f32 v22, v134
mm v[212:215],a[208:211],a[144:147],v[36:39]
buffer_load_dwordx4 v5, s[16:19], s48 offen offset:3072 sc1 lds
mm v[212:215],a[212:215],a[148:151],v[212:215]
v_or3_b32 v12, v66, v67, v12
cv v68,v20,v21
mm v[212:215],a[216:219],a[152:155],v[212:215]
v_exp_f32 v23, v135
mm v[212:215],a[220:223],a[156:159],v[212:215]
v_exp_f32 v24, v148
mm v[216:219],a[208:211],a[160:163],v[40:43]
ds_read_b128 a[244:247], v2 offset:46080
cv v69,v22,v23
mm v[216:219],a[212:215],a[164:167],v[216:219]
v_exp_f32 v25, v149
mm v[216:219],a[216:219],a[168:171],v[216:219]
ds_read_b128 a[248:251], v2 offset:47104
s_add_u32 m0, s49, 69632
mm v[216:219],a[220:223],a[172:175],v[216:219]
v_exp_f32 v26, v150
mm v[220:223],a[208:211],a[176:179],v[44:47]
ds_read_b128 a[252:255], v2 offset:48128
v_or3_b32 v12, v68, v69, v12
mm v[220:223],a[212:215],a[180:183],v[220:223]
v_exp_f32 v27, v151
mm v[220:223],a[216:219],a[184:187],v[220:223]
buffer_load_dwordx4 v10, s[16:19], s48 offen offset:0 sc1 lds
mm v[220:223],a[220:223],a[188:191],v[220:223]
cv v70,v24,v25
s_waitcnt lgkmcnt(4)
mm v[224:227],a[224:227],a[128:131],v[32:35]
v_exp_f32 v20, v136
mm v[224:227],a[228:231],a[132:135],v[224:227]
cv v71,v26,v27
ds_read_b128 a[192:195], v3 offset:32768
mm v[224:227],a[232:235],a[136:139],v[224:227]
v_exp_f32 v21, v137
mm v[224:227],a[236:239],a[140:143],v[224:227]
buffer_load_dwordx4 v10, s[16:19], s48 offen offset:1024 sc1 lds
mm v[228:231],a[224:227],a[144:147],v[36:39]
v_exp_f32 v22, v138
mm v[228:231],a[228:231],a[148:151],v[228:231]
v_or3_b32 v12, v70, v71, v12
cv v72,v20,v21
mm v[228:231],a[232:235],a[152:155],v[228:231]
v_exp_f32 v23, v139
mm v[228:231],a[236:239],a[156:159],v[228:231]
v_exp_f32 v24, v152
mm v[232:235],a[224:227],a[160:163],v[40:43]
buffer_load_dwordx4 v10, s[16:19], s48 offen offset:2048 sc1 lds
mm v[232:235],a[228:231],a[164:167],v[232:235]
ds_read_b128 a[196:199], v3 offset:40960
cv v73,v22,v23
mm v[232:235],a[232:235],a[168:171],v[232:235]
v_exp_f32 v25, v153
mm v[232:235],a[236:239],a[172:175],v[232:235]
v_exp_f32 v26, v154
mm v[236:239],a[224:227],a[176:179],v[44:47]
ds_read_b128 a[200:203], v3 offset:33792
ds_read_b128 a[204:207], v3 offset:41984
mm v[236:239],a[228:231],a[180:183],v[236:239]
buffer_load_dwordx4 v10, s[16:19], s48 offen offset:3072 sc1 lds
mm v[236:239],a[232:235],a[184:187],v[236:239]
v_or3_b32 v12, v72, v73, v12
cv v74,v24,v25
mm v[236:239],a[236:239],a[188:191],v[236:239]
v_exp_f32 v27, v155
s_waitcnt lgkmcnt(4)
mm v[240:243],a[240:243],a[128:131],v[32:35]
v_exp_f32 v20, v140
mm v[240:243],a[244:247],a[132:135],v[240:243]
cv v75,v26,v27
ds_read_b128 a[208:211], v3 offset:34816
mm v[240:243],a[248:251],a[136:139],v[240:243]
v_exp_f32 v21, v141
mm v[240:243],a[252:255],a[140:143],v[240:243]
v_exp_f32 v22, v142
mm v[244:247],a[240:243],a[144:147],v[36:39]
s_add_u32 s48, s48, 32768
v_or3_b32 v12, v74, v75, v12
mm v[244:247],a[244:247],a[148:151],v[244:247]
cv v76,v20,v21
ds_read_b128 a[212:215], v3 offset:43008
mm v[244:247],a[248:251],a[152:155],v[244:247]
v_exp_f32 v23, v143
mm v[244:247],a[252:255],a[156:159],v[244:247]
s_cmp_eq_u32 s48, s34
s_cselect_b32 s48, 0, s48
mm v[248:251],a[240:243],a[160:163],v[40:43]
v_exp_f32 v24, v156
mm v[248:251],a[244:247],a[164:167],v[248:251]
cv v77,v22,v23
ds_read_b128 a[216:219], v3 offset:35840
mm v[248:251],a[248:251],a[168:171],v[248:251]
v_exp_f32 v25, v157
mm v[248:251],a[252:255],a[172:175],v[248:251]
v_exp_f32 v26, v158
mm v[252:255],a[240:243],a[176:179],v[44:47]
ds_read_b128 a[220:223], v3 offset:44032
v_or3_b32 v12, v76, v77, v12
mm v[252:255],a[244:247],a[180:183],v[252:255]
buffer_load_dword v18, v19, s[24:27], s39 offen
mm v[252:255],a[248:251],a[184:187],v[252:255]
v_exp_f32 v27, v159
mm v[252:255],a[252:255],a[188:191],v[252:255]
cv v78,v24,v25
s_waitcnt lgkmcnt(4)
mm a[0:3],a[192:195],v[96:99],a[0:3]
s_add_u32 s39, s39, 2048
cv v79,v26,v27
mm a[0:3],a[196:199],v[112:115],a[0:3]
v_exp_f32 v20, v160
mm a[4:7],a[192:195],v[100:103],a[4:7]
v_exp_f32 v21, v161
mm a[4:7],a[196:199],v[116:119],a[4:7]
v_exp_f32 v22, v162
mm a[8:11],a[192:195],v[104:107],a[8:11]
ds_read_b128 a[224:227], v4 offset:36864
v_or3_b32 v12, v78, v79, v12
mm a[8:11],a[196:199],v[120:123],a[8:11]
v_exp_f32 v23, v163
mm a[12:15],a[192:195],v[108:111],a[12:15]
cv v80,v20,v21
ds_read_b128 a[228:231], v4 offset:45056
mm a[12:15],a[196:199],v[124:127],a[12:15]
v_exp_f32 v24, v176
mm a[16:19],a[200:203],v[96:99],a[16:19]
v_exp_f32 v25, v177
mm a[16:19],a[204:207],v[112:115],a[16:19]
cv v81,v22,v23
ds_read_b128 a[232:235], v4 offset:37888
mm a[20:23],a[200:203],v[100:103],a[20:23]
v_exp_f32 v26, v178
mm a[20:23],a[204:207],v[116:119],a[20:23]
v_or3_b32 v12, v80, v81, v12
cv v82,v24,v25
mm a[24:27],a[200:203],v[104:107],a[24:27]
ds_read_b128 a[236:239], v4 offset:46080
v_exp_f32 v27, v179
mm a[24:27],a[204:207],v[120:123],a[24:27]
v_exp_f32 v20, v164
mm a[28:31],a[200:203],v[108:111],a[28:31]
v_exp_f32 v21, v165
mm a[28:31],a[204:207],v[124:127],a[28:31]
cv v83,v26,v27
v_or3_b32 v12, v82, v83, v12
mm v[48:51],v[28:31],v[96:99],v[48:51]
v_exp_f32 v22, v166
mm v[48:51],v[28:31],v[112:115],v[48:51]
cv v84,v20,v21
s_waitcnt lgkmcnt(4)
mm a[32:35],a[208:211],v[96:99],a[32:35]
v_exp_f32 v23, v167
mm a[32:35],a[212:215],v[112:115],a[32:35]
ds_read_b128 a[240:243], v4 offset:38912
cv v85,v22,v23
mm a[36:39],a[208:211],v[100:103],a[36:39]
v_exp_f32 v24, v180
mm a[36:39],a[212:215],v[116:119],a[36:39]
ds_read_b128 a[244:247], v4 offset:47104
v_or3_b32 v12, v84, v85, v12
mm a[40:43],a[208:211],v[104:107],a[40:43]
v_exp_f32 v25, v181
mm a[40:43],a[212:215],v[120:123],a[40:43]
v_exp_f32 v26, v182
mm a[44:47],a[208:211],v[108:111],a[44:47]
ds_read_b128 a[248:251], v4 offset:39936
cv v86,v24,v25
mm a[44:47],a[212:215],v[124:127],a[44:47]
v_exp_f32 v27, v183
mm a[48:51],a[216:219],v[96:99],a[48:51]
v_exp_f32 v20, v168
mm a[48:51],a[220:223],v[112:115],a[48:51]
v_exp_f32 v21, v169
mm a[52:55],a[216:219],v[100:103],a[52:55]
ds_read_b128 a[252:255], v4 offset:48128
cv v87,v26,v27
mm a[52:55],a[220:223],v[116:119],a[52:55]
v_exp_f32 v22, v170
mm a[56:59],a[216:219],v[104:107],a[56:59]
v_or3_b32 v12, v86, v87, v12
cv v88,v20,v21
mm a[56:59],a[220:223],v[120:123],a[56:59]
v_exp_f32 v23, v171
mm a[60:63],a[216:219],v[108:111],a[60:63]
v_exp_f32 v24, v184
mm a[60:63],a[220:223],v[124:127],a[60:63]
v_exp_f32 v25, v185
mm v[52:55],v[28:31],v[100:103],v[52:55]
v_exp_f32 v26, v186
mm v[52:55],v[28:31],v[116:119],v[52:55]
s_waitcnt vmcnt(1) lgkmcnt(0)
s_barrier
mm a[64:67],a[224:227],v[96:99],a[64:67]
ds_read_b128 a[192:195], v2 offset:0
s_add_u32 m0, s49, 32768
mm a[64:67],a[228:231],v[112:115],a[64:67]
cv v89,v22,v23
v_or3_b32 v12, v88, v89, v12
mm a[68:71],a[224:227],v[100:103],a[68:71]
buffer_load_dwordx4 v5, s[8:11], s47 offen offset:0 sc1 lds
mm a[68:71],a[228:231],v[116:119],a[68:71]
v_exp_f32 v27, v187
mm a[72:75],a[224:227],v[104:107],a[72:75]
ds_read_b128 a[196:199], v2 offset:1024
cv v90,v24,v25
mm a[72:75],a[228:231],v[120:123],a[72:75]
buffer_load_dwordx4 v5, s[8:11], s47 offen offset:1024 sc1 lds
mm a[76:79],a[224:227],v[108:111],a[76:79]
v_exp_f32 v20, v172
mm a[76:79],a[228:231],v[124:127],a[76:79]
v_exp_f32 v21, v173
mm a[80:83],a[232:235],v[96:99],a[80:83]
buffer_load_dwordx4 v5, s[8:11], s47 offen offset:2048 sc1 lds
mm a[80:83],a[236:239],v[112:115],a[80:83]
ds_read_b128 a[200:203], v2 offset:2048
cv v91,v26,v27
mm a[84:87],a[232:235],v[100:103],a[84:87]
v_exp_f32 v22, v174
mm a[84:87],a[236:239],v[116:119],a[84:87]
buffer_load_dwordx4 v5, s[8:11], s47 offen offset:3072 sc1 lds
mm a[88:91],a[232:235],v[104:107],a[88:91]
v_or3_b32 v12, v90, v91, v12
cv v92,v20,v21
mm a[88:91],a[236:239],v[120:123],a[88:91]
v_exp_f32 v23, v175
mm a[92:95],a[232:235],v[108:111],a[92:95]
ds_read_b128 a[204:207], v2 offset:3072
s_add_u32 m0, s49, 36864
mm a[92:95],a[236:239],v[124:127],a[92:95]
v_exp_f32 v24, v188
mm v[56:59],v[28:31],v[104:107],v[56:59]
cv v93,v22,v23
v_or3_b32 v12, v92, v93, v12
mm v[56:59],v[28:31],v[120:123],v[56:59]
buffer_load_dwordx4 v10, s[8:11], s47 offen offset:0 sc1 lds
mm a[96:99],a[240:243],v[96:99],a[96:99]
v_exp_f32 v25, v189
mm a[96:99],a[244:247],v[112:115],a[96:99]
ds_read_b128 a[208:211], v2 offset:4096
cv v94,v24,v25
mm a[100:103],a[240:243],v[100:103],a[100:103]
buffer_load_dwordx4 v10, s[8:11], s47 offen offset:1024 sc1 lds
mm a[100:103],a[244:247],v[116:119],a[100:103]
v_exp_f32 v26, v190
mm a[104:107],a[240:243],v[104:107],a[104:107]
v_exp_f32 v27, v191
mm a[104:107],a[244:247],v[120:123],a[104:107]
buffer_load_dwordx4 v10, s[8:11], s47 offen offset:2048 sc1 lds
mm a[108:111],a[240:243],v[108:111],a[108:111]
ds_read_b128 a[212:215], v2 offset:5120
cv v95,v26,v27
mm a[108:111],a[244:247],v[124:127],a[108:111]
v_or3_b32 v12, v94, v95, v12
v_and_b32 v12, 0x40004000, v12
mm a[112:115],a[248:251],v[96:99],a[112:115]
buffer_load_dwordx4 v10, s[8:11], s47 offen offset:3072 sc1 lds
mm a[112:115],a[252:255],v[112:115],a[112:115]
ds_read_b128 a[216:219], v2 offset:6144
v_cmp_ne_u32 vcc, 0, v12
mm a[116:119],a[248:251],v[100:103],a[116:119]
mm a[116:119],a[252:255],v[116:119],a[116:119]
s_add_u32 s47, s47, 32768
mm a[120:123],a[248:251],v[104:107],a[120:123]
mm a[120:123],a[252:255],v[120:123],a[120:123]
mm a[124:127],a[248:251],v[108:111],a[124:127]
ds_read_b128 a[220:223], v2 offset:7168
s_cmp_eq_u32 s47, s34
s_cselect_b32 s47, 0, s47
s_cselect_b32 s10, s35, s10
mm a[124:127],a[252:255],v[124:127],a[124:127]
mm v[60:63],v[28:31],v[108:111],v[60:63]
mm v[60:63],v[28:31],v[124:127],v[60:63]
s_add_u32 s46, s46, 1
s_cbranch_vccz L_ok_mid0
s_call_b64 s[42:43], L_rare0
L_ok_mid0:
s_branch L_top1
L_evt1:
s_cmp_eq_u32 s51, 0
s_cbranch_scc1 L_x1
s_call_b64 s[42:43], L_merge0
s_mov_b32 s51, 2
s_mov_b32 s36, 0
s_mov_b32 s45, 16
s_mov_b32 s50, s33
s_branch L_top1
L_evt0:
s_cmp_eq_u32 s51, 0
s_cbranch_scc1 L_x0
s_cmp_eq_u32 s51, 2
s_cbranch_scc1 L_last
s_call_b64 s[42:43], L_merge1
s_mov_b32 s51, 2
s_mov_b32 s36, 0
s_mov_b32 s45, 16
s_mov_b32 s50, s33
s_branch L_top0
L_x1:
ds_read_b128 a[224:227], v3 offset:0
ds_read_b128 a[228:231], v3 offset:8192
ds_read_b128 a[232:235], v3 offset:1024
ds_read_b128 a[236:239], v3 offset:9216
ds_read_b128 a[128:131], v13 offset:0
ds_read_b128 a[132:135], v13 offset:1024
ds_read_b128 a[136:139], v13 offset:2048
ds_read_b128 a[140:143], v13 offset:3072
ds_read_b128 a[240:243], v3 offset:2048
ds_read_b128 a[244:247], v3 offset:10240
ds_read_b128 a[248:251], v3 offset:3072
ds_read_b128 a[252:255], v3 offset:11264
v_mov_b32 v14, v32
v_mov_b32 v15, v36
v_mov_b32 v16, v40
v_mov_b32 v17, v44
v_cndmask_b32 v192, v11, v192, s[54:55]
v_cndmask_b32 v193, v11, v193, s[56:57]
v_exp_f32 v20, v192
ds_read_b128 a[144:147], v13 offset:4096
v_exp_f32 v21, v193
ds_read_b128 a[148:151], v13 offset:5120
v_cndmask_b32 v194, v11, v194, s[58:59]
v_cndmask_b32 v195, v11, v195, s[60:61]
ds_read_b128 a[152:155], v13 offset:6144
v_exp_f32 v22, v194
cv v96,v20,v21
ds_read_b128 a[156:159], v13 offset:7168
v_exp_f32 v23, v195
s_waitcnt lgkmcnt(8)
mm a[0:3],a[224:227],v[64:67],a[0:3]
v_cndmask_b32 v208, v11, v208, s[62:63]
v_cndmask_b32 v209, v11, v209, s[62:63]
mm a[0:3],a[228:231],v[80:83],a[0:3]
v_exp_f32 v24, v208
ds_read_b128 a[160:163], v13 offset:8192
mm a[4:7],a[224:227],v[68:71],a[4:7]
s_add_u32 m0, s49, 98304
cv v97,v22,v23
v_exp_f32 v25, v209
mm a[4:7],a[228:231],v[84:87],a[4:7]
ds_read_b128 a[164:167], v13 offset:9216
v_cndmask_b32 v210, v11, v210, s[62:63]
mm a[8:11],a[224:227],v[72:75],a[8:11]
v_cndmask_b32 v211, v11, v211, s[62:63]
ds_read_b128 a[168:171], v13 offset:10240
mm a[8:11],a[228:231],v[88:91],a[8:11]
buffer_load_dwordx4 v5, s[16:19], s48 offen offset:0 sc1 lds
v_or_b32 v12, v96, v97
mm a[12:15],a[224:227],v[76:79],a[12:15]
v_exp_f32 v26, v210
cv v98,v24,v25
mm a[12:15],a[228:231],v[92:95],a[12:15]
v_exp_f32 v27, v211
ds_read_b128 a[172:175], v13 offset:11264
mm a[16:19],a[232:235],v[64:67],a[16:19]
buffer_load_dwordx4 v5, s[16:19], s48 offen offset:1024 sc1 lds
ds_read_b128 a[176:179], v13 offset:12288
mm a[16:19],a[236:239],v[80:83],a[16:19]
v_cndmask_b32 v196, v11, v196, s[52:53]
v_cndmask_b32 v197, v11, v197, s[52:53]
cv v99,v26,v27
mm a[20:23],a[232:235],v[68:71],a[20:23]
v_exp_f32 v20, v196
ds_read_b128 a[180:183], v13 offset:13312
mm a[20:23],a[236:239],v[84:87],a[20:23]
v_exp_f32 v21, v197
v_cndmask_b32 v198, v11, v198, s[52:53]
mm a[24:27],a[232:235],v[72:75],a[24:27]
buffer_load_dwordx4 v5, s[16:19], s48 offen offset:2048 sc1 lds
ds_read_b128 a[184:187], v13 offset:14336
mm a[24:27],a[236:239],v[88:91],a[24:27]
v_exp_f32 v22, v198
v_cndmask_b32 v199, v11, v199, s[52:53]
mm a[28:31],a[232:235],v[76:79],a[28:31]
ds_read_b128 a[188:191], v13 offset:15360
v_or3_b32 v12, v98, v99, v12
cv v100,v20,v21
mm a[28:31],a[236:239],v[92:95],a[28:31]
buffer_load_dwordx4 v5, s[16:19], s48 offen offset:3072 sc1 lds
mm v[48:51],v[28:31],v[64:67],v[48:51]
v_exp_f32 v23, v199
v_cndmask_b32 v212, v11, v212, s[54:55]
mm v[48:51],v[28:31],v[80:83],v[48:51]
v_cndmask_b32 v213, v11, v213, s[56:57]
cv v101,v22,v23
s_waitcnt lgkmcnt(12)
mm a[32:35],a[240:243],v[64:67],a[32:35]
v_exp_f32 v24, v212
v_exp_f32 v25, v213
mm a[32:35],a[244:247],v[80:83],a[32:35]
s_add_u32 m0, s49, 102400
v_cndmask_b32 v214, v11, v214, s[58:59]
mm a[36:39],a[240:243],v[68:71],a[36:39]
ds_read_b128 a[224:227], v4 offset:4096
v_cndmask_b32 v215, v11, v215, s[60:61]
v_or3_b32 v12, v100, v101, v12
mm a[36:39],a[244:247],v[84:87],a[36:39]
v_exp_f32 v26, v214
cv v102,v24,v25
mm a[40:43],a[240:243],v[72:75],a[40:43]
buffer_load_dwordx4 v10, s[16:19], s48 offen offset:0 sc1 lds
v_exp_f32 v27, v215
mm a[40:43],a[244:247],v[88:91],a[40:43]
v_cndmask_b32 v200, v11, v200, s[52:53]
v_cndmask_b32 v201, v11, v201, s[52:53]
mm a[44:47],a[240:243],v[76:79],a[44:47]
v_exp_f32 v20, v200
ds_read_b128 a[228:231], v4 offset:12288
mm a[44:47],a[244:247],v[92:95],a[44:47]
cv v103,v26,v27
v_exp_f32 v21, v201
mm a[48:51],a[248:251],v[64:67],a[48:51]
buffer_load_dwordx4 v10, s[16:19], s48 offen offset:1024 sc1 lds
mm a[48:51],a[252:255],v[80:83],a[48:51]
v_cndmask_b32 v202, v11, v202, s[52:53]
v_cndmask_b32 v203, v11, v203, s[52:53]
mm a[52:55],a[248:251],v[68:71],a[52:55]
ds_read_b128 a[232:235], v4 offset:5120
v_or3_b32 v12, v102, v103, v12
mm a[52:55],a[252:255],v[84:87],a[52:55]
buffer_load_dwordx4 v10, s[16:19], s48 offen offset:2048 sc1 lds
cv v104,v20,v21
v_exp_f32 v22, v202
mm a[56:59],a[248:251],v[72:75],a[56:59]
v_exp_f32 v23, v203
mm a[56:59],a[252:255],v[88:91],a[56:59]
v_cndmask_b32 v216, v11, v216, s[52:53]
v_cndmask_b32 v217, v11, v217, s[52:53]
mm a[60:63],a[248:251],v[76:79],a[60:63]
ds_read_b128 a[236:239], v4 offset:13312
cv v105,v22,v23
mm a[60:63],a[252:255],v[92:95],a[60:63]
buffer_load_dwordx4 v10, s[16:19], s48 offen offset:3072 sc1 lds
v_exp_f32 v24, v216
mm v[52:55],v[28:31],v[68:71],v[52:55]
v_exp_f32 v25, v217
mm v[52:55],v[28:31],v[84:87],v[52:55]
v_cndmask_b32 v218, v11, v218, s[52:53]
v_cndmask_b32 v219, v11, v219, s[52:53]
s_waitcnt lgkmcnt(4)
mm v[128:131],a[192:195],a[128:131],0
s_add_u32 s48, s48, 32768
v_or3_b32 v12, v104, v105, v12
mm v[128:131],a[196:199],a[132:135],v[128:131]
v_exp_f32 v26, v218
ds_read_b128 a[240:243], v4 offset:6144
cv v106,v24,v25
mm v[128:131],a[200:203],a[136:139],v[128:131]
v_exp_f32 v27, v219
mm v[128:131],a[204:207],a[140:143],v[128:131]
v_cndmask_b32 v204, v11, v204, s[52:53]
v_cndmask_b32 v205, v11, v205, s[52:53]
mm v[132:135],a[192:195],a[144:147],0
s_cmp_eq_u32 s48, s34
s_cselect_b32 s48, 0, s48
ds_read_b128 a[244:247], v4 offset:14336
mm v[132:135],a[196:199],a[148:151],v[132:135]
v_exp_f32 v20, v204
cv v107,v26,v27
mm v[132:135],a[200:203],a[152:155],v[132:135]
v_exp_f32 v21, v205
mm v[132:135],a[204:207],a[156:159],v[132:135]
v_cndmask_b32 v206, v11, v206, s[52:53]
v_cndmask_b32 v207, v11, v207, s[52:53]
mm v[136:139],a[192:195],a[160:163],0
ds_read_b128 a[248:251], v4 offset:7168
v_or3_b32 v12, v106, v107, v12
mm v[136:139],a[196:199],a[164:167],v[136:139]
v_exp_f32 v22, v206
cv v108,v20,v21
mm v[136:139],a[200:203],a[168:171],v[136:139]
v_exp_f32 v23, v207
mm v[136:139],a[204:207],a[172:175],v[136:139]
v_cndmask_b32 v220, v11, v220, s[52:53]
v_cndmask_b32 v221, v11, v221, s[52:53]
mm v[140:143],a[192:195],a[176:179],0
ds_read_b128 a[252:255], v4 offset:15360
cv v109,v22,v23
mm v[140:143],a[196:199],a[180:183],v[140:143]
v_exp_f32 v24, v220
mm v[140:143],a[200:203],a[184:187],v[140:143]
v_exp_f32 v25, v221
mm v[140:143],a[204:207],a[188:191],v[140:143]
v_cndmask_b32 v222, v11, v222, s[52:53]
s_waitcnt lgkmcnt(4)
mm a[64:67],a[224:227],v[64:67],a[64:67]
v_cndmask_b32 v223, v11, v223, s[52:53]
v_or3_b32 v12, v108, v109, v12
mm a[64:67],a[228:231],v[80:83],a[64:67]
v_exp_f32 v26, v222
cv v110,v24,v25
mm a[68:71],a[224:227],v[68:71],a[68:71]
v_exp_f32 v27, v223
mm a[68:71],a[228:231],v[84:87],a[68:71]
v_cndmask_b32 v224, v11, v224, s[62:63]
v_cndmask_b32 v225, v11, v225, s[62:63]
mm a[72:75],a[224:227],v[72:75],a[72:75]
v_exp_f32 v20, v224
mm a[72:75],a[228:231],v[88:91],a[72:75]
v_cndmask_b32 v128, v11, v128, s[66:67]
v_cndmask_b32 v129, v11, v129, s[68:69]
v_cndmask_b32 v130, v11, v130, s[70:71]
cv v111,v26,v27
mm a[76:79],a[224:227],v[76:79],a[76:79]
v_cndmask_b32 v131, v11, v131, s[72:73]
v_cndmask_b32 v132, v11, v132, s[84:85]
mm a[76:79],a[228:231],v[92:95],a[76:79]
v_cndmask_b32 v133, v11, v133, s[84:85]
v_cndmask_b32 v134, v11, v134, s[84:85]
v_cndmask_b32 v135, v11, v135, s[84:85]
mm a[80:83],a[232:235],v[64:67],a[80:83]
v_exp_f32 v21, v225
v_cndmask_b32 v136, v11, v136, s[84:85]
v_cndmask_b32 v137, v11, v137, s[84:85]
v_cndmask_b32 v226, v11, v226, s[62:63]
v_cndmask_b32 v227, v11, v227, s[62:63]
mm a[80:83],a[236:239],v[80:83],a[80:83]
v_cndmask_b32 v138, v11, v138, s[84:85]
v_cndmask_b32 v139, v11, v139, s[84:85]
v_cndmask_b32 v140, v11, v140, s[84:85]
mm a[84:87],a[232:235],v[68:71],a[84:87]
v_exp_f32 v22, v226
v_cndmask_b32 v141, v11, v141, s[84:85]
v_cndmask_b32 v142, v11, v142, s[84:85]
v_or3_b32 v12, v110, v111, v12
cv v112,v20,v21
mm a[84:87],a[236:239],v[84:87],a[84:87]
v_cndmask_b32 v143, v11, v143, s[84:85]
v_max3_f32 v33, v128, v129, v130
v_max3_f32 v37, v132, v133, v134
mm a[88:91],a[232:235],v[72:75],a[88:91]
v_exp_f32 v23, v227
v_max3_f32 v41, v136, v137, v138
v_max3_f32 v45, v140, v141, v142
v_cndmask_b32 v240, v11, v240, s[62:63]
v_cndmask_b32 v241, v11, v241, s[62:63]
mm a[88:91],a[236:239],v[88:91],a[88:91]
v_max_f32 v33, v131, v33
v_max_f32 v37, v135, v37
v_max_f32 v41, v139, v41
mm a[92:95],a[232:235],v[76:79],a[92:95]
v_exp_f32 v24, v240
v_max_f32 v45, v143, v45
v_mov_b32 v34, v33
cv v113,v22,v23
mm a[92:95],a[236:239],v[92:95],a[92:95]
v_mov_b32 v38, v37
v_mov_b32 v42, v41
v_mov_b32 v46, v45
mm v[56:59],v[28:31],v[72:75],v[56:59]
v_exp_f32 v25, v241
v_permlane16_swap_b32 v33, v34
v_permlane16_swap_b32 v37, v38
v_cndmask_b32 v242, v11, v242, s[62:63]
v_cndmask_b32 v243, v11, v243, s[62:63]
mm v[56:59],v[28:31],v[88:91],v[56:59]
v_permlane16_swap_b32 v41, v42
v_permlane16_swap_b32 v45, v46
v_max_f32 v33, v33, v34
s_waitcnt lgkmcnt(0)
mm a[96:99],a[240:243],v[64:67],a[96:99]
v_exp_f32 v26, v242
mm a[96:99],a[244:247],v[80:83],a[96:99]
v_max_f32 v37, v37, v38
v_max_f32 v41, v41, v42
v_max_f32 v45, v45, v46
mm a[100:103],a[240:243],v[68:71],a[100:103]
v_mov_b32 v34, v33
v_mov_b32 v38, v37
ds_read_b128 a[224:227], v2 offset:8192
mm a[100:103],a[244:247],v[84:87],a[100:103]
v_mov_b32 v42, v41
v_or3_b32 v12, v112, v113, v12
cv v114,v24,v25
mm a[104:107],a[240:243],v[72:75],a[104:107]
v_exp_f32 v27, v243
v_mov_b32 v46, v45
mm a[104:107],a[244:247],v[88:91],a[104:107]
v_permlane32_swap_b32 v33, v34
v_permlane32_swap_b32 v37, v38
v_permlane32_swap_b32 v41, v42
mm a[108:111],a[240:243],v[76:79],a[108:111]
v_permlane32_swap_b32 v45, v46
v_max_f32 v33, v33, v34
v_cndmask_b32 v228, v11, v228, s[62:63]
mm a[108:111],a[244:247],v[92:95],a[108:111]
v_cndmask_b32 v229, v11, v229, s[62:63]
v_max_f32 v37, v37, v38
v_max_f32 v41, v41, v42
mm a[112:115],a[248:251],v[64:67],a[112:115]
v_exp_f32 v20, v228
v_max_f32 v45, v45, v46
mm a[112:115],a[252:255],v[80:83],a[112:115]
ds_read_b128 a[228:231], v2 offset:9216
v_max_f32 v33, 0xf149f2ca, v33
cv v115,v26,v27
mm a[116:119],a[248:251],v[68:71],a[116:119]
v_exp_f32 v21, v229
v_max_f32 v37, 0xf149f2ca, v37
mm a[116:119],a[252:255],v[84:87],a[116:119]
v_max_f32 v41, 0xf149f2ca, v41
v_max_f32 v45, 0xf149f2ca, v45
mm a[120:123],a[248:251],v[72:75],a[120:123]
v_sub_f32 v32, 0xc1c00000, v33
v_sub_f32 v36, 0xc1c00000, v37
v_sub_f32 v40, 0xc1c00000, v41
mm a[120:123],a[252:255],v[88:91],a[120:123]
v_cndmask_b32 v230, v11, v230, s[62:63]
v_cndmask_b32 v231, v11, v231, s[62:63]
v_sub_f32 v44, 0xc1c00000, v45
mm a[124:127],a[248:251],v[76:79],a[124:127]
v_mov_b32 v33, v32
v_mov_b32 v34, v32
ds_read_b128 a[232:235], v2 offset:10240
v_mov_b32 v35, v32
v_mov_b32 v37, v36
v_mov_b32 v38, v36
v_mov_b32 v39, v36
v_mov_b32 v41, v40
v_mov_b32 v42, v40
v_mov_b32 v43, v40
v_mov_b32 v45, v44
v_mov_b32 v46, v44
ds_read_b128 a[236:239], v2 offset:11264
v_mov_b32 v47, v44
mm a[124:127],a[252:255],v[92:95],a[124:127]
v_exp_f32 v22, v230
mm v[60:63],v[28:31],v[76:79],v[60:63]
v_or3_b32 v12, v114, v115, v12
cv v116,v20,v21
mm v[60:63],v[28:31],v[92:95],v[60:63]
v_exp_f32 v23, v231
mm v[144:147],a[208:211],a[128:131],v[32:35]
v_cndmask_b32 v244, v11, v244, s[62:63]
v_cndmask_b32 v245, v11, v245, s[62:63]
mm v[144:147],a[212:215],a[132:135],v[144:147]
v_exp_f32 v24, v244
mm v[144:147],a[216:219],a[136:139],v[144:147]
v_exp_f32 v25, v245
mm v[144:147],a[220:223],a[140:143],v[144:147]
cv v117,v22,v23
v_cndmask_b32 v246, v11, v246, s[62:63]
mm v[148:151],a[208:211],a[144:147],v[36:39]
v_exp_f32 v26, v246
mm v[148:151],a[212:215],a[148:151],v[148:151]
v_cndmask_b32 v247, v11, v247, s[62:63]
v_or3_b32 v12, v116, v117, v12
mm v[148:151],a[216:219],a[152:155],v[148:151]
cv v118,v24,v25
ds_read_b128 a[240:243], v2 offset:12288
mm v[148:151],a[220:223],a[156:159],v[148:151]
v_exp_f32 v27, v247
mm v[152:155],a[208:211],a[160:163],v[40:43]
v_add_f32 v128, v128, v32
v_cndmask_b32 v232, v11, v232, s[54:55]
mm v[152:155],a[212:215],a[164:167],v[152:155]
v_exp_f32 v20, v232
v_cndmask_b32 v233, v11, v233, s[56:57]
mm v[152:155],a[216:219],a[168:171],v[152:155]
ds_read_b128 a[244:247], v2 offset:13312
ds_read_b128 a[248:251], v2 offset:14336
ds_read_b128 a[252:255], v2 offset:15360
mm v[152:155],a[220:223],a[172:175],v[152:155]
v_add_f32 v129, v129, v32
cv v119,v26,v27
v_exp_f32 v21, v233
mm v[156:159],a[208:211],a[176:179],v[44:47]
v_add_f32 v130, v130, v32
v_cndmask_b32 v234, v11, v234, s[58:59]
mm v[156:159],a[212:215],a[180:183],v[156:159]
v_exp_f32 v22, v234
v_cndmask_b32 v235, v11, v235, s[60:61]
mm v[156:159],a[216:219],a[184:187],v[156:159]
v_or3_b32 v12, v118, v119, v12
cv v120,v20,v21
v_add_f32 v131, v131, v32
mm v[156:159],a[220:223],a[188:191],v[156:159]
s_waitcnt vmcnt(0) lgkmcnt(0)
s_barrier
mm v[160:163],a[224:227],a[128:131],v[32:35]
v_exp_f32 v23, v235
v_cndmask_b32 v248, v11, v248, s[62:63]
mm v[160:163],a[228:231],a[132:135],v[160:163]
v_exp_f32 v24, v248
v_cndmask_b32 v249, v11, v249, s[62:63]
mm v[160:163],a[232:235],a[136:139],v[160:163]
v_add_f32 v132, v132, v36
cv v121,v22,v23
v_exp_f32 v25, v249
mm v[160:163],a[236:239],a[140:143],v[160:163]
v_add_f32 v133, v133, v36
v_cndmask_b32 v250, v11, v250, s[62:63]
mm v[164:167],a[224:227],a[144:147],v[36:39]
v_cndmask_b32 v251, v11, v251, s[62:63]
ds_read_b128 a[192:195], v2 offset:32768
s_add_u32 m0, s49, 0
mm v[164:167],a[228:231],a[148:151],v[164:167]
v_exp_f32 v26, v250
v_or3_b32 v12, v120, v121, v12
mm v[164:167],a[232:235],a[152:155],v[164:167]
buffer_load_dwordx4 v5, s[8:11], s47 offen offset:0 sc1 lds
cv v122,v24,v25
mm v[164:167],a[236:239],a[156:159],v[164:167]
v_exp_f32 v27, v251
v_add_f32 v134, v134, v36
mm v[168:171],a[224:227],a[160:163],v[40:43]
v_cndmask_b32 v236, v11, v236, s[52:53]
v_cndmask_b32 v237, v11, v237, s[52:53]
ds_read_b128 a[196:199], v2 offset:33792
mm v[168:171],a[228:231],a[164:167],v[168:171]
buffer_load_dwordx4 v5, s[8:11], s47 offen offset:1024 sc1 lds
v_add_f32 v135, v135, v36
mm v[168:171],a[232:235],a[168:171],v[168:171]
v_exp_f32 v20, v236
mm v[168:171],a[236:239],a[172:175],v[168:171]
v_exp_f32 v21, v237
cv v123,v26,v27
mm v[172:175],a[224:227],a[176:179],v[44:47]
ds_read_b128 a[200:203], v2 offset:34816
ds_read_b128 a[204:207], v2 offset:35840
v_add_f32 v136, v136, v40
mm v[172:175],a[228:231],a[180:183],v[172:175]
buffer_load_dwordx4 v5, s[8:11], s47 offen offset:2048 sc1 lds
v_cndmask_b32 v238, v11, v238, s[52:53]
mm v[172:175],a[232:235],a[184:187],v[172:175]
v_exp_f32 v22, v238
v_cndmask_b32 v239, v11, v239, s[52:53]
mm v[172:175],a[236:239],a[188:191],v[172:175]
buffer_load_dwordx4 v5, s[8:11], s47 offen offset:3072 sc1 lds
v_or3_b32 v12, v122, v123, v12
mm v[176:179],a[240:243],a[128:131],v[32:35]
cv v124,v20,v21
v_add_f32 v137, v137, v40
v_exp_f32 v23, v239
mm v[176:179],a[244:247],a[132:135],v[176:179]
v_cndmask_b32 v252, v11, v252, s[54:55]
v_cndmask_b32 v253, v11, v253, s[56:57]
mm v[176:179],a[248:251],a[136:139],v[176:179]
v_exp_f32 v24, v252
v_add_f32 v138, v138, v40
mm v[176:179],a[252:255],a[140:143],v[176:179]
s_add_u32 m0, s49, 4096
cv v125,v22,v23
v_add_f32 v139, v139, v40
mm v[180:183],a[240:243],a[144:147],v[36:39]
buffer_load_dwordx4 v10, s[8:11], s47 offen offset:0 sc1 lds
v_exp_f32 v25, v253
mm v[180:183],a[244:247],a[148:151],v[180:183]
ds_read_b128 a[208:211], v2 offset:36864
v_cndmask_b32 v254, v11, v254, s[58:59]
mm v[180:183],a[248:251],a[152:155],v[180:183]
v_exp_f32 v26, v254
mm v[180:183],a[252:255],a[156:159],v[180:183]
buffer_load_dwordx4 v10, s[8:11], s47 offen offset:1024 sc1 lds
v_cndmask_b32 v255, v11, v255, s[60:61]
mm v[184:187],a[240:243],a[160:163],v[40:43]
v_or3_b32 v12, v124, v125, v12
cv v126,v24,v25
v_add_f32 v140, v140, v44
mm v[184:187],a[244:247],a[164:167],v[184:187]
v_exp_f32 v27, v255
ds_read_b128 a[212:215], v2 offset:37888
mm v[184:187],a[248:251],a[168:171],v[184:187]
v_add_f32 v141, v141, v44
v_add_f32 v142, v142, v44
v_add_f32 v143, v143, v44
mm v[184:187],a[252:255],a[172:175],v[184:187]
buffer_load_dwordx4 v10, s[8:11], s47 offen offset:2048 sc1 lds
cv v127,v26,v27
mm v[188:191],a[240:243],a[176:179],v[44:47]
ds_read_b128 a[216:219], v2 offset:38912
ds_read_b128 a[220:223], v2 offset:39936
buffer_load_dwordx4 v10, s[8:11], s47 offen offset:3072 sc1 lds
mm v[188:191],a[244:247],a[180:183],v[188:191]
s_add_u32 s47, s47, 32768
v_or3_b32 v12, v126, v127, v12
mm v[188:191],a[248:251],a[184:187],v[188:191]
v_and_b32 v12, 0x40004000, v12
v_cmp_ne_u32 vcc, 0, v12
s_cmp_eq_u32 s47, s34
s_cselect_b32 s47, 0, s47
s_cselect_b32 s10, s35, s10
mm v[188:191],a[252:255],a[188:191],v[188:191]
s_add_u32 s46, s46, 1
s_cbranch_vccz L_ok_x1
s_call_b64 s[42:43], L_rarex1
L_ok_x1:
s_mov_b32 s36, 1
s_mov_b32 s51, 1
s_add_u32 s45, s46, 1
s_cmp_eq_u32 s46, 16
s_cbranch_scc1 L_last
s_branch L_mid0
L_x0:
ds_read_b128 a[224:227], v3 offset:32768
ds_read_b128 a[228:231], v3 offset:40960
ds_read_b128 a[232:235], v3 offset:33792
ds_read_b128 a[236:239], v3 offset:41984
ds_read_b128 a[128:131], v13 offset:0
ds_read_b128 a[132:135], v13 offset:1024
ds_read_b128 a[136:139], v13 offset:2048
ds_read_b128 a[140:143], v13 offset:3072
ds_read_b128 a[240:243], v3 offset:34816
ds_read_b128 a[244:247], v3 offset:43008
ds_read_b128 a[248:251], v3 offset:35840
ds_read_b128 a[252:255], v3 offset:44032
v_mov_b32 v14, v32
v_mov_b32 v15, v36
v_mov_b32 v16, v40
v_mov_b32 v17, v44
v_cndmask_b32 v128, v11, v128, s[54:55]
v_cndmask_b32 v129, v11, v129, s[56:57]
v_exp_f32 v20, v128
ds_read_b128 a[144:147], v13 offset:4096
v_exp_f32 v21, v129
ds_read_b128 a[148:151], v13 offset:5120
v_cndmask_b32 v130, v11, v130, s[58:59]
v_cndmask_b32 v131, v11, v131, s[60:61]
ds_read_b128 a[152:155], v13 offset:6144
v_exp_f32 v22, v130
cv v64,v20,v21
ds_read_b128 a[156:159], v13 offset:7168
v_exp_f32 v23, v131
s_waitcnt lgkmcnt(8)
mm a[0:3],a[224:227],v[96:99],a[0:3]
v_cndmask_b32 v144, v11, v144, s[62:63]
v_cndmask_b32 v145, v11, v145, s[62:63]
mm a[0:3],a[228:231],v[112:115],a[0:3]
v_exp_f32 v24, v144
ds_read_b128 a[160:163], v13 offset:8192
mm a[4:7],a[224:227],v[100:103],a[4:7]
s_add_u32 m0, s49, 65536
cv v65,v22,v23
v_exp_f32 v25, v145
mm a[4:7],a[228:231],v[116:119],a[4:7]
ds_read_b128 a[164:167], v13 offset:9216
v_cndmask_b32 v146, v11, v146, s[62:63]
mm a[8:11],a[224:227],v[104:107],a[8:11]
v_cndmask_b32 v147, v11, v147, s[62:63]
ds_read_b128 a[168:171], v13 offset:10240
mm a[8:11],a[228:231],v[120:123],a[8:11]
buffer_load_dwordx4 v5, s[16:19], s48 offen offset:0 sc1 lds
v_or_b32 v12, v64, v65
mm a[12:15],a[224:227],v[108:111],a[12:15]
v_exp_f32 v26, v146
cv v66,v24,v25
mm a[12:15],a[228:231],v[124:127],a[12:15]
v_exp_f32 v27, v147
ds_read_b128 a[172:175], v13 offset:11264
mm a[16:19],a[232:235],v[96:99],a[16:19]
buffer_load_dwordx4 v5, s[16:19], s48 offen offset:1024 sc1 lds
ds_read_b128 a[176:179], v13 offset:12288
mm a[16:19],a[236:239],v[112:115],a[16:19]
v_cndmask_b32 v132, v11, v132, s[52:53]
v_cndmask_b32 v133, v11, v133, s[52:53]
cv v67,v26,v27
mm a[20:23],a[232:235],v[100:103],a[20:23]
v_exp_f32 v20, v132
ds_read_b128 a[180:183], v13 offset:13312
mm a[20:23],a[236:239],v[116:119],a[20:23]
v_exp_f32 v21, v133
v_cndmask_b32 v134, v11, v134, s[52:53]
mm a[24:27],a[232:235],v[104:107],a[24:27]
buffer_load_dwordx4 v5, s[16:19], s48 offen offset:2048 sc1 lds
ds_read_b128 a[184:187], v13 offset:14336
mm a[24:27],a[236:239],v[120:123],a[24:27]
v_exp_f32 v22, v134
v_cndmask_b32 v135, v11, v135, s[52:53]
mm a[28:31],a[232:235],v[108:111],a[28:31]
ds_read_b128 a[188:191], v13 offset:15360
v_or3_b32 v12, v66, v67, v12
cv v68,v20,v21
mm a[28:31],a[236:239],v[124:127],a[28:31]
buffer_load_dwordx4 v5, s[16:19], s48 offen offset:3072 sc1 lds
mm v[48:51],v[28:31],v[96:99],v[48:51]
v_exp_f32 v23, v135
v_cndmask_b32 v148, v11, v148, s[54:55]
mm v[48:51],v[28:31],v[112:115],v[48:51]
v_cndmask_b32 v149, v11, v149, s[56:57]
cv v69,v22,v23
s_waitcnt lgkmcnt(12)
mm a[32:35],a[240:243],v[96:99],a[32:35]
v_exp_f32 v24, v148
v_exp_f32 v25, v149
mm a[32:35],a[244:247],v[112:115],a[32:35]
s_add_u32 m0, s49, 69632
v_cndmask_b32 v150, v11, v150, s[58:59]
mm a[36:39],a[240:243],v[100:103],a[36:39]
ds_read_b128 a[224:227], v4 offset:36864
v_cndmask_b32 v151, v11, v151, s[60:61]
v_or3_b32 v12, v68, v69, v12
mm a[36:39],a[244:247],v[116:119],a[36:39]
v_exp_f32 v26, v150
cv v70,v24,v25
mm a[40:43],a[240:243],v[104:107],a[40:43]
buffer_load_dwordx4 v10, s[16:19], s48 offen offset:0 sc1 lds
v_exp_f32 v27, v151
mm a[40:43],a[244:247],v[120:123],a[40:43]
v_cndmask_b32 v136, v11, v136, s[52:53]
v_cndmask_b32 v137, v11, v137, s[52:53]
mm a[44:47],a[240:243],v[108:111],a[44:47]
v_exp_f32 v20, v136
ds_read_b128 a[228:231], v4 offset:45056
mm a[44:47],a[244:247],v[124:127],a[44:47]
cv v71,v26,v27
v_exp_f32 v21, v137
mm a[48:51],a[248:251],v[96:99],a[48:51]
buffer_load_dwordx4 v10, s[16:19], s48 offen offset:1024 sc1 lds
mm a[48:51],a[252:255],v[112:115],a[48:51]
v_cndmask_b32 v138, v11, v138, s[52:53]
v_cndmask_b32 v139, v11, v139, s[52:53]
mm a[52:55],a[248:251],v[100:103],a[52:55]
ds_read_b128 a[232:235], v4 offset:37888
v_or3_b32 v12, v70, v71, v12
mm a[52:55],a[252:255],v[116:119],a[52:55]
buffer_load_dwordx4 v10, s[16:19], s48 offen offset:2048 sc1 lds
cv v72,v20,v21
v_exp_f32 v22, v138
mm a[56:59],a[248:251],v[104:107],a[56:59]
v_exp_f32 v23, v139
mm a[56:59],a[252:255],v[120:123],a[56:59]
v_cndmask_b32 v152, v11, v152, s[52:53]
v_cndmask_b32 v153, v11, v153, s[52:53]
mm a[60:63],a[248:251],v[108:111],a[60:63]
ds_read_b128 a[236:239], v4 offset:46080
cv v73,v22,v23
mm a[60:63],a[252:255],v[124:127],a[60:63]
buffer_load_dwordx4 v10, s[16:19], s48 offen offset:3072 sc1 lds
v_exp_f32 v24, v152
mm v[52:55],v[28:31],v[100:103],v[52:55]
v_exp_f32 v25, v153
mm v[52:55],v[28:31],v[116:119],v[52:55]
v_cndmask_b32 v154, v11, v154, s[52:53]
v_cndmask_b32 v155, v11, v155, s[52:53]
s_waitcnt lgkmcnt(4)
mm v[192:195],a[192:195],a[128:131],0
s_add_u32 s48, s48, 32768
v_or3_b32 v12, v72, v73, v12
mm v[192:195],a[196:199],a[132:135],v[192:195]
v_exp_f32 v26, v154
ds_read_b128 a[240:243], v4 offset:38912
cv v74,v24,v25
mm v[192:195],a[200:203],a[136:139],v[192:195]
v_exp_f32 v27, v155
mm v[192:195],a[204:207],a[140:143],v[192:195]
v_cndmask_b32 v140, v11, v140, s[52:53]
v_cndmask_b32 v141, v11, v141, s[52:53]
mm v[196:199],a[192:195],a[144:147],0
s_cmp_eq_u32 s48, s34
s_cselect_b32 s48, 0, s48
ds_read_b128 a[244:247], v4 offset:47104
mm v[196:199],a[196:199],a[148:151],v[196:199]
v_exp_f32 v20, v140
cv v75,v26,v27
mm v[196:199],a[200:203],a[152:155],v[196:199]
v_exp_f32 v21, v141
mm v[196:199],a[204:207],a[156:159],v[196:199]
v_cndmask_b32 v142, v11, v142, s[52:53]
v_cndmask_b32 v143, v11, v143, s[52:53]
mm v[200:203],a[192:195],a[160:163],0
ds_read_b128 a[248:251], v4 offset:39936
v_or3_b32 v12, v74, v75, v12
mm v[200:203],a[196:199],a[164:167],v[200:203]
v_exp_f32 v22, v142
cv v76,v20,v21
mm v[200:203],a[200:203],a[168:171],v[200:203]
v_exp_f32 v23, v143
mm v[200:203],a[204:207],a[172:175],v[200:203]
v_cndmask_b32 v156, v11, v156, s[52:53]
v_cndmask_b32 v157, v11, v157, s[52:53]
mm v[204:207],a[192:195],a[176:179],0
ds_read_b128 a[252:255], v4 offset:48128
cv v77,v22,v23
mm v[204:207],a[196:199],a[180:183],v[204:207]
v_exp_f32 v24, v156
mm v[204:207],a[200:203],a[184:187],v[204:207]
v_exp_f32 v25, v157
mm v[204:207],a[204:207],a[188:191],v[204:207]
v_cndmask_b32 v158, v11, v158, s[52:53]
s_waitcnt lgkmcnt(4)
mm a[64:67],a[224:227],v[96:99],a[64:67]
v_cndmask_b32 v159, v11, v159, s[52:53]
v_or3_b32 v12, v76, v77, v12
mm a[64:67],a[228:231],v[112:115],a[64:67]
v_exp_f32 v26, v158
cv v78,v24,v25
mm a[68:71],a[224:227],v[100:103],a[68:71]
v_exp_f32 v27, v159
mm a[68:71],a[228:231],v[116:119],a[68:71]
v_cndmask_b32 v160, v11, v160, s[62:63]
v_cndmask_b32 v161, v11, v161, s[62:63]
mm a[72:75],a[224:227],v[104:107],a[72:75]
v_exp_f32 v20, v160
mm a[72:75],a[228:231],v[120:123],a[72:75]
v_cndmask_b32 v192, v11, v192, s[66:67]
v_cndmask_b32 v193, v11, v193, s[68:69]
v_cndmask_b32 v194, v11, v194, s[70:71]
cv v79,v26,v27
mm a[76:79],a[224:227],v[108:111],a[76:79]
v_cndmask_b32 v195, v11, v195, s[72:73]
v_cndmask_b32 v196, v11, v196, s[84:85]
mm a[76:79],a[228:231],v[124:127],a[76:79]
v_cndmask_b32 v197, v11, v197, s[84:85]
v_cndmask_b32 v198, v11, v198, s[84:85]
v_cndmask_b32 v199, v11, v199, s[84:85]
mm a[80:83],a[232:235],v[96:99],a[80:83]
v_exp_f32 v21, v161
v_cndmask_b32 v200, v11, v200, s[84:85]
v_cndmask_b32 v201, v11, v201, s[84:85]
v_cndmask_b32 v162, v11, v162, s[62:63]
v_cndmask_b32 v163, v11, v163, s[62:63]
mm a[80:83],a[236:239],v[112:115],a[80:83]
v_cndmask_b32 v202, v11, v202, s[84:85]
v_cndmask_b32 v203, v11, v203, s[84:85]
v_cndmask_b32 v204, v11, v204, s[84:85]
mm a[84:87],a[232:235],v[100:103],a[84:87]
v_exp_f32 v22, v162
v_cndmask_b32 v205, v11, v205, s[84:85]
v_cndmask_b32 v206, v11, v206, s[84:85]
v_or3_b32 v12, v78, v79, v12
cv v80,v20,v21
mm a[84:87],a[236:239],v[116:119],a[84:87]
v_cndmask_b32 v207, v11, v207, s[84:85]
v_max3_f32 v33, v192, v193, v194
v_max3_f32 v37, v196, v197, v198
mm a[88:91],a[232:235],v[104:107],a[88:91]
v_exp_f32 v23, v163
v_max3_f32 v41, v200, v201, v202
v_max3_f32 v45, v204, v205, v206
v_cndmask_b32 v176, v11, v176, s[62:63]
v_cndmask_b32 v177, v11, v177, s[62:63]
mm a[88:91],a[236:239],v[120:123],a[88:91]
v_max_f32 v33, v195, v33
v_max_f32 v37, v199, v37
v_max_f32 v41, v203, v41
mm a[92:95],a[232:235],v[108:111],a[92:95]
v_exp_f32 v24, v176
v_max_f32 v45, v207, v45
v_mov_b32 v34, v33
cv v81,v22,v23
mm a[92:95],a[236:239],v[124:127],a[92:95]
v_mov_b32 v38, v37
v_mov_b32 v42, v41
v_mov_b32 v46, v45
mm v[56:59],v[28:31],v[104:107],v[56:59]
v_exp_f32 v25, v177
v_permlane16_swap_b32 v33, v34
v_permlane16_swap_b32 v37, v38
v_cndmask_b32 v178, v11, v178, s[62:63]
v_cndmask_b32 v179, v11, v179, s[62:63]
mm v[56:59],v[28:31],v[120:123],v[56:59]
v_permlane16_swap_b32 v41, v42
v_permlane16_swap_b32 v45, v46
v_max_f32 v33, v33, v34
s_waitcnt lgkmcnt(0)
mm a[96:99],a[240:243],v[96:99],a[96:99]
v_exp_f32 v26, v178
mm a[96:99],a[244:247],v[112:115],a[96:99]
v_max_f32 v37, v37, v38
v_max_f32 v41, v41, v42
v_max_f32 v45, v45, v46
mm a[100:103],a[240:243],v[100:103],a[100:103]
v_mov_b32 v34, v33
v_mov_b32 v38, v37
ds_read_b128 a[224:227], v2 offset:40960
mm a[100:103],a[244:247],v[116:119],a[100:103]
v_mov_b32 v42, v41
v_or3_b32 v12, v80, v81, v12
cv v82,v24,v25
mm a[104:107],a[240:243],v[104:107],a[104:107]
v_exp_f32 v27, v179
v_mov_b32 v46, v45
mm a[104:107],a[244:247],v[120:123],a[104:107]
v_permlane32_swap_b32 v33, v34
v_permlane32_swap_b32 v37, v38
v_permlane32_swap_b32 v41, v42
mm a[108:111],a[240:243],v[108:111],a[108:111]
v_permlane32_swap_b32 v45, v46
v_max_f32 v33, v33, v34
v_cndmask_b32 v164, v11, v164, s[62:63]
mm a[108:111],a[244:247],v[124:127],a[108:111]
v_cndmask_b32 v165, v11, v165, s[62:63]
v_max_f32 v37, v37, v38
v_max_f32 v41, v41, v42
mm a[112:115],a[248:251],v[96:99],a[112:115]
v_exp_f32 v20, v164
v_max_f32 v45, v45, v46
mm a[112:115],a[252:255],v[112:115],a[112:115]
ds_read_b128 a[228:231], v2 offset:41984
v_max_f32 v33, 0xf149f2ca, v33
cv v83,v26,v27
mm a[116:119],a[248:251],v[100:103],a[116:119]
v_exp_f32 v21, v165
v_max_f32 v37, 0xf149f2ca, v37
mm a[116:119],a[252:255],v[116:119],a[116:119]
v_max_f32 v41, 0xf149f2ca, v41
v_max_f32 v45, 0xf149f2ca, v45
mm a[120:123],a[248:251],v[104:107],a[120:123]
v_sub_f32 v32, 0xc1c00000, v33
v_sub_f32 v36, 0xc1c00000, v37
v_sub_f32 v40, 0xc1c00000, v41
mm a[120:123],a[252:255],v[120:123],a[120:123]
v_cndmask_b32 v166, v11, v166, s[62:63]
v_cndmask_b32 v167, v11, v167, s[62:63]
v_sub_f32 v44, 0xc1c00000, v45
mm a[124:127],a[248:251],v[108:111],a[124:127]
v_mov_b32 v33, v32
v_mov_b32 v34, v32
ds_read_b128 a[232:235], v2 offset:43008
v_mov_b32 v35, v32
v_mov_b32 v37, v36
v_mov_b32 v38, v36
v_mov_b32 v39, v36
v_mov_b32 v41, v40
v_mov_b32 v42, v40
v_mov_b32 v43, v40
v_mov_b32 v45, v44
v_mov_b32 v46, v44
ds_read_b128 a[236:239], v2 offset:44032
v_mov_b32 v47, v44
mm a[124:127],a[252:255],v[124:127],a[124:127]
v_exp_f32 v22, v166
mm v[60:63],v[28:31],v[108:111],v[60:63]
v_or3_b32 v12, v82, v83, v12
cv v84,v20,v21
mm v[60:63],v[28:31],v[124:127],v[60:63]
v_exp_f32 v23, v167
mm v[208:211],a[208:211],a[128:131],v[32:35]
v_cndmask_b32 v180, v11, v180, s[62:63]
v_cndmask_b32 v181, v11, v181, s[62:63]
mm v[208:211],a[212:215],a[132:135],v[208:211]
v_exp_f32 v24, v180
mm v[208:211],a[216:219],a[136:139],v[208:211]
v_exp_f32 v25, v181
mm v[208:211],a[220:223],a[140:143],v[208:211]
cv v85,v22,v23
v_cndmask_b32 v182, v11, v182, s[62:63]
mm v[212:215],a[208:211],a[144:147],v[36:39]
v_exp_f32 v26, v182
mm v[212:215],a[212:215],a[148:151],v[212:215]
v_cndmask_b32 v183, v11, v183, s[62:63]
v_or3_b32 v12, v84, v85, v12
mm v[212:215],a[216:219],a[152:155],v[212:215]
cv v86,v24,v25
ds_read_b128 a[240:243], v2 offset:45056
mm v[212:215],a[220:223],a[156:159],v[212:215]
v_exp_f32 v27, v183
mm v[216:219],a[208:211],a[160:163],v[40:43]
v_add_f32 v192, v192, v32
v_cndmask_b32 v168, v11, v168, s[54:55]
mm v[216:219],a[212:215],a[164:167],v[216:219]
v_exp_f32 v20, v168
v_cndmask_b32 v169, v11, v169, s[56:57]
mm v[216:219],a[216:219],a[168:171],v[216:219]
ds_read_b128 a[244:247], v2 offset:46080
ds_read_b128 a[248:251], v2 offset:47104
ds_read_b128 a[252:255], v2 offset:48128
mm v[216:219],a[220:223],a[172:175],v[216:219]
v_add_f32 v193, v193, v32
cv v87,v26,v27
v_exp_f32 v21, v169
mm v[220:223],a[208:211],a[176:179],v[44:47]
v_add_f32 v194, v194, v32
v_cndmask_b32 v170, v11, v170, s[58:59]
mm v[220:223],a[212:215],a[180:183],v[220:223]
v_exp_f32 v22, v170
v_cndmask_b32 v171, v11, v171, s[60:61]
mm v[220:223],a[216:219],a[184:187],v[220:223]
v_or3_b32 v12, v86, v87, v12
cv v88,v20,v21
v_add_f32 v195, v195, v32
mm v[220:223],a[220:223],a[188:191],v[220:223]
s_waitcnt vmcnt(0) lgkmcnt(0)
s_barrier
mm v[224:227],a[224:227],a[128:131],v[32:35]
v_exp_f32 v23, v171
v_cndmask_b32 v184, v11, v184, s[62:63]
mm v[224:227],a[228:231],a[132:135],v[224:227]
v_exp_f32 v24, v184
v_cndmask_b32 v185, v11, v185, s[62:63]
mm v[224:227],a[232:235],a[136:139],v[224:227]
v_add_f32 v196, v196, v36
cv v89,v22,v23
v_exp_f32 v25, v185
mm v[224:227],a[236:239],a[140:143],v[224:227]
v_add_f32 v197, v197, v36
v_cndmask_b32 v186, v11, v186, s[62:63]
mm v[228:231],a[224:227],a[144:147],v[36:39]
v_cndmask_b32 v187, v11, v187, s[62:63]
ds_read_b128 a[192:195], v2 offset:0
s_add_u32 m0, s49, 32768
mm v[228:231],a[228:231],a[148:151],v[228:231]
v_exp_f32 v26, v186
v_or3_b32 v12, v88, v89, v12
mm v[228:231],a[232:235],a[152:155],v[228:231]
buffer_load_dwordx4 v5, s[8:11], s47 offen offset:0 sc1 lds
cv v90,v24,v25
mm v[228:231],a[236:239],a[156:159],v[228:231]
v_exp_f32 v27, v187
v_add_f32 v198, v198, v36
mm v[232:235],a[224:227],a[160:163],v[40:43]
v_cndmask_b32 v172, v11, v172, s[52:53]
v_cndmask_b32 v173, v11, v173, s[52:53]
ds_read_b128 a[196:199], v2 offset:1024
mm v[232:235],a[228:231],a[164:167],v[232:235]
buffer_load_dwordx4 v5, s[8:11], s47 offen offset:1024 sc1 lds
v_add_f32 v199, v199, v36
mm v[232:235],a[232:235],a[168:171],v[232:235]
v_exp_f32 v20, v172
mm v[232:235],a[236:239],a[172:175],v[232:235]
v_exp_f32 v21, v173
cv v91,v26,v27
mm v[236:239],a[224:227],a[176:179],v[44:47]
ds_read_b128 a[200:203], v2 offset:2048
ds_read_b128 a[204:207], v2 offset:3072
v_add_f32 v200, v200, v40
mm v[236:239],a[228:231],a[180:183],v[236:239]
buffer_load_dwordx4 v5, s[8:11], s47 offen offset:2048 sc1 lds
v_cndmask_b32 v174, v11, v174, s[52:53]
mm v[236:239],a[232:235],a[184:187],v[236:239]
v_exp_f32 v22, v174
v_cndmask_b32 v175, v11, v175, s[52:53]
mm v[236:239],a[236:239],a[188:191],v[236:239]
buffer_load_dwordx4 v5, s[8:11], s47 offen offset:3072 sc1 lds
v_or3_b32 v12, v90, v91, v12
mm v[240:243],a[240:243],a[128:131],v[32:35]
cv v92,v20,v21
v_add_f32 v201, v201, v40
v_exp_f32 v23, v175
mm v[240:243],a[244:247],a[132:135],v[240:243]
v_cndmask_b32 v188, v11, v188, s[54:55]
v_cndmask_b32 v189, v11, v189, s[56:57]
mm v[240:243],a[248:251],a[136:139],v[240:243]
v_exp_f32 v24, v188
v_add_f32 v202, v202, v40
mm v[240:243],a[252:255],a[140:143],v[240:243]
s_add_u32 m0, s49, 36864
cv v93,v22,v23
v_add_f32 v203, v203, v40
mm v[244:247],a[240:243],a[144:147],v[36:39]
buffer_load_dwordx4 v10, s[8:11], s47 offen offset:0 sc1 lds
v_exp_f32 v25, v189
mm v[244:247],a[244:247],a[148:151],v[244:247]
ds_read_b128 a[208:211], v2 offset:4096
v_cndmask_b32 v190, v11, v190, s[58:59]
mm v[244:247],a[248:251],a[152:155],v[244:247]
v_exp_f32 v26, v190
mm v[244:247],a[252:255],a[156:159],v[244:247]
buffer_load_dwordx4 v10, s[8:11], s47 offen offset:1024 sc1 lds
v_cndmask_b32 v191, v11, v191, s[60:61]
mm v[248:251],a[240:243],a[160:163],v[40:43]
v_or3_b32 v12, v92, v93, v12
cv v94,v24,v25
v_add_f32 v204, v204, v44
mm v[248:251],a[244:247],a[164:167],v[248:251]
v_exp_f32 v27, v191
ds_read_b128 a[212:215], v2 offset:5120
mm v[248:251],a[248:251],a[168:171],v[248:251]
v_add_f32 v205, v205, v44
v_add_f32 v206, v206, v44
v_add_f32 v207, v207, v44
mm v[248:251],a[252:255],a[172:175],v[248:251]
buffer_load_dwordx4 v10, s[8:11], s47 offen offset:2048 sc1 lds
cv v95,v26,v27
mm v[252:255],a[240:243],a[176:179],v[44:47]
ds_read_b128 a[216:219], v2 offset:6144
ds_read_b128 a[220:223], v2 offset:7168
buffer_load_dwordx4 v10, s[8:11], s47 offen offset:3072 sc1 lds
mm v[252:255],a[244:247],a[180:183],v[252:255]
s_add_u32 s47, s47, 32768
v_or3_b32 v12, v94, v95, v12
mm v[252:255],a[248:251],a[184:187],v[252:255]
v_and_b32 v12, 0x40004000, v12
v_cmp_ne_u32 vcc, 0, v12
s_cmp_eq_u32 s47, s34
s_cselect_b32 s47, 0, s47
s_cselect_b32 s10, s35, s10
mm v[252:255],a[252:255],a[188:191],v[252:255]
s_add_u32 s46, s46, 1
s_cbranch_vccz L_ok_x0
s_call_b64 s[42:43], L_rarex0
L_ok_x0:
s_mov_b32 s36, 1
s_mov_b32 s51, 1
s_add_u32 s45, s46, 1
s_branch L_mid1
L_merge0:
s_lshl_b32 s4, s3, 13
s_add_u32 s5, s4, 131072
v_add_u32 v20, s5, v1
v_xor_b32 v22, 16384, v20
s_add_u32 s5, s4, 98304
v_add_u32 v23, s5, v1
v_xor_b32 v21, 16384, v23
s_lshl_b32 s4, s50, 3
s_lshl_b32 s5, s41, 2
s_add_u32 s4, s4, s5
s_lshl_b32 s4, s4, 7
s_lshl_b32 s5, s32, 2
s_add_u32 s4, s4, s5
s_lshl_b32 s5, s44, 1
s_add_u32 s4, s4, s5
s_lshl_b32 s6, s4, 10
s_nop 1
v_mov_b32 v24, v48
v_mov_b32 v25, v52
v_mov_b32 v26, v56
v_mov_b32 v27, v60
ds_write_b128 v22, v[14:17]
ds_write_b128 v22, v[24:27] offset:1024
ds_write_b128 v21, a[96:99] offset:0
ar v128,a0
ar v129,a1
ar v130,a2
ar v131,a3
ds_write_b128 v21, a[100:103] offset:1024
ar v132,a4
ar v133,a5
ar v134,a6
ar v135,a7
ds_write_b128 v21, a[104:107] offset:2048
ar v136,a8
ar v137,a9
ar v138,a10
ar v139,a11
ds_write_b128 v21, a[108:111] offset:3072
ar v140,a12
ar v141,a13
ar v142,a14
ar v143,a15
ds_write_b128 v21, a[112:115] offset:4096
ar v144,a16
ar v145,a17
ar v146,a18
ar v147,a19
ds_write_b128 v21, a[116:119] offset:5120
ar v148,a20
ar v149,a21
ar v150,a22
ar v151,a23
ds_write_b128 v21, a[120:123] offset:6144
ar v152,a24
ar v153,a25
ar v154,a26
ar v155,a27
ds_write_b128 v21, a[124:127] offset:7168
ar v156,a28
ar v157,a29
ar v158,a30
ar v159,a31
s_waitcnt lgkmcnt(0)
s_barrier
ds_read_b128 v[160:163], v20
ds_read_b128 v[164:167], v20 offset:1024
aw a0,0
aw a1,0
aw a2,0
aw a3,0
aw a4,0
aw a5,0
aw a6,0
aw a7,0
aw a8,0
aw a9,0
aw a10,0
aw a11,0
s_waitcnt lgkmcnt(0)
v_min_f32 v168, v14, v160
v_min_f32 v169, v15, v161
v_min_f32 v170, v16, v162
v_min_f32 v171, v17, v163
v_sub_f32 v6, v168, v14
v_sub_f32 v14, v168, v160
v_sub_f32 v7, v169, v15
ds_write_b128 v20, a[64:67] offset:0
v_sub_f32 v15, v169, v161
v_sub_f32 v8, v170, v16
v_sub_f32 v16, v170, v162
v_sub_f32 v9, v171, v17
v_sub_f32 v17, v171, v163
v_exp_f32 v6, v6
v_exp_f32 v14, v14
ds_write_b128 v20, a[68:71] offset:1024
v_exp_f32 v7, v7
v_exp_f32 v15, v15
v_exp_f32 v8, v8
v_exp_f32 v16, v16
v_exp_f32 v9, v9
v_exp_f32 v17, v17
v_mul_f32 v168, v6, v24
ds_write_b128 v20, a[72:75] offset:2048
v_mul_f32 v169, v7, v25
v_mul_f32 v170, v8, v26
v_mul_f32 v171, v9, v27
v_fmac_f32 v168, v14, v164
v_fmac_f32 v169, v15, v165
v_fmac_f32 v170, v16, v166
ds_write_b128 v20, a[76:79] offset:3072
v_fmac_f32 v171, v17, v167
v_rcp_f32 v168, v168
v_rcp_f32 v169, v169
v_rcp_f32 v170, v170
v_rcp_f32 v171, v171
v_mul_f32 v6, v6, v168
v_mul_f32 v14, v14, v168
ds_write_b128 v20, a[80:83] offset:4096
v_mul_f32 v7, v7, v169
v_mul_f32 v15, v15, v169
v_mul_f32 v8, v8, v170
v_mul_f32 v16, v16, v170
v_mul_f32 v9, v9, v171
v_mul_f32 v17, v17, v171
aw a12,0
ds_write_b128 v20, a[84:87] offset:5120
aw a13,0
aw a14,0
aw a15,0
aw a16,0
aw a17,0
aw a18,0
aw a19,0
ds_write_b128 v20, a[88:91] offset:6144
aw a20,0
aw a21,0
aw a22,0
aw a23,0
aw a24,0
aw a25,0
ds_write_b128 v20, a[92:95] offset:7168
aw a26,0
aw a27,0
aw a28,0
aw a29,0
aw a30,0
aw a31,0
aw a96,0
aw a97,0
aw a98,0
aw a99,0
aw a100,0
aw a101,0
aw a102,0
aw a103,0
s_waitcnt lgkmcnt(0)
s_barrier
ds_read_b128 v[160:163], v22 offset:0
ds_read_b128 v[164:167], v22 offset:1024
ds_read_b128 v[168:171], v22 offset:2048
ds_read_b128 v[172:175], v22 offset:3072
ds_read_b128 v[176:179], v22 offset:4096
ds_read_b128 v[180:183], v22 offset:5120
ds_read_b128 v[184:187], v22 offset:6144
ds_read_b128 v[188:191], v22 offset:7168
v_pk_mul_f32 v[128:129], v[128:129], v[6:7] op_sel_hi:[1,0]
v_pk_mul_f32 v[130:131], v[130:131], v[6:7] op_sel_hi:[1,0]
v_pk_mul_f32 v[132:133], v[132:133], v[6:7] op_sel:[0,1]
v_pk_mul_f32 v[134:135], v[134:135], v[6:7] op_sel:[0,1]
v_pk_mul_f32 v[136:137], v[136:137], v[8:9] op_sel_hi:[1,0]
v_pk_mul_f32 v[138:139], v[138:139], v[8:9] op_sel_hi:[1,0]
v_pk_mul_f32 v[140:141], v[140:141], v[8:9] op_sel:[0,1]
v_pk_mul_f32 v[142:143], v[142:143], v[8:9] op_sel:[0,1]
v_pk_mul_f32 v[144:145], v[144:145], v[6:7] op_sel_hi:[1,0]
v_pk_mul_f32 v[146:147], v[146:147], v[6:7] op_sel_hi:[1,0]
v_pk_mul_f32 v[148:149], v[148:149], v[6:7] op_sel:[0,1]
v_pk_mul_f32 v[150:151], v[150:151], v[6:7] op_sel:[0,1]
v_pk_mul_f32 v[152:153], v[152:153], v[8:9] op_sel_hi:[1,0]
v_pk_mul_f32 v[154:155], v[154:155], v[8:9] op_sel_hi:[1,0]
v_pk_mul_f32 v[156:157], v[156:157], v[8:9] op_sel:[0,1]
v_pk_mul_f32 v[158:159], v[158:159], v[8:9] op_sel:[0,1]
aw a104,0
aw a105,0
aw a106,0
aw a107,0
aw a108,0
aw a109,0
aw a110,0
aw a111,0
aw a112,0
aw a113,0
aw a114,0
aw a115,0
s_waitcnt lgkmcnt(0)
v_pk_fma_f32 v[128:129], v[160:161], v[14:15], v[128:129] op_sel_hi:[1,0,1]
v_pk_fma_f32 v[130:131], v[162:163], v[14:15], v[130:131] op_sel_hi:[1,0,1]
v_pk_fma_f32 v[144:145], v[176:177], v[14:15], v[144:145] op_sel_hi:[1,0,1]
v_pk_fma_f32 v[146:147], v[178:179], v[14:15], v[146:147] op_sel_hi:[1,0,1]
cv v96,v128,v129
cv v97,v130,v131
cv v98,v144,v145
cv v99,v146,v147
buffer_store_dwordx4 v[96:99], v1, s[20:23], s6 offen offset:0 sc1
s_add_u32 s6, s6, 131072
v_pk_fma_f32 v[132:133], v[164:165], v[14:15], v[132:133] op_sel:[0,1,0]
v_pk_fma_f32 v[134:135], v[166:167], v[14:15], v[134:135] op_sel:[0,1,0]
v_pk_fma_f32 v[148:149], v[180:181], v[14:15], v[148:149] op_sel:[0,1,0]
v_pk_fma_f32 v[150:151], v[182:183], v[14:15], v[150:151] op_sel:[0,1,0]
cv v100,v132,v133
cv v101,v134,v135
cv v102,v148,v149
cv v103,v150,v151
buffer_store_dwordx4 v[100:103], v1, s[20:23], s6 offen offset:0 sc1
s_add_u32 s6, s6, 131072
v_pk_fma_f32 v[136:137], v[168:169], v[16:17], v[136:137] op_sel_hi:[1,0,1]
v_pk_fma_f32 v[138:139], v[170:171], v[16:17], v[138:139] op_sel_hi:[1,0,1]
v_pk_fma_f32 v[152:153], v[184:185], v[16:17], v[152:153] op_sel_hi:[1,0,1]
v_pk_fma_f32 v[154:155], v[186:187], v[16:17], v[154:155] op_sel_hi:[1,0,1]
cv v104,v136,v137
cv v105,v138,v139
cv v106,v152,v153
cv v107,v154,v155
buffer_store_dwordx4 v[104:107], v1, s[20:23], s6 offen offset:0 sc1
s_add_u32 s6, s6, 131072
v_pk_fma_f32 v[140:141], v[172:173], v[16:17], v[140:141] op_sel:[0,1,0]
v_pk_fma_f32 v[142:143], v[174:175], v[16:17], v[142:143] op_sel:[0,1,0]
v_pk_fma_f32 v[156:157], v[188:189], v[16:17], v[156:157] op_sel:[0,1,0]
v_pk_fma_f32 v[158:159], v[190:191], v[16:17], v[158:159] op_sel:[0,1,0]
cv v108,v140,v141
cv v109,v142,v143
cv v110,v156,v157
cv v111,v158,v159
buffer_store_dwordx4 v[108:111], v1, s[20:23], s6 offen offset:0 sc1
s_add_u32 s6, s6, 4294574080
ds_read_b128 v[160:163], v23 offset:0
ds_read_b128 v[164:167], v23 offset:1024
ds_read_b128 v[168:171], v23 offset:2048
ds_read_b128 v[172:175], v23 offset:3072
ds_read_b128 v[176:179], v23 offset:4096
ds_read_b128 v[180:183], v23 offset:5120
ds_read_b128 v[184:187], v23 offset:6144
ds_read_b128 v[188:191], v23 offset:7168
ar v128,a32
ar v129,a33
ar v130,a34
ar v131,a35
ar v132,a36
ar v133,a37
ar v134,a38
ar v135,a39
ar v136,a40
ar v137,a41
ar v138,a42
ar v139,a43
ar v140,a44
ar v141,a45
ar v142,a46
ar v143,a47
ar v144,a48
ar v145,a49
ar v146,a50
ar v147,a51
ar v148,a52
ar v149,a53
ar v150,a54
ar v151,a55
ar v152,a56
ar v153,a57
ar v154,a58
ar v155,a59
ar v156,a60
ar v157,a61
ar v158,a62
ar v159,a63
v_pk_mul_f32 v[128:129], v[128:129], v[6:7] op_sel_hi:[1,0]
v_pk_mul_f32 v[130:131], v[130:131], v[6:7] op_sel_hi:[1,0]
v_pk_mul_f32 v[132:133], v[132:133], v[6:7] op_sel:[0,1]
v_pk_mul_f32 v[134:135], v[134:135], v[6:7] op_sel:[0,1]
v_pk_mul_f32 v[136:137], v[136:137], v[8:9] op_sel_hi:[1,0]
v_pk_mul_f32 v[138:139], v[138:139], v[8:9] op_sel_hi:[1,0]
v_pk_mul_f32 v[140:141], v[140:141], v[8:9] op_sel:[0,1]
v_pk_mul_f32 v[142:143], v[142:143], v[8:9] op_sel:[0,1]
v_pk_mul_f32 v[144:145], v[144:145], v[6:7] op_sel_hi:[1,0]
v_pk_mul_f32 v[146:147], v[146:147], v[6:7] op_sel_hi:[1,0]
v_pk_mul_f32 v[148:149], v[148:149], v[6:7] op_sel:[0,1]
v_pk_mul_f32 v[150:151], v[150:151], v[6:7] op_sel:[0,1]
v_pk_mul_f32 v[152:153], v[152:153], v[8:9] op_sel_hi:[1,0]
v_pk_mul_f32 v[154:155], v[154:155], v[8:9] op_sel_hi:[1,0]
v_pk_mul_f32 v[156:157], v[156:157], v[8:9] op_sel:[0,1]
v_pk_mul_f32 v[158:159], v[158:159], v[8:9] op_sel:[0,1]
s_waitcnt lgkmcnt(0)
v_pk_fma_f32 v[128:129], v[160:161], v[14:15], v[128:129] op_sel_hi:[1,0,1]
v_pk_fma_f32 v[130:131], v[162:163], v[14:15], v[130:131] op_sel_hi:[1,0,1]
v_pk_fma_f32 v[144:145], v[176:177], v[14:15], v[144:145] op_sel_hi:[1,0,1]
v_pk_fma_f32 v[146:147], v[178:179], v[14:15], v[146:147] op_sel_hi:[1,0,1]
cv v112,v128,v129
cv v113,v130,v131
cv v114,v144,v145
cv v115,v146,v147
buffer_store_dwordx4 v[112:115], v1, s[20:23], s6 offen offset:1024 sc1
s_add_u32 s6, s6, 131072
v_pk_fma_f32 v[132:133], v[164:165], v[14:15], v[132:133] op_sel:[0,1,0]
v_pk_fma_f32 v[134:135], v[166:167], v[14:15], v[134:135] op_sel:[0,1,0]
v_pk_fma_f32 v[148:149], v[180:181], v[14:15], v[148:149] op_sel:[0,1,0]
v_pk_fma_f32 v[150:151], v[182:183], v[14:15], v[150:151] op_sel:[0,1,0]
cv v116,v132,v133
cv v117,v134,v135
cv v118,v148,v149
cv v119,v150,v151
buffer_store_dwordx4 v[116:119], v1, s[20:23], s6 offen offset:1024 sc1
s_add_u32 s6, s6, 131072
v_pk_fma_f32 v[136:137], v[168:169], v[16:17], v[136:137] op_sel_hi:[1,0,1]
v_pk_fma_f32 v[138:139], v[170:171], v[16:17], v[138:139] op_sel_hi:[1,0,1]
v_pk_fma_f32 v[152:153], v[184:185], v[16:17], v[152:153] op_sel_hi:[1,0,1]
v_pk_fma_f32 v[154:155], v[186:187], v[16:17], v[154:155] op_sel_hi:[1,0,1]
cv v120,v136,v137
cv v121,v138,v139
cv v122,v152,v153
cv v123,v154,v155
buffer_store_dwordx4 v[120:123], v1, s[20:23], s6 offen offset:1024 sc1
s_add_u32 s6, s6, 131072
v_pk_fma_f32 v[140:141], v[172:173], v[16:17], v[140:141] op_sel:[0,1,0]
v_pk_fma_f32 v[142:143], v[174:175], v[16:17], v[142:143] op_sel:[0,1,0]
v_pk_fma_f32 v[156:157], v[188:189], v[16:17], v[156:157] op_sel:[0,1,0]
v_pk_fma_f32 v[158:159], v[190:191], v[16:17], v[158:159] op_sel:[0,1,0]
cv v124,v140,v141
cv v125,v142,v143
cv v126,v156,v157
cv v127,v158,v159
buffer_store_dwordx4 v[124:127], v1, s[20:23], s6 offen offset:1024 sc1
s_add_u32 s6, s6, 4294574080
aw a116,0
aw a117,0
aw a118,0
aw a119,0
aw a120,0
aw a121,0
aw a122,0
aw a123,0
aw a124,0
aw a125,0
aw a126,0
aw a127,0
v_mov_b32 v48, 0
v_mov_b32 v49, 0
v_mov_b32 v50, 0
v_mov_b32 v51, 0
v_mov_b32 v52, 0
v_mov_b32 v53, 0
v_mov_b32 v54, 0
v_mov_b32 v55, 0
v_mov_b32 v56, 0
v_mov_b32 v57, 0
v_mov_b32 v58, 0
v_mov_b32 v59, 0
v_mov_b32 v60, 0
v_mov_b32 v61, 0
v_mov_b32 v62, 0
v_mov_b32 v63, 0
aw a32,0
aw a33,0
aw a34,0
aw a35,0
aw a36,0
aw a37,0
aw a38,0
aw a39,0
aw a40,0
aw a41,0
aw a42,0
aw a43,0
aw a44,0
aw a45,0
aw a46,0
aw a47,0
aw a48,0
aw a49,0
aw a50,0
aw a51,0
aw a52,0
aw a53,0
aw a54,0
aw a55,0
aw a56,0
aw a57,0
aw a58,0
aw a59,0
aw a60,0
aw a61,0
aw a62,0
aw a63,0
aw a64,0
aw a65,0
aw a66,0
aw a67,0
aw a68,0
aw a69,0
aw a70,0
aw a71,0
aw a72,0
aw a73,0
aw a74,0
aw a75,0
aw a76,0
aw a77,0
aw a78,0
aw a79,0
aw a80,0
aw a81,0
aw a82,0
aw a83,0
aw a84,0
aw a85,0
aw a86,0
aw a87,0
aw a88,0
aw a89,0
aw a90,0
aw a91,0
aw a92,0
aw a93,0
aw a94,0
aw a95,0
s_nop 1
s_setpc_b64 s[42:43]
L_merge1:
s_lshl_b32 s4, s3, 13
s_add_u32 s5, s4, 131072
v_add_u32 v20, s5, v1
v_xor_b32 v22, 16384, v20
s_add_u32 s5, s4, 65536
v_add_u32 v23, s5, v1
v_xor_b32 v21, 16384, v23
s_lshl_b32 s4, s50, 3
s_lshl_b32 s5, s41, 2
s_add_u32 s4, s4, s5
s_lshl_b32 s4, s4, 7
s_lshl_b32 s5, s32, 2
s_add_u32 s4, s4, s5
s_lshl_b32 s5, s44, 1
s_add_u32 s4, s4, s5
s_lshl_b32 s6, s4, 10
s_nop 1
v_mov_b32 v24, v48
v_mov_b32 v25, v52
v_mov_b32 v26, v56
v_mov_b32 v27, v60
ds_write_b128 v22, v[14:17]
ds_write_b128 v22, v[24:27] offset:1024
ds_write_b128 v21, a[96:99] offset:0
ar v192,a0
ar v193,a1
ar v194,a2
ar v195,a3
ds_write_b128 v21, a[100:103] offset:1024
ar v196,a4
ar v197,a5
ar v198,a6
ar v199,a7
ds_write_b128 v21, a[104:107] offset:2048
ar v200,a8
ar v201,a9
ar v202,a10
ar v203,a11
ds_write_b128 v21, a[108:111] offset:3072
ar v204,a12
ar v205,a13
ar v206,a14
ar v207,a15
ds_write_b128 v21, a[112:115] offset:4096
ar v208,a16
ar v209,a17
ar v210,a18
ar v211,a19
ds_write_b128 v21, a[116:119] offset:5120
ar v212,a20
ar v213,a21
ar v214,a22
ar v215,a23
ds_write_b128 v21, a[120:123] offset:6144
ar v216,a24
ar v217,a25
ar v218,a26
ar v219,a27
ds_write_b128 v21, a[124:127] offset:7168
ar v220,a28
ar v221,a29
ar v222,a30
ar v223,a31
s_waitcnt lgkmcnt(0)
s_barrier
ds_read_b128 v[224:227], v20
ds_read_b128 v[228:231], v20 offset:1024
aw a0,0
aw a1,0
aw a2,0
aw a3,0
aw a4,0
aw a5,0
aw a6,0
aw a7,0
aw a8,0
aw a9,0
aw a10,0
aw a11,0
s_waitcnt lgkmcnt(0)
v_min_f32 v232, v14, v224
v_min_f32 v233, v15, v225
v_min_f32 v234, v16, v226
v_min_f32 v235, v17, v227
v_sub_f32 v6, v232, v14
v_sub_f32 v14, v232, v224
v_sub_f32 v7, v233, v15
ds_write_b128 v20, a[64:67] offset:0
v_sub_f32 v15, v233, v225
v_sub_f32 v8, v234, v16
v_sub_f32 v16, v234, v226
v_sub_f32 v9, v235, v17
v_sub_f32 v17, v235, v227
v_exp_f32 v6, v6
v_exp_f32 v14, v14
ds_write_b128 v20, a[68:71] offset:1024
v_exp_f32 v7, v7
v_exp_f32 v15, v15
v_exp_f32 v8, v8
v_exp_f32 v16, v16
v_exp_f32 v9, v9
v_exp_f32 v17, v17
v_mul_f32 v232, v6, v24
ds_write_b128 v20, a[72:75] offset:2048
v_mul_f32 v233, v7, v25
v_mul_f32 v234, v8, v26
v_mul_f32 v235, v9, v27
v_fmac_f32 v232, v14, v228
v_fmac_f32 v233, v15, v229
v_fmac_f32 v234, v16, v230
ds_write_b128 v20, a[76:79] offset:3072
v_fmac_f32 v235, v17, v231
v_rcp_f32 v232, v232
v_rcp_f32 v233, v233
v_rcp_f32 v234, v234
v_rcp_f32 v235, v235
v_mul_f32 v6, v6, v232
v_mul_f32 v14, v14, v232
ds_write_b128 v20, a[80:83] offset:4096
v_mul_f32 v7, v7, v233
v_mul_f32 v15, v15, v233
v_mul_f32 v8, v8, v234
v_mul_f32 v16, v16, v234
v_mul_f32 v9, v9, v235
v_mul_f32 v17, v17, v235
aw a12,0
ds_write_b128 v20, a[84:87] offset:5120
aw a13,0
aw a14,0
aw a15,0
aw a16,0
aw a17,0
aw a18,0
aw a19,0
ds_write_b128 v20, a[88:91] offset:6144
aw a20,0
aw a21,0
aw a22,0
aw a23,0
aw a24,0
aw a25,0
ds_write_b128 v20, a[92:95] offset:7168
aw a26,0
aw a27,0
aw a28,0
aw a29,0
aw a30,0
aw a31,0
aw a96,0
aw a97,0
aw a98,0
aw a99,0
aw a100,0
aw a101,0
aw a102,0
aw a103,0
s_waitcnt lgkmcnt(0)
s_barrier
ds_read_b128 v[224:227], v22 offset:0
ds_read_b128 v[228:231], v22 offset:1024
ds_read_b128 v[232:235], v22 offset:2048
ds_read_b128 v[236:239], v22 offset:3072
ds_read_b128 v[240:243], v22 offset:4096
ds_read_b128 v[244:247], v22 offset:5120
ds_read_b128 v[248:251], v22 offset:6144
ds_read_b128 v[252:255], v22 offset:7168
v_pk_mul_f32 v[192:193], v[192:193], v[6:7] op_sel_hi:[1,0]
v_pk_mul_f32 v[194:195], v[194:195], v[6:7] op_sel_hi:[1,0]
v_pk_mul_f32 v[196:197], v[196:197], v[6:7] op_sel:[0,1]
v_pk_mul_f32 v[198:199], v[198:199], v[6:7] op_sel:[0,1]
v_pk_mul_f32 v[200:201], v[200:201], v[8:9] op_sel_hi:[1,0]
v_pk_mul_f32 v[202:203], v[202:203], v[8:9] op_sel_hi:[1,0]
v_pk_mul_f32 v[204:205], v[204:205], v[8:9] op_sel:[0,1]
v_pk_mul_f32 v[206:207], v[206:207], v[8:9] op_sel:[0,1]
v_pk_mul_f32 v[208:209], v[208:209], v[6:7] op_sel_hi:[1,0]
v_pk_mul_f32 v[210:211], v[210:211], v[6:7] op_sel_hi:[1,0]
v_pk_mul_f32 v[212:213], v[212:213], v[6:7] op_sel:[0,1]
v_pk_mul_f32 v[214:215], v[214:215], v[6:7] op_sel:[0,1]
v_pk_mul_f32 v[216:217], v[216:217], v[8:9] op_sel_hi:[1,0]
v_pk_mul_f32 v[218:219], v[218:219], v[8:9] op_sel_hi:[1,0]
v_pk_mul_f32 v[220:221], v[220:221], v[8:9] op_sel:[0,1]
v_pk_mul_f32 v[222:223], v[222:223], v[8:9] op_sel:[0,1]
aw a104,0
aw a105,0
aw a106,0
aw a107,0
aw a108,0
aw a109,0
aw a110,0
aw a111,0
aw a112,0
aw a113,0
aw a114,0
aw a115,0
s_waitcnt lgkmcnt(0)
v_pk_fma_f32 v[192:193], v[224:225], v[14:15], v[192:193] op_sel_hi:[1,0,1]
v_pk_fma_f32 v[194:195], v[226:227], v[14:15], v[194:195] op_sel_hi:[1,0,1]
v_pk_fma_f32 v[208:209], v[240:241], v[14:15], v[208:209] op_sel_hi:[1,0,1]
v_pk_fma_f32 v[210:211], v[242:243], v[14:15], v[210:211] op_sel_hi:[1,0,1]
cv v64,v192,v193
cv v65,v194,v195
cv v66,v208,v209
cv v67,v210,v211
buffer_store_dwordx4 v[64:67], v1, s[20:23], s6 offen offset:0 sc1
s_add_u32 s6, s6, 131072
v_pk_fma_f32 v[196:197], v[228:229], v[14:15], v[196:197] op_sel:[0,1,0]
v_pk_fma_f32 v[198:199], v[230:231], v[14:15], v[198:199] op_sel:[0,1,0]
v_pk_fma_f32 v[212:213], v[244:245], v[14:15], v[212:213] op_sel:[0,1,0]
v_pk_fma_f32 v[214:215], v[246:247], v[14:15], v[214:215] op_sel:[0,1,0]
cv v68,v196,v197
cv v69,v198,v199
cv v70,v212,v213
cv v71,v214,v215
buffer_store_dwordx4 v[68:71], v1, s[20:23], s6 offen offset:0 sc1
s_add_u32 s6, s6, 131072
v_pk_fma_f32 v[200:201], v[232:233], v[16:17], v[200:201] op_sel_hi:[1,0,1]
v_pk_fma_f32 v[202:203], v[234:235], v[16:17], v[202:203] op_sel_hi:[1,0,1]
v_pk_fma_f32 v[216:217], v[248:249], v[16:17], v[216:217] op_sel_hi:[1,0,1]
v_pk_fma_f32 v[218:219], v[250:251], v[16:17], v[218:219] op_sel_hi:[1,0,1]
cv v72,v200,v201
cv v73,v202,v203
cv v74,v216,v217
cv v75,v218,v219
buffer_store_dwordx4 v[72:75], v1, s[20:23], s6 offen offset:0 sc1
s_add_u32 s6, s6, 131072
v_pk_fma_f32 v[204:205], v[236:237], v[16:17], v[204:205] op_sel:[0,1,0]
v_pk_fma_f32 v[206:207], v[238:239], v[16:17], v[206:207] op_sel:[0,1,0]
v_pk_fma_f32 v[220:221], v[252:253], v[16:17], v[220:221] op_sel:[0,1,0]
v_pk_fma_f32 v[222:223], v[254:255], v[16:17], v[222:223] op_sel:[0,1,0]
cv v76,v204,v205
cv v77,v206,v207
cv v78,v220,v221
cv v79,v222,v223
buffer_store_dwordx4 v[76:79], v1, s[20:23], s6 offen offset:0 sc1
s_add_u32 s6, s6, 4294574080
ds_read_b128 v[224:227], v23 offset:0
ds_read_b128 v[228:231], v23 offset:1024
ds_read_b128 v[232:235], v23 offset:2048
ds_read_b128 v[236:239], v23 offset:3072
ds_read_b128 v[240:243], v23 offset:4096
ds_read_b128 v[244:247], v23 offset:5120
ds_read_b128 v[248:251], v23 offset:6144
ds_read_b128 v[252:255], v23 offset:7168
ar v192,a32
ar v193,a33
ar v194,a34
ar v195,a35
ar v196,a36
ar v197,a37
ar v198,a38
ar v199,a39
ar v200,a40
ar v201,a41
ar v202,a42
ar v203,a43
ar v204,a44
ar v205,a45
ar v206,a46
ar v207,a47
ar v208,a48
ar v209,a49
ar v210,a50
ar v211,a51
ar v212,a52
ar v213,a53
ar v214,a54
ar v215,a55
ar v216,a56
ar v217,a57
ar v218,a58
ar v219,a59
ar v220,a60
ar v221,a61
ar v222,a62
ar v223,a63
v_pk_mul_f32 v[192:193], v[192:193], v[6:7] op_sel_hi:[1,0]
v_pk_mul_f32 v[194:195], v[194:195], v[6:7] op_sel_hi:[1,0]
v_pk_mul_f32 v[196:197], v[196:197], v[6:7] op_sel:[0,1]
v_pk_mul_f32 v[198:199], v[198:199], v[6:7] op_sel:[0,1]
v_pk_mul_f32 v[200:201], v[200:201], v[8:9] op_sel_hi:[1,0]
v_pk_mul_f32 v[202:203], v[202:203], v[8:9] op_sel_hi:[1,0]
v_pk_mul_f32 v[204:205], v[204:205], v[8:9] op_sel:[0,1]
v_pk_mul_f32 v[206:207], v[206:207], v[8:9] op_sel:[0,1]
v_pk_mul_f32 v[208:209], v[208:209], v[6:7] op_sel_hi:[1,0]
v_pk_mul_f32 v[210:211], v[210:211], v[6:7] op_sel_hi:[1,0]
v_pk_mul_f32 v[212:213], v[212:213], v[6:7] op_sel:[0,1]
v_pk_mul_f32 v[214:215], v[214:215], v[6:7] op_sel:[0,1]
v_pk_mul_f32 v[216:217], v[216:217], v[8:9] op_sel_hi:[1,0]
v_pk_mul_f32 v[218:219], v[218:219], v[8:9] op_sel_hi:[1,0]
v_pk_mul_f32 v[220:221], v[220:221], v[8:9] op_sel:[0,1]
v_pk_mul_f32 v[222:223], v[222:223], v[8:9] op_sel:[0,1]
s_waitcnt lgkmcnt(0)
v_pk_fma_f32 v[192:193], v[224:225], v[14:15], v[192:193] op_sel_hi:[1,0,1]
v_pk_fma_f32 v[194:195], v[226:227], v[14:15], v[194:195] op_sel_hi:[1,0,1]
v_pk_fma_f32 v[208:209], v[240:241], v[14:15], v[208:209] op_sel_hi:[1,0,1]
v_pk_fma_f32 v[210:211], v[242:243], v[14:15], v[210:211] op_sel_hi:[1,0,1]
cv v80,v192,v193
cv v81,v194,v195
cv v82,v208,v209
cv v83,v210,v211
buffer_store_dwordx4 v[80:83], v1, s[20:23], s6 offen offset:1024 sc1
s_add_u32 s6, s6, 131072
v_pk_fma_f32 v[196:197], v[228:229], v[14:15], v[196:197] op_sel:[0,1,0]
v_pk_fma_f32 v[198:199], v[230:231], v[14:15], v[198:199] op_sel:[0,1,0]
v_pk_fma_f32 v[212:213], v[244:245], v[14:15], v[212:213] op_sel:[0,1,0]
v_pk_fma_f32 v[214:215], v[246:247], v[14:15], v[214:215] op_sel:[0,1,0]
cv v84,v196,v197
cv v85,v198,v199
cv v86,v212,v213
cv v87,v214,v215
buffer_store_dwordx4 v[84:87], v1, s[20:23], s6 offen offset:1024 sc1
s_add_u32 s6, s6, 131072
v_pk_fma_f32 v[200:201], v[232:233], v[16:17], v[200:201] op_sel_hi:[1,0,1]
v_pk_fma_f32 v[202:203], v[234:235], v[16:17], v[202:203] op_sel_hi:[1,0,1]
v_pk_fma_f32 v[216:217], v[248:249], v[16:17], v[216:217] op_sel_hi:[1,0,1]
v_pk_fma_f32 v[218:219], v[250:251], v[16:17], v[218:219] op_sel_hi:[1,0,1]
cv v88,v200,v201
cv v89,v202,v203
cv v90,v216,v217
cv v91,v218,v219
buffer_store_dwordx4 v[88:91], v1, s[20:23], s6 offen offset:1024 sc1
s_add_u32 s6, s6, 131072
v_pk_fma_f32 v[204:205], v[236:237], v[16:17], v[204:205] op_sel:[0,1,0]
v_pk_fma_f32 v[206:207], v[238:239], v[16:17], v[206:207] op_sel:[0,1,0]
v_pk_fma_f32 v[220:221], v[252:253], v[16:17], v[220:221] op_sel:[0,1,0]
v_pk_fma_f32 v[222:223], v[254:255], v[16:17], v[222:223] op_sel:[0,1,0]
cv v92,v204,v205
cv v93,v206,v207
cv v94,v220,v221
cv v95,v222,v223
buffer_store_dwordx4 v[92:95], v1, s[20:23], s6 offen offset:1024 sc1
s_add_u32 s6, s6, 4294574080
aw a116,0
aw a117,0
aw a118,0
aw a119,0
aw a120,0
aw a121,0
aw a122,0
aw a123,0
aw a124,0
aw a125,0
aw a126,0
aw a127,0
v_mov_b32 v48, 0
v_mov_b32 v49, 0
v_mov_b32 v50, 0
v_mov_b32 v51, 0
v_mov_b32 v52, 0
v_mov_b32 v53, 0
v_mov_b32 v54, 0
v_mov_b32 v55, 0
v_mov_b32 v56, 0
v_mov_b32 v57, 0
v_mov_b32 v58, 0
v_mov_b32 v59, 0
v_mov_b32 v60, 0
v_mov_b32 v61, 0
v_mov_b32 v62, 0
v_mov_b32 v63, 0
aw a32,0
aw a33,0
aw a34,0
aw a35,0
aw a36,0
aw a37,0
aw a38,0
aw a39,0
aw a40,0
aw a41,0
aw a42,0
aw a43,0
aw a44,0
aw a45,0
aw a46,0
aw a47,0
aw a48,0
aw a49,0
aw a50,0
aw a51,0
aw a52,0
aw a53,0
aw a54,0
aw a55,0
aw a56,0
aw a57,0
aw a58,0
aw a59,0
aw a60,0
aw a61,0
aw a62,0
aw a63,0
aw a64,0
aw a65,0
aw a66,0
aw a67,0
aw a68,0
aw a69,0
aw a70,0
aw a71,0
aw a72,0
aw a73,0
aw a74,0
aw a75,0
aw a76,0
aw a77,0
aw a78,0
aw a79,0
aw a80,0
aw a81,0
aw a82,0
aw a83,0
aw a84,0
aw a85,0
aw a86,0
aw a87,0
aw a88,0
aw a89,0
aw a90,0
aw a91,0
aw a92,0
aw a93,0
aw a94,0
aw a95,0
s_nop 1
s_setpc_b64 s[42:43]
L_rare0:
s_nop 15
v_max3_f32 v24, v128, v129, v130
v_max3_f32 v24, v131, v144, v24
v_max3_f32 v24, v145, v146, v24
v_max3_f32 v24, v147, v160, v24
v_max3_f32 v24, v161, v162, v24
v_max3_f32 v24, v163, v176, v24
v_max3_f32 v24, v177, v178, v24
v_max_f32 v24, v179, v24
v_max3_f32 v25, v132, v133, v134
v_max3_f32 v25, v135, v148, v25
v_max3_f32 v25, v149, v150, v25
v_max3_f32 v25, v151, v164, v25
v_max3_f32 v25, v165, v166, v25
v_max3_f32 v25, v167, v180, v25
v_max3_f32 v25, v181, v182, v25
v_max_f32 v25, v183, v25
v_max3_f32 v26, v136, v137, v138
v_max3_f32 v26, v139, v152, v26
v_max3_f32 v26, v153, v154, v26
v_max3_f32 v26, v155, v168, v26
v_max3_f32 v26, v169, v170, v26
v_max3_f32 v26, v171, v184, v26
v_max3_f32 v26, v185, v186, v26
v_max_f32 v26, v187, v26
v_max3_f32 v27, v140, v141, v142
v_max3_f32 v27, v143, v156, v27
v_max3_f32 v27, v157, v158, v27
v_max3_f32 v27, v159, v172, v27
v_max3_f32 v27, v173, v174, v27
v_max3_f32 v27, v175, v188, v27
v_max3_f32 v27, v189, v190, v27
v_max_f32 v27, v191, v27
v_mov_b32 v20, v24
v_mov_b32 v21, v25
v_mov_b32 v22, v26
v_mov_b32 v23, v27
v_permlane16_swap_b32 v24, v20
v_permlane16_swap_b32 v25, v21
v_permlane16_swap_b32 v26, v22
v_permlane16_swap_b32 v27, v23
v_max_f32 v24, v24, v20
v_max_f32 v25, v25, v21
v_max_f32 v26, v26, v22
v_max_f32 v27, v27, v23
v_mov_b32 v20, v24
v_mov_b32 v21, v25
v_mov_b32 v22, v26
v_mov_b32 v23, v27
v_permlane32_swap_b32 v24, v20
v_permlane32_swap_b32 v25, v21
v_permlane32_swap_b32 v26, v22
v_permlane32_swap_b32 v27, v23
v_max_f32 v24, v24, v20
v_max_f32 v25, v25, v21
v_max_f32 v26, v26, v22
v_max_f32 v27, v27, v23
v_add_f32 v24, 0x41c00000, v24
v_add_f32 v25, 0x41c00000, v25
v_add_f32 v26, 0x41c00000, v26
v_add_f32 v27, 0x41c00000, v27
v_max_f32 v24, 0, v24
v_max_f32 v25, 0, v25
v_max_f32 v26, 0, v26
v_max_f32 v27, 0, v27
v_exp_f32 v6, -v24
v_exp_f32 v7, -v25
v_exp_f32 v8, -v26
v_exp_f32 v9, -v27
v_sub_f32 v32, v32, v24
v_sub_f32 v33, v33, v24
v_sub_f32 v34, v34, v24
v_sub_f32 v35, v35, v24
v_sub_f32 v36, v36, v25
v_sub_f32 v37, v37, v25
v_sub_f32 v38, v38, v25
v_sub_f32 v39, v39, v25
v_sub_f32 v40, v40, v26
v_sub_f32 v41, v41, v26
v_sub_f32 v42, v42, v26
v_sub_f32 v43, v43, v26
v_sub_f32 v44, v44, v27
v_sub_f32 v45, v45, v27
v_sub_f32 v46, v46, v27
v_sub_f32 v47, v47, v27
v_sub_f32 v128, v128, v24
v_sub_f32 v129, v129, v24
v_sub_f32 v130, v130, v24
v_sub_f32 v131, v131, v24
v_sub_f32 v132, v132, v25
v_sub_f32 v133, v133, v25
v_sub_f32 v134, v134, v25
v_sub_f32 v135, v135, v25
v_sub_f32 v136, v136, v26
v_sub_f32 v137, v137, v26
v_sub_f32 v138, v138, v26
v_sub_f32 v139, v139, v26
v_sub_f32 v140, v140, v27
v_sub_f32 v141, v141, v27
v_sub_f32 v142, v142, v27
v_sub_f32 v143, v143, v27
v_sub_f32 v144, v144, v24
v_sub_f32 v145, v145, v24
v_sub_f32 v146, v146, v24
v_sub_f32 v147, v147, v24
v_sub_f32 v148, v148, v25
v_sub_f32 v149, v149, v25
v_sub_f32 v150, v150, v25
v_sub_f32 v151, v151, v25
v_sub_f32 v152, v152, v26
v_sub_f32 v153, v153, v26
v_sub_f32 v154, v154, v26
v_sub_f32 v155, v155, v26
v_sub_f32 v156, v156, v27
v_sub_f32 v157, v157, v27
v_sub_f32 v158, v158, v27
v_sub_f32 v159, v159, v27
v_sub_f32 v160, v160, v24
v_sub_f32 v161, v161, v24
v_sub_f32 v162, v162, v24
v_sub_f32 v163, v163, v24
v_sub_f32 v164, v164, v25
v_sub_f32 v165, v165, v25
v_sub_f32 v166, v166, v25
v_sub_f32 v167, v167, v25
v_sub_f32 v168, v168, v26
v_sub_f32 v169, v169, v26
v_sub_f32 v170, v170, v26
v_sub_f32 v171, v171, v26
v_sub_f32 v172, v172, v27
v_sub_f32 v173, v173, v27
v_sub_f32 v174, v174, v27
v_sub_f32 v175, v175, v27
v_sub_f32 v176, v176, v24
v_sub_f32 v177, v177, v24
v_sub_f32 v178, v178, v24
v_sub_f32 v179, v179, v24
v_sub_f32 v180, v180, v25
v_sub_f32 v181, v181, v25
v_sub_f32 v182, v182, v25
v_sub_f32 v183, v183, v25
v_sub_f32 v184, v184, v26
v_sub_f32 v185, v185, v26
v_sub_f32 v186, v186, v26
v_sub_f32 v187, v187, v26
v_sub_f32 v188, v188, v27
v_sub_f32 v189, v189, v27
v_sub_f32 v190, v190, v27
v_sub_f32 v191, v191, v27
v_sub_f32 v192, v192, v24
v_sub_f32 v193, v193, v24
v_sub_f32 v194, v194, v24
v_sub_f32 v195, v195, v24
v_sub_f32 v196, v196, v25
v_sub_f32 v197, v197, v25
v_sub_f32 v198, v198, v25
v_sub_f32 v199, v199, v25
v_sub_f32 v200, v200, v26
v_sub_f32 v201, v201, v26
v_sub_f32 v202, v202, v26
v_sub_f32 v203, v203, v26
v_sub_f32 v204, v204, v27
v_sub_f32 v205, v205, v27
v_sub_f32 v206, v206, v27
v_sub_f32 v207, v207, v27
v_sub_f32 v208, v208, v24
v_sub_f32 v209, v209, v24
v_sub_f32 v210, v210, v24
v_sub_f32 v211, v211, v24
v_sub_f32 v212, v212, v25
v_sub_f32 v213, v213, v25
v_sub_f32 v214, v214, v25
v_sub_f32 v215, v215, v25
v_sub_f32 v216, v216, v26
v_sub_f32 v217, v217, v26
v_sub_f32 v218, v218, v26
v_sub_f32 v219, v219, v26
v_sub_f32 v220, v220, v27
v_sub_f32 v221, v221, v27
v_sub_f32 v222, v222, v27
v_sub_f32 v223, v223, v27
v_sub_f32 v224, v224, v24
v_sub_f32 v225, v225, v24
v_sub_f32 v226, v226, v24
v_sub_f32 v227, v227, v24
v_sub_f32 v228, v228, v25
v_sub_f32 v229, v229, v25
v_sub_f32 v230, v230, v25
v_sub_f32 v231, v231, v25
v_sub_f32 v232, v232, v26
v_sub_f32 v233, v233, v26
v_sub_f32 v234, v234, v26
v_sub_f32 v235, v235, v26
v_sub_f32 v236, v236, v27
v_sub_f32 v237, v237, v27
v_sub_f32 v238, v238, v27
v_sub_f32 v239, v239, v27
v_sub_f32 v240, v240, v24
v_sub_f32 v241, v241, v24
v_sub_f32 v242, v242, v24
v_sub_f32 v243, v243, v24
v_sub_f32 v244, v244, v25
v_sub_f32 v245, v245, v25
v_sub_f32 v246, v246, v25
v_sub_f32 v247, v247, v25
v_sub_f32 v248, v248, v26
v_sub_f32 v249, v249, v26
v_sub_f32 v250, v250, v26
v_sub_f32 v251, v251, v26
v_sub_f32 v252, v252, v27
v_sub_f32 v253, v253, v27
v_sub_f32 v254, v254, v27
v_sub_f32 v255, v255, v27
s_cmp_eq_u32 s36, 1
s_cbranch_scc1 L_rare0_p
v_mul_f32 v48, v48, v6
v_mul_f32 v49, v49, v6
v_mul_f32 v50, v50, v6
v_mul_f32 v51, v51, v6
v_mul_f32 v52, v52, v7
v_mul_f32 v53, v53, v7
v_mul_f32 v54, v54, v7
v_mul_f32 v55, v55, v7
v_mul_f32 v56, v56, v8
v_mul_f32 v57, v57, v8
v_mul_f32 v58, v58, v8
v_mul_f32 v59, v59, v8
v_mul_f32 v60, v60, v9
v_mul_f32 v61, v61, v9
v_mul_f32 v62, v62, v9
v_mul_f32 v63, v63, v9
ar v20,a0
ar v21,a1
ar v22,a2
ar v23,a3
v_mul_f32 v20, v20, v6
v_mul_f32 v21, v21, v6
v_mul_f32 v22, v22, v6
v_mul_f32 v23, v23, v6
aw a0,v20
aw a1,v21
aw a2,v22
aw a3,v23
ar v20,a4
ar v21,a5
ar v22,a6
ar v23,a7
v_mul_f32 v20, v20, v7
v_mul_f32 v21, v21, v7
v_mul_f32 v22, v22, v7
v_mul_f32 v23, v23, v7
aw a4,v20
aw a5,v21
aw a6,v22
aw a7,v23
ar v20,a8
ar v21,a9
ar v22,a10
ar v23,a11
v_mul_f32 v20, v20, v8
v_mul_f32 v21, v21, v8
v_mul_f32 v22, v22, v8
v_mul_f32 v23, v23, v8
aw a8,v20
aw a9,v21
aw a10,v22
aw a11,v23
ar v20,a12
ar v21,a13
ar v22,a14
ar v23,a15
v_mul_f32 v20, v20, v9
v_mul_f32 v21, v21, v9
v_mul_f32 v22, v22, v9
v_mul_f32 v23, v23, v9
aw a12,v20
aw a13,v21
aw a14,v22
aw a15,v23
ar v20,a16
ar v21,a17
ar v22,a18
ar v23,a19
v_mul_f32 v20, v20, v6
v_mul_f32 v21, v21, v6
v_mul_f32 v22, v22, v6
v_mul_f32 v23, v23, v6
aw a16,v20
aw a17,v21
aw a18,v22
aw a19,v23
ar v20,a20
ar v21,a21
ar v22,a22
ar v23,a23
v_mul_f32 v20, v20, v7
v_mul_f32 v21, v21, v7
v_mul_f32 v22, v22, v7
v_mul_f32 v23, v23, v7
aw a20,v20
aw a21,v21
aw a22,v22
aw a23,v23
ar v20,a24
ar v21,a25
ar v22,a26
ar v23,a27
v_mul_f32 v20, v20, v8
v_mul_f32 v21, v21, v8
v_mul_f32 v22, v22, v8
v_mul_f32 v23, v23, v8
aw a24,v20
aw a25,v21
aw a26,v22
aw a27,v23
ar v20,a28
ar v21,a29
ar v22,a30
ar v23,a31
v_mul_f32 v20, v20, v9
v_mul_f32 v21, v21, v9
v_mul_f32 v22, v22, v9
v_mul_f32 v23, v23, v9
aw a28,v20
aw a29,v21
aw a30,v22
aw a31,v23
ar v20,a32
ar v21,a33
ar v22,a34
ar v23,a35
v_mul_f32 v20, v20, v6
v_mul_f32 v21, v21, v6
v_mul_f32 v22, v22, v6
v_mul_f32 v23, v23, v6
aw a32,v20
aw a33,v21
aw a34,v22
aw a35,v23
ar v20,a36
ar v21,a37
ar v22,a38
ar v23,a39
v_mul_f32 v20, v20, v7
v_mul_f32 v21, v21, v7
v_mul_f32 v22, v22, v7
v_mul_f32 v23, v23, v7
aw a36,v20
aw a37,v21
aw a38,v22
aw a39,v23
ar v20,a40
ar v21,a41
ar v22,a42
ar v23,a43
v_mul_f32 v20, v20, v8
v_mul_f32 v21, v21, v8
v_mul_f32 v22, v22, v8
v_mul_f32 v23, v23, v8
aw a40,v20
aw a41,v21
aw a42,v22
aw a43,v23
ar v20,a44
ar v21,a45
ar v22,a46
ar v23,a47
v_mul_f32 v20, v20, v9
v_mul_f32 v21, v21, v9
v_mul_f32 v22, v22, v9
v_mul_f32 v23, v23, v9
aw a44,v20
aw a45,v21
aw a46,v22
aw a47,v23
ar v20,a48
ar v21,a49
ar v22,a50
ar v23,a51
v_mul_f32 v20, v20, v6
v_mul_f32 v21, v21, v6
v_mul_f32 v22, v22, v6
v_mul_f32 v23, v23, v6
aw a48,v20
aw a49,v21
aw a50,v22
aw a51,v23
ar v20,a52
ar v21,a53
ar v22,a54
ar v23,a55
v_mul_f32 v20, v20, v7
v_mul_f32 v21, v21, v7
v_mul_f32 v22, v22, v7
v_mul_f32 v23, v23, v7
aw a52,v20
aw a53,v21
aw a54,v22
aw a55,v23
ar v20,a56
ar v21,a57
ar v22,a58
ar v23,a59
v_mul_f32 v20, v20, v8
v_mul_f32 v21, v21, v8
v_mul_f32 v22, v22, v8
v_mul_f32 v23, v23, v8
aw a56,v20
aw a57,v21
aw a58,v22
aw a59,v23
ar v20,a60
ar v21,a61
ar v22,a62
ar v23,a63
v_mul_f32 v20, v20, v9
v_mul_f32 v21, v21, v9
v_mul_f32 v22, v22, v9
v_mul_f32 v23, v23, v9
aw a60,v20
aw a61,v21
aw a62,v22
aw a63,v23
ar v20,a64
ar v21,a65
ar v22,a66
ar v23,a67
v_mul_f32 v20, v20, v6
v_mul_f32 v21, v21, v6
v_mul_f32 v22, v22, v6
v_mul_f32 v23, v23, v6
aw a64,v20
aw a65,v21
aw a66,v22
aw a67,v23
ar v20,a68
ar v21,a69
ar v22,a70
ar v23,a71
v_mul_f32 v20, v20, v7
v_mul_f32 v21, v21, v7
v_mul_f32 v22, v22, v7
v_mul_f32 v23, v23, v7
aw a68,v20
aw a69,v21
aw a70,v22
aw a71,v23
ar v20,a72
ar v21,a73
ar v22,a74
ar v23,a75
v_mul_f32 v20, v20, v8
v_mul_f32 v21, v21, v8
v_mul_f32 v22, v22, v8
v_mul_f32 v23, v23, v8
aw a72,v20
aw a73,v21
aw a74,v22
aw a75,v23
ar v20,a76
ar v21,a77
ar v22,a78
ar v23,a79
v_mul_f32 v20, v20, v9
v_mul_f32 v21, v21, v9
v_mul_f32 v22, v22, v9
v_mul_f32 v23, v23, v9
aw a76,v20
aw a77,v21
aw a78,v22
aw a79,v23
ar v20,a80
ar v21,a81
ar v22,a82
ar v23,a83
v_mul_f32 v20, v20, v6
v_mul_f32 v21, v21, v6
v_mul_f32 v22, v22, v6
v_mul_f32 v23, v23, v6
aw a80,v20
aw a81,v21
aw a82,v22
aw a83,v23
ar v20,a84
ar v21,a85
ar v22,a86
ar v23,a87
v_mul_f32 v20, v20, v7
v_mul_f32 v21, v21, v7
v_mul_f32 v22, v22, v7
v_mul_f32 v23, v23, v7
aw a84,v20
aw a85,v21
aw a86,v22
aw a87,v23
ar v20,a88
ar v21,a89
ar v22,a90
ar v23,a91
v_mul_f32 v20, v20, v8
v_mul_f32 v21, v21, v8
v_mul_f32 v22, v22, v8
v_mul_f32 v23, v23, v8
aw a88,v20
aw a89,v21
aw a90,v22
aw a91,v23
ar v20,a92
ar v21,a93
ar v22,a94
ar v23,a95
v_mul_f32 v20, v20, v9
v_mul_f32 v21, v21, v9
v_mul_f32 v22, v22, v9
v_mul_f32 v23, v23, v9
aw a92,v20
aw a93,v21
aw a94,v22
aw a95,v23
ar v20,a96
ar v21,a97
ar v22,a98
ar v23,a99
v_mul_f32 v20, v20, v6
v_mul_f32 v21, v21, v6
v_mul_f32 v22, v22, v6
v_mul_f32 v23, v23, v6
aw a96,v20
aw a97,v21
aw a98,v22
aw a99,v23
ar v20,a100
ar v21,a101
ar v22,a102
ar v23,a103
v_mul_f32 v20, v20, v7
v_mul_f32 v21, v21, v7
v_mul_f32 v22, v22, v7
v_mul_f32 v23, v23, v7
aw a100,v20
aw a101,v21
aw a102,v22
aw a103,v23
ar v20,a104
ar v21,a105
ar v22,a106
ar v23,a107
v_mul_f32 v20, v20, v8
v_mul_f32 v21, v21, v8
v_mul_f32 v22, v22, v8
v_mul_f32 v23, v23, v8
aw a104,v20
aw a105,v21
aw a106,v22
aw a107,v23
ar v20,a108
ar v21,a109
ar v22,a110
ar v23,a111
v_mul_f32 v20, v20, v9
v_mul_f32 v21, v21, v9
v_mul_f32 v22, v22, v9
v_mul_f32 v23, v23, v9
aw a108,v20
aw a109,v21
aw a110,v22
aw a111,v23
ar v20,a112
ar v21,a113
ar v22,a114
ar v23,a115
v_mul_f32 v20, v20, v6
v_mul_f32 v21, v21, v6
v_mul_f32 v22, v22, v6
v_mul_f32 v23, v23, v6
aw a112,v20
aw a113,v21
aw a114,v22
aw a115,v23
ar v20,a116
ar v21,a117
ar v22,a118
ar v23,a119
v_mul_f32 v20, v20, v7
v_mul_f32 v21, v21, v7
v_mul_f32 v22, v22, v7
v_mul_f32 v23, v23, v7
aw a116,v20
aw a117,v21
aw a118,v22
aw a119,v23
ar v20,a120
ar v21,a121
ar v22,a122
ar v23,a123
v_mul_f32 v20, v20, v8
v_mul_f32 v21, v21, v8
v_mul_f32 v22, v22, v8
v_mul_f32 v23, v23, v8
aw a120,v20
aw a121,v21
aw a122,v22
aw a123,v23
ar v20,a124
ar v21,a125
ar v22,a126
ar v23,a127
v_mul_f32 v20, v20, v9
v_mul_f32 v21, v21, v9
v_mul_f32 v22, v22, v9
v_mul_f32 v23, v23, v9
aw a124,v20
aw a125,v21
aw a126,v22
aw a127,v23
L_rare0_p:
v_exp_f32 v20, v128
v_exp_f32 v21, v129
v_exp_f32 v22, v130
cv v64,v20,v21
v_exp_f32 v23, v131
v_exp_f32 v24, v144
cv v65,v22,v23
v_exp_f32 v25, v145
v_or_b32 v12, v64, v65
cv v66,v24,v25
v_exp_f32 v26, v146
v_exp_f32 v27, v147
v_exp_f32 v20, v132
cv v67,v26,v27
v_exp_f32 v21, v133
v_or3_b32 v12, v66, v67, v12
cv v68,v20,v21
v_exp_f32 v22, v134
v_exp_f32 v23, v135
v_exp_f32 v24, v148
cv v69,v22,v23
v_exp_f32 v25, v149
v_or3_b32 v12, v68, v69, v12
cv v70,v24,v25
v_exp_f32 v26, v150
v_exp_f32 v27, v151
v_exp_f32 v20, v136
cv v71,v26,v27
v_exp_f32 v21, v137
v_or3_b32 v12, v70, v71, v12
cv v72,v20,v21
v_exp_f32 v22, v138
v_exp_f32 v23, v139
v_exp_f32 v24, v152
cv v73,v22,v23
v_exp_f32 v25, v153
v_or3_b32 v12, v72, v73, v12
cv v74,v24,v25
v_exp_f32 v26, v154
v_exp_f32 v27, v155
v_exp_f32 v20, v140
cv v75,v26,v27
v_exp_f32 v21, v141
v_or3_b32 v12, v74, v75, v12
cv v76,v20,v21
v_exp_f32 v22, v142
v_exp_f32 v23, v143
v_exp_f32 v24, v156
cv v77,v22,v23
v_exp_f32 v25, v157
v_or3_b32 v12, v76, v77, v12
cv v78,v24,v25
v_exp_f32 v26, v158
v_exp_f32 v27, v159
v_exp_f32 v20, v160
cv v79,v26,v27
v_exp_f32 v21, v161
v_or3_b32 v12, v78, v79, v12
cv v80,v20,v21
v_exp_f32 v22, v162
v_exp_f32 v23, v163
v_exp_f32 v24, v176
cv v81,v22,v23
v_exp_f32 v25, v177
v_or3_b32 v12, v80, v81, v12
cv v82,v24,v25
v_exp_f32 v26, v178
v_exp_f32 v27, v179
v_exp_f32 v20, v164
cv v83,v26,v27
v_exp_f32 v21, v165
v_or3_b32 v12, v82, v83, v12
cv v84,v20,v21
v_exp_f32 v22, v166
v_exp_f32 v23, v167
v_exp_f32 v24, v180
cv v85,v22,v23
v_exp_f32 v25, v181
v_or3_b32 v12, v84, v85, v12
cv v86,v24,v25
v_exp_f32 v26, v182
v_exp_f32 v27, v183
v_exp_f32 v20, v168
cv v87,v26,v27
v_exp_f32 v21, v169
v_or3_b32 v12, v86, v87, v12
cv v88,v20,v21
v_exp_f32 v22, v170
v_exp_f32 v23, v171
v_exp_f32 v24, v184
cv v89,v22,v23
v_exp_f32 v25, v185
v_or3_b32 v12, v88, v89, v12
cv v90,v24,v25
v_exp_f32 v26, v186
v_exp_f32 v27, v187
v_exp_f32 v20, v172
cv v91,v26,v27
v_exp_f32 v21, v173
v_or3_b32 v12, v90, v91, v12
cv v92,v20,v21
v_exp_f32 v22, v174
v_exp_f32 v23, v175
v_exp_f32 v24, v188
cv v93,v22,v23
v_exp_f32 v25, v189
v_or3_b32 v12, v92, v93, v12
cv v94,v24,v25
v_exp_f32 v26, v190
v_exp_f32 v27, v191
s_nop 0
cv v95,v26,v27
v_or3_b32 v12, v94, v95, v12
v_and_b32 v12, 0x40004000, v12
v_cmp_ne_u32 vcc, 0, v12
s_nop 3
s_setpc_b64 s[42:43]
L_rare1:
s_nop 15
v_max3_f32 v24, v192, v193, v194
v_max3_f32 v24, v195, v208, v24
v_max3_f32 v24, v209, v210, v24
v_max3_f32 v24, v211, v224, v24
v_max3_f32 v24, v225, v226, v24
v_max3_f32 v24, v227, v240, v24
v_max3_f32 v24, v241, v242, v24
v_max_f32 v24, v243, v24
v_max3_f32 v25, v196, v197, v198
v_max3_f32 v25, v199, v212, v25
v_max3_f32 v25, v213, v214, v25
v_max3_f32 v25, v215, v228, v25
v_max3_f32 v25, v229, v230, v25
v_max3_f32 v25, v231, v244, v25
v_max3_f32 v25, v245, v246, v25
v_max_f32 v25, v247, v25
v_max3_f32 v26, v200, v201, v202
v_max3_f32 v26, v203, v216, v26
v_max3_f32 v26, v217, v218, v26
v_max3_f32 v26, v219, v232, v26
v_max3_f32 v26, v233, v234, v26
v_max3_f32 v26, v235, v248, v26
v_max3_f32 v26, v249, v250, v26
v_max_f32 v26, v251, v26
v_max3_f32 v27, v204, v205, v206
v_max3_f32 v27, v207, v220, v27
v_max3_f32 v27, v221, v222, v27
v_max3_f32 v27, v223, v236, v27
v_max3_f32 v27, v237, v238, v27
v_max3_f32 v27, v239, v252, v27
v_max3_f32 v27, v253, v254, v27
v_max_f32 v27, v255, v27
v_mov_b32 v20, v24
v_mov_b32 v21, v25
v_mov_b32 v22, v26
v_mov_b32 v23, v27
v_permlane16_swap_b32 v24, v20
v_permlane16_swap_b32 v25, v21
v_permlane16_swap_b32 v26, v22
v_permlane16_swap_b32 v27, v23
v_max_f32 v24, v24, v20
v_max_f32 v25, v25, v21
v_max_f32 v26, v26, v22
v_max_f32 v27, v27, v23
v_mov_b32 v20, v24
v_mov_b32 v21, v25
v_mov_b32 v22, v26
v_mov_b32 v23, v27
v_permlane32_swap_b32 v24, v20
v_permlane32_swap_b32 v25, v21
v_permlane32_swap_b32 v26, v22
v_permlane32_swap_b32 v27, v23
v_max_f32 v24, v24, v20
v_max_f32 v25, v25, v21
v_max_f32 v26, v26, v22
v_max_f32 v27, v27, v23
v_add_f32 v24, 0x41c00000, v24
v_add_f32 v25, 0x41c00000, v25
v_add_f32 v26, 0x41c00000, v26
v_add_f32 v27, 0x41c00000, v27
v_max_f32 v24, 0, v24
v_max_f32 v25, 0, v25
v_max_f32 v26, 0, v26
v_max_f32 v27, 0, v27
v_exp_f32 v6, -v24
v_exp_f32 v7, -v25
v_exp_f32 v8, -v26
v_exp_f32 v9, -v27
v_sub_f32 v32, v32, v24
v_sub_f32 v33, v33, v24
v_sub_f32 v34, v34, v24
v_sub_f32 v35, v35, v24
v_sub_f32 v36, v36, v25
v_sub_f32 v37, v37, v25
v_sub_f32 v38, v38, v25
v_sub_f32 v39, v39, v25
v_sub_f32 v40, v40, v26
v_sub_f32 v41, v41, v26
v_sub_f32 v42, v42, v26
v_sub_f32 v43, v43, v26
v_sub_f32 v44, v44, v27
v_sub_f32 v45, v45, v27
v_sub_f32 v46, v46, v27
v_sub_f32 v47, v47, v27
v_sub_f32 v128, v128, v24
v_sub_f32 v129, v129, v24
v_sub_f32 v130, v130, v24
v_sub_f32 v131, v131, v24
v_sub_f32 v132, v132, v25
v_sub_f32 v133, v133, v25
v_sub_f32 v134, v134, v25
v_sub_f32 v135, v135, v25
v_sub_f32 v136, v136, v26
v_sub_f32 v137, v137, v26
v_sub_f32 v138, v138, v26
v_sub_f32 v139, v139, v26
v_sub_f32 v140, v140, v27
v_sub_f32 v141, v141, v27
v_sub_f32 v142, v142, v27
v_sub_f32 v143, v143, v27
v_sub_f32 v144, v144, v24
v_sub_f32 v145, v145, v24
v_sub_f32 v146, v146, v24
v_sub_f32 v147, v147, v24
v_sub_f32 v148, v148, v25
v_sub_f32 v149, v149, v25
v_sub_f32 v150, v150, v25
v_sub_f32 v151, v151, v25
v_sub_f32 v152, v152, v26
v_sub_f32 v153, v153, v26
v_sub_f32 v154, v154, v26
v_sub_f32 v155, v155, v26
v_sub_f32 v156, v156, v27
v_sub_f32 v157, v157, v27
v_sub_f32 v158, v158, v27
v_sub_f32 v159, v159, v27
v_sub_f32 v160, v160, v24
v_sub_f32 v161, v161, v24
v_sub_f32 v162, v162, v24
v_sub_f32 v163, v163, v24
v_sub_f32 v164, v164, v25
v_sub_f32 v165, v165, v25
v_sub_f32 v166, v166, v25
v_sub_f32 v167, v167, v25
v_sub_f32 v168, v168, v26
v_sub_f32 v169, v169, v26
v_sub_f32 v170, v170, v26
v_sub_f32 v171, v171, v26
v_sub_f32 v172, v172, v27
v_sub_f32 v173, v173, v27
v_sub_f32 v174, v174, v27
v_sub_f32 v175, v175, v27
v_sub_f32 v176, v176, v24
v_sub_f32 v177, v177, v24
v_sub_f32 v178, v178, v24
v_sub_f32 v179, v179, v24
v_sub_f32 v180, v180, v25
v_sub_f32 v181, v181, v25
v_sub_f32 v182, v182, v25
v_sub_f32 v183, v183, v25
v_sub_f32 v184, v184, v26
v_sub_f32 v185, v185, v26
v_sub_f32 v186, v186, v26
v_sub_f32 v187, v187, v26
v_sub_f32 v188, v188, v27
v_sub_f32 v189, v189, v27
v_sub_f32 v190, v190, v27
v_sub_f32 v191, v191, v27
v_sub_f32 v192, v192, v24
v_sub_f32 v193, v193, v24
v_sub_f32 v194, v194, v24
v_sub_f32 v195, v195, v24
v_sub_f32 v196, v196, v25
v_sub_f32 v197, v197, v25
v_sub_f32 v198, v198, v25
v_sub_f32 v199, v199, v25
v_sub_f32 v200, v200, v26
v_sub_f32 v201, v201, v26
v_sub_f32 v202, v202, v26
v_sub_f32 v203, v203, v26
v_sub_f32 v204, v204, v27
v_sub_f32 v205, v205, v27
v_sub_f32 v206, v206, v27
v_sub_f32 v207, v207, v27
v_sub_f32 v208, v208, v24
v_sub_f32 v209, v209, v24
v_sub_f32 v210, v210, v24
v_sub_f32 v211, v211, v24
v_sub_f32 v212, v212, v25
v_sub_f32 v213, v213, v25
v_sub_f32 v214, v214, v25
v_sub_f32 v215, v215, v25
v_sub_f32 v216, v216, v26
v_sub_f32 v217, v217, v26
v_sub_f32 v218, v218, v26
v_sub_f32 v219, v219, v26
v_sub_f32 v220, v220, v27
v_sub_f32 v221, v221, v27
v_sub_f32 v222, v222, v27
v_sub_f32 v223, v223, v27
v_sub_f32 v224, v224, v24
v_sub_f32 v225, v225, v24
v_sub_f32 v226, v226, v24
v_sub_f32 v227, v227, v24
v_sub_f32 v228, v228, v25
v_sub_f32 v229, v229, v25
v_sub_f32 v230, v230, v25
v_sub_f32 v231, v231, v25
v_sub_f32 v232, v232, v26
v_sub_f32 v233, v233, v26
v_sub_f32 v234, v234, v26
v_sub_f32 v235, v235, v26
v_sub_f32 v236, v236, v27
v_sub_f32 v237, v237, v27
v_sub_f32 v238, v238, v27
v_sub_f32 v239, v239, v27
v_sub_f32 v240, v240, v24
v_sub_f32 v241, v241, v24
v_sub_f32 v242, v242, v24
v_sub_f32 v243, v243, v24
v_sub_f32 v244, v244, v25
v_sub_f32 v245, v245, v25
v_sub_f32 v246, v246, v25
v_sub_f32 v247, v247, v25
v_sub_f32 v248, v248, v26
v_sub_f32 v249, v249, v26
v_sub_f32 v250, v250, v26
v_sub_f32 v251, v251, v26
v_sub_f32 v252, v252, v27
v_sub_f32 v253, v253, v27
v_sub_f32 v254, v254, v27
v_sub_f32 v255, v255, v27
s_cmp_eq_u32 s36, 1
s_cbranch_scc1 L_rare1_p
v_mul_f32 v48, v48, v6
v_mul_f32 v49, v49, v6
v_mul_f32 v50, v50, v6
v_mul_f32 v51, v51, v6
v_mul_f32 v52, v52, v7
v_mul_f32 v53, v53, v7
v_mul_f32 v54, v54, v7
v_mul_f32 v55, v55, v7
v_mul_f32 v56, v56, v8
v_mul_f32 v57, v57, v8
v_mul_f32 v58, v58, v8
v_mul_f32 v59, v59, v8
v_mul_f32 v60, v60, v9
v_mul_f32 v61, v61, v9
v_mul_f32 v62, v62, v9
v_mul_f32 v63, v63, v9
ar v20,a0
ar v21,a1
ar v22,a2
ar v23,a3
v_mul_f32 v20, v20, v6
v_mul_f32 v21, v21, v6
v_mul_f32 v22, v22, v6
v_mul_f32 v23, v23, v6
aw a0,v20
aw a1,v21
aw a2,v22
aw a3,v23
ar v20,a4
ar v21,a5
ar v22,a6
ar v23,a7
v_mul_f32 v20, v20, v7
v_mul_f32 v21, v21, v7
v_mul_f32 v22, v22, v7
v_mul_f32 v23, v23, v7
aw a4,v20
aw a5,v21
aw a6,v22
aw a7,v23
ar v20,a8
ar v21,a9
ar v22,a10
ar v23,a11
v_mul_f32 v20, v20, v8
v_mul_f32 v21, v21, v8
v_mul_f32 v22, v22, v8
v_mul_f32 v23, v23, v8
aw a8,v20
aw a9,v21
aw a10,v22
aw a11,v23
ar v20,a12
ar v21,a13
ar v22,a14
ar v23,a15
v_mul_f32 v20, v20, v9
v_mul_f32 v21, v21, v9
v_mul_f32 v22, v22, v9
v_mul_f32 v23, v23, v9
aw a12,v20
aw a13,v21
aw a14,v22
aw a15,v23
ar v20,a16
ar v21,a17
ar v22,a18
ar v23,a19
v_mul_f32 v20, v20, v6
v_mul_f32 v21, v21, v6
v_mul_f32 v22, v22, v6
v_mul_f32 v23, v23, v6
aw a16,v20
aw a17,v21
aw a18,v22
aw a19,v23
ar v20,a20
ar v21,a21
ar v22,a22
ar v23,a23
v_mul_f32 v20, v20, v7
v_mul_f32 v21, v21, v7
v_mul_f32 v22, v22, v7
v_mul_f32 v23, v23, v7
aw a20,v20
aw a21,v21
aw a22,v22
aw a23,v23
ar v20,a24
ar v21,a25
ar v22,a26
ar v23,a27
v_mul_f32 v20, v20, v8
v_mul_f32 v21, v21, v8
v_mul_f32 v22, v22, v8
v_mul_f32 v23, v23, v8
aw a24,v20
aw a25,v21
aw a26,v22
aw a27,v23
ar v20,a28
ar v21,a29
ar v22,a30
ar v23,a31
v_mul_f32 v20, v20, v9
v_mul_f32 v21, v21, v9
v_mul_f32 v22, v22, v9
v_mul_f32 v23, v23, v9
aw a28,v20
aw a29,v21
aw a30,v22
aw a31,v23
ar v20,a32
ar v21,a33
ar v22,a34
ar v23,a35
v_mul_f32 v20, v20, v6
v_mul_f32 v21, v21, v6
v_mul_f32 v22, v22, v6
v_mul_f32 v23, v23, v6
aw a32,v20
aw a33,v21
aw a34,v22
aw a35,v23
ar v20,a36
ar v21,a37
ar v22,a38
ar v23,a39
v_mul_f32 v20, v20, v7
v_mul_f32 v21, v21, v7
v_mul_f32 v22, v22, v7
v_mul_f32 v23, v23, v7
aw a36,v20
aw a37,v21
aw a38,v22
aw a39,v23
ar v20,a40
ar v21,a41
ar v22,a42
ar v23,a43
v_mul_f32 v20, v20, v8
v_mul_f32 v21, v21, v8
v_mul_f32 v22, v22, v8
v_mul_f32 v23, v23, v8
aw a40,v20
aw a41,v21
aw a42,v22
aw a43,v23
ar v20,a44
ar v21,a45
ar v22,a46
ar v23,a47
v_mul_f32 v20, v20, v9
v_mul_f32 v21, v21, v9
v_mul_f32 v22, v22, v9
v_mul_f32 v23, v23, v9
aw a44,v20
aw a45,v21
aw a46,v22
aw a47,v23
ar v20,a48
ar v21,a49
ar v22,a50
ar v23,a51
v_mul_f32 v20, v20, v6
v_mul_f32 v21, v21, v6
v_mul_f32 v22, v22, v6
v_mul_f32 v23, v23, v6
aw a48,v20
aw a49,v21
aw a50,v22
aw a51,v23
ar v20,a52
ar v21,a53
ar v22,a54
ar v23,a55
v_mul_f32 v20, v20, v7
v_mul_f32 v21, v21, v7
v_mul_f32 v22, v22, v7
v_mul_f32 v23, v23, v7
aw a52,v20
aw a53,v21
aw a54,v22
aw a55,v23
ar v20,a56
ar v21,a57
ar v22,a58
ar v23,a59
v_mul_f32 v20, v20, v8
v_mul_f32 v21, v21, v8
v_mul_f32 v22, v22, v8
v_mul_f32 v23, v23, v8
aw a56,v20
aw a57,v21
aw a58,v22
aw a59,v23
ar v20,a60
ar v21,a61
ar v22,a62
ar v23,a63
v_mul_f32 v20, v20, v9
v_mul_f32 v21, v21, v9
v_mul_f32 v22, v22, v9
v_mul_f32 v23, v23, v9
aw a60,v20
aw a61,v21
aw a62,v22
aw a63,v23
ar v20,a64
ar v21,a65
ar v22,a66
ar v23,a67
v_mul_f32 v20, v20, v6
v_mul_f32 v21, v21, v6
v_mul_f32 v22, v22, v6
v_mul_f32 v23, v23, v6
aw a64,v20
aw a65,v21
aw a66,v22
aw a67,v23
ar v20,a68
ar v21,a69
ar v22,a70
ar v23,a71
v_mul_f32 v20, v20, v7
v_mul_f32 v21, v21, v7
v_mul_f32 v22, v22, v7
v_mul_f32 v23, v23, v7
aw a68,v20
aw a69,v21
aw a70,v22
aw a71,v23
ar v20,a72
ar v21,a73
ar v22,a74
ar v23,a75
v_mul_f32 v20, v20, v8
v_mul_f32 v21, v21, v8
v_mul_f32 v22, v22, v8
v_mul_f32 v23, v23, v8
aw a72,v20
aw a73,v21
aw a74,v22
aw a75,v23
ar v20,a76
ar v21,a77
ar v22,a78
ar v23,a79
v_mul_f32 v20, v20, v9
v_mul_f32 v21, v21, v9
v_mul_f32 v22, v22, v9
v_mul_f32 v23, v23, v9
aw a76,v20
aw a77,v21
aw a78,v22
aw a79,v23
ar v20,a80
ar v21,a81
ar v22,a82
ar v23,a83
v_mul_f32 v20, v20, v6
v_mul_f32 v21, v21, v6
v_mul_f32 v22, v22, v6
v_mul_f32 v23, v23, v6
aw a80,v20
aw a81,v21
aw a82,v22
aw a83,v23
ar v20,a84
ar v21,a85
ar v22,a86
ar v23,a87
v_mul_f32 v20, v20, v7
v_mul_f32 v21, v21, v7
v_mul_f32 v22, v22, v7
v_mul_f32 v23, v23, v7
aw a84,v20
aw a85,v21
aw a86,v22
aw a87,v23
ar v20,a88
ar v21,a89
ar v22,a90
ar v23,a91
v_mul_f32 v20, v20, v8
v_mul_f32 v21, v21, v8
v_mul_f32 v22, v22, v8
v_mul_f32 v23, v23, v8
aw a88,v20
aw a89,v21
aw a90,v22
aw a91,v23
ar v20,a92
ar v21,a93
ar v22,a94
ar v23,a95
v_mul_f32 v20, v20, v9
v_mul_f32 v21, v21, v9
v_mul_f32 v22, v22, v9
v_mul_f32 v23, v23, v9
aw a92,v20
aw a93,v21
aw a94,v22
aw a95,v23
ar v20,a96
ar v21,a97
ar v22,a98
ar v23,a99
v_mul_f32 v20, v20, v6
v_mul_f32 v21, v21, v6
v_mul_f32 v22, v22, v6
v_mul_f32 v23, v23, v6
aw a96,v20
aw a97,v21
aw a98,v22
aw a99,v23
ar v20,a100
ar v21,a101
ar v22,a102
ar v23,a103
v_mul_f32 v20, v20, v7
v_mul_f32 v21, v21, v7
v_mul_f32 v22, v22, v7
v_mul_f32 v23, v23, v7
aw a100,v20
aw a101,v21
aw a102,v22
aw a103,v23
ar v20,a104
ar v21,a105
ar v22,a106
ar v23,a107
v_mul_f32 v20, v20, v8
v_mul_f32 v21, v21, v8
v_mul_f32 v22, v22, v8
v_mul_f32 v23, v23, v8
aw a104,v20
aw a105,v21
aw a106,v22
aw a107,v23
ar v20,a108
ar v21,a109
ar v22,a110
ar v23,a111
v_mul_f32 v20, v20, v9
v_mul_f32 v21, v21, v9
v_mul_f32 v22, v22, v9
v_mul_f32 v23, v23, v9
aw a108,v20
aw a109,v21
aw a110,v22
aw a111,v23
ar v20,a112
ar v21,a113
ar v22,a114
ar v23,a115
v_mul_f32 v20, v20, v6
v_mul_f32 v21, v21, v6
v_mul_f32 v22, v22, v6
v_mul_f32 v23, v23, v6
aw a112,v20
aw a113,v21
aw a114,v22
aw a115,v23
ar v20,a116
ar v21,a117
ar v22,a118
ar v23,a119
v_mul_f32 v20, v20, v7
v_mul_f32 v21, v21, v7
v_mul_f32 v22, v22, v7
v_mul_f32 v23, v23, v7
aw a116,v20
aw a117,v21
aw a118,v22
aw a119,v23
ar v20,a120
ar v21,a121
ar v22,a122
ar v23,a123
v_mul_f32 v20, v20, v8
v_mul_f32 v21, v21, v8
v_mul_f32 v22, v22, v8
v_mul_f32 v23, v23, v8
aw a120,v20
aw a121,v21
aw a122,v22
aw a123,v23
ar v20,a124
ar v21,a125
ar v22,a126
ar v23,a127
v_mul_f32 v20, v20, v9
v_mul_f32 v21, v21, v9
v_mul_f32 v22, v22, v9
v_mul_f32 v23, v23, v9
aw a124,v20
aw a125,v21
aw a126,v22
aw a127,v23
L_rare1_p:
v_exp_f32 v20, v192
v_exp_f32 v21, v193
v_exp_f32 v22, v194
cv v96,v20,v21
v_exp_f32 v23, v195
v_exp_f32 v24, v208
cv v97,v22,v23
v_exp_f32 v25, v209
v_or_b32 v12, v96, v97
cv v98,v24,v25
v_exp_f32 v26, v210
v_exp_f32 v27, v211
v_exp_f32 v20, v196
cv v99,v26,v27
v_exp_f32 v21, v197
v_or3_b32 v12, v98, v99, v12
cv v100,v20,v21
v_exp_f32 v22, v198
v_exp_f32 v23, v199
v_exp_f32 v24, v212
cv v101,v22,v23
v_exp_f32 v25, v213
v_or3_b32 v12, v100, v101, v12
cv v102,v24,v25
v_exp_f32 v26, v214
v_exp_f32 v27, v215
v_exp_f32 v20, v200
cv v103,v26,v27
v_exp_f32 v21, v201
v_or3_b32 v12, v102, v103, v12
cv v104,v20,v21
v_exp_f32 v22, v202
v_exp_f32 v23, v203
v_exp_f32 v24, v216
cv v105,v22,v23
v_exp_f32 v25, v217
v_or3_b32 v12, v104, v105, v12
cv v106,v24,v25
v_exp_f32 v26, v218
v_exp_f32 v27, v219
v_exp_f32 v20, v204
cv v107,v26,v27
v_exp_f32 v21, v205
v_or3_b32 v12, v106, v107, v12
cv v108,v20,v21
v_exp_f32 v22, v206
v_exp_f32 v23, v207
v_exp_f32 v24, v220
cv v109,v22,v23
v_exp_f32 v25, v221
v_or3_b32 v12, v108, v109, v12
cv v110,v24,v25
v_exp_f32 v26, v222
v_exp_f32 v27, v223
v_exp_f32 v20, v224
cv v111,v26,v27
v_exp_f32 v21, v225
v_or3_b32 v12, v110, v111, v12
cv v112,v20,v21
v_exp_f32 v22, v226
v_exp_f32 v23, v227
v_exp_f32 v24, v240
cv v113,v22,v23
v_exp_f32 v25, v241
v_or3_b32 v12, v112, v113, v12
cv v114,v24,v25
v_exp_f32 v26, v242
v_exp_f32 v27, v243
v_exp_f32 v20, v228
cv v115,v26,v27
v_exp_f32 v21, v229
v_or3_b32 v12, v114, v115, v12
cv v116,v20,v21
v_exp_f32 v22, v230
v_exp_f32 v23, v231
v_exp_f32 v24, v244
cv v117,v22,v23
v_exp_f32 v25, v245
v_or3_b32 v12, v116, v117, v12
cv v118,v24,v25
v_exp_f32 v26, v246
v_exp_f32 v27, v247
v_exp_f32 v20, v232
cv v119,v26,v27
v_exp_f32 v21, v233
v_or3_b32 v12, v118, v119, v12
cv v120,v20,v21
v_exp_f32 v22, v234
v_exp_f32 v23, v235
v_exp_f32 v24, v248
cv v121,v22,v23
v_exp_f32 v25, v249
v_or3_b32 v12, v120, v121, v12
cv v122,v24,v25
v_exp_f32 v26, v250
v_exp_f32 v27, v251
v_exp_f32 v20, v236
cv v123,v26,v27
v_exp_f32 v21, v237
v_or3_b32 v12, v122, v123, v12
cv v124,v20,v21
v_exp_f32 v22, v238
v_exp_f32 v23, v239
v_exp_f32 v24, v252
cv v125,v22,v23
v_exp_f32 v25, v253
v_or3_b32 v12, v124, v125, v12
cv v126,v24,v25
v_exp_f32 v26, v254
v_exp_f32 v27, v255
s_nop 0
cv v127,v26,v27
v_or3_b32 v12, v126, v127, v12
v_and_b32 v12, 0x40004000, v12
v_cmp_ne_u32 vcc, 0, v12
s_nop 3
s_setpc_b64 s[42:43]
L_rarex0:
s_nop 15
v_max3_f32 v24, v128, v129, v130
v_max3_f32 v24, v131, v144, v24
v_max3_f32 v24, v145, v146, v24
v_max3_f32 v24, v147, v160, v24
v_max3_f32 v24, v161, v162, v24
v_max3_f32 v24, v163, v176, v24
v_max3_f32 v24, v177, v178, v24
v_max_f32 v24, v179, v24
v_max3_f32 v25, v132, v133, v134
v_max3_f32 v25, v135, v148, v25
v_max3_f32 v25, v149, v150, v25
v_max3_f32 v25, v151, v164, v25
v_max3_f32 v25, v165, v166, v25
v_max3_f32 v25, v167, v180, v25
v_max3_f32 v25, v181, v182, v25
v_max_f32 v25, v183, v25
v_max3_f32 v26, v136, v137, v138
v_max3_f32 v26, v139, v152, v26
v_max3_f32 v26, v153, v154, v26
v_max3_f32 v26, v155, v168, v26
v_max3_f32 v26, v169, v170, v26
v_max3_f32 v26, v171, v184, v26
v_max3_f32 v26, v185, v186, v26
v_max_f32 v26, v187, v26
v_max3_f32 v27, v140, v141, v142
v_max3_f32 v27, v143, v156, v27
v_max3_f32 v27, v157, v158, v27
v_max3_f32 v27, v159, v172, v27
v_max3_f32 v27, v173, v174, v27
v_max3_f32 v27, v175, v188, v27
v_max3_f32 v27, v189, v190, v27
v_max_f32 v27, v191, v27
v_mov_b32 v20, v24
v_mov_b32 v21, v25
v_mov_b32 v22, v26
v_mov_b32 v23, v27
v_permlane16_swap_b32 v24, v20
v_permlane16_swap_b32 v25, v21
v_permlane16_swap_b32 v26, v22
v_permlane16_swap_b32 v27, v23
v_max_f32 v24, v24, v20
v_max_f32 v25, v25, v21
v_max_f32 v26, v26, v22
v_max_f32 v27, v27, v23
v_mov_b32 v20, v24
v_mov_b32 v21, v25
v_mov_b32 v22, v26
v_mov_b32 v23, v27
v_permlane32_swap_b32 v24, v20
v_permlane32_swap_b32 v25, v21
v_permlane32_swap_b32 v26, v22
v_permlane32_swap_b32 v27, v23
v_max_f32 v24, v24, v20
v_max_f32 v25, v25, v21
v_max_f32 v26, v26, v22
v_max_f32 v27, v27, v23
v_add_f32 v24, 0x41c00000, v24
v_add_f32 v25, 0x41c00000, v25
v_add_f32 v26, 0x41c00000, v26
v_add_f32 v27, 0x41c00000, v27
v_max_f32 v24, 0, v24
v_max_f32 v25, 0, v25
v_max_f32 v26, 0, v26
v_max_f32 v27, 0, v27
v_exp_f32 v6, -v24
v_exp_f32 v7, -v25
v_exp_f32 v8, -v26
v_exp_f32 v9, -v27
v_sub_f32 v14, v14, v24
v_sub_f32 v15, v15, v25
v_sub_f32 v16, v16, v26
v_sub_f32 v17, v17, v27
v_sub_f32 v128, v128, v24
v_sub_f32 v129, v129, v24
v_sub_f32 v130, v130, v24
v_sub_f32 v131, v131, v24
v_sub_f32 v132, v132, v25
v_sub_f32 v133, v133, v25
v_sub_f32 v134, v134, v25
v_sub_f32 v135, v135, v25
v_sub_f32 v136, v136, v26
v_sub_f32 v137, v137, v26
v_sub_f32 v138, v138, v26
v_sub_f32 v139, v139, v26
v_sub_f32 v140, v140, v27
v_sub_f32 v141, v141, v27
v_sub_f32 v142, v142, v27
v_sub_f32 v143, v143, v27
v_sub_f32 v144, v144, v24
v_sub_f32 v145, v145, v24
v_sub_f32 v146, v146, v24
v_sub_f32 v147, v147, v24
v_sub_f32 v148, v148, v25
v_sub_f32 v149, v149, v25
v_sub_f32 v150, v150, v25
v_sub_f32 v151, v151, v25
v_sub_f32 v152, v152, v26
v_sub_f32 v153, v153, v26
v_sub_f32 v154, v154, v26
v_sub_f32 v155, v155, v26
v_sub_f32 v156, v156, v27
v_sub_f32 v157, v157, v27
v_sub_f32 v158, v158, v27
v_sub_f32 v159, v159, v27
v_sub_f32 v160, v160, v24
v_sub_f32 v161, v161, v24
v_sub_f32 v162, v162, v24
v_sub_f32 v163, v163, v24
v_sub_f32 v164, v164, v25
v_sub_f32 v165, v165, v25
v_sub_f32 v166, v166, v25
v_sub_f32 v167, v167, v25
v_sub_f32 v168, v168, v26
v_sub_f32 v169, v169, v26
v_sub_f32 v170, v170, v26
v_sub_f32 v171, v171, v26
v_sub_f32 v172, v172, v27
v_sub_f32 v173, v173, v27
v_sub_f32 v174, v174, v27
v_sub_f32 v175, v175, v27
v_sub_f32 v176, v176, v24
v_sub_f32 v177, v177, v24
v_sub_f32 v178, v178, v24
v_sub_f32 v179, v179, v24
v_sub_f32 v180, v180, v25
v_sub_f32 v181, v181, v25
v_sub_f32 v182, v182, v25
v_sub_f32 v183, v183, v25
v_sub_f32 v184, v184, v26
v_sub_f32 v185, v185, v26
v_sub_f32 v186, v186, v26
v_sub_f32 v187, v187, v26
v_sub_f32 v188, v188, v27
v_sub_f32 v189, v189, v27
v_sub_f32 v190, v190, v27
v_sub_f32 v191, v191, v27
v_mul_f32 v48, v48, v6
v_mul_f32 v49, v49, v6
v_mul_f32 v50, v50, v6
v_mul_f32 v51, v51, v6
v_mul_f32 v52, v52, v7
v_mul_f32 v53, v53, v7
v_mul_f32 v54, v54, v7
v_mul_f32 v55, v55, v7
v_mul_f32 v56, v56, v8
v_mul_f32 v57, v57, v8
v_mul_f32 v58, v58, v8
v_mul_f32 v59, v59, v8
v_mul_f32 v60, v60, v9
v_mul_f32 v61, v61, v9
v_mul_f32 v62, v62, v9
v_mul_f32 v63, v63, v9
ar v20,a0
ar v21,a1
ar v22,a2
ar v23,a3
v_mul_f32 v20, v20, v6
v_mul_f32 v21, v21, v6
v_mul_f32 v22, v22, v6
v_mul_f32 v23, v23, v6
aw a0,v20
aw a1,v21
aw a2,v22
aw a3,v23
ar v20,a4
ar v21,a5
ar v22,a6
ar v23,a7
v_mul_f32 v20, v20, v7
v_mul_f32 v21, v21, v7
v_mul_f32 v22, v22, v7
v_mul_f32 v23, v23, v7
aw a4,v20
aw a5,v21
aw a6,v22
aw a7,v23
ar v20,a8
ar v21,a9
ar v22,a10
ar v23,a11
v_mul_f32 v20, v20, v8
v_mul_f32 v21, v21, v8
v_mul_f32 v22, v22, v8
v_mul_f32 v23, v23, v8
aw a8,v20
aw a9,v21
aw a10,v22
aw a11,v23
ar v20,a12
ar v21,a13
ar v22,a14
ar v23,a15
v_mul_f32 v20, v20, v9
v_mul_f32 v21, v21, v9
v_mul_f32 v22, v22, v9
v_mul_f32 v23, v23, v9
aw a12,v20
aw a13,v21
aw a14,v22
aw a15,v23
ar v20,a16
ar v21,a17
ar v22,a18
ar v23,a19
v_mul_f32 v20, v20, v6
v_mul_f32 v21, v21, v6
v_mul_f32 v22, v22, v6
v_mul_f32 v23, v23, v6
aw a16,v20
aw a17,v21
aw a18,v22
aw a19,v23
ar v20,a20
ar v21,a21
ar v22,a22
ar v23,a23
v_mul_f32 v20, v20, v7
v_mul_f32 v21, v21, v7
v_mul_f32 v22, v22, v7
v_mul_f32 v23, v23, v7
aw a20,v20
aw a21,v21
aw a22,v22
aw a23,v23
ar v20,a24
ar v21,a25
ar v22,a26
ar v23,a27
v_mul_f32 v20, v20, v8
v_mul_f32 v21, v21, v8
v_mul_f32 v22, v22, v8
v_mul_f32 v23, v23, v8
aw a24,v20
aw a25,v21
aw a26,v22
aw a27,v23
ar v20,a28
ar v21,a29
ar v22,a30
ar v23,a31
v_mul_f32 v20, v20, v9
v_mul_f32 v21, v21, v9
v_mul_f32 v22, v22, v9
v_mul_f32 v23, v23, v9
aw a28,v20
aw a29,v21
aw a30,v22
aw a31,v23
ar v20,a32
ar v21,a33
ar v22,a34
ar v23,a35
v_mul_f32 v20, v20, v6
v_mul_f32 v21, v21, v6
v_mul_f32 v22, v22, v6
v_mul_f32 v23, v23, v6
aw a32,v20
aw a33,v21
aw a34,v22
aw a35,v23
ar v20,a36
ar v21,a37
ar v22,a38
ar v23,a39
v_mul_f32 v20, v20, v7
v_mul_f32 v21, v21, v7
v_mul_f32 v22, v22, v7
v_mul_f32 v23, v23, v7
aw a36,v20
aw a37,v21
aw a38,v22
aw a39,v23
ar v20,a40
ar v21,a41
ar v22,a42
ar v23,a43
v_mul_f32 v20, v20, v8
v_mul_f32 v21, v21, v8
v_mul_f32 v22, v22, v8
v_mul_f32 v23, v23, v8
aw a40,v20
aw a41,v21
aw a42,v22
aw a43,v23
ar v20,a44
ar v21,a45
ar v22,a46
ar v23,a47
v_mul_f32 v20, v20, v9
v_mul_f32 v21, v21, v9
v_mul_f32 v22, v22, v9
v_mul_f32 v23, v23, v9
aw a44,v20
aw a45,v21
aw a46,v22
aw a47,v23
ar v20,a48
ar v21,a49
ar v22,a50
ar v23,a51
v_mul_f32 v20, v20, v6
v_mul_f32 v21, v21, v6
v_mul_f32 v22, v22, v6
v_mul_f32 v23, v23, v6
aw a48,v20
aw a49,v21
aw a50,v22
aw a51,v23
ar v20,a52
ar v21,a53
ar v22,a54
ar v23,a55
v_mul_f32 v20, v20, v7
v_mul_f32 v21, v21, v7
v_mul_f32 v22, v22, v7
v_mul_f32 v23, v23, v7
aw a52,v20
aw a53,v21
aw a54,v22
aw a55,v23
ar v20,a56
ar v21,a57
ar v22,a58
ar v23,a59
v_mul_f32 v20, v20, v8
v_mul_f32 v21, v21, v8
v_mul_f32 v22, v22, v8
v_mul_f32 v23, v23, v8
aw a56,v20
aw a57,v21
aw a58,v22
aw a59,v23
ar v20,a60
ar v21,a61
ar v22,a62
ar v23,a63
v_mul_f32 v20, v20, v9
v_mul_f32 v21, v21, v9
v_mul_f32 v22, v22, v9
v_mul_f32 v23, v23, v9
aw a60,v20
aw a61,v21
aw a62,v22
aw a63,v23
ar v20,a64
ar v21,a65
ar v22,a66
ar v23,a67
v_mul_f32 v20, v20, v6
v_mul_f32 v21, v21, v6
v_mul_f32 v22, v22, v6
v_mul_f32 v23, v23, v6
aw a64,v20
aw a65,v21
aw a66,v22
aw a67,v23
ar v20,a68
ar v21,a69
ar v22,a70
ar v23,a71
v_mul_f32 v20, v20, v7
v_mul_f32 v21, v21, v7
v_mul_f32 v22, v22, v7
v_mul_f32 v23, v23, v7
aw a68,v20
aw a69,v21
aw a70,v22
aw a71,v23
ar v20,a72
ar v21,a73
ar v22,a74
ar v23,a75
v_mul_f32 v20, v20, v8
v_mul_f32 v21, v21, v8
v_mul_f32 v22, v22, v8
v_mul_f32 v23, v23, v8
aw a72,v20
aw a73,v21
aw a74,v22
aw a75,v23
ar v20,a76
ar v21,a77
ar v22,a78
ar v23,a79
v_mul_f32 v20, v20, v9
v_mul_f32 v21, v21, v9
v_mul_f32 v22, v22, v9
v_mul_f32 v23, v23, v9
aw a76,v20
aw a77,v21
aw a78,v22
aw a79,v23
ar v20,a80
ar v21,a81
ar v22,a82
ar v23,a83
v_mul_f32 v20, v20, v6
v_mul_f32 v21, v21, v6
v_mul_f32 v22, v22, v6
v_mul_f32 v23, v23, v6
aw a80,v20
aw a81,v21
aw a82,v22
aw a83,v23
ar v20,a84
ar v21,a85
ar v22,a86
ar v23,a87
v_mul_f32 v20, v20, v7
v_mul_f32 v21, v21, v7
v_mul_f32 v22, v22, v7
v_mul_f32 v23, v23, v7
aw a84,v20
aw a85,v21
aw a86,v22
aw a87,v23
ar v20,a88
ar v21,a89
ar v22,a90
ar v23,a91
v_mul_f32 v20, v20, v8
v_mul_f32 v21, v21, v8
v_mul_f32 v22, v22, v8
v_mul_f32 v23, v23, v8
aw a88,v20
aw a89,v21
aw a90,v22
aw a91,v23
ar v20,a92
ar v21,a93
ar v22,a94
ar v23,a95
v_mul_f32 v20, v20, v9
v_mul_f32 v21, v21, v9
v_mul_f32 v22, v22, v9
v_mul_f32 v23, v23, v9
aw a92,v20
aw a93,v21
aw a94,v22
aw a95,v23
ar v20,a96
ar v21,a97
ar v22,a98
ar v23,a99
v_mul_f32 v20, v20, v6
v_mul_f32 v21, v21, v6
v_mul_f32 v22, v22, v6
v_mul_f32 v23, v23, v6
aw a96,v20
aw a97,v21
aw a98,v22
aw a99,v23
ar v20,a100
ar v21,a101
ar v22,a102
ar v23,a103
v_mul_f32 v20, v20, v7
v_mul_f32 v21, v21, v7
v_mul_f32 v22, v22, v7
v_mul_f32 v23, v23, v7
aw a100,v20
aw a101,v21
aw a102,v22
aw a103,v23
ar v20,a104
ar v21,a105
ar v22,a106
ar v23,a107
v_mul_f32 v20, v20, v8
v_mul_f32 v21, v21, v8
v_mul_f32 v22, v22, v8
v_mul_f32 v23, v23, v8
aw a104,v20
aw a105,v21
aw a106,v22
aw a107,v23
ar v20,a108
ar v21,a109
ar v22,a110
ar v23,a111
v_mul_f32 v20, v20, v9
v_mul_f32 v21, v21, v9
v_mul_f32 v22, v22, v9
v_mul_f32 v23, v23, v9
aw a108,v20
aw a109,v21
aw a110,v22
aw a111,v23
ar v20,a112
ar v21,a113
ar v22,a114
ar v23,a115
v_mul_f32 v20, v20, v6
v_mul_f32 v21, v21, v6
v_mul_f32 v22, v22, v6
v_mul_f32 v23, v23, v6
aw a112,v20
aw a113,v21
aw a114,v22
aw a115,v23
ar v20,a116
ar v21,a117
ar v22,a118
ar v23,a119
v_mul_f32 v20, v20, v7
v_mul_f32 v21, v21, v7
v_mul_f32 v22, v22, v7
v_mul_f32 v23, v23, v7
aw a116,v20
aw a117,v21
aw a118,v22
aw a119,v23
ar v20,a120
ar v21,a121
ar v22,a122
ar v23,a123
v_mul_f32 v20, v20, v8
v_mul_f32 v21, v21, v8
v_mul_f32 v22, v22, v8
v_mul_f32 v23, v23, v8
aw a120,v20
aw a121,v21
aw a122,v22
aw a123,v23
ar v20,a124
ar v21,a125
ar v22,a126
ar v23,a127
v_mul_f32 v20, v20, v9
v_mul_f32 v21, v21, v9
v_mul_f32 v22, v22, v9
v_mul_f32 v23, v23, v9
aw a124,v20
aw a125,v21
aw a126,v22
aw a127,v23
L_rarex0_p:
v_exp_f32 v20, v128
v_exp_f32 v21, v129
v_exp_f32 v22, v130
cv v64,v20,v21
v_exp_f32 v23, v131
v_exp_f32 v24, v144
cv v65,v22,v23
v_exp_f32 v25, v145
v_or_b32 v12, v64, v65
cv v66,v24,v25
v_exp_f32 v26, v146
v_exp_f32 v27, v147
v_exp_f32 v20, v132
cv v67,v26,v27
v_exp_f32 v21, v133
v_or3_b32 v12, v66, v67, v12
cv v68,v20,v21
v_exp_f32 v22, v134
v_exp_f32 v23, v135
v_exp_f32 v24, v148
cv v69,v22,v23
v_exp_f32 v25, v149
v_or3_b32 v12, v68, v69, v12
cv v70,v24,v25
v_exp_f32 v26, v150
v_exp_f32 v27, v151
v_exp_f32 v20, v136
cv v71,v26,v27
v_exp_f32 v21, v137
v_or3_b32 v12, v70, v71, v12
cv v72,v20,v21
v_exp_f32 v22, v138
v_exp_f32 v23, v139
v_exp_f32 v24, v152
cv v73,v22,v23
v_exp_f32 v25, v153
v_or3_b32 v12, v72, v73, v12
cv v74,v24,v25
v_exp_f32 v26, v154
v_exp_f32 v27, v155
v_exp_f32 v20, v140
cv v75,v26,v27
v_exp_f32 v21, v141
v_or3_b32 v12, v74, v75, v12
cv v76,v20,v21
v_exp_f32 v22, v142
v_exp_f32 v23, v143
v_exp_f32 v24, v156
cv v77,v22,v23
v_exp_f32 v25, v157
v_or3_b32 v12, v76, v77, v12
cv v78,v24,v25
v_exp_f32 v26, v158
v_exp_f32 v27, v159
v_exp_f32 v20, v160
cv v79,v26,v27
v_exp_f32 v21, v161
v_or3_b32 v12, v78, v79, v12
cv v80,v20,v21
v_exp_f32 v22, v162
v_exp_f32 v23, v163
v_exp_f32 v24, v176
cv v81,v22,v23
v_exp_f32 v25, v177
v_or3_b32 v12, v80, v81, v12
cv v82,v24,v25
v_exp_f32 v26, v178
v_exp_f32 v27, v179
v_exp_f32 v20, v164
cv v83,v26,v27
v_exp_f32 v21, v165
v_or3_b32 v12, v82, v83, v12
cv v84,v20,v21
v_exp_f32 v22, v166
v_exp_f32 v23, v167
v_exp_f32 v24, v180
cv v85,v22,v23
v_exp_f32 v25, v181
v_or3_b32 v12, v84, v85, v12
cv v86,v24,v25
v_exp_f32 v26, v182
v_exp_f32 v27, v183
v_exp_f32 v20, v168
cv v87,v26,v27
v_exp_f32 v21, v169
v_or3_b32 v12, v86, v87, v12
cv v88,v20,v21
v_exp_f32 v22, v170
v_exp_f32 v23, v171
v_exp_f32 v24, v184
cv v89,v22,v23
v_exp_f32 v25, v185
v_or3_b32 v12, v88, v89, v12
cv v90,v24,v25
v_exp_f32 v26, v186
v_exp_f32 v27, v187
v_exp_f32 v20, v172
cv v91,v26,v27
v_exp_f32 v21, v173
v_or3_b32 v12, v90, v91, v12
cv v92,v20,v21
v_exp_f32 v22, v174
v_exp_f32 v23, v175
v_exp_f32 v24, v188
cv v93,v22,v23
v_exp_f32 v25, v189
v_or3_b32 v12, v92, v93, v12
cv v94,v24,v25
v_exp_f32 v26, v190
v_exp_f32 v27, v191
s_nop 0
cv v95,v26,v27
v_or3_b32 v12, v94, v95, v12
v_and_b32 v12, 0x40004000, v12
v_cmp_ne_u32 vcc, 0, v12
s_nop 3
s_setpc_b64 s[42:43]
L_rarex1:
s_nop 15
v_max3_f32 v24, v192, v193, v194
v_max3_f32 v24, v195, v208, v24
v_max3_f32 v24, v209, v210, v24
v_max3_f32 v24, v211, v224, v24
v_max3_f32 v24, v225, v226, v24
v_max3_f32 v24, v227, v240, v24
v_max3_f32 v24, v241, v242, v24
v_max_f32 v24, v243, v24
v_max3_f32 v25, v196, v197, v198
v_max3_f32 v25, v199, v212, v25
v_max3_f32 v25, v213, v214, v25
v_max3_f32 v25, v215, v228, v25
v_max3_f32 v25, v229, v230, v25
v_max3_f32 v25, v231, v244, v25
v_max3_f32 v25, v245, v246, v25
v_max_f32 v25, v247, v25
v_max3_f32 v26, v200, v201, v202
v_max3_f32 v26, v203, v216, v26
v_max3_f32 v26, v217, v218, v26
v_max3_f32 v26, v219, v232, v26
v_max3_f32 v26, v233, v234, v26
v_max3_f32 v26, v235, v248, v26
v_max3_f32 v26, v249, v250, v26
v_max_f32 v26, v251, v26
v_max3_f32 v27, v204, v205, v206
v_max3_f32 v27, v207, v220, v27
v_max3_f32 v27, v221, v222, v27
v_max3_f32 v27, v223, v236, v27
v_max3_f32 v27, v237, v238, v27
v_max3_f32 v27, v239, v252, v27
v_max3_f32 v27, v253, v254, v27
v_max_f32 v27, v255, v27
v_mov_b32 v20, v24
v_mov_b32 v21, v25
v_mov_b32 v22, v26
v_mov_b32 v23, v27
v_permlane16_swap_b32 v24, v20
v_permlane16_swap_b32 v25, v21
v_permlane16_swap_b32 v26, v22
v_permlane16_swap_b32 v27, v23
v_max_f32 v24, v24, v20
v_max_f32 v25, v25, v21
v_max_f32 v26, v26, v22
v_max_f32 v27, v27, v23
v_mov_b32 v20, v24
v_mov_b32 v21, v25
v_mov_b32 v22, v26
v_mov_b32 v23, v27
v_permlane32_swap_b32 v24, v20
v_permlane32_swap_b32 v25, v21
v_permlane32_swap_b32 v26, v22
v_permlane32_swap_b32 v27, v23
v_max_f32 v24, v24, v20
v_max_f32 v25, v25, v21
v_max_f32 v26, v26, v22
v_max_f32 v27, v27, v23
v_add_f32 v24, 0x41c00000, v24
v_add_f32 v25, 0x41c00000, v25
v_add_f32 v26, 0x41c00000, v26
v_add_f32 v27, 0x41c00000, v27
v_max_f32 v24, 0, v24
v_max_f32 v25, 0, v25
v_max_f32 v26, 0, v26
v_max_f32 v27, 0, v27
v_exp_f32 v6, -v24
v_exp_f32 v7, -v25
v_exp_f32 v8, -v26
v_exp_f32 v9, -v27
v_sub_f32 v14, v14, v24
v_sub_f32 v15, v15, v25
v_sub_f32 v16, v16, v26
v_sub_f32 v17, v17, v27
v_sub_f32 v192, v192, v24
v_sub_f32 v193, v193, v24
v_sub_f32 v194, v194, v24
v_sub_f32 v195, v195, v24
v_sub_f32 v196, v196, v25
v_sub_f32 v197, v197, v25
v_sub_f32 v198, v198, v25
v_sub_f32 v199, v199, v25
v_sub_f32 v200, v200, v26
v_sub_f32 v201, v201, v26
v_sub_f32 v202, v202, v26
v_sub_f32 v203, v203, v26
v_sub_f32 v204, v204, v27
v_sub_f32 v205, v205, v27
v_sub_f32 v206, v206, v27
v_sub_f32 v207, v207, v27
v_sub_f32 v208, v208, v24
v_sub_f32 v209, v209, v24
v_sub_f32 v210, v210, v24
v_sub_f32 v211, v211, v24
v_sub_f32 v212, v212, v25
v_sub_f32 v213, v213, v25
v_sub_f32 v214, v214, v25
v_sub_f32 v215, v215, v25
v_sub_f32 v216, v216, v26
v_sub_f32 v217, v217, v26
v_sub_f32 v218, v218, v26
v_sub_f32 v219, v219, v26
v_sub_f32 v220, v220, v27
v_sub_f32 v221, v221, v27
v_sub_f32 v222, v222, v27
v_sub_f32 v223, v223, v27
v_sub_f32 v224, v224, v24
v_sub_f32 v225, v225, v24
v_sub_f32 v226, v226, v24
v_sub_f32 v227, v227, v24
v_sub_f32 v228, v228, v25
v_sub_f32 v229, v229, v25
v_sub_f32 v230, v230, v25
v_sub_f32 v231, v231, v25
v_sub_f32 v232, v232, v26
v_sub_f32 v233, v233, v26
v_sub_f32 v234, v234, v26
v_sub_f32 v235, v235, v26
v_sub_f32 v236, v236, v27
v_sub_f32 v237, v237, v27
v_sub_f32 v238, v238, v27
v_sub_f32 v239, v239, v27
v_sub_f32 v240, v240, v24
v_sub_f32 v241, v241, v24
v_sub_f32 v242, v242, v24
v_sub_f32 v243, v243, v24
v_sub_f32 v244, v244, v25
v_sub_f32 v245, v245, v25
v_sub_f32 v246, v246, v25
v_sub_f32 v247, v247, v25
v_sub_f32 v248, v248, v26
v_sub_f32 v249, v249, v26
v_sub_f32 v250, v250, v26
v_sub_f32 v251, v251, v26
v_sub_f32 v252, v252, v27
v_sub_f32 v253, v253, v27
v_sub_f32 v254, v254, v27
v_sub_f32 v255, v255, v27
v_mul_f32 v48, v48, v6
v_mul_f32 v49, v49, v6
v_mul_f32 v50, v50, v6
v_mul_f32 v51, v51, v6
v_mul_f32 v52, v52, v7
v_mul_f32 v53, v53, v7
v_mul_f32 v54, v54, v7
v_mul_f32 v55, v55, v7
v_mul_f32 v56, v56, v8
v_mul_f32 v57, v57, v8
v_mul_f32 v58, v58, v8
v_mul_f32 v59, v59, v8
v_mul_f32 v60, v60, v9
v_mul_f32 v61, v61, v9
v_mul_f32 v62, v62, v9
v_mul_f32 v63, v63, v9
ar v20,a0
ar v21,a1
ar v22,a2
ar v23,a3
v_mul_f32 v20, v20, v6
v_mul_f32 v21, v21, v6
v_mul_f32 v22, v22, v6
v_mul_f32 v23, v23, v6
aw a0,v20
aw a1,v21
aw a2,v22
aw a3,v23
ar v20,a4
ar v21,a5
ar v22,a6
ar v23,a7
v_mul_f32 v20, v20, v7
v_mul_f32 v21, v21, v7
v_mul_f32 v22, v22, v7
v_mul_f32 v23, v23, v7
aw a4,v20
aw a5,v21
aw a6,v22
aw a7,v23
ar v20,a8
ar v21,a9
ar v22,a10
ar v23,a11
v_mul_f32 v20, v20, v8
v_mul_f32 v21, v21, v8
v_mul_f32 v22, v22, v8
v_mul_f32 v23, v23, v8
aw a8,v20
aw a9,v21
aw a10,v22
aw a11,v23
ar v20,a12
ar v21,a13
ar v22,a14
ar v23,a15
v_mul_f32 v20, v20, v9
v_mul_f32 v21, v21, v9
v_mul_f32 v22, v22, v9
v_mul_f32 v23, v23, v9
aw a12,v20
aw a13,v21
aw a14,v22
aw a15,v23
ar v20,a16
ar v21,a17
ar v22,a18
ar v23,a19
v_mul_f32 v20, v20, v6
v_mul_f32 v21, v21, v6
v_mul_f32 v22, v22, v6
v_mul_f32 v23, v23, v6
aw a16,v20
aw a17,v21
aw a18,v22
aw a19,v23
ar v20,a20
ar v21,a21
ar v22,a22
ar v23,a23
v_mul_f32 v20, v20, v7
v_mul_f32 v21, v21, v7
v_mul_f32 v22, v22, v7
v_mul_f32 v23, v23, v7
aw a20,v20
aw a21,v21
aw a22,v22
aw a23,v23
ar v20,a24
ar v21,a25
ar v22,a26
ar v23,a27
v_mul_f32 v20, v20, v8
v_mul_f32 v21, v21, v8
v_mul_f32 v22, v22, v8
v_mul_f32 v23, v23, v8
aw a24,v20
aw a25,v21
aw a26,v22
aw a27,v23
ar v20,a28
ar v21,a29
ar v22,a30
ar v23,a31
v_mul_f32 v20, v20, v9
v_mul_f32 v21, v21, v9
v_mul_f32 v22, v22, v9
v_mul_f32 v23, v23, v9
aw a28,v20
aw a29,v21
aw a30,v22
aw a31,v23
ar v20,a32
ar v21,a33
ar v22,a34
ar v23,a35
v_mul_f32 v20, v20, v6
v_mul_f32 v21, v21, v6
v_mul_f32 v22, v22, v6
v_mul_f32 v23, v23, v6
aw a32,v20
aw a33,v21
aw a34,v22
aw a35,v23
ar v20,a36
ar v21,a37
ar v22,a38
ar v23,a39
v_mul_f32 v20, v20, v7
v_mul_f32 v21, v21, v7
v_mul_f32 v22, v22, v7
v_mul_f32 v23, v23, v7
aw a36,v20
aw a37,v21
aw a38,v22
aw a39,v23
ar v20,a40
ar v21,a41
ar v22,a42
ar v23,a43
v_mul_f32 v20, v20, v8
v_mul_f32 v21, v21, v8
v_mul_f32 v22, v22, v8
v_mul_f32 v23, v23, v8
aw a40,v20
aw a41,v21
aw a42,v22
aw a43,v23
ar v20,a44
ar v21,a45
ar v22,a46
ar v23,a47
v_mul_f32 v20, v20, v9
v_mul_f32 v21, v21, v9
v_mul_f32 v22, v22, v9
v_mul_f32 v23, v23, v9
aw a44,v20
aw a45,v21
aw a46,v22
aw a47,v23
ar v20,a48
ar v21,a49
ar v22,a50
ar v23,a51
v_mul_f32 v20, v20, v6
v_mul_f32 v21, v21, v6
v_mul_f32 v22, v22, v6
v_mul_f32 v23, v23, v6
aw a48,v20
aw a49,v21
aw a50,v22
aw a51,v23
ar v20,a52
ar v21,a53
ar v22,a54
ar v23,a55
v_mul_f32 v20, v20, v7
v_mul_f32 v21, v21, v7
v_mul_f32 v22, v22, v7
v_mul_f32 v23, v23, v7
aw a52,v20
aw a53,v21
aw a54,v22
aw a55,v23
ar v20,a56
ar v21,a57
ar v22,a58
ar v23,a59
v_mul_f32 v20, v20, v8
v_mul_f32 v21, v21, v8
v_mul_f32 v22, v22, v8
v_mul_f32 v23, v23, v8
aw a56,v20
aw a57,v21
aw a58,v22
aw a59,v23
ar v20,a60
ar v21,a61
ar v22,a62
ar v23,a63
v_mul_f32 v20, v20, v9
v_mul_f32 v21, v21, v9
v_mul_f32 v22, v22, v9
v_mul_f32 v23, v23, v9
aw a60,v20
aw a61,v21
aw a62,v22
aw a63,v23
ar v20,a64
ar v21,a65
ar v22,a66
ar v23,a67
v_mul_f32 v20, v20, v6
v_mul_f32 v21, v21, v6
v_mul_f32 v22, v22, v6
v_mul_f32 v23, v23, v6
aw a64,v20
aw a65,v21
aw a66,v22
aw a67,v23
ar v20,a68
ar v21,a69
ar v22,a70
ar v23,a71
v_mul_f32 v20, v20, v7
v_mul_f32 v21, v21, v7
v_mul_f32 v22, v22, v7
v_mul_f32 v23, v23, v7
aw a68,v20
aw a69,v21
aw a70,v22
aw a71,v23
ar v20,a72
ar v21,a73
ar v22,a74
ar v23,a75
v_mul_f32 v20, v20, v8
v_mul_f32 v21, v21, v8
v_mul_f32 v22, v22, v8
v_mul_f32 v23, v23, v8
aw a72,v20
aw a73,v21
aw a74,v22
aw a75,v23
ar v20,a76
ar v21,a77
ar v22,a78
ar v23,a79
v_mul_f32 v20, v20, v9
v_mul_f32 v21, v21, v9
v_mul_f32 v22, v22, v9
v_mul_f32 v23, v23, v9
aw a76,v20
aw a77,v21
aw a78,v22
aw a79,v23
ar v20,a80
ar v21,a81
ar v22,a82
ar v23,a83
v_mul_f32 v20, v20, v6
v_mul_f32 v21, v21, v6
v_mul_f32 v22, v22, v6
v_mul_f32 v23, v23, v6
aw a80,v20
aw a81,v21
aw a82,v22
aw a83,v23
ar v20,a84
ar v21,a85
ar v22,a86
ar v23,a87
v_mul_f32 v20, v20, v7
v_mul_f32 v21, v21, v7
v_mul_f32 v22, v22, v7
v_mul_f32 v23, v23, v7
aw a84,v20
aw a85,v21
aw a86,v22
aw a87,v23
ar v20,a88
ar v21,a89
ar v22,a90
ar v23,a91
v_mul_f32 v20, v20, v8
v_mul_f32 v21, v21, v8
v_mul_f32 v22, v22, v8
v_mul_f32 v23, v23, v8
aw a88,v20
aw a89,v21
aw a90,v22
aw a91,v23
ar v20,a92
ar v21,a93
ar v22,a94
ar v23,a95
v_mul_f32 v20, v20, v9
v_mul_f32 v21, v21, v9
v_mul_f32 v22, v22, v9
v_mul_f32 v23, v23, v9
aw a92,v20
aw a93,v21
aw a94,v22
aw a95,v23
ar v20,a96
ar v21,a97
ar v22,a98
ar v23,a99
v_mul_f32 v20, v20, v6
v_mul_f32 v21, v21, v6
v_mul_f32 v22, v22, v6
v_mul_f32 v23, v23, v6
aw a96,v20
aw a97,v21
aw a98,v22
aw a99,v23
ar v20,a100
ar v21,a101
ar v22,a102
ar v23,a103
v_mul_f32 v20, v20, v7
v_mul_f32 v21, v21, v7
v_mul_f32 v22, v22, v7
v_mul_f32 v23, v23, v7
aw a100,v20
aw a101,v21
aw a102,v22
aw a103,v23
ar v20,a104
ar v21,a105
ar v22,a106
ar v23,a107
v_mul_f32 v20, v20, v8
v_mul_f32 v21, v21, v8
v_mul_f32 v22, v22, v8
v_mul_f32 v23, v23, v8
aw a104,v20
aw a105,v21
aw a106,v22
aw a107,v23
ar v20,a108
ar v21,a109
ar v22,a110
ar v23,a111
v_mul_f32 v20, v20, v9
v_mul_f32 v21, v21, v9
v_mul_f32 v22, v22, v9
v_mul_f32 v23, v23, v9
aw a108,v20
aw a109,v21
aw a110,v22
aw a111,v23
ar v20,a112
ar v21,a113
ar v22,a114
ar v23,a115
v_mul_f32 v20, v20, v6
v_mul_f32 v21, v21, v6
v_mul_f32 v22, v22, v6
v_mul_f32 v23, v23, v6
aw a112,v20
aw a113,v21
aw a114,v22
aw a115,v23
ar v20,a116
ar v21,a117
ar v22,a118
ar v23,a119
v_mul_f32 v20, v20, v7
v_mul_f32 v21, v21, v7
v_mul_f32 v22, v22, v7
v_mul_f32 v23, v23, v7
aw a116,v20
aw a117,v21
aw a118,v22
aw a119,v23
ar v20,a120
ar v21,a121
ar v22,a122
ar v23,a123
v_mul_f32 v20, v20, v8
v_mul_f32 v21, v21, v8
v_mul_f32 v22, v22, v8
v_mul_f32 v23, v23, v8
aw a120,v20
aw a121,v21
aw a122,v22
aw a123,v23
ar v20,a124
ar v21,a125
ar v22,a126
ar v23,a127
v_mul_f32 v20, v20, v9
v_mul_f32 v21, v21, v9
v_mul_f32 v22, v22, v9
v_mul_f32 v23, v23, v9
aw a124,v20
aw a125,v21
aw a126,v22
aw a127,v23
L_rarex1_p:
v_exp_f32 v20, v192
v_exp_f32 v21, v193
v_exp_f32 v22, v194
cv v96,v20,v21
v_exp_f32 v23, v195
v_exp_f32 v24, v208
cv v97,v22,v23
v_exp_f32 v25, v209
v_or_b32 v12, v96, v97
cv v98,v24,v25
v_exp_f32 v26, v210
v_exp_f32 v27, v211
v_exp_f32 v20, v196
cv v99,v26,v27
v_exp_f32 v21, v197
v_or3_b32 v12, v98, v99, v12
cv v100,v20,v21
v_exp_f32 v22, v198
v_exp_f32 v23, v199
v_exp_f32 v24, v212
cv v101,v22,v23
v_exp_f32 v25, v213
v_or3_b32 v12, v100, v101, v12
cv v102,v24,v25
v_exp_f32 v26, v214
v_exp_f32 v27, v215
v_exp_f32 v20, v200
cv v103,v26,v27
v_exp_f32 v21, v201
v_or3_b32 v12, v102, v103, v12
cv v104,v20,v21
v_exp_f32 v22, v202
v_exp_f32 v23, v203
v_exp_f32 v24, v216
cv v105,v22,v23
v_exp_f32 v25, v217
v_or3_b32 v12, v104, v105, v12
cv v106,v24,v25
v_exp_f32 v26, v218
v_exp_f32 v27, v219
v_exp_f32 v20, v204
cv v107,v26,v27
v_exp_f32 v21, v205
v_or3_b32 v12, v106, v107, v12
cv v108,v20,v21
v_exp_f32 v22, v206
v_exp_f32 v23, v207
v_exp_f32 v24, v220
cv v109,v22,v23
v_exp_f32 v25, v221
v_or3_b32 v12, v108, v109, v12
cv v110,v24,v25
v_exp_f32 v26, v222
v_exp_f32 v27, v223
v_exp_f32 v20, v224
cv v111,v26,v27
v_exp_f32 v21, v225
v_or3_b32 v12, v110, v111, v12
cv v112,v20,v21
v_exp_f32 v22, v226
v_exp_f32 v23, v227
v_exp_f32 v24, v240
cv v113,v22,v23
v_exp_f32 v25, v241
v_or3_b32 v12, v112, v113, v12
cv v114,v24,v25
v_exp_f32 v26, v242
v_exp_f32 v27, v243
v_exp_f32 v20, v228
cv v115,v26,v27
v_exp_f32 v21, v229
v_or3_b32 v12, v114, v115, v12
cv v116,v20,v21
v_exp_f32 v22, v230
v_exp_f32 v23, v231
v_exp_f32 v24, v244
cv v117,v22,v23
v_exp_f32 v25, v245
v_or3_b32 v12, v116, v117, v12
cv v118,v24,v25
v_exp_f32 v26, v246
v_exp_f32 v27, v247
v_exp_f32 v20, v232
cv v119,v26,v27
v_exp_f32 v21, v233
v_or3_b32 v12, v118, v119, v12
cv v120,v20,v21
v_exp_f32 v22, v234
v_exp_f32 v23, v235
v_exp_f32 v24, v248
cv v121,v22,v23
v_exp_f32 v25, v249
v_or3_b32 v12, v120, v121, v12
cv v122,v24,v25
v_exp_f32 v26, v250
v_exp_f32 v27, v251
v_exp_f32 v20, v236
cv v123,v26,v27
v_exp_f32 v21, v237
v_or3_b32 v12, v122, v123, v12
cv v124,v20,v21
v_exp_f32 v22, v238
v_exp_f32 v23, v239
v_exp_f32 v24, v252
cv v125,v22,v23
v_exp_f32 v25, v253
v_or3_b32 v12, v124, v125, v12
cv v126,v24,v25
v_exp_f32 v26, v254
v_exp_f32 v27, v255
s_nop 0
cv v127,v26,v27
v_or3_b32 v12, v126, v127, v12
v_and_b32 v12, 0x40004000, v12
v_cmp_ne_u32 vcc, 0, v12
s_nop 3
s_setpc_b64 s[42:43]
L_last:
s_waitcnt lgkmcnt(0)
ds_read_b128 a[192:195], v3 offset:32768
ds_read_b128 a[196:199], v3 offset:40960
ds_read_b128 a[200:203], v3 offset:33792
ds_read_b128 a[204:207], v3 offset:41984
ds_read_b128 a[208:211], v3 offset:34816
ds_read_b128 a[212:215], v3 offset:43008
ds_read_b128 a[216:219], v3 offset:35840
ds_read_b128 a[220:223], v3 offset:44032
v_cndmask_b32 v128, v11, v128, s[54:55]
v_cndmask_b32 v129, v11, v129, s[56:57]
v_exp_f32 v20, v128
v_exp_f32 v21, v129
s_add_u32 m0, s49, 65536
v_cndmask_b32 v130, v11, v130, s[58:59]
v_cndmask_b32 v131, v11, v131, s[60:61]
cv v64,v20,v21
v_exp_f32 v22, v130
buffer_load_dwordx4 v5, s[16:19], s48 offen offset:0 sc1 lds
v_exp_f32 v23, v131
v_cndmask_b32 v144, v11, v144, s[62:63]
v_exp_f32 v24, v144
v_cndmask_b32 v145, v11, v145, s[62:63]
v_exp_f32 v25, v145
cv v65,v22,v23
v_cndmask_b32 v146, v11, v146, s[62:63]
v_cndmask_b32 v147, v11, v147, s[62:63]
buffer_load_dwordx4 v5, s[16:19], s48 offen offset:1024 sc1 lds
s_waitcnt lgkmcnt(4)
mm a[0:3],a[192:195],v[96:99],a[0:3]
v_exp_f32 v26, v146
mm a[0:3],a[196:199],v[112:115],a[0:3]
v_or_b32 v12, v64, v65
cv v66,v24,v25
v_cndmask_b32 v132, v11, v132, s[52:53]
v_cndmask_b32 v133, v11, v133, s[52:53]
mm a[4:7],a[192:195],v[100:103],a[4:7]
v_exp_f32 v27, v147
ds_read_b128 a[224:227], v4 offset:36864
mm a[4:7],a[196:199],v[116:119],a[4:7]
buffer_load_dwordx4 v5, s[16:19], s48 offen offset:2048 sc1 lds
cv v67,v26,v27
mm a[8:11],a[192:195],v[104:107],a[8:11]
v_exp_f32 v20, v132
v_cndmask_b32 v134, v11, v134, s[52:53]
v_cndmask_b32 v135, v11, v135, s[52:53]
mm a[8:11],a[196:199],v[120:123],a[8:11]
v_exp_f32 v21, v133
v_or3_b32 v12, v66, v67, v12
mm a[12:15],a[192:195],v[108:111],a[12:15]
v_exp_f32 v22, v134
cv v68,v20,v21
buffer_load_dwordx4 v5, s[16:19], s48 offen offset:3072 sc1 lds
mm a[12:15],a[196:199],v[124:127],a[12:15]
v_exp_f32 v23, v135
mm a[16:19],a[200:203],v[96:99],a[16:19]
v_cndmask_b32 v148, v11, v148, s[54:55]
v_cndmask_b32 v149, v11, v149, s[56:57]
ds_read_b128 a[228:231], v4 offset:45056
cv v69,v22,v23
mm a[16:19],a[204:207],v[112:115],a[16:19]
v_exp_f32 v24, v148
v_cndmask_b32 v150, v11, v150, s[58:59]
mm a[20:23],a[200:203],v[100:103],a[20:23]
v_exp_f32 v25, v149
v_cndmask_b32 v151, v11, v151, s[60:61]
mm a[20:23],a[204:207],v[116:119],a[20:23]
v_exp_f32 v26, v150
s_add_u32 m0, s49, 69632
v_or3_b32 v12, v68, v69, v12
mm a[24:27],a[200:203],v[104:107],a[24:27]
v_exp_f32 v27, v151
cv v70,v24,v25
mm a[24:27],a[204:207],v[120:123],a[24:27]
buffer_load_dwordx4 v10, s[16:19], s48 offen offset:0 sc1 lds
v_cndmask_b32 v136, v11, v136, s[52:53]
v_cndmask_b32 v137, v11, v137, s[52:53]
mm a[28:31],a[200:203],v[108:111],a[28:31]
ds_read_b128 a[232:235], v4 offset:37888
ds_read_b128 a[236:239], v4 offset:46080
cv v71,v26,v27
mm a[28:31],a[204:207],v[124:127],a[28:31]
v_exp_f32 v20, v136
v_cndmask_b32 v138, v11, v138, s[52:53]
mm v[48:51],v[28:31],v[96:99],v[48:51]
v_exp_f32 v21, v137
v_cndmask_b32 v139, v11, v139, s[52:53]
v_or3_b32 v12, v70, v71, v12
mm v[48:51],v[28:31],v[112:115],v[48:51]
cv v72,v20,v21
v_exp_f32 v22, v138
s_waitcnt lgkmcnt(4)
mm a[32:35],a[208:211],v[96:99],a[32:35]
buffer_load_dwordx4 v10, s[16:19], s48 offen offset:1024 sc1 lds
v_cndmask_b32 v152, v11, v152, s[52:53]
mm a[32:35],a[212:215],v[112:115],a[32:35]
v_exp_f32 v23, v139
v_cndmask_b32 v153, v11, v153, s[52:53]
mm a[36:39],a[208:211],v[100:103],a[36:39]
v_exp_f32 v24, v152
cv v73,v22,v23
mm a[36:39],a[212:215],v[116:119],a[36:39]
buffer_load_dwordx4 v10, s[16:19], s48 offen offset:2048 sc1 lds
v_cndmask_b32 v154, v11, v154, s[52:53]
v_cndmask_b32 v155, v11, v155, s[52:53]
mm a[40:43],a[208:211],v[104:107],a[40:43]
buffer_load_dwordx4 v10, s[16:19], s48 offen offset:3072 sc1 lds
s_add_u32 s48, s48, 32768
mm a[40:43],a[212:215],v[120:123],a[40:43]
v_exp_f32 v25, v153
v_or3_b32 v12, v72, v73, v12
cv v74,v24,v25
mm a[44:47],a[208:211],v[108:111],a[44:47]
v_exp_f32 v26, v154
ds_read_b128 a[240:243], v4 offset:38912
mm a[44:47],a[212:215],v[124:127],a[44:47]
v_exp_f32 v27, v155
v_cndmask_b32 v140, v11, v140, s[52:53]
v_cndmask_b32 v141, v11, v141, s[52:53]
mm a[48:51],a[216:219],v[96:99],a[48:51]
v_exp_f32 v20, v140
cv v75,v26,v27
mm a[48:51],a[220:223],v[112:115],a[48:51]
v_exp_f32 v21, v141
v_cndmask_b32 v142, v11, v142, s[52:53]
mm a[52:55],a[216:219],v[100:103],a[52:55]
v_exp_f32 v22, v142
v_cndmask_b32 v143, v11, v143, s[52:53]
v_or3_b32 v12, v74, v75, v12
mm a[52:55],a[220:223],v[116:119],a[52:55]
v_exp_f32 v23, v143
cv v76,v20,v21
mm a[56:59],a[216:219],v[104:107],a[56:59]
ds_read_b128 a[244:247], v4 offset:47104
v_cndmask_b32 v156, v11, v156, s[52:53]
v_cndmask_b32 v157, v11, v157, s[52:53]
cv v77,v22,v23
mm a[56:59],a[220:223],v[120:123],a[56:59]
v_exp_f32 v24, v156
v_cndmask_b32 v158, v11, v158, s[52:53]
mm a[60:63],a[216:219],v[108:111],a[60:63]
ds_read_b128 a[248:251], v4 offset:39936
ds_read_b128 a[252:255], v4 offset:48128
v_cndmask_b32 v159, v11, v159, s[52:53]
mm a[60:63],a[220:223],v[124:127],a[60:63]
v_exp_f32 v25, v157
v_or3_b32 v12, v76, v77, v12
cv v78,v24,v25
mm v[52:55],v[28:31],v[100:103],v[52:55]
v_exp_f32 v26, v158
v_cndmask_b32 v160, v11, v160, s[62:63]
mm v[52:55],v[28:31],v[116:119],v[52:55]
v_cndmask_b32 v161, v11, v161, s[62:63]
v_exp_f32 v27, v159
s_waitcnt lgkmcnt(4)
mm a[64:67],a[224:227],v[96:99],a[64:67]
v_exp_f32 v20, v160
cv v79,v26,v27
mm a[64:67],a[228:231],v[112:115],a[64:67]
v_exp_f32 v21, v161
v_cndmask_b32 v162, v11, v162, s[62:63]
mm a[68:71],a[224:227],v[100:103],a[68:71]
v_exp_f32 v22, v162
v_cndmask_b32 v163, v11, v163, s[62:63]
v_or3_b32 v12, v78, v79, v12
mm a[68:71],a[228:231],v[116:119],a[68:71]
v_exp_f32 v23, v163
cv v80,v20,v21
mm a[72:75],a[224:227],v[104:107],a[72:75]
v_cndmask_b32 v176, v11, v176, s[62:63]
v_cndmask_b32 v177, v11, v177, s[62:63]
cv v81,v22,v23
v_exp_f32 v24, v176
mm a[72:75],a[228:231],v[120:123],a[72:75]
v_exp_f32 v25, v177
mm a[76:79],a[224:227],v[108:111],a[76:79]
v_cndmask_b32 v178, v11, v178, s[62:63]
v_cndmask_b32 v179, v11, v179, s[62:63]
v_or3_b32 v12, v80, v81, v12
cv v82,v24,v25
mm a[76:79],a[228:231],v[124:127],a[76:79]
v_exp_f32 v26, v178
v_cndmask_b32 v164, v11, v164, s[62:63]
mm a[80:83],a[232:235],v[96:99],a[80:83]
v_exp_f32 v27, v179
v_cndmask_b32 v165, v11, v165, s[62:63]
mm a[80:83],a[236:239],v[112:115],a[80:83]
v_exp_f32 v20, v164
cv v83,v26,v27
v_cndmask_b32 v166, v11, v166, s[62:63]
mm a[84:87],a[232:235],v[100:103],a[84:87]
v_exp_f32 v21, v165
v_cndmask_b32 v167, v11, v167, s[62:63]
mm a[84:87],a[236:239],v[116:119],a[84:87]
v_exp_f32 v22, v166
v_or3_b32 v12, v82, v83, v12
cv v84,v20,v21
mm a[88:91],a[232:235],v[104:107],a[88:91]
v_exp_f32 v23, v167
v_cndmask_b32 v180, v11, v180, s[62:63]
mm a[88:91],a[236:239],v[120:123],a[88:91]
v_exp_f32 v24, v180
v_cndmask_b32 v181, v11, v181, s[62:63]
mm a[92:95],a[232:235],v[108:111],a[92:95]
v_exp_f32 v25, v181
cv v85,v22,v23
v_cndmask_b32 v182, v11, v182, s[62:63]
mm a[92:95],a[236:239],v[124:127],a[92:95]
v_exp_f32 v26, v182
v_cndmask_b32 v183, v11, v183, s[62:63]
mm v[56:59],v[28:31],v[104:107],v[56:59]
v_or3_b32 v12, v84, v85, v12
cv v86,v24,v25
v_cndmask_b32 v168, v11, v168, s[54:55]
v_cndmask_b32 v169, v11, v169, s[56:57]
mm v[56:59],v[28:31],v[120:123],v[56:59]
v_exp_f32 v27, v183
s_waitcnt lgkmcnt(0)
mm a[96:99],a[240:243],v[96:99],a[96:99]
v_exp_f32 v20, v168
cv v87,v26,v27
mm a[96:99],a[244:247],v[112:115],a[96:99]
v_exp_f32 v21, v169
v_cndmask_b32 v170, v11, v170, s[58:59]
v_cndmask_b32 v171, v11, v171, s[60:61]
mm a[100:103],a[240:243],v[100:103],a[100:103]
v_exp_f32 v22, v170
v_or3_b32 v12, v86, v87, v12
mm a[100:103],a[244:247],v[116:119],a[100:103]
v_exp_f32 v23, v171
cv v88,v20,v21
v_cndmask_b32 v184, v11, v184, s[62:63]
mm a[104:107],a[240:243],v[104:107],a[104:107]
v_exp_f32 v24, v184
v_cndmask_b32 v185, v11, v185, s[62:63]
mm a[104:107],a[244:247],v[120:123],a[104:107]
v_exp_f32 v25, v185
cv v89,v22,v23
v_cndmask_b32 v186, v11, v186, s[62:63]
mm a[108:111],a[240:243],v[108:111],a[108:111]
v_exp_f32 v26, v186
v_cndmask_b32 v187, v11, v187, s[62:63]
mm a[108:111],a[244:247],v[124:127],a[108:111]
v_or3_b32 v12, v88, v89, v12
cv v90,v24,v25
v_cndmask_b32 v172, v11, v172, s[52:53]
mm a[112:115],a[248:251],v[96:99],a[112:115]
v_exp_f32 v27, v187
v_cndmask_b32 v173, v11, v173, s[52:53]
cv v91,v26,v27
mm a[112:115],a[252:255],v[112:115],a[112:115]
v_exp_f32 v20, v172
v_cndmask_b32 v174, v11, v174, s[52:53]
mm a[116:119],a[248:251],v[100:103],a[116:119]
v_exp_f32 v21, v173
v_cndmask_b32 v175, v11, v175, s[52:53]
v_or3_b32 v12, v90, v91, v12
mm a[116:119],a[252:255],v[116:119],a[116:119]
v_exp_f32 v22, v174
cv v92,v20,v21
mm a[120:123],a[248:251],v[104:107],a[120:123]
v_exp_f32 v23, v175
v_cndmask_b32 v188, v11, v188, s[54:55]
mm a[120:123],a[252:255],v[120:123],a[120:123]
v_exp_f32 v24, v188
v_cndmask_b32 v189, v11, v189, s[56:57]
cv v93,v22,v23
mm a[124:127],a[248:251],v[108:111],a[124:127]
v_exp_f32 v25, v189
v_cndmask_b32 v190, v11, v190, s[58:59]
mm a[124:127],a[252:255],v[124:127],a[124:127]
v_exp_f32 v26, v190
v_cndmask_b32 v191, v11, v191, s[60:61]
v_or3_b32 v12, v92, v93, v12
mm v[60:63],v[28:31],v[108:111],v[60:63]
v_exp_f32 v27, v191
cv v94,v24,v25
mm v[60:63],v[28:31],v[124:127],v[60:63]
cv v95,v26,v27
v_or3_b32 v12, v94, v95, v12
v_and_b32 v12, 0x40004000, v12
v_cmp_ne_u32 vcc, 0, v12
s_nop 0
s_cbranch_vccz L_ok_last
s_call_b64 s[42:43], L_rare0
L_ok_last:
s_waitcnt vmcnt(0) lgkmcnt(0)
s_barrier
s_cmp_eq_u32 s51, 2
s_cbranch_scc1 L_sig1
s_call_b64 s[42:43], L_merge0
s_mov_b32 s50, s33
s_barrier
s_branch L_tail
L_sig1:
s_lshl_b32 s4, s2, 7
s_cmp_lg_u32 s3, 0
s_cbranch_scc1 L_sg5
v_mov_b32 v18, 1
s_mov_b64 exec, 1
buffer_store_dword v18, off, s[28:31], s4 offset:4 sc1
s_mov_b64 exec, -1
L_sg5:
L_tail:
ds_read_b128 a[208:211], v4 offset:4096
ds_read_b128 a[240:243], v4 offset:12288
ds_read_b128 a[212:215], v4 offset:5120
ds_read_b128 a[244:247], v4 offset:13312
ds_read_b128 a[216:219], v4 offset:6144
ds_read_b128 a[248:251], v4 offset:14336
ds_read_b128 a[220:223], v4 offset:7168
ds_read_b128 a[252:255], v4 offset:15360
s_lshl_b32 s4, s3, 14
v_add_u32 v20, s4, v1
v_xor_b32 v21, 32768, v20
s_lshl_b32 s4, s3, 11
s_add_u32 s4, s4, 131072
v_add_u32 v22, s4, v1
s_waitcnt lgkmcnt(4)
mm a[64:67],a[208:211],v[64:67],a[64:67]
ds_read_b128 a[192:195], v3 offset:0
mm a[64:67],a[240:243],v[80:83],a[64:67]
mm a[68:71],a[208:211],v[68:71],a[68:71]
s_lshl_b32 s4, s50, 3
mm a[68:71],a[240:243],v[84:87],a[68:71]
s_lshl_b32 s5, s41, 2
mm a[72:75],a[208:211],v[72:75],a[72:75]
s_add_u32 s4, s4, s5
ds_read_b128 a[224:227], v3 offset:8192
mm a[72:75],a[240:243],v[88:91],a[72:75]
s_lshl_b32 s4, s4, 7
mm a[76:79],a[208:211],v[76:79],a[76:79]
mm a[76:79],a[240:243],v[92:95],a[76:79]
s_lshl_b32 s5, s32, 2
mm v[48:51],v[28:31],v[64:67],v[48:51]
s_add_u32 s4, s4, s5
mm v[48:51],v[28:31],v[80:83],v[48:51]
ds_read_b128 a[196:199], v3 offset:1024
s_lshl_b32 s5, s44, 1
mm a[80:83],a[212:215],v[64:67],a[80:83]
s_add_u32 s4, s4, s5
mm a[80:83],a[244:247],v[80:83],a[80:83]
mm a[84:87],a[212:215],v[68:71],a[84:87]
s_lshl_b32 s6, s4, 10
mm a[84:87],a[244:247],v[84:87],a[84:87]
mm a[88:91],a[212:215],v[72:75],a[88:91]
ds_read_b128 a[228:231], v3 offset:9216
mm a[88:91],a[244:247],v[88:91],a[88:91]
mm a[92:95],a[212:215],v[76:79],a[92:95]
mm a[92:95],a[244:247],v[92:95],a[92:95]
mm v[52:55],v[28:31],v[68:71],v[52:55]
mm v[52:55],v[28:31],v[84:87],v[52:55]
s_waitcnt lgkmcnt(4)
mm a[96:99],a[216:219],v[64:67],a[96:99]
ds_read_b128 a[200:203], v3 offset:2048
mm a[96:99],a[248:251],v[80:83],a[96:99]
mm a[100:103],a[216:219],v[68:71],a[100:103]
mm a[100:103],a[248:251],v[84:87],a[100:103]
mm a[104:107],a[216:219],v[72:75],a[104:107]
ds_read_b128 a[232:235], v3 offset:10240
mm a[104:107],a[248:251],v[88:91],a[104:107]
mm a[108:111],a[216:219],v[76:79],a[108:111]
mm a[108:111],a[248:251],v[92:95],a[108:111]
mm v[56:59],v[28:31],v[72:75],v[56:59]
mm v[56:59],v[28:31],v[88:91],v[56:59]
ds_read_b128 a[204:207], v3 offset:3072
mm a[112:115],a[220:223],v[64:67],a[112:115]
mm a[112:115],a[252:255],v[80:83],a[112:115]
mm a[116:119],a[220:223],v[68:71],a[116:119]
mm a[116:119],a[252:255],v[84:87],a[116:119]
mm a[120:123],a[220:223],v[72:75],a[120:123]
ds_read_b128 a[236:239], v3 offset:11264
mm a[120:123],a[252:255],v[88:91],a[120:123]
mm a[124:127],a[220:223],v[76:79],a[124:127]
mm a[124:127],a[252:255],v[92:95],a[124:127]
mm v[60:63],v[28:31],v[76:79],v[60:63]
mm v[60:63],v[28:31],v[92:95],v[60:63]
s_waitcnt lgkmcnt(0)
mm a[0:3],a[192:195],v[64:67],a[0:3]
ds_write_b128 v20, a[64:67] offset:0
mm a[0:3],a[224:227],v[80:83],a[0:3]
mm a[4:7],a[192:195],v[68:71],a[4:7]
ds_write_b128 v20, a[68:71] offset:1024
mm a[4:7],a[224:227],v[84:87],a[4:7]
mm a[8:11],a[192:195],v[72:75],a[8:11]
ds_write_b128 v20, a[72:75] offset:2048
mm a[8:11],a[224:227],v[88:91],a[8:11]
v_mov_b32 v14, v32
mm a[12:15],a[192:195],v[76:79],a[12:15]
ds_write_b128 v20, a[76:79] offset:3072
mm a[12:15],a[224:227],v[92:95],a[12:15]
v_mov_b32 v15, v36
mm a[16:19],a[196:199],v[64:67],a[16:19]
ds_write_b128 v20, a[80:83] offset:4096
mm a[16:19],a[228:231],v[80:83],a[16:19]
v_mov_b32 v16, v40
mm a[20:23],a[196:199],v[68:71],a[20:23]
ds_write_b128 v20, a[84:87] offset:5120
mm a[20:23],a[228:231],v[84:87],a[20:23]
mm a[24:27],a[196:199],v[72:75],a[24:27]
ds_write_b128 v20, a[88:91] offset:6144
v_mov_b32 v17, v44
mm a[24:27],a[228:231],v[88:91],a[24:27]
mm a[28:31],a[196:199],v[76:79],a[28:31]
ds_write_b128 v20, a[92:95] offset:7168
v_mov_b32 v24, v48
mm a[28:31],a[228:231],v[92:95],a[28:31]
mm a[32:35],a[200:203],v[64:67],a[32:35]
ds_write_b128 v20, a[96:99] offset:8192
mm a[32:35],a[232:235],v[80:83],a[32:35]
v_mov_b32 v25, v52
mm a[36:39],a[200:203],v[68:71],a[36:39]
ds_write_b128 v20, a[100:103] offset:9216
mm a[36:39],a[232:235],v[84:87],a[36:39]
v_mov_b32 v26, v56
mm a[40:43],a[200:203],v[72:75],a[40:43]
ds_write_b128 v20, a[104:107] offset:10240
mm a[40:43],a[232:235],v[88:91],a[40:43]
v_mov_b32 v27, v60
mm a[44:47],a[200:203],v[76:79],a[44:47]
ds_write_b128 v20, a[108:111] offset:11264
mm a[44:47],a[232:235],v[92:95],a[44:47]
mm a[48:51],a[204:207],v[64:67],a[48:51]
ds_write_b128 v20, a[112:115] offset:12288
ds_write_b128 v22, v[14:17]
mm a[48:51],a[236:239],v[80:83],a[48:51]
mm a[52:55],a[204:207],v[68:71],a[52:55]
ds_write_b128 v20, a[116:119] offset:13312
ds_write_b128 v22, v[24:27] offset:1024
mm a[52:55],a[236:239],v[84:87],a[52:55]
mm a[56:59],a[204:207],v[72:75],a[56:59]
ds_write_b128 v20, a[120:123] offset:14336
mm a[56:59],a[236:239],v[88:91],a[56:59]
v_xor_b32 v22, 4096, v22
mm a[60:63],a[204:207],v[76:79],a[60:63]
ds_write_b128 v20, a[124:127] offset:15360
mm a[60:63],a[236:239],v[92:95],a[60:63]
ar v192,a0
ar v193,a1
ar v194,a2
ar v195,a3
ar v196,a4
ar v197,a5
ar v198,a6
ar v199,a7
ar v200,a8
ar v201,a9
ar v202,a10
ar v203,a11
ar v204,a12
ar v205,a13
ar v206,a14
ar v207,a15
ar v208,a16
ar v209,a17
ar v210,a18
ar v211,a19
ar v212,a20
ar v213,a21
ar v214,a22
ar v215,a23
ar v216,a24
ar v217,a25
ar v218,a26
ar v219,a27
ar v220,a28
ar v221,a29
ar v222,a30
ar v223,a31
s_waitcnt lgkmcnt(0)
s_barrier
ds_read_b128 v[64:67], v22
ds_read_b128 v[68:71], v22 offset:1024
ds_read_b128 v[128:131], v21 offset:0
ds_read_b128 v[132:135], v21 offset:1024
ds_read_b128 v[136:139], v21 offset:2048
ds_read_b128 v[140:143], v21 offset:3072
ds_read_b128 v[144:147], v21 offset:4096
ds_read_b128 v[148:151], v21 offset:5120
ds_read_b128 v[152:155], v21 offset:6144
ds_read_b128 v[156:159], v21 offset:7168
ds_read_b128 v[160:163], v21 offset:8192
ds_read_b128 v[164:167], v21 offset:9216
ds_read_b128 v[168:171], v21 offset:10240
ds_read_b128 v[172:175], v21 offset:11264
ar v224,a32
ar v225,a33
ar v226,a34
ar v227,a35
ar v228,a36
ar v229,a37
ar v230,a38
ar v231,a39
ar v232,a40
ar v233,a41
ar v234,a42
ar v235,a43
ar v236,a44
ar v237,a45
ar v238,a46
ar v239,a47
s_waitcnt lgkmcnt(11)
ds_read_b128 v[176:179], v21 offset:12288
ds_read_b128 v[180:183], v21 offset:13312
ds_read_b128 v[184:187], v21 offset:14336
ds_read_b128 v[188:191], v21 offset:15360
v_min_f32 v72, v14, v64
v_min_f32 v73, v15, v65
v_min_f32 v74, v16, v66
v_min_f32 v75, v17, v67
v_sub_f32 v6, v72, v14
v_sub_f32 v14, v72, v64
v_sub_f32 v7, v73, v15
v_sub_f32 v15, v73, v65
v_sub_f32 v8, v74, v16
v_sub_f32 v16, v74, v66
v_sub_f32 v9, v75, v17
v_sub_f32 v17, v75, v67
v_exp_f32 v6, v6
v_exp_f32 v14, v14
v_exp_f32 v7, v7
v_exp_f32 v15, v15
v_exp_f32 v8, v8
v_exp_f32 v16, v16
v_exp_f32 v9, v9
v_exp_f32 v17, v17
v_mul_f32 v72, v6, v24
v_mul_f32 v73, v7, v25
v_mul_f32 v74, v8, v26
v_mul_f32 v75, v9, v27
v_fmac_f32 v72, v14, v68
v_fmac_f32 v73, v15, v69
v_fmac_f32 v74, v16, v70
v_fmac_f32 v75, v17, v71
v_rcp_f32 v72, v72
v_rcp_f32 v73, v73
v_rcp_f32 v74, v74
v_rcp_f32 v75, v75
ar v240,a48
ar v241,a49
ar v242,a50
ar v243,a51
ar v244,a52
ar v245,a53
ar v246,a54
ar v247,a55
ar v248,a56
ar v249,a57
ar v250,a58
ar v251,a59
ar v252,a60
ar v253,a61
ar v254,a62
ar v255,a63
v_mul_f32 v6, v6, v72
v_mul_f32 v14, v14, v72
v_mul_f32 v7, v7, v73
v_mul_f32 v15, v15, v73
v_mul_f32 v8, v8, v74
v_mul_f32 v16, v16, v74
v_mul_f32 v9, v9, v75
v_mul_f32 v17, v17, v75
s_waitcnt lgkmcnt(0)
v_pk_mul_f32 v[192:193], v[192:193], v[6:7] op_sel_hi:[1,0]
v_pk_mul_f32 v[194:195], v[194:195], v[6:7] op_sel_hi:[1,0]
v_pk_mul_f32 v[208:209], v[208:209], v[6:7] op_sel_hi:[1,0]
v_pk_mul_f32 v[210:211], v[210:211], v[6:7] op_sel_hi:[1,0]
v_pk_fma_f32 v[192:193], v[128:129], v[14:15], v[192:193] op_sel_hi:[1,0,1]
v_pk_fma_f32 v[194:195], v[130:131], v[14:15], v[194:195] op_sel_hi:[1,0,1]
v_pk_fma_f32 v[208:209], v[144:145], v[14:15], v[208:209] op_sel_hi:[1,0,1]
v_pk_fma_f32 v[210:211], v[146:147], v[14:15], v[210:211] op_sel_hi:[1,0,1]
cv v96,v192,v193
cv v97,v194,v195
cv v98,v208,v209
cv v99,v210,v211
buffer_store_dwordx4 v[96:99], v1, s[20:23], s6 offen offset:0 sc1
v_pk_mul_f32 v[224:225], v[224:225], v[6:7] op_sel_hi:[1,0]
v_pk_mul_f32 v[226:227], v[226:227], v[6:7] op_sel_hi:[1,0]
v_pk_mul_f32 v[240:241], v[240:241], v[6:7] op_sel_hi:[1,0]
v_pk_mul_f32 v[242:243], v[242:243], v[6:7] op_sel_hi:[1,0]
v_pk_fma_f32 v[224:225], v[160:161], v[14:15], v[224:225] op_sel_hi:[1,0,1]
v_pk_fma_f32 v[226:227], v[162:163], v[14:15], v[226:227] op_sel_hi:[1,0,1]
v_pk_fma_f32 v[240:241], v[176:177], v[14:15], v[240:241] op_sel_hi:[1,0,1]
v_pk_fma_f32 v[242:243], v[178:179], v[14:15], v[242:243] op_sel_hi:[1,0,1]
cv v100,v224,v225
cv v101,v226,v227
cv v102,v240,v241
cv v103,v242,v243
buffer_store_dwordx4 v[100:103], v1, s[20:23], s6 offen offset:1024 sc1
s_add_u32 s6, s6, 131072
v_pk_mul_f32 v[196:197], v[196:197], v[6:7] op_sel:[0,1]
v_pk_mul_f32 v[198:199], v[198:199], v[6:7] op_sel:[0,1]
v_pk_mul_f32 v[212:213], v[212:213], v[6:7] op_sel:[0,1]
v_pk_mul_f32 v[214:215], v[214:215], v[6:7] op_sel:[0,1]
v_pk_fma_f32 v[196:197], v[132:133], v[14:15], v[196:197] op_sel:[0,1,0]
v_pk_fma_f32 v[198:199], v[134:135], v[14:15], v[198:199] op_sel:[0,1,0]
v_pk_fma_f32 v[212:213], v[148:149], v[14:15], v[212:213] op_sel:[0,1,0]
v_pk_fma_f32 v[214:215], v[150:151], v[14:15], v[214:215] op_sel:[0,1,0]
cv v104,v196,v197
cv v105,v198,v199
cv v106,v212,v213
cv v107,v214,v215
buffer_store_dwordx4 v[104:107], v1, s[20:23], s6 offen offset:0 sc1
v_pk_mul_f32 v[228:229], v[228:229], v[6:7] op_sel:[0,1]
v_pk_mul_f32 v[230:231], v[230:231], v[6:7] op_sel:[0,1]
v_pk_mul_f32 v[244:245], v[244:245], v[6:7] op_sel:[0,1]
v_pk_mul_f32 v[246:247], v[246:247], v[6:7] op_sel:[0,1]
v_pk_fma_f32 v[228:229], v[164:165], v[14:15], v[228:229] op_sel:[0,1,0]
v_pk_fma_f32 v[230:231], v[166:167], v[14:15], v[230:231] op_sel:[0,1,0]
v_pk_fma_f32 v[244:245], v[180:181], v[14:15], v[244:245] op_sel:[0,1,0]
v_pk_fma_f32 v[246:247], v[182:183], v[14:15], v[246:247] op_sel:[0,1,0]
cv v108,v228,v229
cv v109,v230,v231
cv v110,v244,v245
cv v111,v246,v247
buffer_store_dwordx4 v[108:111], v1, s[20:23], s6 offen offset:1024 sc1
s_add_u32 s6, s6, 131072
v_pk_mul_f32 v[200:201], v[200:201], v[8:9] op_sel_hi:[1,0]
v_pk_mul_f32 v[202:203], v[202:203], v[8:9] op_sel_hi:[1,0]
v_pk_mul_f32 v[216:217], v[216:217], v[8:9] op_sel_hi:[1,0]
v_pk_mul_f32 v[218:219], v[218:219], v[8:9] op_sel_hi:[1,0]
v_pk_fma_f32 v[200:201], v[136:137], v[16:17], v[200:201] op_sel_hi:[1,0,1]
v_pk_fma_f32 v[202:203], v[138:139], v[16:17], v[202:203] op_sel_hi:[1,0,1]
v_pk_fma_f32 v[216:217], v[152:153], v[16:17], v[216:217] op_sel_hi:[1,0,1]
v_pk_fma_f32 v[218:219], v[154:155], v[16:17], v[218:219] op_sel_hi:[1,0,1]
cv v112,v200,v201
cv v113,v202,v203
cv v114,v216,v217
cv v115,v218,v219
buffer_store_dwordx4 v[112:115], v1, s[20:23], s6 offen offset:0 sc1
v_pk_mul_f32 v[232:233], v[232:233], v[8:9] op_sel_hi:[1,0]
v_pk_mul_f32 v[234:235], v[234:235], v[8:9] op_sel_hi:[1,0]
v_pk_mul_f32 v[248:249], v[248:249], v[8:9] op_sel_hi:[1,0]
v_pk_mul_f32 v[250:251], v[250:251], v[8:9] op_sel_hi:[1,0]
v_pk_fma_f32 v[232:233], v[168:169], v[16:17], v[232:233] op_sel_hi:[1,0,1]
v_pk_fma_f32 v[234:235], v[170:171], v[16:17], v[234:235] op_sel_hi:[1,0,1]
v_pk_fma_f32 v[248:249], v[184:185], v[16:17], v[248:249] op_sel_hi:[1,0,1]
v_pk_fma_f32 v[250:251], v[186:187], v[16:17], v[250:251] op_sel_hi:[1,0,1]
cv v116,v232,v233
cv v117,v234,v235
cv v118,v248,v249
cv v119,v250,v251
buffer_store_dwordx4 v[116:119], v1, s[20:23], s6 offen offset:1024 sc1
s_add_u32 s6, s6, 131072
v_pk_mul_f32 v[204:205], v[204:205], v[8:9] op_sel:[0,1]
v_pk_mul_f32 v[206:207], v[206:207], v[8:9] op_sel:[0,1]
v_pk_mul_f32 v[220:221], v[220:221], v[8:9] op_sel:[0,1]
v_pk_mul_f32 v[222:223], v[222:223], v[8:9] op_sel:[0,1]
v_pk_fma_f32 v[204:205], v[140:141], v[16:17], v[204:205] op_sel:[0,1,0]
v_pk_fma_f32 v[206:207], v[142:143], v[16:17], v[206:207] op_sel:[0,1,0]
v_pk_fma_f32 v[220:221], v[156:157], v[16:17], v[220:221] op_sel:[0,1,0]
v_pk_fma_f32 v[222:223], v[158:159], v[16:17], v[222:223] op_sel:[0,1,0]
cv v120,v204,v205
cv v121,v206,v207
cv v122,v220,v221
cv v123,v222,v223
buffer_store_dwordx4 v[120:123], v1, s[20:23], s6 offen offset:0 sc1
v_pk_mul_f32 v[236:237], v[236:237], v[8:9] op_sel:[0,1]
v_pk_mul_f32 v[238:239], v[238:239], v[8:9] op_sel:[0,1]
v_pk_mul_f32 v[252:253], v[252:253], v[8:9] op_sel:[0,1]
v_pk_mul_f32 v[254:255], v[254:255], v[8:9] op_sel:[0,1]
v_pk_fma_f32 v[236:237], v[172:173], v[16:17], v[236:237] op_sel:[0,1,0]
v_pk_fma_f32 v[238:239], v[174:175], v[16:17], v[238:239] op_sel:[0,1,0]
v_pk_fma_f32 v[252:253], v[188:189], v[16:17], v[252:253] op_sel:[0,1,0]
v_pk_fma_f32 v[254:255], v[190:191], v[16:17], v[254:255] op_sel:[0,1,0]
cv v124,v236,v237
cv v125,v238,v239
cv v126,v252,v253
cv v127,v254,v255
buffer_store_dwordx4 v[124:127], v1, s[20:23], s6 offen offset:1024 sc1
L_a_fin:
s_and_b32 s34, s2, 4
s_lshl_b32 s34, s34, 1
s_bfe_u32 s4, s2, 0x30003
s_add_u32 s34, s34, s4
s_and_b32 s35, s2, 2
s_lshl_b32 s35, s35, 1
s_lshr_b32 s4, s2, 6
s_add_u32 s35, s35, s4
s_lshl_b32 s35, s35, 1
s_and_b32 s4, s2, 1
s_add_u32 s35, s35, s4
s_mov_b32 s12, s74
s_and_b32 s13, s75, 0xffff
s_mov_b32 s14, 8388608
s_mov_b32 s15, 0x20000
v_lshrrev_b32 v18, 4, v0
v_lshlrev_b32 v19, 11, v18
v_lshlrev_b32 v18, 1, v18
v_and_b32 v28, 15, v0
v_xor_b32 v18, v18, v28
v_xor_b32 v28, 8, v18
v_lshl_add_u32 v10, v18, 4, v19
v_lshl_add_u32 v11, v28, 4, v19
v_add_u32 v11, 7168, v11
v_lshl_add_u32 v12, v18, 4, v19
v_add_u32 v12, 14336, v12
v_lshl_add_u32 v13, v28, 4, v19
v_add_u32 v13, 21504, v13
s_and_b32 s6, s35, 1
s_lshl_b32 s6, s6, 2
s_add_u32 s7, s6, s3
s_mul_i32 s37, s7, 1048576
s_lshr_b32 s4, s35, 1
s_lshl_b32 s4, s4, 8
s_add_u32 s37, s37, s4
s_add_u32 s39, s37, 32768
s_lshl_b32 s38, s3, 15
s_mul_i32 s36, s34, 1048576
s_mul_i32 s4, s7, 16384
s_add_u32 s36, s36, s4
v_lshrrev_b32 v28, 4, v0
v_bfe_u32 v29, v0, 2, 2
v_lshl_add_u32 v18, v28, 2, v29
v_and_b32 v19, 7, v18
v_xor_b32 v19, s6, v19
v_lshlrev_b32 v18, 8, v18
v_and_b32 v28, 3, v0
v_lshl_add_u32 v18, v28, 3, v18
v_lshl_add_u32 v18, v19, 5, v18
v_add_u32 v18, s38, v18
v_xor_b32 v48, 0, v18
v_xor_b32 v49, 32, v18
v_xor_b32 v50, 64, v18
v_xor_b32 v51, 96, v18
v_xor_b32 v52, 128, v18
v_xor_b32 v53, 160, v18
v_xor_b32 v54, 192, v18
v_xor_b32 v55, 224, v18
s_add_u32 s8, s86, 41943040
s_addc_u32 s9, s87, 0
s_and_b32 s9, s9, 0xffff
s_mov_b32 s10, 16777216
s_mov_b32 s11, 0x20000
s_mov_b32 s16, s64
s_and_b32 s17, s65, 0xffff
s_mov_b32 s18, 4194304
s_mov_b32 s19, 0x20000
s_lshl_b32 s5, s3, 1
s_lshl_b32 s4, s34, 3
s_add_u32 s4, s4, s5
s_lshl_b32 s4, s4, 15
s_lshl_b32 s40, s35, 11
s_add_u32 s40, s4, s40
s_add_u32 s4, s5, 0
s_and_b32 s4, s4, 7
s_mul_i32 s4, s4, 131072
v_add_u32 v2, s4, v1
s_add_u32 s4, s5, 1
s_and_b32 s4, s4, 7
s_mul_i32 s4, s4, 131072
v_add_u32 v3, s4, v1
s_add_u32 s4, s5, 2
s_and_b32 s4, s4, 7
s_mul_i32 s4, s4, 131072
v_add_u32 v4, s4, v1
s_add_u32 s4, s5, 3
s_and_b32 s4, s4, 7
s_mul_i32 s4, s4, 131072
v_add_u32 v5, s4, v1
s_add_u32 s4, s5, 4
s_and_b32 s4, s4, 7
s_mul_i32 s4, s4, 131072
v_add_u32 v6, s4, v1
s_add_u32 s4, s5, 5
s_and_b32 s4, s4, 7
s_mul_i32 s4, s4, 131072
v_add_u32 v7, s4, v1
s_add_u32 s4, s5, 6
s_and_b32 s4, s4, 7
s_mul_i32 s4, s4, 131072
v_add_u32 v8, s4, v1
s_add_u32 s4, s5, 7
s_and_b32 s4, s4, 7
s_mul_i32 s4, s4, 131072
v_add_u32 v9, s4, v1
s_waitcnt vmcnt(0)
s_barrier
s_lshl_b32 s4, s2, 7
s_cmp_lg_u32 s3, 0
s_cbranch_scc1 L_sg6
v_mov_b32 v18, 1
s_mov_b64 exec, 1
buffer_store_dword v18, off, s[28:31], s4 offset:8 sc1
s_mov_b64 exec, -1
L_sg6:
s_cmp_lg_u32 s33, 0
s_cbranch_scc1 L_nosig1
s_lshl_b32 s4, s2, 7
s_cmp_lg_u32 s3, 0
s_cbranch_scc1 L_sg7
v_mov_b32 v18, 1
s_mov_b64 exec, 1
buffer_store_dword v18, off, s[28:31], s4 offset:4 sc1
s_mov_b64 exec, -1
L_sg7:
L_nosig1:
s_add_u32 m0, s38, 0
s_nop 0
buffer_load_dwordx4 v10, s[12:15], s37 offen offset:0 lds
buffer_load_dwordx4 v11, s[12:15], s37 offen offset:1024 lds
buffer_load_dwordx4 v12, s[12:15], s37 offen offset:2048 lds
buffer_load_dwordx4 v13, s[12:15], s37 offen offset:3072 lds
s_add_u32 s37, s37, 65536
s_add_u32 m0, s38, 4096
s_nop 0
buffer_load_dwordx4 v10, s[12:15], s39 offen offset:0 lds
buffer_load_dwordx4 v11, s[12:15], s39 offen offset:1024 lds
buffer_load_dwordx4 v12, s[12:15], s39 offen offset:2048 lds
buffer_load_dwordx4 v13, s[12:15], s39 offen offset:3072 lds
s_add_u32 s39, s39, 65536
s_add_u32 m0, s38, 8192
s_nop 0
buffer_load_dwordx4 v10, s[12:15], s37 offen offset:0 lds
buffer_load_dwordx4 v11, s[12:15], s37 offen offset:1024 lds
buffer_load_dwordx4 v12, s[12:15], s37 offen offset:2048 lds
buffer_load_dwordx4 v13, s[12:15], s37 offen offset:3072 lds
s_add_u32 s37, s37, 65536
s_add_u32 m0, s38, 12288
s_nop 0
buffer_load_dwordx4 v10, s[12:15], s39 offen offset:0 lds
buffer_load_dwordx4 v11, s[12:15], s39 offen offset:1024 lds
buffer_load_dwordx4 v12, s[12:15], s39 offen offset:2048 lds
buffer_load_dwordx4 v13, s[12:15], s39 offen offset:3072 lds
s_add_u32 s39, s39, 65536
s_and_b32 s4, s35, 1
s_lshl_b32 s4, s4, 2
s_add_u32 s4, s4, s3
s_sub_u32 s5, 15, s34
s_cmp_lt_u32 s34, 8
s_cselect_b32 s5, s34, s5
s_cselect_b32 s6, 8, 4
s_lshl_b32 s5, s5, 5
s_add_u32 s4, s4, s5
s_lshl_b32 s5, s4, 7
s_add_u32 s5, s5, s6
v_min_u32 v19, 3, v0
v_lshlrev_b32 v19, 10, v19
buffer_load_dword v18, v19, s[28:31], s5 offen sc1
s_add_u32 m0, s38, 16384
s_nop 0
buffer_load_dwordx4 v10, s[12:15], s37 offen offset:0 lds
buffer_load_dwordx4 v11, s[12:15], s37 offen offset:1024 lds
buffer_load_dwordx4 v12, s[12:15], s37 offen offset:2048 lds
buffer_load_dwordx4 v13, s[12:15], s37 offen offset:3072 lds
s_add_u32 s37, s37, 65536
s_add_u32 m0, s38, 20480
s_nop 0
buffer_load_dwordx4 v10, s[12:15], s39 offen offset:0 lds
buffer_load_dwordx4 v11, s[12:15], s39 offen offset:1024 lds
buffer_load_dwordx4 v12, s[12:15], s39 offen offset:2048 lds
buffer_load_dwordx4 v13, s[12:15], s39 offen offset:3072 lds
s_add_u32 s39, s39, 65536
s_add_u32 m0, s38, 24576
s_nop 0
buffer_load_dwordx4 v10, s[12:15], s37 offen offset:0 lds
buffer_load_dwordx4 v11, s[12:15], s37 offen offset:1024 lds
buffer_load_dwordx4 v12, s[12:15], s37 offen offset:2048 lds
buffer_load_dwordx4 v13, s[12:15], s37 offen offset:3072 lds
s_add_u32 s37, s37, 65536
s_add_u32 m0, s38, 28672
s_nop 0
buffer_load_dwordx4 v10, s[12:15], s39 offen offset:0 lds
buffer_load_dwordx4 v11, s[12:15], s39 offen offset:1024 lds
buffer_load_dwordx4 v12, s[12:15], s39 offen offset:2048 lds
buffer_load_dwordx4 v13, s[12:15], s39 offen offset:3072 lds
s_add_u32 s39, s39, 65536
s_waitcnt vmcnt(16)
rt v[64:65],v48,0
rt v[66:67],v48,4096
rt v[68:69],v49,0
rt v[70:71],v49,4096
rt v[72:73],v50,0
rt v[74:75],v50,4096
rt v[76:77],v51,0
rt v[78:79],v51,4096
rt v[80:81],v52,0
rt v[82:83],v52,4096
rt v[84:85],v53,0
rt v[86:87],v53,4096
rt v[88:89],v54,0
rt v[90:91],v54,4096
rt v[92:93],v55,0
rt v[94:95],v55,4096
s_mov_b32 s7, 0x100000
s_branch L_spc8
L_sp8:
buffer_load_dword v18, v19, s[28:31], s5 offen sc1
s_waitcnt vmcnt(0)
L_spc8:
v_cmp_gt_u32 vcc, 1, v18
s_sub_u32 s7, s7, 1
s_cbranch_vccz L_spd8
s_cmp_lg_u32 s7, 0
s_cbranch_scc1 L_sp8
L_spd8:
buffer_load_dwordx4 a[136:139], v4, s[8:11], s36 offen offset:0 sc1
buffer_load_dwordx4 a[140:143], v5, s[8:11], s36 offen offset:0 sc1
buffer_load_dwordx4 a[144:147], v6, s[8:11], s36 offen offset:0 sc1
buffer_load_dwordx4 a[148:151], v7, s[8:11], s36 offen offset:0 sc1
buffer_load_dwordx4 a[152:155], v8, s[8:11], s36 offen offset:0 sc1
buffer_load_dwordx4 a[156:159], v9, s[8:11], s36 offen offset:0 sc1
buffer_load_dwordx4 a[128:131], v2, s[8:11], s36 offen offset:0 sc1
buffer_load_dwordx4 a[132:135], v3, s[8:11], s36 offen offset:0 sc1
buffer_load_dwordx4 a[168:171], v4, s[8:11], s36 offen offset:1024 sc1
buffer_load_dwordx4 a[172:175], v5, s[8:11], s36 offen offset:1024 sc1
buffer_load_dwordx4 a[176:179], v6, s[8:11], s36 offen offset:1024 sc1
buffer_load_dwordx4 a[180:183], v7, s[8:11], s36 offen offset:1024 sc1
buffer_load_dwordx4 a[184:187], v8, s[8:11], s36 offen offset:1024 sc1
buffer_load_dwordx4 a[188:191], v9, s[8:11], s36 offen offset:1024 sc1
buffer_load_dwordx4 a[160:163], v2, s[8:11], s36 offen offset:1024 sc1
buffer_load_dwordx4 a[164:167], v3, s[8:11], s36 offen offset:1024 sc1
s_waitcnt vmcnt(8) lgkmcnt(0)
mm v[160:163],v[64:67],a[136:139],0
buffer_load_dwordx4 a[200:203], v4, s[8:11], s36 offen offset:2048 sc1
mm v[164:167],v[68:71],a[136:139],0
buffer_load_dwordx4 a[204:207], v5, s[8:11], s36 offen offset:2048 sc1
mm v[168:171],v[72:75],a[136:139],0
mm v[172:175],v[76:79],a[136:139],0
buffer_load_dwordx4 a[208:211], v6, s[8:11], s36 offen offset:2048 sc1
mm a[32:35],v[80:83],a[136:139],0
rt v[96:97],v48,16384
mm a[36:39],v[84:87],a[136:139],0
buffer_load_dwordx4 a[212:215], v7, s[8:11], s36 offen offset:2048 sc1
mm a[40:43],v[88:91],a[136:139],0
mm a[44:47],v[92:95],a[136:139],0
buffer_load_dwordx4 a[216:219], v8, s[8:11], s36 offen offset:2048 sc1
rt v[98:99],v48,20480
mm v[176:179],v[64:67],a[140:143],0
buffer_load_dwordx4 a[220:223], v9, s[8:11], s36 offen offset:2048 sc1
mm v[180:183],v[68:71],a[140:143],0
mm v[184:187],v[72:75],a[140:143],0
buffer_load_dwordx4 a[192:195], v2, s[8:11], s36 offen offset:2048 sc1
rt v[100:101],v49,16384
mm v[188:191],v[76:79],a[140:143],0
mm a[48:51],v[80:83],a[140:143],0
buffer_load_dwordx4 a[196:199], v3, s[8:11], s36 offen offset:2048 sc1
mm a[52:55],v[84:87],a[140:143],0
rt v[102:103],v49,20480
mm a[56:59],v[88:91],a[140:143],0
buffer_load_dwordx4 a[232:235], v4, s[8:11], s36 offen offset:3072 sc1
mm a[60:63],v[92:95],a[140:143],0
mm v[192:195],v[64:67],a[144:147],0
buffer_load_dwordx4 a[236:239], v5, s[8:11], s36 offen offset:3072 sc1
rt v[104:105],v50,16384
mm v[196:199],v[68:71],a[144:147],0
buffer_load_dwordx4 a[240:243], v6, s[8:11], s36 offen offset:3072 sc1
mm v[200:203],v[72:75],a[144:147],0
mm v[204:207],v[76:79],a[144:147],0
buffer_load_dwordx4 a[244:247], v7, s[8:11], s36 offen offset:3072 sc1
rt v[106:107],v50,20480
mm a[64:67],v[80:83],a[144:147],0
mm a[68:71],v[84:87],a[144:147],0
buffer_load_dwordx4 a[248:251], v8, s[8:11], s36 offen offset:3072 sc1
mm a[72:75],v[88:91],a[144:147],0
rt v[108:109],v51,16384
mm a[76:79],v[92:95],a[144:147],0
buffer_load_dwordx4 a[252:255], v9, s[8:11], s36 offen offset:3072 sc1
mm v[208:211],v[64:67],a[148:151],0
mm v[212:215],v[68:71],a[148:151],0
buffer_load_dwordx4 a[224:227], v2, s[8:11], s36 offen offset:3072 sc1
rt v[110:111],v51,20480
mm v[216:219],v[72:75],a[148:151],0
buffer_load_dwordx4 a[228:231], v3, s[8:11], s36 offen offset:3072 sc1
mm v[220:223],v[76:79],a[148:151],0
mm a[80:83],v[80:83],a[148:151],0
rt v[112:113],v52,16384
s_add_u32 m0, s38, 0
mm a[84:87],v[84:87],a[148:151],0
mm a[88:91],v[88:91],a[148:151],0
buffer_load_dwordx4 v10, s[12:15], s37 offen offset:0 lds
mm a[92:95],v[92:95],a[148:151],0
rt v[114:115],v52,20480
mm v[224:227],v[64:67],a[152:155],0
buffer_load_dwordx4 v11, s[12:15], s37 offen offset:1024 lds
mm v[228:231],v[68:71],a[152:155],0
buffer_load_dwordx4 v12, s[12:15], s37 offen offset:2048 lds
mm v[232:235],v[72:75],a[152:155],0
rt v[116:117],v53,16384
mm v[236:239],v[76:79],a[152:155],0
buffer_load_dwordx4 v13, s[12:15], s37 offen offset:3072 lds
mm a[96:99],v[80:83],a[152:155],0
mm a[100:103],v[84:87],a[152:155],0
s_add_u32 s37, s37, 65536
rt v[118:119],v53,20480
mm a[104:107],v[88:91],a[152:155],0
mm a[108:111],v[92:95],a[152:155],0
s_add_u32 m0, s38, 4096
mm v[240:243],v[64:67],a[156:159],0
rt v[120:121],v54,16384
mm v[244:247],v[68:71],a[156:159],0
buffer_load_dwordx4 v10, s[12:15], s39 offen offset:0 lds
mm v[248:251],v[72:75],a[156:159],0
buffer_load_dwordx4 v11, s[12:15], s39 offen offset:1024 lds
mm v[252:255],v[76:79],a[156:159],0
rt v[122:123],v54,20480
mm a[112:115],v[80:83],a[156:159],0
buffer_load_dwordx4 v12, s[12:15], s39 offen offset:2048 lds
mm a[116:119],v[84:87],a[156:159],0
mm a[120:123],v[88:91],a[156:159],0
buffer_load_dwordx4 v13, s[12:15], s39 offen offset:3072 lds
rt v[124:125],v55,16384
mm a[124:127],v[92:95],a[156:159],0
mm v[128:131],v[64:67],a[128:131],0
s_add_u32 s39, s39, 65536
mm v[132:135],v[68:71],a[128:131],0
mm v[136:139],v[72:75],a[128:131],0
s_add_u32 s36, s36, 4096
rt v[126:127],v55,20480
mm v[140:143],v[76:79],a[128:131],0
mm a[0:3],v[80:83],a[128:131],0
buffer_load_dwordx4 a[136:139], v4, s[8:11], s36 offen offset:0 sc1
mm a[4:7],v[84:87],a[128:131],0
buffer_load_dwordx4 a[140:143], v5, s[8:11], s36 offen offset:0 sc1
mm a[8:11],v[88:91],a[128:131],0
buffer_load_dwordx4 a[144:147], v6, s[8:11], s36 offen offset:0 sc1
mm a[12:15],v[92:95],a[128:131],0
buffer_load_dwordx4 a[148:151], v7, s[8:11], s36 offen offset:0 sc1
mm v[144:147],v[64:67],a[132:135],0
rt v[64:65],v48,8192
rt v[66:67],v48,12288
buffer_load_dwordx4 a[152:155], v8, s[8:11], s36 offen offset:0 sc1
mm v[148:151],v[68:71],a[132:135],0
rt v[68:69],v49,8192
rt v[70:71],v49,12288
buffer_load_dwordx4 a[156:159], v9, s[8:11], s36 offen offset:0 sc1
mm v[152:155],v[72:75],a[132:135],0
rt v[72:73],v50,8192
rt v[74:75],v50,12288
buffer_load_dwordx4 a[128:131], v2, s[8:11], s36 offen offset:0 sc1
mm v[156:159],v[76:79],a[132:135],0
rt v[76:77],v51,8192
rt v[78:79],v51,12288
mm a[16:19],v[80:83],a[132:135],0
rt v[80:81],v52,8192
rt v[82:83],v52,12288
mm a[20:23],v[84:87],a[132:135],0
rt v[84:85],v53,8192
rt v[86:87],v53,12288
mm a[24:27],v[88:91],a[132:135],0
rt v[88:89],v54,8192
rt v[90:91],v54,12288
mm a[28:31],v[92:95],a[132:135],0
buffer_load_dwordx4 a[132:135], v3, s[8:11], s36 offen offset:0 sc1
rt v[92:93],v55,8192
rt v[94:95],v55,12288
s_add_u32 s36, s36, 1024
s_waitcnt vmcnt(24) lgkmcnt(12)
mm v[160:163],v[64:67],a[168:171],v[160:163]
mm v[160:163],v[96:99],a[200:203],v[160:163]
mm v[164:167],v[68:71],a[168:171],v[164:167]
mm v[164:167],v[100:103],a[200:203],v[164:167]
mm v[168:171],v[72:75],a[168:171],v[168:171]
mm v[168:171],v[104:107],a[200:203],v[168:171]
mm v[172:175],v[76:79],a[168:171],v[172:175]
mm v[172:175],v[108:111],a[200:203],v[172:175]
s_waitcnt lgkmcnt(0)
mm a[32:35],v[80:83],a[168:171],a[32:35]
mm a[32:35],v[112:115],a[200:203],a[32:35]
s_add_u32 m0, s38, 8192
mm a[36:39],v[84:87],a[168:171],a[36:39]
mm a[36:39],v[116:119],a[200:203],a[36:39]
mm a[40:43],v[88:91],a[168:171],a[40:43]
buffer_load_dwordx4 v10, s[12:15], s37 offen offset:0 lds
mm a[40:43],v[120:123],a[200:203],a[40:43]
mm a[44:47],v[92:95],a[168:171],a[44:47]
mm a[44:47],v[124:127],a[200:203],a[44:47]
buffer_load_dwordx4 v11, s[12:15], s37 offen offset:1024 lds
mm v[176:179],v[64:67],a[172:175],v[176:179]
mm v[176:179],v[96:99],a[204:207],v[176:179]
mm v[180:183],v[68:71],a[172:175],v[180:183]
mm v[180:183],v[100:103],a[204:207],v[180:183]
buffer_load_dwordx4 v12, s[12:15], s37 offen offset:2048 lds
mm v[184:187],v[72:75],a[172:175],v[184:187]
mm v[184:187],v[104:107],a[204:207],v[184:187]
mm v[188:191],v[76:79],a[172:175],v[188:191]
buffer_load_dwordx4 a[168:171], v4, s[8:11], s36 offen offset:0 sc1
mm v[188:191],v[108:111],a[204:207],v[188:191]
mm a[48:51],v[80:83],a[172:175],a[48:51]
mm a[48:51],v[112:115],a[204:207],a[48:51]
buffer_load_dwordx4 a[200:203], v4, s[8:11], s36 offen offset:1024 sc1
mm a[52:55],v[84:87],a[172:175],a[52:55]
mm a[52:55],v[116:119],a[204:207],a[52:55]
mm a[56:59],v[88:91],a[172:175],a[56:59]
mm a[56:59],v[120:123],a[204:207],a[56:59]
buffer_load_dwordx4 v13, s[12:15], s37 offen offset:3072 lds
s_add_u32 s37, s37, 65536
mm a[60:63],v[92:95],a[172:175],a[60:63]
s_add_u32 m0, s38, 12288
mm a[60:63],v[124:127],a[204:207],a[60:63]
mm v[192:195],v[64:67],a[176:179],v[192:195]
mm v[192:195],v[96:99],a[208:211],v[192:195]
buffer_load_dwordx4 v10, s[12:15], s39 offen offset:0 lds
mm v[196:199],v[68:71],a[176:179],v[196:199]
mm v[196:199],v[100:103],a[208:211],v[196:199]
mm v[200:203],v[72:75],a[176:179],v[200:203]
mm v[200:203],v[104:107],a[208:211],v[200:203]
buffer_load_dwordx4 a[172:175], v5, s[8:11], s36 offen offset:0 sc1
mm v[204:207],v[76:79],a[176:179],v[204:207]
mm v[204:207],v[108:111],a[208:211],v[204:207]
mm a[64:67],v[80:83],a[176:179],a[64:67]
buffer_load_dwordx4 a[204:207], v5, s[8:11], s36 offen offset:1024 sc1
mm a[64:67],v[112:115],a[208:211],a[64:67]
mm a[68:71],v[84:87],a[176:179],a[68:71]
mm a[68:71],v[116:119],a[208:211],a[68:71]
buffer_load_dwordx4 v11, s[12:15], s39 offen offset:1024 lds
mm a[72:75],v[88:91],a[176:179],a[72:75]
mm a[72:75],v[120:123],a[208:211],a[72:75]
mm a[76:79],v[92:95],a[176:179],a[76:79]
mm a[76:79],v[124:127],a[208:211],a[76:79]
buffer_load_dwordx4 v12, s[12:15], s39 offen offset:2048 lds
mm v[208:211],v[64:67],a[180:183],v[208:211]
mm v[208:211],v[96:99],a[212:215],v[208:211]
mm v[212:215],v[68:71],a[180:183],v[212:215]
buffer_load_dwordx4 v13, s[12:15], s39 offen offset:3072 lds
mm v[212:215],v[100:103],a[212:215],v[212:215]
s_add_u32 s39, s39, 65536
mm v[216:219],v[72:75],a[180:183],v[216:219]
mm v[216:219],v[104:107],a[212:215],v[216:219]
mm v[220:223],v[76:79],a[180:183],v[220:223]
buffer_load_dwordx4 a[176:179], v6, s[8:11], s36 offen offset:0 sc1
mm v[220:223],v[108:111],a[212:215],v[220:223]
mm a[80:83],v[80:83],a[180:183],a[80:83]
mm a[80:83],v[112:115],a[212:215],a[80:83]
mm a[84:87],v[84:87],a[180:183],a[84:87]
buffer_load_dwordx4 a[208:211], v6, s[8:11], s36 offen offset:1024 sc1
s_add_u32 m0, s38, 16384
mm a[84:87],v[116:119],a[212:215],a[84:87]
mm a[88:91],v[88:91],a[180:183],a[88:91]
mm a[88:91],v[120:123],a[212:215],a[88:91]
buffer_load_dwordx4 v10, s[12:15], s37 offen offset:0 lds
mm a[92:95],v[92:95],a[180:183],a[92:95]
mm a[92:95],v[124:127],a[212:215],a[92:95]
mm v[224:227],v[64:67],a[184:187],v[224:227]
mm v[224:227],v[96:99],a[216:219],v[224:227]
buffer_load_dwordx4 v11, s[12:15], s37 offen offset:1024 lds
mm v[228:231],v[68:71],a[184:187],v[228:231]
mm v[228:231],v[100:103],a[216:219],v[228:231]
mm v[232:235],v[72:75],a[184:187],v[232:235]
buffer_load_dwordx4 v12, s[12:15], s37 offen offset:2048 lds
mm v[232:235],v[104:107],a[216:219],v[232:235]
mm v[236:239],v[76:79],a[184:187],v[236:239]
mm v[236:239],v[108:111],a[216:219],v[236:239]
mm a[96:99],v[80:83],a[184:187],a[96:99]
buffer_load_dwordx4 a[180:183], v7, s[8:11], s36 offen offset:0 sc1
mm a[96:99],v[112:115],a[216:219],a[96:99]
mm a[100:103],v[84:87],a[184:187],a[100:103]
mm a[100:103],v[116:119],a[216:219],a[100:103]
buffer_load_dwordx4 a[212:215], v7, s[8:11], s36 offen offset:1024 sc1
mm a[104:107],v[88:91],a[184:187],a[104:107]
mm a[104:107],v[120:123],a[216:219],a[104:107]
mm a[108:111],v[92:95],a[184:187],a[108:111]
mm a[108:111],v[124:127],a[216:219],a[108:111]
buffer_load_dwordx4 v13, s[12:15], s37 offen offset:3072 lds
s_add_u32 s37, s37, 65536
mm v[240:243],v[64:67],a[188:191],v[240:243]
s_add_u32 m0, s38, 20480
mm v[240:243],v[96:99],a[220:223],v[240:243]
mm v[244:247],v[68:71],a[188:191],v[244:247]
mm v[244:247],v[100:103],a[220:223],v[244:247]
buffer_load_dwordx4 v10, s[12:15], s39 offen offset:0 lds
mm v[248:251],v[72:75],a[188:191],v[248:251]
mm v[248:251],v[104:107],a[220:223],v[248:251]
mm v[252:255],v[76:79],a[188:191],v[252:255]
buffer_load_dwordx4 a[184:187], v8, s[8:11], s36 offen offset:0 sc1
mm v[252:255],v[108:111],a[220:223],v[252:255]
mm a[112:115],v[80:83],a[188:191],a[112:115]
mm a[112:115],v[112:115],a[220:223],a[112:115]
mm a[116:119],v[84:87],a[188:191],a[116:119]
buffer_load_dwordx4 a[216:219], v8, s[8:11], s36 offen offset:1024 sc1
mm a[116:119],v[116:119],a[220:223],a[116:119]
mm a[120:123],v[88:91],a[188:191],a[120:123]
mm a[120:123],v[120:123],a[220:223],a[120:123]
buffer_load_dwordx4 v11, s[12:15], s39 offen offset:1024 lds
mm a[124:127],v[92:95],a[188:191],a[124:127]
mm a[124:127],v[124:127],a[220:223],a[124:127]
mm v[128:131],v[64:67],a[160:163],v[128:131]
mm v[128:131],v[96:99],a[192:195],v[128:131]
buffer_load_dwordx4 v12, s[12:15], s39 offen offset:2048 lds
mm v[132:135],v[68:71],a[160:163],v[132:135]
mm v[132:135],v[100:103],a[192:195],v[132:135]
mm v[136:139],v[72:75],a[160:163],v[136:139]
buffer_load_dwordx4 v13, s[12:15], s39 offen offset:3072 lds
s_add_u32 s39, s39, 65536
mm v[136:139],v[104:107],a[192:195],v[136:139]
mm v[140:143],v[76:79],a[160:163],v[140:143]
mm v[140:143],v[108:111],a[192:195],v[140:143]
mm a[0:3],v[80:83],a[160:163],a[0:3]
buffer_load_dwordx4 a[188:191], v9, s[8:11], s36 offen offset:0 sc1
mm a[0:3],v[112:115],a[192:195],a[0:3]
mm a[4:7],v[84:87],a[160:163],a[4:7]
buffer_load_dwordx4 a[220:223], v9, s[8:11], s36 offen offset:1024 sc1
mm a[4:7],v[116:119],a[192:195],a[4:7]
s_waitcnt vmcnt(36)
mm a[8:11],v[88:91],a[160:163],a[8:11]
mm a[8:11],v[120:123],a[192:195],a[8:11]
mm a[12:15],v[92:95],a[160:163],a[12:15]
mm a[12:15],v[124:127],a[192:195],a[12:15]
mm v[144:147],v[64:67],a[164:167],v[144:147]
buffer_load_dwordx4 a[160:163], v2, s[8:11], s36 offen offset:0 sc1
mm v[144:147],v[96:99],a[196:199],v[144:147]
rt v[64:65],v48,24576
rt v[66:67],v48,28672
rt v[96:97],v48,0
mm v[148:151],v[68:71],a[164:167],v[148:151]
rt v[98:99],v48,4096
mm v[148:151],v[100:103],a[196:199],v[148:151]
buffer_load_dwordx4 a[192:195], v2, s[8:11], s36 offen offset:1024 sc1
rt v[68:69],v49,24576
rt v[70:71],v49,28672
rt v[100:101],v49,0
mm v[152:155],v[72:75],a[164:167],v[152:155]
rt v[102:103],v49,4096
mm v[152:155],v[104:107],a[196:199],v[152:155]
rt v[72:73],v50,24576
rt v[74:75],v50,28672
rt v[104:105],v50,0
mm v[156:159],v[76:79],a[164:167],v[156:159]
rt v[106:107],v50,4096
mm v[156:159],v[108:111],a[196:199],v[156:159]
rt v[76:77],v51,24576
rt v[78:79],v51,28672
rt v[108:109],v51,0
mm a[16:19],v[80:83],a[164:167],a[16:19]
rt v[110:111],v51,4096
mm a[16:19],v[112:115],a[196:199],a[16:19]
rt v[80:81],v52,24576
rt v[82:83],v52,28672
rt v[112:113],v52,0
mm a[20:23],v[84:87],a[164:167],a[20:23]
rt v[114:115],v52,4096
mm a[20:23],v[116:119],a[196:199],a[20:23]
rt v[84:85],v53,24576
rt v[86:87],v53,28672
rt v[116:117],v53,0
mm a[24:27],v[88:91],a[164:167],a[24:27]
rt v[118:119],v53,4096
mm a[24:27],v[120:123],a[196:199],a[24:27]
rt v[88:89],v54,24576
rt v[90:91],v54,28672
rt v[120:121],v54,0
mm a[28:31],v[92:95],a[164:167],a[28:31]
rt v[122:123],v54,4096
mm a[28:31],v[124:127],a[196:199],a[28:31]
buffer_load_dwordx4 a[164:167], v3, s[8:11], s36 offen offset:0 sc1
buffer_load_dwordx4 a[196:199], v3, s[8:11], s36 offen offset:1024 sc1
rt v[92:93],v55,24576
rt v[94:95],v55,28672
rt v[124:125],v55,0
rt v[126:127],v55,4096
s_add_u32 s36, s36, 2048
s_waitcnt vmcnt(32) lgkmcnt(12)
mm v[160:163],v[64:67],a[232:235],v[160:163]
mm v[160:163],v[96:99],a[136:139],v[160:163]
mm v[164:167],v[68:71],a[232:235],v[164:167]
mm v[164:167],v[100:103],a[136:139],v[164:167]
mm v[168:171],v[72:75],a[232:235],v[168:171]
mm v[168:171],v[104:107],a[136:139],v[168:171]
mm v[172:175],v[76:79],a[232:235],v[172:175]
mm v[172:175],v[108:111],a[136:139],v[172:175]
s_waitcnt lgkmcnt(0)
mm a[32:35],v[80:83],a[232:235],a[32:35]
mm a[32:35],v[112:115],a[136:139],a[32:35]
s_add_u32 m0, s38, 24576
mm a[36:39],v[84:87],a[232:235],a[36:39]
mm a[36:39],v[116:119],a[136:139],a[36:39]
mm a[40:43],v[88:91],a[232:235],a[40:43]
buffer_load_dwordx4 v10, s[12:15], s37 offen offset:0 lds
mm a[40:43],v[120:123],a[136:139],a[40:43]
mm a[44:47],v[92:95],a[232:235],a[44:47]
mm a[44:47],v[124:127],a[136:139],a[44:47]
buffer_load_dwordx4 v11, s[12:15], s37 offen offset:1024 lds
mm v[176:179],v[64:67],a[236:239],v[176:179]
mm v[176:179],v[96:99],a[140:143],v[176:179]
mm v[180:183],v[68:71],a[236:239],v[180:183]
mm v[180:183],v[100:103],a[140:143],v[180:183]
buffer_load_dwordx4 v12, s[12:15], s37 offen offset:2048 lds
mm v[184:187],v[72:75],a[236:239],v[184:187]
mm v[184:187],v[104:107],a[140:143],v[184:187]
mm v[188:191],v[76:79],a[236:239],v[188:191]
buffer_load_dwordx4 a[232:235], v4, s[8:11], s36 offen offset:0 sc1
mm v[188:191],v[108:111],a[140:143],v[188:191]
mm a[48:51],v[80:83],a[236:239],a[48:51]
mm a[48:51],v[112:115],a[140:143],a[48:51]
buffer_load_dwordx4 a[136:139], v4, s[8:11], s36 offen offset:1024 sc1
mm a[52:55],v[84:87],a[236:239],a[52:55]
mm a[52:55],v[116:119],a[140:143],a[52:55]
mm a[56:59],v[88:91],a[236:239],a[56:59]
mm a[56:59],v[120:123],a[140:143],a[56:59]
buffer_load_dwordx4 v13, s[12:15], s37 offen offset:3072 lds
s_add_u32 s37, s37, 65536
mm a[60:63],v[92:95],a[236:239],a[60:63]
s_add_u32 m0, s38, 28672
mm a[60:63],v[124:127],a[140:143],a[60:63]
mm v[192:195],v[64:67],a[240:243],v[192:195]
mm v[192:195],v[96:99],a[144:147],v[192:195]
buffer_load_dwordx4 v10, s[12:15], s39 offen offset:0 lds
mm v[196:199],v[68:71],a[240:243],v[196:199]
mm v[196:199],v[100:103],a[144:147],v[196:199]
mm v[200:203],v[72:75],a[240:243],v[200:203]
mm v[200:203],v[104:107],a[144:147],v[200:203]
buffer_load_dwordx4 a[236:239], v5, s[8:11], s36 offen offset:0 sc1
mm v[204:207],v[76:79],a[240:243],v[204:207]
mm v[204:207],v[108:111],a[144:147],v[204:207]
mm a[64:67],v[80:83],a[240:243],a[64:67]
buffer_load_dwordx4 a[140:143], v5, s[8:11], s36 offen offset:1024 sc1
mm a[64:67],v[112:115],a[144:147],a[64:67]
mm a[68:71],v[84:87],a[240:243],a[68:71]
mm a[68:71],v[116:119],a[144:147],a[68:71]
buffer_load_dwordx4 v11, s[12:15], s39 offen offset:1024 lds
mm a[72:75],v[88:91],a[240:243],a[72:75]
mm a[72:75],v[120:123],a[144:147],a[72:75]
mm a[76:79],v[92:95],a[240:243],a[76:79]
mm a[76:79],v[124:127],a[144:147],a[76:79]
buffer_load_dwordx4 v12, s[12:15], s39 offen offset:2048 lds
mm v[208:211],v[64:67],a[244:247],v[208:211]
mm v[208:211],v[96:99],a[148:151],v[208:211]
mm v[212:215],v[68:71],a[244:247],v[212:215]
buffer_load_dwordx4 v13, s[12:15], s39 offen offset:3072 lds
mm v[212:215],v[100:103],a[148:151],v[212:215]
s_add_u32 s39, s39, 65536
mm v[216:219],v[72:75],a[244:247],v[216:219]
mm v[216:219],v[104:107],a[148:151],v[216:219]
mm v[220:223],v[76:79],a[244:247],v[220:223]
buffer_load_dwordx4 a[240:243], v6, s[8:11], s36 offen offset:0 sc1
mm v[220:223],v[108:111],a[148:151],v[220:223]
mm a[80:83],v[80:83],a[244:247],a[80:83]
mm a[80:83],v[112:115],a[148:151],a[80:83]
mm a[84:87],v[84:87],a[244:247],a[84:87]
buffer_load_dwordx4 a[144:147], v6, s[8:11], s36 offen offset:1024 sc1
s_add_u32 m0, s38, 0
mm a[84:87],v[116:119],a[148:151],a[84:87]
mm a[88:91],v[88:91],a[244:247],a[88:91]
mm a[88:91],v[120:123],a[148:151],a[88:91]
buffer_load_dwordx4 v10, s[12:15], s37 offen offset:0 lds
mm a[92:95],v[92:95],a[244:247],a[92:95]
mm a[92:95],v[124:127],a[148:151],a[92:95]
mm v[224:227],v[64:67],a[248:251],v[224:227]
mm v[224:227],v[96:99],a[152:155],v[224:227]
buffer_load_dwordx4 v11, s[12:15], s37 offen offset:1024 lds
mm v[228:231],v[68:71],a[248:251],v[228:231]
mm v[228:231],v[100:103],a[152:155],v[228:231]
mm v[232:235],v[72:75],a[248:251],v[232:235]
buffer_load_dwordx4 v12, s[12:15], s37 offen offset:2048 lds
mm v[232:235],v[104:107],a[152:155],v[232:235]
mm v[236:239],v[76:79],a[248:251],v[236:239]
mm v[236:239],v[108:111],a[152:155],v[236:239]
mm a[96:99],v[80:83],a[248:251],a[96:99]
buffer_load_dwordx4 a[244:247], v7, s[8:11], s36 offen offset:0 sc1
mm a[96:99],v[112:115],a[152:155],a[96:99]
mm a[100:103],v[84:87],a[248:251],a[100:103]
mm a[100:103],v[116:119],a[152:155],a[100:103]
buffer_load_dwordx4 a[148:151], v7, s[8:11], s36 offen offset:1024 sc1
mm a[104:107],v[88:91],a[248:251],a[104:107]
mm a[104:107],v[120:123],a[152:155],a[104:107]
mm a[108:111],v[92:95],a[248:251],a[108:111]
mm a[108:111],v[124:127],a[152:155],a[108:111]
buffer_load_dwordx4 v13, s[12:15], s37 offen offset:3072 lds
s_add_u32 s37, s37, 65536
mm v[240:243],v[64:67],a[252:255],v[240:243]
s_add_u32 m0, s38, 4096
mm v[240:243],v[96:99],a[156:159],v[240:243]
mm v[244:247],v[68:71],a[252:255],v[244:247]
mm v[244:247],v[100:103],a[156:159],v[244:247]
buffer_load_dwordx4 v10, s[12:15], s39 offen offset:0 lds
mm v[248:251],v[72:75],a[252:255],v[248:251]
mm v[248:251],v[104:107],a[156:159],v[248:251]
mm v[252:255],v[76:79],a[252:255],v[252:255]
buffer_load_dwordx4 a[248:251], v8, s[8:11], s36 offen offset:0 sc1
mm v[252:255],v[108:111],a[156:159],v[252:255]
mm a[112:115],v[80:83],a[252:255],a[112:115]
mm a[112:115],v[112:115],a[156:159],a[112:115]
mm a[116:119],v[84:87],a[252:255],a[116:119]
buffer_load_dwordx4 a[152:155], v8, s[8:11], s36 offen offset:1024 sc1
mm a[116:119],v[116:119],a[156:159],a[116:119]
mm a[120:123],v[88:91],a[252:255],a[120:123]
mm a[120:123],v[120:123],a[156:159],a[120:123]
buffer_load_dwordx4 v11, s[12:15], s39 offen offset:1024 lds
mm a[124:127],v[92:95],a[252:255],a[124:127]
mm a[124:127],v[124:127],a[156:159],a[124:127]
mm v[128:131],v[64:67],a[224:227],v[128:131]
mm v[128:131],v[96:99],a[128:131],v[128:131]
buffer_load_dwordx4 v12, s[12:15], s39 offen offset:2048 lds
mm v[132:135],v[68:71],a[224:227],v[132:135]
mm v[132:135],v[100:103],a[128:131],v[132:135]
mm v[136:139],v[72:75],a[224:227],v[136:139]
buffer_load_dwordx4 v13, s[12:15], s39 offen offset:3072 lds
s_add_u32 s39, s39, 65536
mm v[136:139],v[104:107],a[128:131],v[136:139]
mm v[140:143],v[76:79],a[224:227],v[140:143]
mm v[140:143],v[108:111],a[128:131],v[140:143]
mm a[0:3],v[80:83],a[224:227],a[0:3]
buffer_load_dwordx4 a[252:255], v9, s[8:11], s36 offen offset:0 sc1
mm a[0:3],v[112:115],a[128:131],a[0:3]
mm a[4:7],v[84:87],a[224:227],a[4:7]
buffer_load_dwordx4 a[156:159], v9, s[8:11], s36 offen offset:1024 sc1
mm a[4:7],v[116:119],a[128:131],a[4:7]
s_waitcnt vmcnt(34)
mm a[8:11],v[88:91],a[224:227],a[8:11]
mm a[8:11],v[120:123],a[128:131],a[8:11]
mm a[12:15],v[92:95],a[224:227],a[12:15]
mm a[12:15],v[124:127],a[128:131],a[12:15]
mm v[144:147],v[64:67],a[228:231],v[144:147]
buffer_load_dwordx4 a[224:227], v2, s[8:11], s36 offen offset:0 sc1
mm v[144:147],v[96:99],a[132:135],v[144:147]
rt v[64:65],v48,8192
rt v[66:67],v48,12288
rt v[96:97],v48,16384
mm v[148:151],v[68:71],a[228:231],v[148:151]
rt v[98:99],v48,20480
mm v[148:151],v[100:103],a[132:135],v[148:151]
buffer_load_dwordx4 a[128:131], v2, s[8:11], s36 offen offset:1024 sc1
rt v[68:69],v49,8192
rt v[70:71],v49,12288
rt v[100:101],v49,16384
mm v[152:155],v[72:75],a[228:231],v[152:155]
rt v[102:103],v49,20480
mm v[152:155],v[104:107],a[132:135],v[152:155]
rt v[72:73],v50,8192
rt v[74:75],v50,12288
rt v[104:105],v50,16384
mm v[156:159],v[76:79],a[228:231],v[156:159]
rt v[106:107],v50,20480
mm v[156:159],v[108:111],a[132:135],v[156:159]
rt v[76:77],v51,8192
rt v[78:79],v51,12288
rt v[108:109],v51,16384
mm a[16:19],v[80:83],a[228:231],a[16:19]
rt v[110:111],v51,20480
mm a[16:19],v[112:115],a[132:135],a[16:19]
rt v[80:81],v52,8192
rt v[82:83],v52,12288
rt v[112:113],v52,16384
mm a[20:23],v[84:87],a[228:231],a[20:23]
rt v[114:115],v52,20480
mm a[20:23],v[116:119],a[132:135],a[20:23]
rt v[84:85],v53,8192
rt v[86:87],v53,12288
rt v[116:117],v53,16384
mm a[24:27],v[88:91],a[228:231],a[24:27]
rt v[118:119],v53,20480
mm a[24:27],v[120:123],a[132:135],a[24:27]
rt v[88:89],v54,8192
rt v[90:91],v54,12288
rt v[120:121],v54,16384
mm a[28:31],v[92:95],a[228:231],a[28:31]
rt v[122:123],v54,20480
mm a[28:31],v[124:127],a[132:135],a[28:31]
buffer_load_dwordx4 a[228:231], v3, s[8:11], s36 offen offset:0 sc1
buffer_load_dwordx4 a[132:135], v3, s[8:11], s36 offen offset:1024 sc1
rt v[92:93],v55,8192
rt v[94:95],v55,12288
rt v[124:125],v55,16384
rt v[126:127],v55,20480
s_add_u32 s36, s36, 2048
s_waitcnt vmcnt(32) lgkmcnt(12)
mm v[160:163],v[64:67],a[168:171],v[160:163]
mm v[160:163],v[96:99],a[200:203],v[160:163]
mm v[164:167],v[68:71],a[168:171],v[164:167]
mm v[164:167],v[100:103],a[200:203],v[164:167]
mm v[168:171],v[72:75],a[168:171],v[168:171]
mm v[168:171],v[104:107],a[200:203],v[168:171]
mm v[172:175],v[76:79],a[168:171],v[172:175]
mm v[172:175],v[108:111],a[200:203],v[172:175]
s_waitcnt lgkmcnt(0)
mm a[32:35],v[80:83],a[168:171],a[32:35]
mm a[32:35],v[112:115],a[200:203],a[32:35]
s_add_u32 m0, s38, 8192
mm a[36:39],v[84:87],a[168:171],a[36:39]
mm a[36:39],v[116:119],a[200:203],a[36:39]
mm a[40:43],v[88:91],a[168:171],a[40:43]
buffer_load_dwordx4 v10, s[12:15], s37 offen offset:0 lds
mm a[40:43],v[120:123],a[200:203],a[40:43]
mm a[44:47],v[92:95],a[168:171],a[44:47]
mm a[44:47],v[124:127],a[200:203],a[44:47]
buffer_load_dwordx4 v11, s[12:15], s37 offen offset:1024 lds
mm v[176:179],v[64:67],a[172:175],v[176:179]
mm v[176:179],v[96:99],a[204:207],v[176:179]
mm v[180:183],v[68:71],a[172:175],v[180:183]
mm v[180:183],v[100:103],a[204:207],v[180:183]
buffer_load_dwordx4 v12, s[12:15], s37 offen offset:2048 lds
mm v[184:187],v[72:75],a[172:175],v[184:187]
mm v[184:187],v[104:107],a[204:207],v[184:187]
mm v[188:191],v[76:79],a[172:175],v[188:191]
buffer_load_dwordx4 a[168:171], v4, s[8:11], s36 offen offset:0 sc1
mm v[188:191],v[108:111],a[204:207],v[188:191]
mm a[48:51],v[80:83],a[172:175],a[48:51]
mm a[48:51],v[112:115],a[204:207],a[48:51]
buffer_load_dwordx4 a[200:203], v4, s[8:11], s36 offen offset:1024 sc1
mm a[52:55],v[84:87],a[172:175],a[52:55]
mm a[52:55],v[116:119],a[204:207],a[52:55]
mm a[56:59],v[88:91],a[172:175],a[56:59]
mm a[56:59],v[120:123],a[204:207],a[56:59]
buffer_load_dwordx4 v13, s[12:15], s37 offen offset:3072 lds
s_add_u32 s37, s37, 65536
mm a[60:63],v[92:95],a[172:175],a[60:63]
s_add_u32 m0, s38, 12288
mm a[60:63],v[124:127],a[204:207],a[60:63]
mm v[192:195],v[64:67],a[176:179],v[192:195]
mm v[192:195],v[96:99],a[208:211],v[192:195]
buffer_load_dwordx4 v10, s[12:15], s39 offen offset:0 lds
mm v[196:199],v[68:71],a[176:179],v[196:199]
mm v[196:199],v[100:103],a[208:211],v[196:199]
mm v[200:203],v[72:75],a[176:179],v[200:203]
mm v[200:203],v[104:107],a[208:211],v[200:203]
buffer_load_dwordx4 a[172:175], v5, s[8:11], s36 offen offset:0 sc1
mm v[204:207],v[76:79],a[176:179],v[204:207]
mm v[204:207],v[108:111],a[208:211],v[204:207]
mm a[64:67],v[80:83],a[176:179],a[64:67]
buffer_load_dwordx4 a[204:207], v5, s[8:11], s36 offen offset:1024 sc1
mm a[64:67],v[112:115],a[208:211],a[64:67]
mm a[68:71],v[84:87],a[176:179],a[68:71]
mm a[68:71],v[116:119],a[208:211],a[68:71]
buffer_load_dwordx4 v11, s[12:15], s39 offen offset:1024 lds
mm a[72:75],v[88:91],a[176:179],a[72:75]
mm a[72:75],v[120:123],a[208:211],a[72:75]
mm a[76:79],v[92:95],a[176:179],a[76:79]
mm a[76:79],v[124:127],a[208:211],a[76:79]
buffer_load_dwordx4 v12, s[12:15], s39 offen offset:2048 lds
mm v[208:211],v[64:67],a[180:183],v[208:211]
mm v[208:211],v[96:99],a[212:215],v[208:211]
mm v[212:215],v[68:71],a[180:183],v[212:215]
buffer_load_dwordx4 v13, s[12:15], s39 offen offset:3072 lds
mm v[212:215],v[100:103],a[212:215],v[212:215]
s_add_u32 s39, s39, 65536
mm v[216:219],v[72:75],a[180:183],v[216:219]
mm v[216:219],v[104:107],a[212:215],v[216:219]
mm v[220:223],v[76:79],a[180:183],v[220:223]
buffer_load_dwordx4 a[176:179], v6, s[8:11], s36 offen offset:0 sc1
mm v[220:223],v[108:111],a[212:215],v[220:223]
mm a[80:83],v[80:83],a[180:183],a[80:83]
mm a[80:83],v[112:115],a[212:215],a[80:83]
mm a[84:87],v[84:87],a[180:183],a[84:87]
buffer_load_dwordx4 a[208:211], v6, s[8:11], s36 offen offset:1024 sc1
s_add_u32 m0, s38, 16384
mm a[84:87],v[116:119],a[212:215],a[84:87]
mm a[88:91],v[88:91],a[180:183],a[88:91]
mm a[88:91],v[120:123],a[212:215],a[88:91]
buffer_load_dwordx4 v10, s[12:15], s37 offen offset:0 lds
mm a[92:95],v[92:95],a[180:183],a[92:95]
mm a[92:95],v[124:127],a[212:215],a[92:95]
mm v[224:227],v[64:67],a[184:187],v[224:227]
mm v[224:227],v[96:99],a[216:219],v[224:227]
buffer_load_dwordx4 v11, s[12:15], s37 offen offset:1024 lds
mm v[228:231],v[68:71],a[184:187],v[228:231]
mm v[228:231],v[100:103],a[216:219],v[228:231]
mm v[232:235],v[72:75],a[184:187],v[232:235]
buffer_load_dwordx4 v12, s[12:15], s37 offen offset:2048 lds
mm v[232:235],v[104:107],a[216:219],v[232:235]
mm v[236:239],v[76:79],a[184:187],v[236:239]
mm v[236:239],v[108:111],a[216:219],v[236:239]
mm a[96:99],v[80:83],a[184:187],a[96:99]
buffer_load_dwordx4 a[180:183], v7, s[8:11], s36 offen offset:0 sc1
mm a[96:99],v[112:115],a[216:219],a[96:99]
mm a[100:103],v[84:87],a[184:187],a[100:103]
mm a[100:103],v[116:119],a[216:219],a[100:103]
buffer_load_dwordx4 a[212:215], v7, s[8:11], s36 offen offset:1024 sc1
mm a[104:107],v[88:91],a[184:187],a[104:107]
mm a[104:107],v[120:123],a[216:219],a[104:107]
mm a[108:111],v[92:95],a[184:187],a[108:111]
mm a[108:111],v[124:127],a[216:219],a[108:111]
buffer_load_dwordx4 v13, s[12:15], s37 offen offset:3072 lds
s_add_u32 s37, s37, 65536
mm v[240:243],v[64:67],a[188:191],v[240:243]
s_add_u32 m0, s38, 20480
mm v[240:243],v[96:99],a[220:223],v[240:243]
mm v[244:247],v[68:71],a[188:191],v[244:247]
mm v[244:247],v[100:103],a[220:223],v[244:247]
buffer_load_dwordx4 v10, s[12:15], s39 offen offset:0 lds
mm v[248:251],v[72:75],a[188:191],v[248:251]
mm v[248:251],v[104:107],a[220:223],v[248:251]
mm v[252:255],v[76:79],a[188:191],v[252:255]
buffer_load_dwordx4 a[184:187], v8, s[8:11], s36 offen offset:0 sc1
mm v[252:255],v[108:111],a[220:223],v[252:255]
mm a[112:115],v[80:83],a[188:191],a[112:115]
mm a[112:115],v[112:115],a[220:223],a[112:115]
mm a[116:119],v[84:87],a[188:191],a[116:119]
buffer_load_dwordx4 a[216:219], v8, s[8:11], s36 offen offset:1024 sc1
mm a[116:119],v[116:119],a[220:223],a[116:119]
mm a[120:123],v[88:91],a[188:191],a[120:123]
mm a[120:123],v[120:123],a[220:223],a[120:123]
buffer_load_dwordx4 v11, s[12:15], s39 offen offset:1024 lds
mm a[124:127],v[92:95],a[188:191],a[124:127]
mm a[124:127],v[124:127],a[220:223],a[124:127]
mm v[128:131],v[64:67],a[160:163],v[128:131]
mm v[128:131],v[96:99],a[192:195],v[128:131]
buffer_load_dwordx4 v12, s[12:15], s39 offen offset:2048 lds
mm v[132:135],v[68:71],a[160:163],v[132:135]
mm v[132:135],v[100:103],a[192:195],v[132:135]
mm v[136:139],v[72:75],a[160:163],v[136:139]
buffer_load_dwordx4 v13, s[12:15], s39 offen offset:3072 lds
s_add_u32 s39, s39, 65536
mm v[136:139],v[104:107],a[192:195],v[136:139]
mm v[140:143],v[76:79],a[160:163],v[140:143]
mm v[140:143],v[108:111],a[192:195],v[140:143]
mm a[0:3],v[80:83],a[160:163],a[0:3]
buffer_load_dwordx4 a[188:191], v9, s[8:11], s36 offen offset:0 sc1
mm a[0:3],v[112:115],a[192:195],a[0:3]
mm a[4:7],v[84:87],a[160:163],a[4:7]
buffer_load_dwordx4 a[220:223], v9, s[8:11], s36 offen offset:1024 sc1
mm a[4:7],v[116:119],a[192:195],a[4:7]
s_waitcnt vmcnt(34)
mm a[8:11],v[88:91],a[160:163],a[8:11]
mm a[8:11],v[120:123],a[192:195],a[8:11]
mm a[12:15],v[92:95],a[160:163],a[12:15]
mm a[12:15],v[124:127],a[192:195],a[12:15]
mm v[144:147],v[64:67],a[164:167],v[144:147]
buffer_load_dwordx4 a[160:163], v2, s[8:11], s36 offen offset:0 sc1
mm v[144:147],v[96:99],a[196:199],v[144:147]
rt v[64:65],v48,24576
rt v[66:67],v48,28672
rt v[96:97],v48,0
mm v[148:151],v[68:71],a[164:167],v[148:151]
rt v[98:99],v48,4096
mm v[148:151],v[100:103],a[196:199],v[148:151]
buffer_load_dwordx4 a[192:195], v2, s[8:11], s36 offen offset:1024 sc1
rt v[68:69],v49,24576
rt v[70:71],v49,28672
rt v[100:101],v49,0
mm v[152:155],v[72:75],a[164:167],v[152:155]
rt v[102:103],v49,4096
mm v[152:155],v[104:107],a[196:199],v[152:155]
rt v[72:73],v50,24576
rt v[74:75],v50,28672
rt v[104:105],v50,0
mm v[156:159],v[76:79],a[164:167],v[156:159]
rt v[106:107],v50,4096
mm v[156:159],v[108:111],a[196:199],v[156:159]
rt v[76:77],v51,24576
rt v[78:79],v51,28672
rt v[108:109],v51,0
mm a[16:19],v[80:83],a[164:167],a[16:19]
rt v[110:111],v51,4096
mm a[16:19],v[112:115],a[196:199],a[16:19]
rt v[80:81],v52,24576
rt v[82:83],v52,28672
rt v[112:113],v52,0
mm a[20:23],v[84:87],a[164:167],a[20:23]
rt v[114:115],v52,4096
mm a[20:23],v[116:119],a[196:199],a[20:23]
rt v[84:85],v53,24576
rt v[86:87],v53,28672
rt v[116:117],v53,0
mm a[24:27],v[88:91],a[164:167],a[24:27]
rt v[118:119],v53,4096
mm a[24:27],v[120:123],a[196:199],a[24:27]
rt v[88:89],v54,24576
rt v[90:91],v54,28672
rt v[120:121],v54,0
mm a[28:31],v[92:95],a[164:167],a[28:31]
rt v[122:123],v54,4096
mm a[28:31],v[124:127],a[196:199],a[28:31]
buffer_load_dwordx4 a[164:167], v3, s[8:11], s36 offen offset:0 sc1
buffer_load_dwordx4 a[196:199], v3, s[8:11], s36 offen offset:1024 sc1
rt v[92:93],v55,24576
rt v[94:95],v55,28672
rt v[124:125],v55,0
rt v[126:127],v55,4096
s_add_u32 s36, s36, 2048
s_waitcnt vmcnt(32) lgkmcnt(12)
mm v[160:163],v[64:67],a[232:235],v[160:163]
mm v[160:163],v[96:99],a[136:139],v[160:163]
mm v[164:167],v[68:71],a[232:235],v[164:167]
mm v[164:167],v[100:103],a[136:139],v[164:167]
mm v[168:171],v[72:75],a[232:235],v[168:171]
mm v[168:171],v[104:107],a[136:139],v[168:171]
mm v[172:175],v[76:79],a[232:235],v[172:175]
mm v[172:175],v[108:111],a[136:139],v[172:175]
s_waitcnt lgkmcnt(0)
mm a[32:35],v[80:83],a[232:235],a[32:35]
mm a[32:35],v[112:115],a[136:139],a[32:35]
s_add_u32 m0, s38, 24576
mm a[36:39],v[84:87],a[232:235],a[36:39]
mm a[36:39],v[116:119],a[136:139],a[36:39]
mm a[40:43],v[88:91],a[232:235],a[40:43]
buffer_load_dwordx4 v10, s[12:15], s37 offen offset:0 lds
mm a[40:43],v[120:123],a[136:139],a[40:43]
mm a[44:47],v[92:95],a[232:235],a[44:47]
mm a[44:47],v[124:127],a[136:139],a[44:47]
buffer_load_dwordx4 v11, s[12:15], s37 offen offset:1024 lds
mm v[176:179],v[64:67],a[236:239],v[176:179]
mm v[176:179],v[96:99],a[140:143],v[176:179]
mm v[180:183],v[68:71],a[236:239],v[180:183]
mm v[180:183],v[100:103],a[140:143],v[180:183]
buffer_load_dwordx4 v12, s[12:15], s37 offen offset:2048 lds
mm v[184:187],v[72:75],a[236:239],v[184:187]
mm v[184:187],v[104:107],a[140:143],v[184:187]
mm v[188:191],v[76:79],a[236:239],v[188:191]
buffer_load_dwordx4 a[232:235], v4, s[8:11], s36 offen offset:0 sc1
mm v[188:191],v[108:111],a[140:143],v[188:191]
mm a[48:51],v[80:83],a[236:239],a[48:51]
mm a[48:51],v[112:115],a[140:143],a[48:51]
buffer_load_dwordx4 a[136:139], v4, s[8:11], s36 offen offset:1024 sc1
mm a[52:55],v[84:87],a[236:239],a[52:55]
mm a[52:55],v[116:119],a[140:143],a[52:55]
mm a[56:59],v[88:91],a[236:239],a[56:59]
mm a[56:59],v[120:123],a[140:143],a[56:59]
buffer_load_dwordx4 v13, s[12:15], s37 offen offset:3072 lds
s_add_u32 s37, s37, 65536
mm a[60:63],v[92:95],a[236:239],a[60:63]
s_add_u32 m0, s38, 28672
mm a[60:63],v[124:127],a[140:143],a[60:63]
mm v[192:195],v[64:67],a[240:243],v[192:195]
mm v[192:195],v[96:99],a[144:147],v[192:195]
buffer_load_dwordx4 v10, s[12:15], s39 offen offset:0 lds
mm v[196:199],v[68:71],a[240:243],v[196:199]
mm v[196:199],v[100:103],a[144:147],v[196:199]
mm v[200:203],v[72:75],a[240:243],v[200:203]
mm v[200:203],v[104:107],a[144:147],v[200:203]
buffer_load_dwordx4 a[236:239], v5, s[8:11], s36 offen offset:0 sc1
mm v[204:207],v[76:79],a[240:243],v[204:207]
mm v[204:207],v[108:111],a[144:147],v[204:207]
mm a[64:67],v[80:83],a[240:243],a[64:67]
buffer_load_dwordx4 a[140:143], v5, s[8:11], s36 offen offset:1024 sc1
mm a[64:67],v[112:115],a[144:147],a[64:67]
mm a[68:71],v[84:87],a[240:243],a[68:71]
mm a[68:71],v[116:119],a[144:147],a[68:71]
buffer_load_dwordx4 v11, s[12:15], s39 offen offset:1024 lds
mm a[72:75],v[88:91],a[240:243],a[72:75]
mm a[72:75],v[120:123],a[144:147],a[72:75]
mm a[76:79],v[92:95],a[240:243],a[76:79]
mm a[76:79],v[124:127],a[144:147],a[76:79]
buffer_load_dwordx4 v12, s[12:15], s39 offen offset:2048 lds
mm v[208:211],v[64:67],a[244:247],v[208:211]
mm v[208:211],v[96:99],a[148:151],v[208:211]
mm v[212:215],v[68:71],a[244:247],v[212:215]
buffer_load_dwordx4 v13, s[12:15], s39 offen offset:3072 lds
mm v[212:215],v[100:103],a[148:151],v[212:215]
s_add_u32 s39, s39, 65536
mm v[216:219],v[72:75],a[244:247],v[216:219]
mm v[216:219],v[104:107],a[148:151],v[216:219]
mm v[220:223],v[76:79],a[244:247],v[220:223]
buffer_load_dwordx4 a[240:243], v6, s[8:11], s36 offen offset:0 sc1
mm v[220:223],v[108:111],a[148:151],v[220:223]
mm a[80:83],v[80:83],a[244:247],a[80:83]
mm a[80:83],v[112:115],a[148:151],a[80:83]
mm a[84:87],v[84:87],a[244:247],a[84:87]
buffer_load_dwordx4 a[144:147], v6, s[8:11], s36 offen offset:1024 sc1
s_add_u32 m0, s38, 0
mm a[84:87],v[116:119],a[148:151],a[84:87]
mm a[88:91],v[88:91],a[244:247],a[88:91]
mm a[88:91],v[120:123],a[148:151],a[88:91]
buffer_load_dwordx4 v10, s[12:15], s37 offen offset:0 lds
mm a[92:95],v[92:95],a[244:247],a[92:95]
mm a[92:95],v[124:127],a[148:151],a[92:95]
mm v[224:227],v[64:67],a[248:251],v[224:227]
mm v[224:227],v[96:99],a[152:155],v[224:227]
buffer_load_dwordx4 v11, s[12:15], s37 offen offset:1024 lds
mm v[228:231],v[68:71],a[248:251],v[228:231]
mm v[228:231],v[100:103],a[152:155],v[228:231]
mm v[232:235],v[72:75],a[248:251],v[232:235]
buffer_load_dwordx4 v12, s[12:15], s37 offen offset:2048 lds
mm v[232:235],v[104:107],a[152:155],v[232:235]
mm v[236:239],v[76:79],a[248:251],v[236:239]
mm v[236:239],v[108:111],a[152:155],v[236:239]
mm a[96:99],v[80:83],a[248:251],a[96:99]
buffer_load_dwordx4 a[244:247], v7, s[8:11], s36 offen offset:0 sc1
mm a[96:99],v[112:115],a[152:155],a[96:99]
mm a[100:103],v[84:87],a[248:251],a[100:103]
mm a[100:103],v[116:119],a[152:155],a[100:103]
buffer_load_dwordx4 a[148:151], v7, s[8:11], s36 offen offset:1024 sc1
mm a[104:107],v[88:91],a[248:251],a[104:107]
mm a[104:107],v[120:123],a[152:155],a[104:107]
mm a[108:111],v[92:95],a[248:251],a[108:111]
mm a[108:111],v[124:127],a[152:155],a[108:111]
buffer_load_dwordx4 v13, s[12:15], s37 offen offset:3072 lds
s_add_u32 s37, s37, 65536
mm v[240:243],v[64:67],a[252:255],v[240:243]
s_add_u32 m0, s38, 4096
mm v[240:243],v[96:99],a[156:159],v[240:243]
mm v[244:247],v[68:71],a[252:255],v[244:247]
mm v[244:247],v[100:103],a[156:159],v[244:247]
buffer_load_dwordx4 v10, s[12:15], s39 offen offset:0 lds
mm v[248:251],v[72:75],a[252:255],v[248:251]
mm v[248:251],v[104:107],a[156:159],v[248:251]
mm v[252:255],v[76:79],a[252:255],v[252:255]
buffer_load_dwordx4 a[248:251], v8, s[8:11], s36 offen offset:0 sc1
mm v[252:255],v[108:111],a[156:159],v[252:255]
mm a[112:115],v[80:83],a[252:255],a[112:115]
mm a[112:115],v[112:115],a[156:159],a[112:115]
mm a[116:119],v[84:87],a[252:255],a[116:119]
buffer_load_dwordx4 a[152:155], v8, s[8:11], s36 offen offset:1024 sc1
mm a[116:119],v[116:119],a[156:159],a[116:119]
mm a[120:123],v[88:91],a[252:255],a[120:123]
mm a[120:123],v[120:123],a[156:159],a[120:123]
buffer_load_dwordx4 v11, s[12:15], s39 offen offset:1024 lds
mm a[124:127],v[92:95],a[252:255],a[124:127]
mm a[124:127],v[124:127],a[156:159],a[124:127]
mm v[128:131],v[64:67],a[224:227],v[128:131]
mm v[128:131],v[96:99],a[128:131],v[128:131]
buffer_load_dwordx4 v12, s[12:15], s39 offen offset:2048 lds
mm v[132:135],v[68:71],a[224:227],v[132:135]
mm v[132:135],v[100:103],a[128:131],v[132:135]
mm v[136:139],v[72:75],a[224:227],v[136:139]
buffer_load_dwordx4 v13, s[12:15], s39 offen offset:3072 lds
s_add_u32 s39, s39, 65536
mm v[136:139],v[104:107],a[128:131],v[136:139]
mm v[140:143],v[76:79],a[224:227],v[140:143]
mm v[140:143],v[108:111],a[128:131],v[140:143]
mm a[0:3],v[80:83],a[224:227],a[0:3]
buffer_load_dwordx4 a[252:255], v9, s[8:11], s36 offen offset:0 sc1
mm a[0:3],v[112:115],a[128:131],a[0:3]
mm a[4:7],v[84:87],a[224:227],a[4:7]
buffer_load_dwordx4 a[156:159], v9, s[8:11], s36 offen offset:1024 sc1
mm a[4:7],v[116:119],a[128:131],a[4:7]
s_waitcnt vmcnt(34)
mm a[8:11],v[88:91],a[224:227],a[8:11]
mm a[8:11],v[120:123],a[128:131],a[8:11]
mm a[12:15],v[92:95],a[224:227],a[12:15]
mm a[12:15],v[124:127],a[128:131],a[12:15]
mm v[144:147],v[64:67],a[228:231],v[144:147]
buffer_load_dwordx4 a[224:227], v2, s[8:11], s36 offen offset:0 sc1
mm v[144:147],v[96:99],a[132:135],v[144:147]
rt v[64:65],v48,8192
rt v[66:67],v48,12288
rt v[96:97],v48,16384
mm v[148:151],v[68:71],a[228:231],v[148:151]
rt v[98:99],v48,20480
mm v[148:151],v[100:103],a[132:135],v[148:151]
buffer_load_dwordx4 a[128:131], v2, s[8:11], s36 offen offset:1024 sc1
rt v[68:69],v49,8192
rt v[70:71],v49,12288
rt v[100:101],v49,16384
mm v[152:155],v[72:75],a[228:231],v[152:155]
rt v[102:103],v49,20480
mm v[152:155],v[104:107],a[132:135],v[152:155]
rt v[72:73],v50,8192
rt v[74:75],v50,12288
rt v[104:105],v50,16384
mm v[156:159],v[76:79],a[228:231],v[156:159]
rt v[106:107],v50,20480
mm v[156:159],v[108:111],a[132:135],v[156:159]
rt v[76:77],v51,8192
rt v[78:79],v51,12288
rt v[108:109],v51,16384
mm a[16:19],v[80:83],a[228:231],a[16:19]
rt v[110:111],v51,20480
mm a[16:19],v[112:115],a[132:135],a[16:19]
rt v[80:81],v52,8192
rt v[82:83],v52,12288
rt v[112:113],v52,16384
mm a[20:23],v[84:87],a[228:231],a[20:23]
rt v[114:115],v52,20480
mm a[20:23],v[116:119],a[132:135],a[20:23]
rt v[84:85],v53,8192
rt v[86:87],v53,12288
rt v[116:117],v53,16384
mm a[24:27],v[88:91],a[228:231],a[24:27]
rt v[118:119],v53,20480
mm a[24:27],v[120:123],a[132:135],a[24:27]
rt v[88:89],v54,8192
rt v[90:91],v54,12288
rt v[120:121],v54,16384
mm a[28:31],v[92:95],a[228:231],a[28:31]
rt v[122:123],v54,20480
mm a[28:31],v[124:127],a[132:135],a[28:31]
buffer_load_dwordx4 a[228:231], v3, s[8:11], s36 offen offset:0 sc1
buffer_load_dwordx4 a[132:135], v3, s[8:11], s36 offen offset:1024 sc1
rt v[92:93],v55,8192
rt v[94:95],v55,12288
rt v[124:125],v55,16384
rt v[126:127],v55,20480
s_add_u32 s36, s36, 2048
s_waitcnt vmcnt(32) lgkmcnt(12)
mm v[160:163],v[64:67],a[168:171],v[160:163]
mm v[160:163],v[96:99],a[200:203],v[160:163]
mm v[164:167],v[68:71],a[168:171],v[164:167]
mm v[164:167],v[100:103],a[200:203],v[164:167]
mm v[168:171],v[72:75],a[168:171],v[168:171]
mm v[168:171],v[104:107],a[200:203],v[168:171]
mm v[172:175],v[76:79],a[168:171],v[172:175]
mm v[172:175],v[108:111],a[200:203],v[172:175]
s_waitcnt lgkmcnt(0)
mm a[32:35],v[80:83],a[168:171],a[32:35]
mm a[32:35],v[112:115],a[200:203],a[32:35]
s_add_u32 m0, s38, 8192
mm a[36:39],v[84:87],a[168:171],a[36:39]
mm a[36:39],v[116:119],a[200:203],a[36:39]
mm a[40:43],v[88:91],a[168:171],a[40:43]
buffer_load_dwordx4 v10, s[12:15], s37 offen offset:0 lds
mm a[40:43],v[120:123],a[200:203],a[40:43]
mm a[44:47],v[92:95],a[168:171],a[44:47]
mm a[44:47],v[124:127],a[200:203],a[44:47]
buffer_load_dwordx4 v11, s[12:15], s37 offen offset:1024 lds
mm v[176:179],v[64:67],a[172:175],v[176:179]
mm v[176:179],v[96:99],a[204:207],v[176:179]
mm v[180:183],v[68:71],a[172:175],v[180:183]
mm v[180:183],v[100:103],a[204:207],v[180:183]
buffer_load_dwordx4 v12, s[12:15], s37 offen offset:2048 lds
mm v[184:187],v[72:75],a[172:175],v[184:187]
mm v[184:187],v[104:107],a[204:207],v[184:187]
mm v[188:191],v[76:79],a[172:175],v[188:191]
buffer_load_dwordx4 a[168:171], v4, s[8:11], s36 offen offset:0 sc1
mm v[188:191],v[108:111],a[204:207],v[188:191]
mm a[48:51],v[80:83],a[172:175],a[48:51]
mm a[48:51],v[112:115],a[204:207],a[48:51]
buffer_load_dwordx4 a[200:203], v4, s[8:11], s36 offen offset:1024 sc1
mm a[52:55],v[84:87],a[172:175],a[52:55]
mm a[52:55],v[116:119],a[204:207],a[52:55]
mm a[56:59],v[88:91],a[172:175],a[56:59]
mm a[56:59],v[120:123],a[204:207],a[56:59]
buffer_load_dwordx4 v13, s[12:15], s37 offen offset:3072 lds
s_add_u32 s37, s37, 65536
mm a[60:63],v[92:95],a[172:175],a[60:63]
s_add_u32 m0, s38, 12288
mm a[60:63],v[124:127],a[204:207],a[60:63]
mm v[192:195],v[64:67],a[176:179],v[192:195]
mm v[192:195],v[96:99],a[208:211],v[192:195]
buffer_load_dwordx4 v10, s[12:15], s39 offen offset:0 lds
mm v[196:199],v[68:71],a[176:179],v[196:199]
mm v[196:199],v[100:103],a[208:211],v[196:199]
mm v[200:203],v[72:75],a[176:179],v[200:203]
mm v[200:203],v[104:107],a[208:211],v[200:203]
buffer_load_dwordx4 a[172:175], v5, s[8:11], s36 offen offset:0 sc1
mm v[204:207],v[76:79],a[176:179],v[204:207]
mm v[204:207],v[108:111],a[208:211],v[204:207]
mm a[64:67],v[80:83],a[176:179],a[64:67]
buffer_load_dwordx4 a[204:207], v5, s[8:11], s36 offen offset:1024 sc1
mm a[64:67],v[112:115],a[208:211],a[64:67]
mm a[68:71],v[84:87],a[176:179],a[68:71]
mm a[68:71],v[116:119],a[208:211],a[68:71]
buffer_load_dwordx4 v11, s[12:15], s39 offen offset:1024 lds
mm a[72:75],v[88:91],a[176:179],a[72:75]
mm a[72:75],v[120:123],a[208:211],a[72:75]
mm a[76:79],v[92:95],a[176:179],a[76:79]
mm a[76:79],v[124:127],a[208:211],a[76:79]
buffer_load_dwordx4 v12, s[12:15], s39 offen offset:2048 lds
mm v[208:211],v[64:67],a[180:183],v[208:211]
mm v[208:211],v[96:99],a[212:215],v[208:211]
mm v[212:215],v[68:71],a[180:183],v[212:215]
buffer_load_dwordx4 v13, s[12:15], s39 offen offset:3072 lds
mm v[212:215],v[100:103],a[212:215],v[212:215]
s_add_u32 s39, s39, 65536
mm v[216:219],v[72:75],a[180:183],v[216:219]
mm v[216:219],v[104:107],a[212:215],v[216:219]
mm v[220:223],v[76:79],a[180:183],v[220:223]
buffer_load_dwordx4 a[176:179], v6, s[8:11], s36 offen offset:0 sc1
mm v[220:223],v[108:111],a[212:215],v[220:223]
mm a[80:83],v[80:83],a[180:183],a[80:83]
mm a[80:83],v[112:115],a[212:215],a[80:83]
mm a[84:87],v[84:87],a[180:183],a[84:87]
buffer_load_dwordx4 a[208:211], v6, s[8:11], s36 offen offset:1024 sc1
s_add_u32 m0, s38, 16384
mm a[84:87],v[116:119],a[212:215],a[84:87]
mm a[88:91],v[88:91],a[180:183],a[88:91]
mm a[88:91],v[120:123],a[212:215],a[88:91]
buffer_load_dwordx4 v10, s[12:15], s37 offen offset:0 lds
mm a[92:95],v[92:95],a[180:183],a[92:95]
mm a[92:95],v[124:127],a[212:215],a[92:95]
mm v[224:227],v[64:67],a[184:187],v[224:227]
mm v[224:227],v[96:99],a[216:219],v[224:227]
buffer_load_dwordx4 v11, s[12:15], s37 offen offset:1024 lds
mm v[228:231],v[68:71],a[184:187],v[228:231]
mm v[228:231],v[100:103],a[216:219],v[228:231]
mm v[232:235],v[72:75],a[184:187],v[232:235]
buffer_load_dwordx4 v12, s[12:15], s37 offen offset:2048 lds
mm v[232:235],v[104:107],a[216:219],v[232:235]
mm v[236:239],v[76:79],a[184:187],v[236:239]
mm v[236:239],v[108:111],a[216:219],v[236:239]
mm a[96:99],v[80:83],a[184:187],a[96:99]
buffer_load_dwordx4 a[180:183], v7, s[8:11], s36 offen offset:0 sc1
mm a[96:99],v[112:115],a[216:219],a[96:99]
mm a[100:103],v[84:87],a[184:187],a[100:103]
mm a[100:103],v[116:119],a[216:219],a[100:103]
buffer_load_dwordx4 a[212:215], v7, s[8:11], s36 offen offset:1024 sc1
mm a[104:107],v[88:91],a[184:187],a[104:107]
mm a[104:107],v[120:123],a[216:219],a[104:107]
mm a[108:111],v[92:95],a[184:187],a[108:111]
mm a[108:111],v[124:127],a[216:219],a[108:111]
buffer_load_dwordx4 v13, s[12:15], s37 offen offset:3072 lds
s_add_u32 s37, s37, 65536
mm v[240:243],v[64:67],a[188:191],v[240:243]
s_add_u32 m0, s38, 20480
mm v[240:243],v[96:99],a[220:223],v[240:243]
mm v[244:247],v[68:71],a[188:191],v[244:247]
mm v[244:247],v[100:103],a[220:223],v[244:247]
buffer_load_dwordx4 v10, s[12:15], s39 offen offset:0 lds
mm v[248:251],v[72:75],a[188:191],v[248:251]
mm v[248:251],v[104:107],a[220:223],v[248:251]
mm v[252:255],v[76:79],a[188:191],v[252:255]
buffer_load_dwordx4 a[184:187], v8, s[8:11], s36 offen offset:0 sc1
mm v[252:255],v[108:111],a[220:223],v[252:255]
mm a[112:115],v[80:83],a[188:191],a[112:115]
mm a[112:115],v[112:115],a[220:223],a[112:115]
mm a[116:119],v[84:87],a[188:191],a[116:119]
buffer_load_dwordx4 a[216:219], v8, s[8:11], s36 offen offset:1024 sc1
mm a[116:119],v[116:119],a[220:223],a[116:119]
mm a[120:123],v[88:91],a[188:191],a[120:123]
mm a[120:123],v[120:123],a[220:223],a[120:123]
buffer_load_dwordx4 v11, s[12:15], s39 offen offset:1024 lds
mm a[124:127],v[92:95],a[188:191],a[124:127]
mm a[124:127],v[124:127],a[220:223],a[124:127]
mm v[128:131],v[64:67],a[160:163],v[128:131]
mm v[128:131],v[96:99],a[192:195],v[128:131]
buffer_load_dwordx4 v12, s[12:15], s39 offen offset:2048 lds
mm v[132:135],v[68:71],a[160:163],v[132:135]
mm v[132:135],v[100:103],a[192:195],v[132:135]
mm v[136:139],v[72:75],a[160:163],v[136:139]
buffer_load_dwordx4 v13, s[12:15], s39 offen offset:3072 lds
s_add_u32 s39, s39, 65536
mm v[136:139],v[104:107],a[192:195],v[136:139]
mm v[140:143],v[76:79],a[160:163],v[140:143]
mm v[140:143],v[108:111],a[192:195],v[140:143]
mm a[0:3],v[80:83],a[160:163],a[0:3]
buffer_load_dwordx4 a[188:191], v9, s[8:11], s36 offen offset:0 sc1
mm a[0:3],v[112:115],a[192:195],a[0:3]
mm a[4:7],v[84:87],a[160:163],a[4:7]
buffer_load_dwordx4 a[220:223], v9, s[8:11], s36 offen offset:1024 sc1
mm a[4:7],v[116:119],a[192:195],a[4:7]
s_waitcnt vmcnt(34)
mm a[8:11],v[88:91],a[160:163],a[8:11]
mm a[8:11],v[120:123],a[192:195],a[8:11]
mm a[12:15],v[92:95],a[160:163],a[12:15]
mm a[12:15],v[124:127],a[192:195],a[12:15]
mm v[144:147],v[64:67],a[164:167],v[144:147]
buffer_load_dwordx4 a[160:163], v2, s[8:11], s36 offen offset:0 sc1
mm v[144:147],v[96:99],a[196:199],v[144:147]
rt v[64:65],v48,24576
rt v[66:67],v48,28672
rt v[96:97],v48,0
mm v[148:151],v[68:71],a[164:167],v[148:151]
rt v[98:99],v48,4096
mm v[148:151],v[100:103],a[196:199],v[148:151]
buffer_load_dwordx4 a[192:195], v2, s[8:11], s36 offen offset:1024 sc1
rt v[68:69],v49,24576
rt v[70:71],v49,28672
rt v[100:101],v49,0
mm v[152:155],v[72:75],a[164:167],v[152:155]
rt v[102:103],v49,4096
mm v[152:155],v[104:107],a[196:199],v[152:155]
rt v[72:73],v50,24576
rt v[74:75],v50,28672
rt v[104:105],v50,0
mm v[156:159],v[76:79],a[164:167],v[156:159]
rt v[106:107],v50,4096
mm v[156:159],v[108:111],a[196:199],v[156:159]
rt v[76:77],v51,24576
rt v[78:79],v51,28672
rt v[108:109],v51,0
mm a[16:19],v[80:83],a[164:167],a[16:19]
rt v[110:111],v51,4096
mm a[16:19],v[112:115],a[196:199],a[16:19]
rt v[80:81],v52,24576
rt v[82:83],v52,28672
rt v[112:113],v52,0
mm a[20:23],v[84:87],a[164:167],a[20:23]
rt v[114:115],v52,4096
mm a[20:23],v[116:119],a[196:199],a[20:23]
rt v[84:85],v53,24576
rt v[86:87],v53,28672
rt v[116:117],v53,0
mm a[24:27],v[88:91],a[164:167],a[24:27]
rt v[118:119],v53,4096
mm a[24:27],v[120:123],a[196:199],a[24:27]
rt v[88:89],v54,24576
rt v[90:91],v54,28672
rt v[120:121],v54,0
mm a[28:31],v[92:95],a[164:167],a[28:31]
rt v[122:123],v54,4096
mm a[28:31],v[124:127],a[196:199],a[28:31]
buffer_load_dwordx4 a[164:167], v3, s[8:11], s36 offen offset:0 sc1
buffer_load_dwordx4 a[196:199], v3, s[8:11], s36 offen offset:1024 sc1
rt v[92:93],v55,24576
rt v[94:95],v55,28672
rt v[124:125],v55,0
rt v[126:127],v55,4096
s_add_u32 s36, s36, 2048
s_waitcnt vmcnt(32) lgkmcnt(12)
mm v[160:163],v[64:67],a[232:235],v[160:163]
mm v[160:163],v[96:99],a[136:139],v[160:163]
mm v[164:167],v[68:71],a[232:235],v[164:167]
mm v[164:167],v[100:103],a[136:139],v[164:167]
mm v[168:171],v[72:75],a[232:235],v[168:171]
mm v[168:171],v[104:107],a[136:139],v[168:171]
mm v[172:175],v[76:79],a[232:235],v[172:175]
mm v[172:175],v[108:111],a[136:139],v[172:175]
s_waitcnt lgkmcnt(0)
mm a[32:35],v[80:83],a[232:235],a[32:35]
mm a[32:35],v[112:115],a[136:139],a[32:35]
s_add_u32 m0, s38, 24576
mm a[36:39],v[84:87],a[232:235],a[36:39]
mm a[36:39],v[116:119],a[136:139],a[36:39]
mm a[40:43],v[88:91],a[232:235],a[40:43]
buffer_load_dwordx4 v10, s[12:15], s37 offen offset:0 lds
mm a[40:43],v[120:123],a[136:139],a[40:43]
mm a[44:47],v[92:95],a[232:235],a[44:47]
mm a[44:47],v[124:127],a[136:139],a[44:47]
buffer_load_dwordx4 v11, s[12:15], s37 offen offset:1024 lds
mm v[176:179],v[64:67],a[236:239],v[176:179]
mm v[176:179],v[96:99],a[140:143],v[176:179]
mm v[180:183],v[68:71],a[236:239],v[180:183]
mm v[180:183],v[100:103],a[140:143],v[180:183]
buffer_load_dwordx4 v12, s[12:15], s37 offen offset:2048 lds
mm v[184:187],v[72:75],a[236:239],v[184:187]
mm v[184:187],v[104:107],a[140:143],v[184:187]
mm v[188:191],v[76:79],a[236:239],v[188:191]
buffer_load_dwordx4 a[232:235], v4, s[8:11], s36 offen offset:0 sc1
mm v[188:191],v[108:111],a[140:143],v[188:191]
mm a[48:51],v[80:83],a[236:239],a[48:51]
mm a[48:51],v[112:115],a[140:143],a[48:51]
buffer_load_dwordx4 v13, s[12:15], s37 offen offset:3072 lds
mm a[52:55],v[84:87],a[236:239],a[52:55]
s_add_u32 s37, s37, 65536
s_add_u32 m0, s38, 28672
mm a[52:55],v[116:119],a[140:143],a[52:55]
mm a[56:59],v[88:91],a[236:239],a[56:59]
mm a[56:59],v[120:123],a[140:143],a[56:59]
mm a[60:63],v[92:95],a[236:239],a[60:63]
buffer_load_dwordx4 v10, s[12:15], s39 offen offset:0 lds
mm a[60:63],v[124:127],a[140:143],a[60:63]
mm v[192:195],v[64:67],a[240:243],v[192:195]
mm v[192:195],v[96:99],a[144:147],v[192:195]
buffer_load_dwordx4 a[236:239], v5, s[8:11], s36 offen offset:0 sc1
mm v[196:199],v[68:71],a[240:243],v[196:199]
mm v[196:199],v[100:103],a[144:147],v[196:199]
mm v[200:203],v[72:75],a[240:243],v[200:203]
mm v[200:203],v[104:107],a[144:147],v[200:203]
buffer_load_dwordx4 v11, s[12:15], s39 offen offset:1024 lds
mm v[204:207],v[76:79],a[240:243],v[204:207]
mm v[204:207],v[108:111],a[144:147],v[204:207]
mm a[64:67],v[80:83],a[240:243],a[64:67]
buffer_load_dwordx4 v12, s[12:15], s39 offen offset:2048 lds
mm a[64:67],v[112:115],a[144:147],a[64:67]
mm a[68:71],v[84:87],a[240:243],a[68:71]
mm a[68:71],v[116:119],a[144:147],a[68:71]
buffer_load_dwordx4 v13, s[12:15], s39 offen offset:3072 lds
mm a[72:75],v[88:91],a[240:243],a[72:75]
s_add_u32 s39, s39, 65536
mm a[72:75],v[120:123],a[144:147],a[72:75]
mm a[76:79],v[92:95],a[240:243],a[76:79]
mm a[76:79],v[124:127],a[144:147],a[76:79]
mm v[208:211],v[64:67],a[244:247],v[208:211]
buffer_load_dwordx4 a[240:243], v6, s[8:11], s36 offen offset:0 sc1
mm v[208:211],v[96:99],a[148:151],v[208:211]
mm v[212:215],v[68:71],a[244:247],v[212:215]
mm v[212:215],v[100:103],a[148:151],v[212:215]
mm v[216:219],v[72:75],a[244:247],v[216:219]
mm v[216:219],v[104:107],a[148:151],v[216:219]
mm v[220:223],v[76:79],a[244:247],v[220:223]
mm v[220:223],v[108:111],a[148:151],v[220:223]
mm a[80:83],v[80:83],a[244:247],a[80:83]
mm a[80:83],v[112:115],a[148:151],a[80:83]
mm a[84:87],v[84:87],a[244:247],a[84:87]
mm a[84:87],v[116:119],a[148:151],a[84:87]
mm a[88:91],v[88:91],a[244:247],a[88:91]
mm a[88:91],v[120:123],a[148:151],a[88:91]
mm a[92:95],v[92:95],a[244:247],a[92:95]
mm a[92:95],v[124:127],a[148:151],a[92:95]
mm v[224:227],v[64:67],a[248:251],v[224:227]
buffer_load_dwordx4 a[244:247], v7, s[8:11], s36 offen offset:0 sc1
mm v[224:227],v[96:99],a[152:155],v[224:227]
mm v[228:231],v[68:71],a[248:251],v[228:231]
mm v[228:231],v[100:103],a[152:155],v[228:231]
mm v[232:235],v[72:75],a[248:251],v[232:235]
mm v[232:235],v[104:107],a[152:155],v[232:235]
mm v[236:239],v[76:79],a[248:251],v[236:239]
mm v[236:239],v[108:111],a[152:155],v[236:239]
mm a[96:99],v[80:83],a[248:251],a[96:99]
mm a[96:99],v[112:115],a[152:155],a[96:99]
mm a[100:103],v[84:87],a[248:251],a[100:103]
mm a[100:103],v[116:119],a[152:155],a[100:103]
mm a[104:107],v[88:91],a[248:251],a[104:107]
mm a[104:107],v[120:123],a[152:155],a[104:107]
mm a[108:111],v[92:95],a[248:251],a[108:111]
mm a[108:111],v[124:127],a[152:155],a[108:111]
mm v[240:243],v[64:67],a[252:255],v[240:243]
buffer_load_dwordx4 a[248:251], v8, s[8:11], s36 offen offset:0 sc1
mm v[240:243],v[96:99],a[156:159],v[240:243]
mm v[244:247],v[68:71],a[252:255],v[244:247]
mm v[244:247],v[100:103],a[156:159],v[244:247]
mm v[248:251],v[72:75],a[252:255],v[248:251]
mm v[248:251],v[104:107],a[156:159],v[248:251]
mm v[252:255],v[76:79],a[252:255],v[252:255]
mm v[252:255],v[108:111],a[156:159],v[252:255]
mm a[112:115],v[80:83],a[252:255],a[112:115]
mm a[112:115],v[112:115],a[156:159],a[112:115]
mm a[116:119],v[84:87],a[252:255],a[116:119]
mm a[116:119],v[116:119],a[156:159],a[116:119]
mm a[120:123],v[88:91],a[252:255],a[120:123]
mm a[120:123],v[120:123],a[156:159],a[120:123]
mm a[124:127],v[92:95],a[252:255],a[124:127]
mm a[124:127],v[124:127],a[156:159],a[124:127]
mm v[128:131],v[64:67],a[224:227],v[128:131]
buffer_load_dwordx4 a[252:255], v9, s[8:11], s36 offen offset:0 sc1
mm v[128:131],v[96:99],a[128:131],v[128:131]
mm v[132:135],v[68:71],a[224:227],v[132:135]
mm v[132:135],v[100:103],a[128:131],v[132:135]
mm v[136:139],v[72:75],a[224:227],v[136:139]
mm v[136:139],v[104:107],a[128:131],v[136:139]
mm v[140:143],v[76:79],a[224:227],v[140:143]
mm v[140:143],v[108:111],a[128:131],v[140:143]
mm a[0:3],v[80:83],a[224:227],a[0:3]
mm a[0:3],v[112:115],a[128:131],a[0:3]
mm a[4:7],v[84:87],a[224:227],a[4:7]
mm a[4:7],v[116:119],a[128:131],a[4:7]
s_waitcnt vmcnt(4)
mm a[8:11],v[88:91],a[224:227],a[8:11]
rt v[32:33],v52,24576
rt v[34:35],v52,28672
mm a[8:11],v[120:123],a[128:131],a[8:11]
rt v[36:37],v53,24576
mm a[12:15],v[92:95],a[224:227],a[12:15]
rt v[38:39],v53,28672
rt v[40:41],v54,24576
mm a[12:15],v[124:127],a[128:131],a[12:15]
rt v[42:43],v54,28672
mm v[144:147],v[64:67],a[228:231],v[144:147]
buffer_load_dwordx4 a[224:227], v2, s[8:11], s36 offen offset:0 sc1
rt v[44:45],v55,24576
mm v[144:147],v[96:99],a[132:135],v[144:147]
rt v[46:47],v55,28672
rt v[64:65],v48,8192
rt v[66:67],v48,12288
rt v[96:97],v48,16384
mm v[148:151],v[68:71],a[228:231],v[148:151]
rt v[98:99],v48,20480
mm v[148:151],v[100:103],a[132:135],v[148:151]
rt v[68:69],v49,8192
rt v[70:71],v49,12288
rt v[100:101],v49,16384
mm v[152:155],v[72:75],a[228:231],v[152:155]
rt v[102:103],v49,20480
mm v[152:155],v[104:107],a[132:135],v[152:155]
rt v[72:73],v50,8192
rt v[74:75],v50,12288
rt v[104:105],v50,16384
mm v[156:159],v[76:79],a[228:231],v[156:159]
rt v[106:107],v50,20480
mm v[156:159],v[108:111],a[132:135],v[156:159]
rt v[76:77],v51,8192
rt v[78:79],v51,12288
rt v[108:109],v51,16384
mm a[16:19],v[80:83],a[228:231],a[16:19]
rt v[110:111],v51,20480
mm a[16:19],v[112:115],a[132:135],a[16:19]
rt v[80:81],v52,8192
rt v[82:83],v52,12288
rt v[112:113],v52,16384
mm a[20:23],v[84:87],a[228:231],a[20:23]
rt v[114:115],v52,20480
mm a[20:23],v[116:119],a[132:135],a[20:23]
rt v[84:85],v53,8192
rt v[86:87],v53,12288
rt v[116:117],v53,16384
mm a[24:27],v[88:91],a[228:231],a[24:27]
rt v[118:119],v53,20480
mm a[24:27],v[120:123],a[132:135],a[24:27]
rt v[88:89],v54,8192
rt v[90:91],v54,12288
rt v[120:121],v54,16384
mm a[28:31],v[92:95],a[228:231],a[28:31]
rt v[122:123],v54,20480
mm a[28:31],v[124:127],a[132:135],a[28:31]
buffer_load_dwordx4 a[228:231], v3, s[8:11], s36 offen offset:0 sc1
rt v[92:93],v55,8192
rt v[94:95],v55,12288
rt v[124:125],v55,16384
rt v[126:127],v55,20480
s_add_u32 s36, s36, 2048
s_waitcnt vmcnt(9) lgkmcnt(0)
mm a[32:35],v[80:83],a[168:171],a[32:35]
rt v[2:3],v48,24576
mm a[32:35],v[112:115],a[200:203],a[32:35]
v_and_b32 v30, 15, v0
v_lshlrev_b32 v30, 11, v30
mm a[32:35],v[32:35],a[232:235],a[32:35]
v_lshrrev_b32 v31, 4, v0
mm a[36:39],v[84:87],a[168:171],a[36:39]
v_lshl_add_u32 v30, v31, 3, v30
rt v[4:5],v48,28672
mm a[36:39],v[116:119],a[200:203],a[36:39]
s_lshl_b32 s4, s34, 2
mm a[36:39],v[36:39],a[232:235],a[36:39]
s_add_u32 s4, s4, s3
s_lshl_b32 s4, s4, 16
mm a[40:43],v[88:91],a[168:171],a[40:43]
s_lshl_b32 s5, s35, 7
rt v[6:7],v49,24576
mm a[40:43],v[120:123],a[200:203],a[40:43]
s_add_u32 s4, s4, s5
mm a[40:43],v[40:43],a[232:235],a[40:43]
buffer_load_dwordx2 a[128:129], v30, s[16:19], s4 offen offset:0
mm a[44:47],v[92:95],a[168:171],a[44:47]
buffer_load_dwordx2 a[130:131], v30, s[16:19], s4 offen offset:32
mm a[44:47],v[124:127],a[200:203],a[44:47]
rt v[8:9],v49,28672
rt v[10:11],v50,24576
rt v[12:13],v50,28672
rt v[14:15],v51,24576
rt v[16:17],v51,28672
mm a[44:47],v[44:47],a[232:235],a[44:47]
mm a[48:51],v[80:83],a[172:175],a[48:51]
mm a[48:51],v[112:115],a[204:207],a[48:51]
buffer_load_dwordx2 a[132:133], v30, s[16:19], s4 offen offset:64
mm a[48:51],v[32:35],a[236:239],a[48:51]
mm a[52:55],v[84:87],a[172:175],a[52:55]
buffer_load_dwordx2 a[134:135], v30, s[16:19], s4 offen offset:96
mm a[52:55],v[116:119],a[204:207],a[52:55]
s_add_u32 s4, s4, 32768
buffer_load_dwordx2 a[136:137], v30, s[16:19], s4 offen offset:0
mm a[52:55],v[36:39],a[236:239],a[52:55]
mm a[56:59],v[88:91],a[172:175],a[56:59]
buffer_load_dwordx2 a[138:139], v30, s[16:19], s4 offen offset:32
mm a[56:59],v[120:123],a[204:207],a[56:59]
buffer_load_dwordx2 a[140:141], v30, s[16:19], s4 offen offset:64
mm a[56:59],v[40:43],a[236:239],a[56:59]
buffer_load_dwordx2 a[142:143], v30, s[16:19], s4 offen offset:96
mm a[60:63],v[92:95],a[172:175],a[60:63]
s_add_u32 s6, s3, 1
mm a[60:63],v[124:127],a[204:207],a[60:63]
s_and_b32 s6, s6, 3
s_mul_i32 s6, s6, 24576
s_add_u32 s6, s6, 0
v_add_u32 v19, s6, v1
s_add_u32 s6, s3, 2
s_and_b32 s6, s6, 3
s_mul_i32 s6, s6, 24576
s_add_u32 s6, s6, 8192
v_add_u32 v28, s6, v1
s_add_u32 s6, s3, 3
s_and_b32 s6, s6, 3
s_mul_i32 s6, s6, 24576
s_add_u32 s6, s6, 16384
v_add_u32 v29, s6, v1
s_mul_i32 s6, s3, 24576
v_add_u32 v18, s6, v1
s_add_u32 s6, s3, 1
s_and_b32 s6, s6, 3
s_lshl_b32 s6, s6, 14
s_add_u32 s6, s6, 98304
v_add_u32 v21, s6, v1
s_add_u32 s6, s3, 2
s_and_b32 s6, s6, 3
s_lshl_b32 s6, s6, 14
s_add_u32 s6, s6, 106496
v_add_u32 v22, s6, v1
s_add_u32 s6, s3, 0
s_and_b32 s6, s6, 3
s_lshl_b32 s6, s6, 14
s_add_u32 s6, s6, 98304
v_add_u32 v20, s6, v1
s_add_u32 s8, s86, 83886080
s_addc_u32 s9, s87, 0
s_and_b32 s9, s9, 0xffff
s_mov_b32 s10, 8388608
s_mov_b32 s11, 0x20000
s_xor_b32 s6, s2, 1
s_lshl_b32 s36, s6, 2
s_add_u32 s36, s36, s3
s_lshl_b32 s36, s36, 13
s_lshr_b32 s37, s36, 6
s_add_u32 s37, s37, 32768
mm a[60:63],v[44:47],a[236:239],a[60:63]
s_waitcnt vmcnt(12)
s_waitcnt lgkmcnt(0)
s_barrier
mm a[64:67],v[80:83],a[176:179],a[64:67]
mm a[64:67],v[112:115],a[208:211],a[64:67]
ds_write_b128 v19, a[32:35] offset:0
mm a[64:67],v[32:35],a[240:243],a[64:67]
mm a[68:71],v[84:87],a[176:179],a[68:71]
mm a[68:71],v[116:119],a[208:211],a[68:71]
ds_write_b128 v19, a[36:39] offset:1024
mm a[68:71],v[36:39],a[240:243],a[68:71]
mm a[72:75],v[88:91],a[176:179],a[72:75]
mm a[72:75],v[120:123],a[208:211],a[72:75]
ds_write_b128 v19, a[40:43] offset:2048
mm a[72:75],v[40:43],a[240:243],a[72:75]
mm a[76:79],v[92:95],a[176:179],a[76:79]
mm a[76:79],v[124:127],a[208:211],a[76:79]
ds_write_b128 v19, a[44:47] offset:3072
mm a[76:79],v[44:47],a[240:243],a[76:79]
mm a[80:83],v[80:83],a[180:183],a[80:83]
mm a[80:83],v[112:115],a[212:215],a[80:83]
ds_write_b128 v19, a[48:51] offset:4096
mm a[80:83],v[32:35],a[244:247],a[80:83]
mm a[84:87],v[84:87],a[180:183],a[84:87]
mm a[84:87],v[116:119],a[212:215],a[84:87]
ds_write_b128 v19, a[52:55] offset:5120
mm a[84:87],v[36:39],a[244:247],a[84:87]
mm a[88:91],v[88:91],a[180:183],a[88:91]
mm a[88:91],v[120:123],a[212:215],a[88:91]
mm a[88:91],v[40:43],a[244:247],a[88:91]
ds_write_b128 v19, a[56:59] offset:6144
mm a[92:95],v[92:95],a[180:183],a[92:95]
mm a[92:95],v[124:127],a[212:215],a[92:95]
mm a[92:95],v[44:47],a[244:247],a[92:95]
ds_write_b128 v19, a[60:63] offset:7168
s_waitcnt vmcnt(10)
mm a[96:99],v[80:83],a[184:187],a[96:99]
mm a[96:99],v[112:115],a[216:219],a[96:99]
mm a[96:99],v[32:35],a[248:251],a[96:99]
ds_write_b128 v28, a[64:67] offset:0
mm a[100:103],v[84:87],a[184:187],a[100:103]
mm a[100:103],v[116:119],a[216:219],a[100:103]
mm a[100:103],v[36:39],a[248:251],a[100:103]
ds_write_b128 v28, a[68:71] offset:1024
mm a[104:107],v[88:91],a[184:187],a[104:107]
mm a[104:107],v[120:123],a[216:219],a[104:107]
mm a[104:107],v[40:43],a[248:251],a[104:107]
ds_write_b128 v28, a[72:75] offset:2048
mm a[108:111],v[92:95],a[184:187],a[108:111]
mm a[108:111],v[124:127],a[216:219],a[108:111]
mm a[108:111],v[44:47],a[248:251],a[108:111]
ds_write_b128 v28, a[76:79] offset:3072
mm a[112:115],v[80:83],a[188:191],a[112:115]
mm a[112:115],v[112:115],a[220:223],a[112:115]
mm a[112:115],v[32:35],a[252:255],a[112:115]
mm a[116:119],v[84:87],a[188:191],a[116:119]
ds_write_b128 v28, a[80:83] offset:4096
mm a[116:119],v[116:119],a[220:223],a[116:119]
mm a[116:119],v[36:39],a[252:255],a[116:119]
mm a[120:123],v[88:91],a[188:191],a[120:123]
ds_write_b128 v28, a[84:87] offset:5120
mm a[120:123],v[120:123],a[220:223],a[120:123]
mm a[120:123],v[40:43],a[252:255],a[120:123]
mm a[124:127],v[92:95],a[188:191],a[124:127]
ds_write_b128 v28, a[88:91] offset:6144
mm a[124:127],v[124:127],a[220:223],a[124:127]
mm a[124:127],v[44:47],a[252:255],a[124:127]
s_waitcnt vmcnt(8)
mm a[0:3],v[80:83],a[160:163],a[0:3]
ds_write_b128 v28, a[92:95] offset:7168
mm a[0:3],v[112:115],a[192:195],a[0:3]
mm a[0:3],v[32:35],a[224:227],a[0:3]
mm a[4:7],v[84:87],a[160:163],a[4:7]
ds_write_b128 v29, a[96:99] offset:0
mm a[4:7],v[116:119],a[192:195],a[4:7]
mm a[4:7],v[36:39],a[224:227],a[4:7]
mm a[8:11],v[88:91],a[160:163],a[8:11]
ds_write_b128 v29, a[100:103] offset:1024
mm a[8:11],v[120:123],a[192:195],a[8:11]
mm a[8:11],v[40:43],a[224:227],a[8:11]
mm a[12:15],v[92:95],a[160:163],a[12:15]
mm a[12:15],v[124:127],a[192:195],a[12:15]
ds_write_b128 v29, a[104:107] offset:2048
mm a[12:15],v[44:47],a[224:227],a[12:15]
mm a[16:19],v[80:83],a[164:167],a[16:19]
mm a[16:19],v[112:115],a[196:199],a[16:19]
ds_write_b128 v29, a[108:111] offset:3072
mm a[16:19],v[32:35],a[228:231],a[16:19]
mm a[20:23],v[84:87],a[164:167],a[20:23]
mm a[20:23],v[116:119],a[196:199],a[20:23]
ds_write_b128 v29, a[112:115] offset:4096
mm a[20:23],v[36:39],a[228:231],a[20:23]
mm a[24:27],v[88:91],a[164:167],a[24:27]
mm a[24:27],v[120:123],a[196:199],a[24:27]
ds_write_b128 v29, a[116:119] offset:5120
mm a[24:27],v[40:43],a[228:231],a[24:27]
mm a[28:31],v[92:95],a[164:167],a[28:31]
mm a[28:31],v[124:127],a[196:199],a[28:31]
ds_write_b128 v29, a[120:123] offset:6144
mm a[28:31],v[44:47],a[228:231],a[28:31]
mm v[160:163],v[64:67],a[168:171],v[160:163]
mm v[160:163],v[96:99],a[200:203],v[160:163]
mm v[160:163],v[2:5],a[232:235],v[160:163]
ds_write_b128 v29, a[124:127] offset:7168
mm v[164:167],v[68:71],a[168:171],v[164:167]
mm v[164:167],v[100:103],a[200:203],v[164:167]
mm v[164:167],v[6:9],a[232:235],v[164:167]
mm v[168:171],v[72:75],a[168:171],v[168:171]
mm v[168:171],v[104:107],a[200:203],v[168:171]
s_waitcnt lgkmcnt(0)
s_barrier
mm v[168:171],v[10:13],a[232:235],v[168:171]
ds_read_b128 v[80:83], v18 offset:0
ds_read_b128 v[84:87], v18 offset:1024
ds_read_b128 v[88:91], v18 offset:2048
ds_read_b128 v[92:95], v18 offset:3072
mm v[172:175],v[76:79],a[168:171],v[172:175]
ds_read_b128 v[112:115], v18 offset:4096
ds_read_b128 v[116:119], v18 offset:5120
ds_read_b128 v[120:123], v18 offset:6144
mm v[172:175],v[108:111],a[200:203],v[172:175]
ds_read_b128 v[124:127], v18 offset:7168
ar v32,a0
ar v33,a1
ar v34,a2
mm v[172:175],v[14:17],a[232:235],v[172:175]
ar v35,a3
ar v36,a4
ar v37,a5
mm v[176:179],v[64:67],a[172:175],v[176:179]
ar v38,a6
ar v39,a7
ar v40,a8
ar v41,a9
mm v[176:179],v[96:99],a[204:207],v[176:179]
ar v42,a10
ar v43,a11
ar v44,a12
mm v[176:179],v[2:5],a[236:239],v[176:179]
ar v45,a13
ar v46,a14
ar v47,a15
mm v[180:183],v[68:71],a[172:175],v[180:183]
ar v48,a16
ar v49,a17
ar v50,a18
ar v51,a19
mm v[180:183],v[100:103],a[204:207],v[180:183]
ar v52,a20
ar v53,a21
ar v54,a22
mm v[180:183],v[6:9],a[236:239],v[180:183]
ar v55,a23
ar v56,a24
ar v57,a25
ar v58,a26
mm v[184:187],v[72:75],a[172:175],v[184:187]
ar v59,a27
ar v60,a28
ar v61,a29
mm v[184:187],v[104:107],a[204:207],v[184:187]
ar v62,a30
ar v63,a31
s_waitcnt lgkmcnt(4)
mm v[184:187],v[10:13],a[236:239],v[184:187]
v_add_f32 v32, v32, v80
v_add_f32 v33, v33, v81
v_add_f32 v34, v34, v82
v_add_f32 v35, v35, v83
mm v[188:191],v[76:79],a[172:175],v[188:191]
v_add_f32 v36, v36, v84
v_add_f32 v37, v37, v85
v_add_f32 v38, v38, v86
mm v[188:191],v[108:111],a[204:207],v[188:191]
v_add_f32 v39, v39, v87
v_add_f32 v40, v40, v88
v_add_f32 v41, v41, v89
v_add_f32 v42, v42, v90
mm v[188:191],v[14:17],a[236:239],v[188:191]
v_add_f32 v43, v43, v91
v_add_f32 v44, v44, v92
v_add_f32 v45, v45, v93
mm v[192:195],v[64:67],a[176:179],v[192:195]
v_add_f32 v46, v46, v94
v_add_f32 v47, v47, v95
ds_read_b128 v[80:83], v18 offset:8192
mm v[192:195],v[96:99],a[208:211],v[192:195]
ds_read_b128 v[84:87], v18 offset:9216
ds_read_b128 v[88:91], v18 offset:10240
ds_read_b128 v[92:95], v18 offset:11264
s_waitcnt lgkmcnt(4)
mm v[192:195],v[2:5],a[240:243],v[192:195]
v_add_f32 v48, v48, v112
v_add_f32 v49, v49, v113
v_add_f32 v50, v50, v114
mm v[196:199],v[68:71],a[176:179],v[196:199]
v_add_f32 v51, v51, v115
v_add_f32 v52, v52, v116
v_add_f32 v53, v53, v117
v_add_f32 v54, v54, v118
mm v[196:199],v[100:103],a[208:211],v[196:199]
v_add_f32 v55, v55, v119
v_add_f32 v56, v56, v120
v_add_f32 v57, v57, v121
mm v[196:199],v[6:9],a[240:243],v[196:199]
v_add_f32 v58, v58, v122
v_add_f32 v59, v59, v123
v_add_f32 v60, v60, v124
mm v[200:203],v[72:75],a[176:179],v[200:203]
v_add_f32 v61, v61, v125
v_add_f32 v62, v62, v126
v_add_f32 v63, v63, v127
ds_read_b128 v[112:115], v18 offset:12288
mm v[200:203],v[104:107],a[208:211],v[200:203]
ds_read_b128 v[116:119], v18 offset:13312
ds_read_b128 v[120:123], v18 offset:14336
ds_read_b128 v[124:127], v18 offset:15360
mm v[200:203],v[10:13],a[240:243],v[200:203]
s_waitcnt lgkmcnt(4)
v_add_f32 v32, v32, v80
v_add_f32 v33, v33, v81
v_add_f32 v34, v34, v82
mm v[204:207],v[76:79],a[176:179],v[204:207]
v_add_f32 v35, v35, v83
v_add_f32 v36, v36, v84
v_add_f32 v37, v37, v85
mm v[204:207],v[108:111],a[208:211],v[204:207]
v_add_f32 v38, v38, v86
v_add_f32 v39, v39, v87
v_add_f32 v40, v40, v88
mm v[204:207],v[14:17],a[240:243],v[204:207]
v_add_f32 v41, v41, v89
v_add_f32 v42, v42, v90
v_add_f32 v43, v43, v91
v_add_f32 v44, v44, v92
mm v[208:211],v[64:67],a[180:183],v[208:211]
v_add_f32 v45, v45, v93
v_add_f32 v46, v46, v94
v_add_f32 v47, v47, v95
mm v[208:211],v[96:99],a[212:215],v[208:211]
ds_read_b128 v[80:83], v18 offset:16384
ds_read_b128 v[84:87], v18 offset:17408
ds_read_b128 v[88:91], v18 offset:18432
ds_read_b128 v[92:95], v18 offset:19456
mm v[208:211],v[2:5],a[244:247],v[208:211]
s_waitcnt lgkmcnt(4)
v_add_f32 v48, v48, v112
v_add_f32 v49, v49, v113
mm v[212:215],v[68:71],a[180:183],v[212:215]
v_add_f32 v50, v50, v114
v_add_f32 v51, v51, v115
v_add_f32 v52, v52, v116
mm v[212:215],v[100:103],a[212:215],v[212:215]
v_add_f32 v53, v53, v117
v_add_f32 v54, v54, v118
v_add_f32 v55, v55, v119
v_add_f32 v56, v56, v120
mm v[212:215],v[6:9],a[244:247],v[212:215]
v_add_f32 v57, v57, v121
v_add_f32 v58, v58, v122
v_add_f32 v59, v59, v123
mm v[216:219],v[72:75],a[180:183],v[216:219]
v_add_f32 v60, v60, v124
v_add_f32 v61, v61, v125
v_add_f32 v62, v62, v126
v_add_f32 v63, v63, v127
mm v[216:219],v[104:107],a[212:215],v[216:219]
ds_read_b128 v[112:115], v18 offset:20480
ds_read_b128 v[116:119], v18 offset:21504
ds_read_b128 v[120:123], v18 offset:22528
mm v[216:219],v[10:13],a[244:247],v[216:219]
ds_read_b128 v[124:127], v18 offset:23552
s_waitcnt lgkmcnt(4)
v_add_f32 v32, v32, v80
mm v[220:223],v[76:79],a[180:183],v[220:223]
v_add_f32 v33, v33, v81
v_add_f32 v34, v34, v82
v_add_f32 v35, v35, v83
v_add_f32 v36, v36, v84
mm v[220:223],v[108:111],a[212:215],v[220:223]
v_add_f32 v37, v37, v85
v_add_f32 v38, v38, v86
v_add_f32 v39, v39, v87
mm v[220:223],v[14:17],a[244:247],v[220:223]
v_add_f32 v40, v40, v88
v_add_f32 v41, v41, v89
v_add_f32 v42, v42, v90
v_add_f32 v43, v43, v91
mm v[224:227],v[64:67],a[184:187],v[224:227]
v_add_f32 v44, v44, v92
v_add_f32 v45, v45, v93
v_add_f32 v46, v46, v94
mm v[224:227],v[96:99],a[216:219],v[224:227]
v_add_f32 v47, v47, v95
cv v32,v32,v33
cv v33,v34,v35
mm v[224:227],v[2:5],a[248:251],v[224:227]
cv v34,v36,v37
cv v35,v38,v39
buffer_store_dwordx4 v[32:35], v1, s[8:11], s36 offen offset:0 sc1
cv v40,v40,v41
mm v[228:231],v[68:71],a[184:187],v[228:231]
cv v41,v42,v43
cv v42,v44,v45
cv v43,v46,v47
mm v[228:231],v[100:103],a[216:219],v[228:231]
buffer_store_dwordx4 v[40:43], v1, s[8:11], s36 offen offset:1024 sc1
s_waitcnt lgkmcnt(0)
ds_write_b128 v21, v[160:163] offset:0
v_add_f32 v48, v48, v112
v_add_f32 v49, v49, v113
mm v[228:231],v[6:9],a[248:251],v[228:231]
v_add_f32 v50, v50, v114
v_add_f32 v51, v51, v115
v_add_f32 v52, v52, v116
mm v[232:235],v[72:75],a[184:187],v[232:235]
v_add_f32 v53, v53, v117
v_add_f32 v54, v54, v118
v_add_f32 v55, v55, v119
ds_write_b128 v21, v[164:167] offset:1024
mm v[232:235],v[104:107],a[216:219],v[232:235]
v_add_f32 v56, v56, v120
v_add_f32 v57, v57, v121
v_add_f32 v58, v58, v122
v_add_f32 v59, v59, v123
mm v[232:235],v[10:13],a[248:251],v[232:235]
v_add_f32 v60, v60, v124
v_add_f32 v61, v61, v125
v_add_f32 v62, v62, v126
mm v[236:239],v[76:79],a[184:187],v[236:239]
v_add_f32 v63, v63, v127
cv v48,v48,v49
ds_write_b128 v21, v[168:171] offset:2048
cv v49,v50,v51
cv v50,v52,v53
mm v[236:239],v[108:111],a[216:219],v[236:239]
cv v51,v54,v55
buffer_store_dwordx4 v[48:51], v1, s[8:11], s36 offen offset:2048 sc1
cv v56,v56,v57
mm v[236:239],v[14:17],a[248:251],v[236:239]
cv v57,v58,v59
cv v58,v60,v61
cv v59,v62,v63
mm v[240:243],v[64:67],a[188:191],v[240:243]
buffer_store_dwordx4 v[56:59], v1, s[8:11], s36 offen offset:3072 sc1
ds_write_b128 v21, v[172:175] offset:3072
mm v[240:243],v[96:99],a[220:223],v[240:243]
mm v[240:243],v[2:5],a[252:255],v[240:243]
mm v[244:247],v[68:71],a[188:191],v[244:247]
ds_write_b128 v21, v[176:179] offset:4096
mm v[244:247],v[100:103],a[220:223],v[244:247]
mm v[244:247],v[6:9],a[252:255],v[244:247]
mm v[248:251],v[72:75],a[188:191],v[248:251]
ds_write_b128 v21, v[180:183] offset:5120
mm v[248:251],v[104:107],a[220:223],v[248:251]
mm v[248:251],v[10:13],a[252:255],v[248:251]
ds_write_b128 v21, v[184:187] offset:6144
mm v[252:255],v[76:79],a[188:191],v[252:255]
mm v[252:255],v[108:111],a[220:223],v[252:255]
mm v[252:255],v[14:17],a[252:255],v[252:255]
ds_write_b128 v21, v[188:191] offset:7168
mm v[128:131],v[64:67],a[160:163],v[128:131]
mm v[128:131],v[96:99],a[192:195],v[128:131]
mm v[128:131],v[2:5],a[224:227],v[128:131]
ds_write_b128 v22, v[192:195] offset:0
mm v[132:135],v[68:71],a[160:163],v[132:135]
mm v[132:135],v[100:103],a[192:195],v[132:135]
mm v[132:135],v[6:9],a[224:227],v[132:135]
ds_write_b128 v22, v[196:199] offset:1024
mm v[136:139],v[72:75],a[160:163],v[136:139]
mm v[136:139],v[104:107],a[192:195],v[136:139]
mm v[136:139],v[10:13],a[224:227],v[136:139]
ds_write_b128 v22, v[200:203] offset:2048
mm v[140:143],v[76:79],a[160:163],v[140:143]
mm v[140:143],v[108:111],a[192:195],v[140:143]
ds_write_b128 v22, v[204:207] offset:3072
mm v[140:143],v[14:17],a[224:227],v[140:143]
mm v[144:147],v[64:67],a[164:167],v[144:147]
mm v[144:147],v[96:99],a[196:199],v[144:147]
ds_write_b128 v22, v[208:211] offset:4096
mm v[144:147],v[2:5],a[228:231],v[144:147]
mm v[148:151],v[68:71],a[164:167],v[148:151]
mm v[148:151],v[100:103],a[196:199],v[148:151]
ds_write_b128 v22, v[212:215] offset:5120
mm v[148:151],v[6:9],a[228:231],v[148:151]
mm v[152:155],v[72:75],a[164:167],v[152:155]
mm v[152:155],v[104:107],a[196:199],v[152:155]
ds_write_b128 v22, v[216:219] offset:6144
mm v[152:155],v[10:13],a[228:231],v[152:155]
mm v[156:159],v[76:79],a[164:167],v[156:159]
mm v[156:159],v[108:111],a[196:199],v[156:159]
ds_write_b128 v22, v[220:223] offset:7168
mm v[156:159],v[14:17],a[228:231],v[156:159]
s_barrier
s_waitcnt vmcnt(4)
ar v96,a128
ar v97,a129
ar v98,a130
ar v99,a131
ar v100,a132
ds_write_b128 v29, v[224:227] offset:0
ar v101,a133
ar v102,a134
ar v103,a135
ar v104,a136
ar v105,a137
ds_write_b128 v29, v[228:231] offset:1024
ar v106,a138
ar v107,a139
ar v108,a140
ar v109,a141
ar v110,a142
ds_write_b128 v29, v[232:235] offset:2048
ar v111,a143
v_lshlrev_b32 v64, 16, v96
v_and_b32 v65, 0xffff0000, v96
v_lshlrev_b32 v66, 16, v97
ds_write_b128 v29, v[236:239] offset:3072
v_and_b32 v67, 0xffff0000, v97
v_lshlrev_b32 v68, 16, v98
v_and_b32 v69, 0xffff0000, v98
v_lshlrev_b32 v70, 16, v99
v_and_b32 v71, 0xffff0000, v99
ds_write_b128 v29, v[240:243] offset:4096
v_lshlrev_b32 v72, 16, v100
v_and_b32 v73, 0xffff0000, v100
v_lshlrev_b32 v74, 16, v101
v_and_b32 v75, 0xffff0000, v101
v_lshlrev_b32 v76, 16, v102
ds_write_b128 v29, v[244:247] offset:5120
v_and_b32 v77, 0xffff0000, v102
v_lshlrev_b32 v78, 16, v103
v_and_b32 v79, 0xffff0000, v103
v_lshlrev_b32 v80, 16, v104
v_and_b32 v81, 0xffff0000, v104
ds_write_b128 v29, v[248:251] offset:6144
v_lshlrev_b32 v82, 16, v105
v_and_b32 v83, 0xffff0000, v105
v_lshlrev_b32 v84, 16, v106
v_and_b32 v85, 0xffff0000, v106
ds_write_b128 v29, v[252:255] offset:7168
v_lshlrev_b32 v86, 16, v107
v_and_b32 v87, 0xffff0000, v107
v_lshlrev_b32 v88, 16, v108
v_and_b32 v89, 0xffff0000, v108
v_lshlrev_b32 v90, 16, v109
v_and_b32 v91, 0xffff0000, v109
v_lshlrev_b32 v92, 16, v110
v_and_b32 v93, 0xffff0000, v110
v_lshlrev_b32 v94, 16, v111
v_and_b32 v95, 0xffff0000, v111
v_pk_add_f32 v[128:129], v[128:129], v[64:65]
v_pk_add_f32 v[130:131], v[130:131], v[66:67]
v_pk_add_f32 v[132:133], v[132:133], v[68:69]
v_pk_add_f32 v[134:135], v[134:135], v[70:71]
v_pk_add_f32 v[136:137], v[136:137], v[72:73]
v_pk_add_f32 v[138:139], v[138:139], v[74:75]
v_pk_add_f32 v[140:141], v[140:141], v[76:77]
v_pk_add_f32 v[142:143], v[142:143], v[78:79]
v_pk_add_f32 v[144:145], v[144:145], v[80:81]
v_pk_add_f32 v[146:147], v[146:147], v[82:83]
v_pk_add_f32 v[148:149], v[148:149], v[84:85]
v_pk_add_f32 v[150:151], v[150:151], v[86:87]
v_pk_add_f32 v[152:153], v[152:153], v[88:89]
v_pk_add_f32 v[154:155], v[154:155], v[90:91]
v_pk_add_f32 v[156:157], v[156:157], v[92:93]
v_pk_add_f32 v[158:159], v[158:159], v[94:95]
v_mov_b32 v30, 1
s_waitcnt vmcnt(0)
s_mov_b64 exec, 1
buffer_store_dword v30, off, s[28:31], s37 sc1
s_mov_b64 exec, -1
s_xor_b32 s36, s36, 32768
s_xor_b32 s37, s37, 512
s_waitcnt lgkmcnt(0)
s_barrier
buffer_load_dword v31, off, s[28:31], s37 sc1
ds_read_b128 v[160:163], v20 offset:0
ds_read_b128 v[164:167], v20 offset:1024
ds_read_b128 v[168:171], v20 offset:2048
ds_read_b128 v[172:175], v20 offset:3072
ds_read_b128 v[176:179], v20 offset:4096
ds_read_b128 v[180:183], v20 offset:5120
ds_read_b128 v[184:187], v20 offset:6144
ds_read_b128 v[188:191], v20 offset:7168
ds_read_b128 v[192:195], v20 offset:8192
ds_read_b128 v[196:199], v20 offset:9216
ds_read_b128 v[200:203], v20 offset:10240
ds_read_b128 v[204:207], v20 offset:11264
ds_read_b128 v[208:211], v20 offset:12288
ds_read_b128 v[212:215], v20 offset:13312
ds_read_b128 v[216:219], v20 offset:14336
s_waitcnt lgkmcnt(7)
ds_read_b128 v[220:223], v20 offset:15360
ds_read_b128 v[224:227], v18 offset:16384
ds_read_b128 v[228:231], v18 offset:17408
ds_read_b128 v[232:235], v18 offset:18432
ds_read_b128 v[236:239], v18 offset:19456
ds_read_b128 v[240:243], v18 offset:20480
ds_read_b128 v[244:247], v18 offset:21504
ds_read_b128 v[248:251], v18 offset:22528
v_pk_add_f32 v[128:129], v[128:129], v[160:161]
v_pk_add_f32 v[130:131], v[130:131], v[162:163]
v_pk_add_f32 v[132:133], v[132:133], v[164:165]
v_pk_add_f32 v[134:135], v[134:135], v[166:167]
v_pk_add_f32 v[136:137], v[136:137], v[168:169]
v_pk_add_f32 v[138:139], v[138:139], v[170:171]
v_pk_add_f32 v[140:141], v[140:141], v[172:173]
v_pk_add_f32 v[142:143], v[142:143], v[174:175]
v_pk_add_f32 v[144:145], v[144:145], v[176:177]
v_pk_add_f32 v[146:147], v[146:147], v[178:179]
v_pk_add_f32 v[148:149], v[148:149], v[180:181]
v_pk_add_f32 v[150:151], v[150:151], v[182:183]
v_pk_add_f32 v[152:153], v[152:153], v[184:185]
v_pk_add_f32 v[154:155], v[154:155], v[186:187]
v_pk_add_f32 v[156:157], v[156:157], v[188:189]
v_pk_add_f32 v[158:159], v[158:159], v[190:191]
s_waitcnt lgkmcnt(7)
ds_read_b128 v[252:255], v18 offset:23552
s_waitcnt vmcnt(0)
s_mov_b32 s7, 0x100000
s_branch L_spc9
L_sp9:
buffer_load_dword v31, off, s[28:31], s37 sc1
s_waitcnt vmcnt(0)
L_spc9:
v_readfirstlane_b32 s6, v31
s_sub_u32 s7, s7, 1
s_cmp_ge_u32 s6, 1
s_cbranch_scc1 L_spd9
s_sleep 1
s_cmp_lg_u32 s7, 0
s_cbranch_scc1 L_sp9
L_spd9:
buffer_load_dwordx4 v[96:99], v1, s[8:11], s36 offen offset:0 sc1
buffer_load_dwordx4 v[100:103], v1, s[8:11], s36 offen offset:1024 sc1
buffer_load_dwordx4 v[104:107], v1, s[8:11], s36 offen offset:2048 sc1
buffer_load_dwordx4 v[108:111], v1, s[8:11], s36 offen offset:3072 sc1
v_pk_add_f32 v[128:129], v[128:129], v[192:193]
v_pk_add_f32 v[130:131], v[130:131], v[194:195]
v_pk_add_f32 v[132:133], v[132:133], v[196:197]
v_pk_add_f32 v[134:135], v[134:135], v[198:199]
v_pk_add_f32 v[136:137], v[136:137], v[200:201]
v_pk_add_f32 v[138:139], v[138:139], v[202:203]
v_pk_add_f32 v[140:141], v[140:141], v[204:205]
v_pk_add_f32 v[142:143], v[142:143], v[206:207]
v_pk_add_f32 v[144:145], v[144:145], v[208:209]
v_pk_add_f32 v[146:147], v[146:147], v[210:211]
v_pk_add_f32 v[148:149], v[148:149], v[212:213]
v_pk_add_f32 v[150:151], v[150:151], v[214:215]
v_pk_add_f32 v[152:153], v[152:153], v[216:217]
v_pk_add_f32 v[154:155], v[154:155], v[218:219]
v_pk_add_f32 v[156:157], v[156:157], v[220:221]
v_pk_add_f32 v[158:159], v[158:159], v[222:223]
s_waitcnt lgkmcnt(0)
v_pk_add_f32 v[128:129], v[128:129], v[224:225]
v_pk_add_f32 v[130:131], v[130:131], v[226:227]
v_pk_add_f32 v[132:133], v[132:133], v[228:229]
v_pk_add_f32 v[134:135], v[134:135], v[230:231]
v_pk_add_f32 v[136:137], v[136:137], v[232:233]
v_pk_add_f32 v[138:139], v[138:139], v[234:235]
v_pk_add_f32 v[140:141], v[140:141], v[236:237]
v_pk_add_f32 v[142:143], v[142:143], v[238:239]
v_pk_add_f32 v[144:145], v[144:145], v[240:241]
v_pk_add_f32 v[146:147], v[146:147], v[242:243]
v_pk_add_f32 v[148:149], v[148:149], v[244:245]
v_pk_add_f32 v[150:151], v[150:151], v[246:247]
v_pk_add_f32 v[152:153], v[152:153], v[248:249]
v_pk_add_f32 v[154:155], v[154:155], v[250:251]
v_pk_add_f32 v[156:157], v[156:157], v[252:253]
v_pk_add_f32 v[158:159], v[158:159], v[254:255]
s_add_u32 s20, s86, 58720256
s_addc_u32 s21, s87, 0
s_and_b32 s21, s21, 0xffff
s_mov_b32 s22, 4194304
s_mov_b32 s23, 0x20000
s_add_u32 s24, s86, 62914560
s_addc_u32 s25, s87, 0
s_and_b32 s25, s25, 0xffff
s_mov_b32 s26, 262144
s_mov_b32 s27, 0x20000
s_and_b32 s41, s2, 4
s_bfe_u32 s4, s2, 0x20003
s_add_u32 s41, s41, s4
s_and_b32 s44, s2, 3
s_mul_i32 s44, s44, 7
s_lshr_b32 s4, s2, 5
s_add_u32 s44, s44, s4
s_mov_b32 s12, s78
s_and_b32 s13, s79, 0xffff
s_mov_b32 s14, 7340032
s_mov_b32 s15, 0x20000
s_cmp_ge_u32 s2, 224
s_cselect_b32 s14, 0, s14
v_lshrrev_b32 v24, 4, v0
s_lshl_b32 s4, s3, 4
v_add_u32 v25, s4, v24
v_mul_u32_u24 v25, 7168, v25
v_lshlrev_b32 v24, 1, v24
v_and_b32 v26, 15, v0
v_xor_b32 v24, v24, v26
v_xor_b32 v26, 8, v24
v_lshl_add_u32 v20, v24, 4, v25
v_lshl_add_u32 v21, v26, 4, v25
v_add_u32 v21, 27648, v21
v_lshl_add_u32 v22, v24, 4, v25
v_add_u32 v22, 55296, v22
v_lshl_add_u32 v23, v26, 4, v25
v_add_u32 v23, 82944, v23
s_lshl_b32 s46, s44, 8
s_lshl_b32 s47, s3, 12
s_add_u32 s47, s47, 98304
s_waitcnt vmcnt(0)
v_lshlrev_b32 v64, 16, v96
v_and_b32 v65, 0xffff0000, v96
v_lshlrev_b32 v66, 16, v97
v_and_b32 v67, 0xffff0000, v97
v_lshlrev_b32 v68, 16, v98
v_and_b32 v69, 0xffff0000, v98
v_lshlrev_b32 v70, 16, v99
v_and_b32 v71, 0xffff0000, v99
v_lshlrev_b32 v72, 16, v100
v_and_b32 v73, 0xffff0000, v100
v_lshlrev_b32 v74, 16, v101
v_and_b32 v75, 0xffff0000, v101
v_lshlrev_b32 v76, 16, v102
v_and_b32 v77, 0xffff0000, v102
v_lshlrev_b32 v78, 16, v103
v_and_b32 v79, 0xffff0000, v103
v_lshlrev_b32 v80, 16, v104
v_and_b32 v81, 0xffff0000, v104
v_lshlrev_b32 v82, 16, v105
v_and_b32 v83, 0xffff0000, v105
v_lshlrev_b32 v84, 16, v106
v_and_b32 v85, 0xffff0000, v106
v_lshlrev_b32 v86, 16, v107
v_and_b32 v87, 0xffff0000, v107
v_lshlrev_b32 v88, 16, v108
v_and_b32 v89, 0xffff0000, v108
v_lshlrev_b32 v90, 16, v109
v_and_b32 v91, 0xffff0000, v109
v_lshlrev_b32 v92, 16, v110
v_and_b32 v93, 0xffff0000, v110
v_lshlrev_b32 v94, 16, v111
v_and_b32 v95, 0xffff0000, v111
v_pk_add_f32 v[128:129], v[128:129], v[64:65]
v_pk_add_f32 v[130:131], v[130:131], v[66:67]
v_pk_add_f32 v[132:133], v[132:133], v[68:69]
v_pk_add_f32 v[134:135], v[134:135], v[70:71]
v_pk_add_f32 v[136:137], v[136:137], v[72:73]
v_pk_add_f32 v[138:139], v[138:139], v[74:75]
v_pk_add_f32 v[140:141], v[140:141], v[76:77]
v_pk_add_f32 v[142:143], v[142:143], v[78:79]
v_pk_add_f32 v[144:145], v[144:145], v[80:81]
v_pk_add_f32 v[146:147], v[146:147], v[82:83]
v_pk_add_f32 v[148:149], v[148:149], v[84:85]
v_pk_add_f32 v[150:151], v[150:151], v[86:87]
v_pk_add_f32 v[152:153], v[152:153], v[88:89]
v_pk_add_f32 v[154:155], v[154:155], v[90:91]
v_pk_add_f32 v[156:157], v[156:157], v[92:93]
v_pk_add_f32 v[158:159], v[158:159], v[94:95]
cv v64,v128,v129
cv v65,v130,v131
cv v66,v132,v133
cv v67,v134,v135
cv v68,v136,v137
cv v69,v138,v139
cv v70,v140,v141
cv v71,v142,v143
cv v72,v144,v145
cv v73,v146,v147
cv v74,v148,v149
cv v75,v150,v151
cv v76,v152,v153
cv v77,v154,v155
cv v78,v156,v157
cv v79,v158,v159
s_add_u32 s4, s40, 32768
buffer_store_dwordx4 v[64:67], v1, s[20:23], s40 offen offset:0 sc1
buffer_store_dwordx4 v[68:71], v1, s[20:23], s40 offen offset:1024 sc1
buffer_store_dwordx4 v[72:75], v1, s[20:23], s4 offen offset:0 sc1
buffer_store_dwordx4 v[76:79], v1, s[20:23], s4 offen offset:1024 sc1
v_lshlrev_b32 v160, 16, v64
v_and_b32 v161, 0xffff0000, v64
v_lshlrev_b32 v162, 16, v65
v_and_b32 v163, 0xffff0000, v65
v_lshlrev_b32 v164, 16, v66
v_and_b32 v165, 0xffff0000, v66
v_lshlrev_b32 v166, 16, v67
v_and_b32 v167, 0xffff0000, v67
v_lshlrev_b32 v168, 16, v68
v_and_b32 v169, 0xffff0000, v68
v_lshlrev_b32 v170, 16, v69
v_and_b32 v171, 0xffff0000, v69
v_lshlrev_b32 v172, 16, v70
v_and_b32 v173, 0xffff0000, v70
v_lshlrev_b32 v174, 16, v71
v_and_b32 v175, 0xffff0000, v71
v_lshlrev_b32 v176, 16, v72
v_and_b32 v177, 0xffff0000, v72
v_lshlrev_b32 v178, 16, v73
v_and_b32 v179, 0xffff0000, v73
v_lshlrev_b32 v180, 16, v74
v_and_b32 v181, 0xffff0000, v74
v_lshlrev_b32 v182, 16, v75
v_and_b32 v183, 0xffff0000, v75
v_lshlrev_b32 v184, 16, v76
v_and_b32 v185, 0xffff0000, v76
v_lshlrev_b32 v186, 16, v77
v_and_b32 v187, 0xffff0000, v77
v_lshlrev_b32 v188, 16, v78
v_and_b32 v189, 0xffff0000, v78
v_lshlrev_b32 v190, 16, v79
v_and_b32 v191, 0xffff0000, v79
v_pk_add_f32 v[192:193], v[160:161], v[162:163]
v_pk_mul_f32 v[194:195], v[160:161], v[160:161]
v_pk_add_f32 v[196:197], v[176:177], v[178:179]
v_pk_mul_f32 v[198:199], v[176:177], v[176:177]
v_pk_fma_f32 v[194:195], v[162:163], v[162:163], v[194:195]
v_pk_fma_f32 v[198:199], v[178:179], v[178:179], v[198:199]
v_pk_add_f32 v[192:193], v[192:193], v[164:165]
v_pk_fma_f32 v[194:195], v[164:165], v[164:165], v[194:195]
v_pk_add_f32 v[196:197], v[196:197], v[180:181]
v_pk_fma_f32 v[198:199], v[180:181], v[180:181], v[198:199]
v_pk_add_f32 v[192:193], v[192:193], v[166:167]
v_pk_fma_f32 v[194:195], v[166:167], v[166:167], v[194:195]
v_pk_add_f32 v[196:197], v[196:197], v[182:183]
v_pk_fma_f32 v[198:199], v[182:183], v[182:183], v[198:199]
v_pk_add_f32 v[192:193], v[192:193], v[168:169]
v_pk_fma_f32 v[194:195], v[168:169], v[168:169], v[194:195]
v_pk_add_f32 v[196:197], v[196:197], v[184:185]
v_pk_fma_f32 v[198:199], v[184:185], v[184:185], v[198:199]
v_pk_add_f32 v[192:193], v[192:193], v[170:171]
v_pk_fma_f32 v[194:195], v[170:171], v[170:171], v[194:195]
v_pk_add_f32 v[196:197], v[196:197], v[186:187]
v_pk_fma_f32 v[198:199], v[186:187], v[186:187], v[198:199]
v_pk_add_f32 v[192:193], v[192:193], v[172:173]
v_pk_fma_f32 v[194:195], v[172:173], v[172:173], v[194:195]
v_pk_add_f32 v[196:197], v[196:197], v[188:189]
v_pk_fma_f32 v[198:199], v[188:189], v[188:189], v[198:199]
v_pk_add_f32 v[192:193], v[192:193], v[174:175]
v_pk_fma_f32 v[194:195], v[174:175], v[174:175], v[194:195]
v_pk_add_f32 v[196:197], v[196:197], v[190:191]
v_pk_fma_f32 v[198:199], v[190:191], v[190:191], v[198:199]
v_add_f32 v80, v192, v193
v_add_f32 v81, v194, v195
v_add_f32 v82, v196, v197
v_add_f32 v83, v198, v199
v_mov_b32 v84, v80
v_mov_b32 v85, v81
v_mov_b32 v86, v82
v_mov_b32 v87, v83
v_permlane16_swap_b32 v80, v84
v_permlane16_swap_b32 v81, v85
v_permlane16_swap_b32 v82, v86
v_permlane16_swap_b32 v83, v87
v_add_f32 v80, v80, v84
v_add_f32 v81, v81, v85
v_add_f32 v82, v82, v86
v_add_f32 v83, v83, v87
v_mov_b32 v84, v80
v_mov_b32 v85, v81
v_mov_b32 v86, v82
v_mov_b32 v87, v83
v_permlane32_swap_b32 v80, v84
v_permlane32_swap_b32 v81, v85
v_permlane32_swap_b32 v82, v86
v_permlane32_swap_b32 v83, v87
v_add_f32 v80, v80, v84
v_add_f32 v81, v81, v85
v_add_f32 v82, v82, v86
v_add_f32 v83, v83, v87
s_lshl_b32 s4, s35, 11
s_lshl_b32 s5, s34, 7
s_add_u32 s4, s4, s5
s_lshl_b32 s5, s3, 5
s_add_u32 s4, s4, s5
s_lshl_b32 s4, s4, 3
v_lshlrev_b32 v19, 3, v0
s_mov_b64 exec, 0xffff
buffer_store_dwordx2 v[80:81], v19, s[24:27], s4 offen sc1
buffer_store_dwordx2 v[82:83], v19, s[24:27], s4 offen offset:128 sc1
s_mov_b64 exec, -1
s_waitcnt vmcnt(0)
s_barrier
s_lshl_b32 s4, s2, 7
s_cmp_lg_u32 s3, 0
s_cbranch_scc1 L_sg10
v_mov_b32 v18, 1
s_mov_b64 exec, 1
buffer_store_dword v18, off, s[28:31], s4 offset:12 sc1
s_mov_b64 exec, -1
L_sg10:
s_cmp_ge_u32 s2, 224
s_cbranch_scc1 L_p5_skip
s_add_u32 m0, s47, 0
s_nop 0
buffer_load_dwordx4 v20, s[12:15], s46 offen offset:0 lds
buffer_load_dwordx4 v21, s[12:15], s46 offen offset:1024 lds
buffer_load_dwordx4 v22, s[12:15], s46 offen offset:2048 lds
buffer_load_dwordx4 v23, s[12:15], s46 offen offset:3072 lds
s_add_u32 s46, s46, 458752
s_add_u32 m0, s47, 16384
s_nop 0
buffer_load_dwordx4 v20, s[12:15], s46 offen offset:0 lds
buffer_load_dwordx4 v21, s[12:15], s46 offen offset:1024 lds
buffer_load_dwordx4 v22, s[12:15], s46 offen offset:2048 lds
buffer_load_dwordx4 v23, s[12:15], s46 offen offset:3072 lds
s_add_u32 s46, s46, 458752
s_add_u32 m0, s47, 32768
s_nop 0
buffer_load_dwordx4 v20, s[12:15], s46 offen offset:0 lds
buffer_load_dwordx4 v21, s[12:15], s46 offen offset:1024 lds
buffer_load_dwordx4 v22, s[12:15], s46 offen offset:2048 lds
buffer_load_dwordx4 v23, s[12:15], s46 offen offset:3072 lds
s_add_u32 s46, s46, 458752
s_add_u32 m0, s47, 49152
s_nop 0
buffer_load_dwordx4 v20, s[12:15], s46 offen offset:0 lds
buffer_load_dwordx4 v21, s[12:15], s46 offen offset:1024 lds
buffer_load_dwordx4 v22, s[12:15], s46 offen offset:2048 lds
buffer_load_dwordx4 v23, s[12:15], s46 offen offset:3072 lds
s_add_u32 s46, s46, 458752
s_add_u32 s8, s86, 67108864
s_addc_u32 s9, s87, 0
s_and_b32 s9, s9, 0xffff
s_mov_b32 s10, 14680064
s_mov_b32 s11, 0x20000
s_lshl_b32 s4, s41, 4
s_lshl_b32 s5, s3, 2
s_add_u32 s49, s4, s5
s_lshl_b32 s45, s49, 15
s_lshl_b32 s48, s49, 7
v_mov_b32 v2, v1
v_add_u32 v3, 32768, v1
v_add_u32 v4, 65536, v1
v_add_u32 v5, 98304, v1
v_lshrrev_b32 v26, 4, v0
v_bfe_u32 v25, v0, 2, 2
v_lshl_add_u32 v24, v26, 2, v25
v_and_b32 v25, 7, v24
v_lshlrev_b32 v24, 8, v24
v_lshl_add_u32 v24, v25, 5, v24
v_and_b32 v25, 3, v0
v_lshl_add_u32 v24, v25, 3, v24
v_add_u32 v24, 98304, v24
s_mul_i32 s7, s49, 114688
s_lshl_b32 s5, s44, 12
s_add_u32 s7, s7, s5
s_add_u32 s4, s3, 0
s_and_b32 s4, s4, 3
s_lshl_b32 s5, s4, 10
s_add_u32 s54, s7, s5
s_lshl_b32 s5, s4, 6
v_xor_b32 v6, s5, v24
v_xor_b32 v7, 32, v6
s_lshl_b32 s5, s4, 11
s_add_u32 s5, s5, 24576
v_add_u32 v112, s5, v1
s_add_u32 s4, s3, 1
s_and_b32 s4, s4, 3
s_lshl_b32 s5, s4, 10
s_add_u32 s55, s7, s5
s_lshl_b32 s5, s4, 6
v_xor_b32 v8, s5, v24
v_xor_b32 v9, 32, v8
s_lshl_b32 s5, s4, 11
s_add_u32 s5, s5, 24576
v_add_u32 v113, s5, v1
s_add_u32 s4, s3, 2
s_and_b32 s4, s4, 3
s_lshl_b32 s5, s4, 10
s_add_u32 s56, s7, s5
s_lshl_b32 s5, s4, 6
v_xor_b32 v10, s5, v24
v_xor_b32 v11, 32, v10
s_lshl_b32 s5, s4, 11
s_add_u32 s5, s5, 24576
v_add_u32 v114, s5, v1
s_add_u32 s4, s3, 3
s_and_b32 s4, s4, 3
s_lshl_b32 s5, s4, 10
s_add_u32 s57, s7, s5
s_lshl_b32 s5, s4, 6
v_xor_b32 v12, s5, v24
v_xor_b32 v13, 32, v12
s_lshl_b32 s5, s4, 11
s_add_u32 s5, s5, 24576
v_add_u32 v115, s5, v1
v_mov_b32 v28, 0x3f803f80
v_mov_b32 v29, 0x3f803f80
v_mov_b32 v30, 0x3f803f80
v_mov_b32 v31, 0x3f803f80
v_lshlrev_b32 v14, 16, v26
v_and_b32 v25, 15, v0
v_lshl_add_u32 v14, v25, 3, v14
v_add_u32 v24, 0, v1
v_add_u32 v25, 114688, v1
v_add_u32 v26, 229376, v1
v_add_u32 v27, 344064, v1
v_and_b32 v19, 3, v0
v_bfe_u32 v18, v0, 2, 2
v_lshl_add_u32 v19, v18, 6, v19
v_lshlrev_b32 v19, 7, v19
s_and_b32 s4, s41, 4
s_and_b32 s5, s41, 3
s_lshl_b32 s5, s5, 4
s_add_u32 s4, s4, s5
s_lshr_b32 s5, s3, 1
s_lshl_b32 s5, s5, 3
s_add_u32 s4, s4, s5
s_lshl_b32 s4, s4, 7
s_add_u32 s4, s4, 12
buffer_load_dword v18, v19, s[28:31], s4 offen sc1
s_waitcnt vmcnt(0)
s_barrier
rt a[192:193],v6,0
rt a[194:195],v6,4096
rt a[224:225],v6,8192
rt a[226:227],v6,12288
rt a[196:197],v7,0
rt a[198:199],v7,4096
rt a[228:229],v7,8192
rt a[230:231],v7,12288
rt a[200:201],v8,0
rt a[202:203],v8,4096
rt a[232:233],v8,8192
rt a[234:235],v8,12288
rt a[204:205],v9,0
rt a[206:207],v9,4096
rt a[236:237],v9,8192
rt a[238:239],v9,12288
rt a[208:209],v10,0
rt a[210:211],v10,4096
rt a[240:241],v10,8192
rt a[242:243],v10,12288
rt a[212:213],v11,0
rt a[214:215],v11,4096
rt a[244:245],v11,8192
rt a[246:247],v11,12288
rt a[216:217],v12,0
rt a[218:219],v12,4096
rt a[248:249],v12,8192
rt a[250:251],v12,12288
s_mov_b32 s7, 0x100000
s_branch L_spc11
L_sp11:
buffer_load_dword v18, v19, s[28:31], s4 offen sc1
s_waitcnt vmcnt(0)
L_spc11:
v_cmp_gt_u32 vcc, 1, v18
s_sub_u32 s7, s7, 1
s_cbranch_vccz L_spd11
s_cmp_lg_u32 s7, 0
s_cbranch_scc1 L_sp11
L_spd11:
buffer_load_dwordx4 a[0:3], v2, s[20:23], s45 offen sc1
buffer_load_dwordx4 a[4:7], v3, s[20:23], s45 offen sc1
buffer_load_dwordx4 a[8:11], v4, s[20:23], s45 offen sc1
buffer_load_dwordx4 a[12:15], v5, s[20:23], s45 offen sc1
s_add_u32 s45, s45, 1024
buffer_load_dwordx4 a[16:19], v2, s[20:23], s45 offen sc1
buffer_load_dwordx4 a[20:23], v3, s[20:23], s45 offen sc1
buffer_load_dwordx4 a[24:27], v4, s[20:23], s45 offen sc1
buffer_load_dwordx4 a[28:31], v5, s[20:23], s45 offen sc1
s_add_u32 s45, s45, 1024
buffer_load_dwordx4 a[32:35], v2, s[20:23], s45 offen sc1
buffer_load_dwordx4 a[36:39], v3, s[20:23], s45 offen sc1
buffer_load_dwordx4 a[40:43], v4, s[20:23], s45 offen sc1
buffer_load_dwordx4 a[44:47], v5, s[20:23], s45 offen sc1
s_add_u32 s45, s45, 1024
s_waitcnt vmcnt(4) lgkmcnt(0)
mm v[128:131],a[192:195],a[0:3],0
buffer_load_dwordx4 a[48:51], v2, s[20:23], s45 offen sc1
mm v[128:131],a[224:227],a[16:19],v[128:131]
mm v[160:163],a[192:195],a[4:7],0
buffer_load_dwordx4 a[52:55], v3, s[20:23], s45 offen sc1
mm v[160:163],a[224:227],a[20:23],v[160:163]
mm v[192:195],a[192:195],a[8:11],0
buffer_load_dwordx4 a[56:59], v4, s[20:23], s45 offen sc1
mm v[192:195],a[224:227],a[24:27],v[192:195]
rt a[220:221],v13,0
rt a[222:223],v13,4096
rt a[252:253],v13,8192
rt a[254:255],v13,12288
mm v[224:227],a[192:195],a[12:15],0
mm v[224:227],a[224:227],a[28:31],v[224:227]
mm v[32:35],a[192:195],v[28:31],0
mm v[32:35],a[224:227],v[28:31],v[32:35]
buffer_load_dwordx4 a[60:63], v5, s[20:23], s45 offen sc1
s_add_u32 s45, s45, 1024
mm v[132:135],a[196:199],a[0:3],0
mm v[132:135],a[228:231],a[16:19],v[132:135]
s_waitcnt lgkmcnt(0)
s_barrier
mm v[164:167],a[196:199],a[4:7],0
mm v[164:167],a[228:231],a[20:23],v[164:167]
buffer_load_dwordx4 a[64:67], v2, s[20:23], s45 offen sc1
mm v[196:199],a[196:199],a[8:11],0
mm v[196:199],a[228:231],a[24:27],v[196:199]
buffer_load_dwordx4 a[68:71], v3, s[20:23], s45 offen sc1
mm v[228:231],a[196:199],a[12:15],0
mm v[228:231],a[228:231],a[28:31],v[228:231]
rt a[192:193],v6,16384
rt a[194:195],v6,20480
rt a[224:225],v6,24576
rt a[226:227],v6,28672
mm v[36:39],a[196:199],v[28:31],0
mm v[36:39],a[228:231],v[28:31],v[36:39]
mm v[136:139],a[200:203],a[0:3],0
buffer_load_dwordx4 a[72:75], v4, s[20:23], s45 offen sc1
mm v[136:139],a[232:235],a[16:19],v[136:139]
mm v[168:171],a[200:203],a[4:7],0
buffer_load_dwordx4 a[76:79], v5, s[20:23], s45 offen sc1
mm v[168:171],a[232:235],a[20:23],v[168:171]
rt a[196:197],v7,16384
mm v[200:203],a[200:203],a[8:11],0
s_add_u32 s45, s45, 1024
mm v[200:203],a[232:235],a[24:27],v[200:203]
buffer_load_dwordx4 a[80:83], v2, s[20:23], s45 offen sc1
mm v[232:235],a[200:203],a[12:15],0
mm v[232:235],a[232:235],a[28:31],v[232:235]
rt a[198:199],v7,20480
rt a[228:229],v7,24576
rt a[230:231],v7,28672
mm v[140:143],a[204:207],a[0:3],0
mm v[140:143],a[236:239],a[16:19],v[140:143]
buffer_load_dwordx4 a[84:87], v3, s[20:23], s45 offen sc1
mm v[172:175],a[204:207],a[4:7],0
mm v[172:175],a[236:239],a[20:23],v[172:175]
buffer_load_dwordx4 a[88:91], v4, s[20:23], s45 offen sc1
mm v[204:207],a[204:207],a[8:11],0
mm v[204:207],a[236:239],a[24:27],v[204:207]
buffer_load_dwordx4 a[92:95], v5, s[20:23], s45 offen sc1
mm v[236:239],a[204:207],a[12:15],0
rt a[200:201],v8,16384
mm v[236:239],a[236:239],a[28:31],v[236:239]
rt a[202:203],v8,20480
rt a[232:233],v8,24576
rt a[234:235],v8,28672
mm v[144:147],a[208:211],a[0:3],0
mm v[144:147],a[240:243],a[16:19],v[144:147]
mm v[176:179],a[208:211],a[4:7],0
s_add_u32 s45, s45, 1024
mm v[176:179],a[240:243],a[20:23],v[176:179]
buffer_load_dwordx4 a[96:99], v2, s[20:23], s45 offen sc1
mm v[208:211],a[208:211],a[8:11],0
rt a[204:205],v9,16384
mm v[208:211],a[240:243],a[24:27],v[208:211]
buffer_load_dwordx4 a[100:103], v3, s[20:23], s45 offen sc1
mm v[240:243],a[208:211],a[12:15],0
mm v[240:243],a[240:243],a[28:31],v[240:243]
rt a[206:207],v9,20480
rt a[236:237],v9,24576
rt a[238:239],v9,28672
mm v[148:151],a[212:215],a[0:3],0
mm v[148:151],a[244:247],a[16:19],v[148:151]
buffer_load_dwordx4 a[104:107], v4, s[20:23], s45 offen sc1
mm v[180:183],a[212:215],a[4:7],0
mm v[180:183],a[244:247],a[20:23],v[180:183]
buffer_load_dwordx4 a[108:111], v5, s[20:23], s45 offen sc1
mm v[212:215],a[212:215],a[8:11],0
mm v[212:215],a[244:247],a[24:27],v[212:215]
rt a[208:209],v10,16384
mm v[244:247],a[212:215],a[12:15],0
rt a[210:211],v10,20480
mm v[244:247],a[244:247],a[28:31],v[244:247]
rt a[240:241],v10,24576
rt a[242:243],v10,28672
mm v[152:155],a[216:219],a[0:3],0
s_add_u32 s45, s45, 1024
mm v[152:155],a[248:251],a[16:19],v[152:155]
s_add_u32 m0, s47, 0
mm v[184:187],a[216:219],a[4:7],0
rt a[212:213],v11,16384
mm v[184:187],a[248:251],a[20:23],v[184:187]
buffer_load_dwordx4 v20, s[12:15], s46 offen offset:0 lds
mm v[216:219],a[216:219],a[8:11],0
rt a[214:215],v11,20480
mm v[216:219],a[248:251],a[24:27],v[216:219]
buffer_load_dwordx4 v21, s[12:15], s46 offen offset:1024 lds
mm v[248:251],a[216:219],a[12:15],0
mm v[248:251],a[248:251],a[28:31],v[248:251]
rt a[244:245],v11,24576
rt a[246:247],v11,28672
mm v[156:159],a[220:223],a[0:3],0
mm v[156:159],a[252:255],a[16:19],v[156:159]
buffer_load_dwordx4 v22, s[12:15], s46 offen offset:2048 lds
mm v[188:191],a[220:223],a[4:7],0
rt a[216:217],v12,16384
mm v[188:191],a[252:255],a[20:23],v[188:191]
buffer_load_dwordx4 v23, s[12:15], s46 offen offset:3072 lds
mm v[220:223],a[220:223],a[8:11],0
mm v[220:223],a[252:255],a[24:27],v[220:223]
rt a[218:219],v12,20480
mm v[252:255],a[220:223],a[12:15],0
s_add_u32 s46, s46, 458752
mm v[252:255],a[252:255],a[28:31],v[252:255]
rt a[248:249],v12,24576
rt a[250:251],v12,28672
s_waitcnt vmcnt(16) lgkmcnt(8)
mm v[128:131],a[192:195],a[32:35],v[128:131]
buffer_load_dwordx4 a[112:115], v2, s[20:23], s45 offen sc1
mm v[128:131],a[224:227],a[48:51],v[128:131]
mm v[160:163],a[192:195],a[36:39],v[160:163]
buffer_load_dwordx4 a[116:119], v3, s[20:23], s45 offen sc1
mm v[160:163],a[224:227],a[52:55],v[160:163]
mm v[192:195],a[192:195],a[40:43],v[192:195]
buffer_load_dwordx4 a[120:123], v4, s[20:23], s45 offen sc1
mm v[192:195],a[224:227],a[56:59],v[192:195]
rt a[220:221],v13,16384
rt a[222:223],v13,20480
rt a[252:253],v13,24576
rt a[254:255],v13,28672
mm v[224:227],a[192:195],a[44:47],v[224:227]
mm v[224:227],a[224:227],a[60:63],v[224:227]
mm v[32:35],a[192:195],v[28:31],v[32:35]
mm v[32:35],a[224:227],v[28:31],v[32:35]
buffer_load_dwordx4 a[124:127], v5, s[20:23], s45 offen sc1
s_add_u32 s45, s45, 1024
mm v[132:135],a[196:199],a[32:35],v[132:135]
mm v[132:135],a[228:231],a[48:51],v[132:135]
s_waitcnt lgkmcnt(0)
s_barrier
mm v[164:167],a[196:199],a[36:39],v[164:167]
mm v[164:167],a[228:231],a[52:55],v[164:167]
mm v[196:199],a[196:199],a[40:43],v[196:199]
mm v[196:199],a[228:231],a[56:59],v[196:199]
buffer_load_dwordx4 a[0:3], v2, s[20:23], s45 offen sc1
mm v[228:231],a[196:199],a[44:47],v[228:231]
mm v[228:231],a[228:231],a[60:63],v[228:231]
rt a[192:193],v6,32768
rt a[194:195],v6,36864
rt a[224:225],v6,40960
rt a[226:227],v6,45056
mm v[36:39],a[196:199],v[28:31],v[36:39]
mm v[36:39],a[228:231],v[28:31],v[36:39]
mm v[136:139],a[200:203],a[32:35],v[136:139]
mm v[136:139],a[232:235],a[48:51],v[136:139]
buffer_load_dwordx4 a[4:7], v3, s[20:23], s45 offen sc1
mm v[168:171],a[200:203],a[36:39],v[168:171]
buffer_load_dwordx4 a[8:11], v4, s[20:23], s45 offen sc1
mm v[168:171],a[232:235],a[52:55],v[168:171]
mm v[200:203],a[200:203],a[40:43],v[200:203]
buffer_load_dwordx4 a[12:15], v5, s[20:23], s45 offen sc1
mm v[200:203],a[232:235],a[56:59],v[200:203]
mm v[232:235],a[200:203],a[44:47],v[232:235]
rt a[196:197],v7,32768
mm v[232:235],a[232:235],a[60:63],v[232:235]
rt a[198:199],v7,36864
rt a[228:229],v7,40960
rt a[230:231],v7,45056
mm v[140:143],a[204:207],a[32:35],v[140:143]
mm v[140:143],a[236:239],a[48:51],v[140:143]
mm v[172:175],a[204:207],a[36:39],v[172:175]
s_add_u32 s45, s45, 1024
mm v[172:175],a[236:239],a[52:55],v[172:175]
buffer_load_dwordx4 a[16:19], v2, s[20:23], s45 offen sc1
mm v[204:207],a[204:207],a[40:43],v[204:207]
mm v[204:207],a[236:239],a[56:59],v[204:207]
buffer_load_dwordx4 a[20:23], v3, s[20:23], s45 offen sc1
mm v[236:239],a[204:207],a[44:47],v[236:239]
mm v[236:239],a[236:239],a[60:63],v[236:239]
rt a[200:201],v8,32768
rt a[202:203],v8,36864
rt a[232:233],v8,40960
rt a[234:235],v8,45056
mm v[144:147],a[208:211],a[32:35],v[144:147]
mm v[144:147],a[240:243],a[48:51],v[144:147]
mm v[176:179],a[208:211],a[36:39],v[176:179]
mm v[176:179],a[240:243],a[52:55],v[176:179]
buffer_load_dwordx4 a[24:27], v4, s[20:23], s45 offen sc1
mm v[208:211],a[208:211],a[40:43],v[208:211]
mm v[208:211],a[240:243],a[56:59],v[208:211]
buffer_load_dwordx4 a[28:31], v5, s[20:23], s45 offen sc1
mm v[240:243],a[208:211],a[44:47],v[240:243]
mm v[240:243],a[240:243],a[60:63],v[240:243]
rt a[204:205],v9,32768
rt a[206:207],v9,36864
rt a[236:237],v9,40960
rt a[238:239],v9,45056
mm v[148:151],a[212:215],a[32:35],v[148:151]
mm v[148:151],a[244:247],a[48:51],v[148:151]
mm v[180:183],a[212:215],a[36:39],v[180:183]
s_add_u32 s45, s45, 1024
mm v[180:183],a[244:247],a[52:55],v[180:183]
rt a[208:209],v10,32768
mm v[212:215],a[212:215],a[40:43],v[212:215]
rt a[210:211],v10,36864
mm v[212:215],a[244:247],a[56:59],v[212:215]
s_add_u32 m0, s47, 16384
mm v[244:247],a[212:215],a[44:47],v[244:247]
rt a[240:241],v10,40960
mm v[244:247],a[244:247],a[60:63],v[244:247]
rt a[242:243],v10,45056
mm v[152:155],a[216:219],a[32:35],v[152:155]
buffer_load_dwordx4 v20, s[12:15], s46 offen offset:0 lds
mm v[152:155],a[248:251],a[48:51],v[152:155]
mm v[184:187],a[216:219],a[36:39],v[184:187]
rt a[212:213],v11,32768
mm v[184:187],a[248:251],a[52:55],v[184:187]
buffer_load_dwordx4 v21, s[12:15], s46 offen offset:1024 lds
mm v[216:219],a[216:219],a[40:43],v[216:219]
mm v[216:219],a[248:251],a[56:59],v[216:219]
rt a[214:215],v11,36864
mm v[248:251],a[216:219],a[44:47],v[248:251]
buffer_load_dwordx4 v22, s[12:15], s46 offen offset:2048 lds
mm v[248:251],a[248:251],a[60:63],v[248:251]
rt a[244:245],v11,40960
rt a[246:247],v11,45056
mm v[156:159],a[220:223],a[32:35],v[156:159]
mm v[156:159],a[252:255],a[48:51],v[156:159]
mm v[188:191],a[220:223],a[36:39],v[188:191]
buffer_load_dwordx4 v23, s[12:15], s46 offen offset:3072 lds
mm v[188:191],a[252:255],a[52:55],v[188:191]
mm v[220:223],a[220:223],a[40:43],v[220:223]
rt a[216:217],v12,32768
mm v[220:223],a[252:255],a[56:59],v[220:223]
rt a[218:219],v12,36864
mm v[252:255],a[220:223],a[44:47],v[252:255]
s_add_u32 s46, s46, 458752
mm v[252:255],a[252:255],a[60:63],v[252:255]
rt a[248:249],v12,40960
rt a[250:251],v12,45056
s_waitcnt vmcnt(24) lgkmcnt(8)
mm v[128:131],a[192:195],a[64:67],v[128:131]
mm v[128:131],a[224:227],a[80:83],v[128:131]
buffer_load_dwordx4 a[32:35], v2, s[20:23], s45 offen sc1
mm v[160:163],a[192:195],a[68:71],v[160:163]
mm v[160:163],a[224:227],a[84:87],v[160:163]
buffer_load_dwordx4 a[36:39], v3, s[20:23], s45 offen sc1
mm v[192:195],a[192:195],a[72:75],v[192:195]
mm v[192:195],a[224:227],a[88:91],v[192:195]
rt a[220:221],v13,32768
rt a[222:223],v13,36864
rt a[252:253],v13,40960
rt a[254:255],v13,45056
mm v[224:227],a[192:195],a[76:79],v[224:227]
mm v[224:227],a[224:227],a[92:95],v[224:227]
mm v[32:35],a[192:195],v[28:31],v[32:35]
mm v[32:35],a[224:227],v[28:31],v[32:35]
buffer_load_dwordx4 a[40:43], v4, s[20:23], s45 offen sc1
buffer_load_dwordx4 a[44:47], v5, s[20:23], s45 offen sc1
s_add_u32 s45, s45, 1024
mm v[132:135],a[196:199],a[64:67],v[132:135]
mm v[132:135],a[228:231],a[80:83],v[132:135]
s_waitcnt lgkmcnt(0)
s_barrier
mm v[164:167],a[196:199],a[68:71],v[164:167]
mm v[164:167],a[228:231],a[84:87],v[164:167]
mm v[196:199],a[196:199],a[72:75],v[196:199]
mm v[196:199],a[228:231],a[88:91],v[196:199]
mm v[228:231],a[196:199],a[76:79],v[228:231]
mm v[228:231],a[228:231],a[92:95],v[228:231]
rt a[192:193],v6,49152
rt a[194:195],v6,53248
rt a[224:225],v6,57344
rt a[226:227],v6,61440
mm v[36:39],a[196:199],v[28:31],v[36:39]
mm v[36:39],a[228:231],v[28:31],v[36:39]
mm v[136:139],a[200:203],a[64:67],v[136:139]
mm v[136:139],a[232:235],a[80:83],v[136:139]
buffer_load_dwordx4 a[48:51], v2, s[20:23], s45 offen sc1
mm v[168:171],a[200:203],a[68:71],v[168:171]
mm v[168:171],a[232:235],a[84:87],v[168:171]
mm v[200:203],a[200:203],a[72:75],v[200:203]
buffer_load_dwordx4 a[52:55], v3, s[20:23], s45 offen sc1
mm v[200:203],a[232:235],a[88:91],v[200:203]
mm v[232:235],a[200:203],a[76:79],v[232:235]
buffer_load_dwordx4 a[56:59], v4, s[20:23], s45 offen sc1
mm v[232:235],a[232:235],a[92:95],v[232:235]
rt a[196:197],v7,49152
rt a[198:199],v7,53248
rt a[228:229],v7,57344
rt a[230:231],v7,61440
mm v[140:143],a[204:207],a[64:67],v[140:143]
mm v[140:143],a[236:239],a[80:83],v[140:143]
mm v[172:175],a[204:207],a[68:71],v[172:175]
mm v[172:175],a[236:239],a[84:87],v[172:175]
mm v[204:207],a[204:207],a[72:75],v[204:207]
buffer_load_dwordx4 a[60:63], v5, s[20:23], s45 offen sc1
mm v[204:207],a[236:239],a[88:91],v[204:207]
mm v[236:239],a[204:207],a[76:79],v[236:239]
mm v[236:239],a[236:239],a[92:95],v[236:239]
rt a[200:201],v8,49152
rt a[202:203],v8,53248
rt a[232:233],v8,57344
rt a[234:235],v8,61440
mm v[144:147],a[208:211],a[64:67],v[144:147]
mm v[144:147],a[240:243],a[80:83],v[144:147]
mm v[176:179],a[208:211],a[68:71],v[176:179]
mm v[176:179],a[240:243],a[84:87],v[176:179]
s_add_u32 s45, s45, 1024
mm v[208:211],a[208:211],a[72:75],v[208:211]
rt a[204:205],v9,49152
mm v[208:211],a[240:243],a[88:91],v[208:211]
s_add_u32 m0, s47, 32768
mm v[240:243],a[208:211],a[76:79],v[240:243]
rt a[206:207],v9,53248
mm v[240:243],a[240:243],a[92:95],v[240:243]
rt a[236:237],v9,57344
rt a[238:239],v9,61440
mm v[148:151],a[212:215],a[64:67],v[148:151]
mm v[148:151],a[244:247],a[80:83],v[148:151]
mm v[180:183],a[212:215],a[68:71],v[180:183]
buffer_load_dwordx4 v20, s[12:15], s46 offen offset:0 lds
mm v[180:183],a[244:247],a[84:87],v[180:183]
mm v[212:215],a[212:215],a[72:75],v[212:215]
rt a[208:209],v10,49152
mm v[212:215],a[244:247],a[88:91],v[212:215]
buffer_load_dwordx4 v21, s[12:15], s46 offen offset:1024 lds
mm v[244:247],a[212:215],a[76:79],v[244:247]
mm v[244:247],a[244:247],a[92:95],v[244:247]
rt a[210:211],v10,53248
rt a[240:241],v10,57344
rt a[242:243],v10,61440
mm v[152:155],a[216:219],a[64:67],v[152:155]
mm v[152:155],a[248:251],a[80:83],v[152:155]
mm v[184:187],a[216:219],a[68:71],v[184:187]
rt a[212:213],v11,49152
mm v[184:187],a[248:251],a[84:87],v[184:187]
buffer_load_dwordx4 v22, s[12:15], s46 offen offset:2048 lds
mm v[216:219],a[216:219],a[72:75],v[216:219]
mm v[216:219],a[248:251],a[88:91],v[216:219]
mm v[248:251],a[216:219],a[76:79],v[248:251]
rt a[214:215],v11,53248
mm v[248:251],a[248:251],a[92:95],v[248:251]
rt a[244:245],v11,57344
rt a[246:247],v11,61440
mm v[156:159],a[220:223],a[64:67],v[156:159]
mm v[156:159],a[252:255],a[80:83],v[156:159]
buffer_load_dwordx4 v23, s[12:15], s46 offen offset:3072 lds
mm v[188:191],a[220:223],a[68:71],v[188:191]
mm v[188:191],a[252:255],a[84:87],v[188:191]
rt a[216:217],v12,49152
mm v[220:223],a[220:223],a[72:75],v[220:223]
rt a[218:219],v12,53248
mm v[220:223],a[252:255],a[88:91],v[220:223]
rt a[248:249],v12,57344
mm v[252:255],a[220:223],a[76:79],v[252:255]
s_add_u32 s46, s46, 458752
mm v[252:255],a[252:255],a[92:95],v[252:255]
rt a[250:251],v12,61440
s_waitcnt vmcnt(24) lgkmcnt(8)
mm v[128:131],a[192:195],a[96:99],v[128:131]
mm v[128:131],a[224:227],a[112:115],v[128:131]
buffer_load_dwordx4 a[64:67], v2, s[20:23], s45 offen sc1
mm v[160:163],a[192:195],a[100:103],v[160:163]
mm v[160:163],a[224:227],a[116:119],v[160:163]
buffer_load_dwordx4 a[68:71], v3, s[20:23], s45 offen sc1
mm v[192:195],a[192:195],a[104:107],v[192:195]
mm v[192:195],a[224:227],a[120:123],v[192:195]
rt a[220:221],v13,49152
rt a[222:223],v13,53248
rt a[252:253],v13,57344
rt a[254:255],v13,61440
mm v[224:227],a[192:195],a[108:111],v[224:227]
mm v[224:227],a[224:227],a[124:127],v[224:227]
mm v[32:35],a[192:195],v[28:31],v[32:35]
mm v[32:35],a[224:227],v[28:31],v[32:35]
buffer_load_dwordx4 a[72:75], v4, s[20:23], s45 offen sc1
buffer_load_dwordx4 a[76:79], v5, s[20:23], s45 offen sc1
s_add_u32 s45, s45, 1024
mm v[132:135],a[196:199],a[96:99],v[132:135]
mm v[132:135],a[228:231],a[112:115],v[132:135]
s_waitcnt vmcnt(32) lgkmcnt(0)
s_barrier
mm v[164:167],a[196:199],a[100:103],v[164:167]
mm v[164:167],a[228:231],a[116:119],v[164:167]
mm v[196:199],a[196:199],a[104:107],v[196:199]
mm v[196:199],a[228:231],a[120:123],v[196:199]
mm v[228:231],a[196:199],a[108:111],v[228:231]
mm v[228:231],a[228:231],a[124:127],v[228:231]
rt a[192:193],v6,0
rt a[194:195],v6,4096
rt a[224:225],v6,8192
rt a[226:227],v6,12288
mm v[36:39],a[196:199],v[28:31],v[36:39]
mm v[36:39],a[228:231],v[28:31],v[36:39]
mm v[136:139],a[200:203],a[96:99],v[136:139]
mm v[136:139],a[232:235],a[112:115],v[136:139]
buffer_load_dwordx4 a[80:83], v2, s[20:23], s45 offen sc1
mm v[168:171],a[200:203],a[100:103],v[168:171]
mm v[168:171],a[232:235],a[116:119],v[168:171]
mm v[200:203],a[200:203],a[104:107],v[200:203]
buffer_load_dwordx4 a[84:87], v3, s[20:23], s45 offen sc1
mm v[200:203],a[232:235],a[120:123],v[200:203]
mm v[232:235],a[200:203],a[108:111],v[232:235]
buffer_load_dwordx4 a[88:91], v4, s[20:23], s45 offen sc1
mm v[232:235],a[232:235],a[124:127],v[232:235]
rt a[196:197],v7,0
rt a[198:199],v7,4096
rt a[228:229],v7,8192
rt a[230:231],v7,12288
mm v[140:143],a[204:207],a[96:99],v[140:143]
mm v[140:143],a[236:239],a[112:115],v[140:143]
mm v[172:175],a[204:207],a[100:103],v[172:175]
mm v[172:175],a[236:239],a[116:119],v[172:175]
mm v[204:207],a[204:207],a[104:107],v[204:207]
buffer_load_dwordx4 a[92:95], v5, s[20:23], s45 offen sc1
mm v[204:207],a[236:239],a[120:123],v[204:207]
mm v[236:239],a[204:207],a[108:111],v[236:239]
mm v[236:239],a[236:239],a[124:127],v[236:239]
rt a[200:201],v8,0
rt a[202:203],v8,4096
rt a[232:233],v8,8192
rt a[234:235],v8,12288
mm v[144:147],a[208:211],a[96:99],v[144:147]
mm v[144:147],a[240:243],a[112:115],v[144:147]
mm v[176:179],a[208:211],a[100:103],v[176:179]
mm v[176:179],a[240:243],a[116:119],v[176:179]
s_add_u32 s45, s45, 1024
mm v[208:211],a[208:211],a[104:107],v[208:211]
rt a[204:205],v9,0
mm v[208:211],a[240:243],a[120:123],v[208:211]
s_add_u32 m0, s47, 49152
mm v[240:243],a[208:211],a[108:111],v[240:243]
rt a[206:207],v9,4096
mm v[240:243],a[240:243],a[124:127],v[240:243]
rt a[236:237],v9,8192
rt a[238:239],v9,12288
mm v[148:151],a[212:215],a[96:99],v[148:151]
mm v[148:151],a[244:247],a[112:115],v[148:151]
mm v[180:183],a[212:215],a[100:103],v[180:183]
buffer_load_dwordx4 v20, s[12:15], s46 offen offset:0 lds
mm v[180:183],a[244:247],a[116:119],v[180:183]
mm v[212:215],a[212:215],a[104:107],v[212:215]
rt a[208:209],v10,0
mm v[212:215],a[244:247],a[120:123],v[212:215]
buffer_load_dwordx4 v21, s[12:15], s46 offen offset:1024 lds
mm v[244:247],a[212:215],a[108:111],v[244:247]
mm v[244:247],a[244:247],a[124:127],v[244:247]
rt a[210:211],v10,4096
rt a[240:241],v10,8192
rt a[242:243],v10,12288
mm v[152:155],a[216:219],a[96:99],v[152:155]
mm v[152:155],a[248:251],a[112:115],v[152:155]
mm v[184:187],a[216:219],a[100:103],v[184:187]
rt a[212:213],v11,0
mm v[184:187],a[248:251],a[116:119],v[184:187]
buffer_load_dwordx4 v22, s[12:15], s46 offen offset:2048 lds
mm v[216:219],a[216:219],a[104:107],v[216:219]
mm v[216:219],a[248:251],a[120:123],v[216:219]
mm v[248:251],a[216:219],a[108:111],v[248:251]
rt a[214:215],v11,4096
mm v[248:251],a[248:251],a[124:127],v[248:251]
rt a[244:245],v11,8192
rt a[246:247],v11,12288
mm v[156:159],a[220:223],a[96:99],v[156:159]
mm v[156:159],a[252:255],a[112:115],v[156:159]
buffer_load_dwordx4 v23, s[12:15], s46 offen offset:3072 lds
mm v[188:191],a[220:223],a[100:103],v[188:191]
mm v[188:191],a[252:255],a[116:119],v[188:191]
rt a[216:217],v12,0
mm v[220:223],a[220:223],a[104:107],v[220:223]
rt a[218:219],v12,4096
mm v[220:223],a[252:255],a[120:123],v[220:223]
rt a[248:249],v12,8192
mm v[252:255],a[220:223],a[108:111],v[252:255]
s_add_u32 s46, s46, 458752
mm v[252:255],a[252:255],a[124:127],v[252:255]
rt a[250:251],v12,12288
s_waitcnt vmcnt(28) lgkmcnt(8)
mm v[128:131],a[192:195],a[0:3],v[128:131]
mm v[128:131],a[224:227],a[16:19],v[128:131]
buffer_load_dwordx4 a[96:99], v2, s[20:23], s45 offen sc1
mm v[160:163],a[192:195],a[4:7],v[160:163]
mm v[160:163],a[224:227],a[20:23],v[160:163]
buffer_load_dwordx4 a[100:103], v3, s[20:23], s45 offen sc1
mm v[192:195],a[192:195],a[8:11],v[192:195]
mm v[192:195],a[224:227],a[24:27],v[192:195]
rt a[220:221],v13,0
rt a[222:223],v13,4096
rt a[252:253],v13,8192
rt a[254:255],v13,12288
mm v[224:227],a[192:195],a[12:15],v[224:227]
mm v[224:227],a[224:227],a[28:31],v[224:227]
mm v[32:35],a[192:195],v[28:31],v[32:35]
mm v[32:35],a[224:227],v[28:31],v[32:35]
buffer_load_dwordx4 a[104:107], v4, s[20:23], s45 offen sc1
buffer_load_dwordx4 a[108:111], v5, s[20:23], s45 offen sc1
s_add_u32 s45, s45, 1024
mm v[132:135],a[196:199],a[0:3],v[132:135]
mm v[132:135],a[228:231],a[16:19],v[132:135]
s_waitcnt vmcnt(28) lgkmcnt(0)
s_barrier
mm v[164:167],a[196:199],a[4:7],v[164:167]
mm v[164:167],a[228:231],a[20:23],v[164:167]
mm v[196:199],a[196:199],a[8:11],v[196:199]
mm v[196:199],a[228:231],a[24:27],v[196:199]
mm v[228:231],a[196:199],a[12:15],v[228:231]
mm v[228:231],a[228:231],a[28:31],v[228:231]
rt a[192:193],v6,16384
rt a[194:195],v6,20480
rt a[224:225],v6,24576
rt a[226:227],v6,28672
mm v[36:39],a[196:199],v[28:31],v[36:39]
mm v[36:39],a[228:231],v[28:31],v[36:39]
mm v[136:139],a[200:203],a[0:3],v[136:139]
mm v[136:139],a[232:235],a[16:19],v[136:139]
buffer_load_dwordx4 a[112:115], v2, s[20:23], s45 offen sc1
mm v[168:171],a[200:203],a[4:7],v[168:171]
mm v[168:171],a[232:235],a[20:23],v[168:171]
mm v[200:203],a[200:203],a[8:11],v[200:203]
buffer_load_dwordx4 a[116:119], v3, s[20:23], s45 offen sc1
mm v[200:203],a[232:235],a[24:27],v[200:203]
mm v[232:235],a[200:203],a[12:15],v[232:235]
buffer_load_dwordx4 a[120:123], v4, s[20:23], s45 offen sc1
mm v[232:235],a[232:235],a[28:31],v[232:235]
rt a[196:197],v7,16384
rt a[198:199],v7,20480
rt a[228:229],v7,24576
rt a[230:231],v7,28672
mm v[140:143],a[204:207],a[0:3],v[140:143]
mm v[140:143],a[236:239],a[16:19],v[140:143]
mm v[172:175],a[204:207],a[4:7],v[172:175]
mm v[172:175],a[236:239],a[20:23],v[172:175]
mm v[204:207],a[204:207],a[8:11],v[204:207]
buffer_load_dwordx4 a[124:127], v5, s[20:23], s45 offen sc1
mm v[204:207],a[236:239],a[24:27],v[204:207]
mm v[236:239],a[204:207],a[12:15],v[236:239]
mm v[236:239],a[236:239],a[28:31],v[236:239]
rt a[200:201],v8,16384
rt a[202:203],v8,20480
rt a[232:233],v8,24576
rt a[234:235],v8,28672
mm v[144:147],a[208:211],a[0:3],v[144:147]
mm v[144:147],a[240:243],a[16:19],v[144:147]
mm v[176:179],a[208:211],a[4:7],v[176:179]
mm v[176:179],a[240:243],a[20:23],v[176:179]
s_add_u32 s45, s45, 1024
mm v[208:211],a[208:211],a[8:11],v[208:211]
rt a[204:205],v9,16384
mm v[208:211],a[240:243],a[24:27],v[208:211]
s_add_u32 m0, s47, 0
mm v[240:243],a[208:211],a[12:15],v[240:243]
rt a[206:207],v9,20480
mm v[240:243],a[240:243],a[28:31],v[240:243]
rt a[236:237],v9,24576
rt a[238:239],v9,28672
mm v[148:151],a[212:215],a[0:3],v[148:151]
mm v[148:151],a[244:247],a[16:19],v[148:151]
mm v[180:183],a[212:215],a[4:7],v[180:183]
buffer_load_dwordx4 v20, s[12:15], s46 offen offset:0 lds
mm v[180:183],a[244:247],a[20:23],v[180:183]
mm v[212:215],a[212:215],a[8:11],v[212:215]
rt a[208:209],v10,16384
mm v[212:215],a[244:247],a[24:27],v[212:215]
buffer_load_dwordx4 v21, s[12:15], s46 offen offset:1024 lds
mm v[244:247],a[212:215],a[12:15],v[244:247]
mm v[244:247],a[244:247],a[28:31],v[244:247]
rt a[210:211],v10,20480
rt a[240:241],v10,24576
rt a[242:243],v10,28672
mm v[152:155],a[216:219],a[0:3],v[152:155]
mm v[152:155],a[248:251],a[16:19],v[152:155]
mm v[184:187],a[216:219],a[4:7],v[184:187]
rt a[212:213],v11,16384
mm v[184:187],a[248:251],a[20:23],v[184:187]
buffer_load_dwordx4 v22, s[12:15], s46 offen offset:2048 lds
mm v[216:219],a[216:219],a[8:11],v[216:219]
mm v[216:219],a[248:251],a[24:27],v[216:219]
mm v[248:251],a[216:219],a[12:15],v[248:251]
rt a[214:215],v11,20480
mm v[248:251],a[248:251],a[28:31],v[248:251]
rt a[244:245],v11,24576
rt a[246:247],v11,28672
mm v[156:159],a[220:223],a[0:3],v[156:159]
mm v[156:159],a[252:255],a[16:19],v[156:159]
buffer_load_dwordx4 v23, s[12:15], s46 offen offset:3072 lds
mm v[188:191],a[220:223],a[4:7],v[188:191]
mm v[188:191],a[252:255],a[20:23],v[188:191]
rt a[216:217],v12,16384
mm v[220:223],a[220:223],a[8:11],v[220:223]
rt a[218:219],v12,20480
mm v[220:223],a[252:255],a[24:27],v[220:223]
rt a[248:249],v12,24576
mm v[252:255],a[220:223],a[12:15],v[252:255]
s_add_u32 s46, s46, 458752
mm v[252:255],a[252:255],a[28:31],v[252:255]
rt a[250:251],v12,28672
s_waitcnt vmcnt(28) lgkmcnt(8)
mm v[128:131],a[192:195],a[32:35],v[128:131]
mm v[128:131],a[224:227],a[48:51],v[128:131]
buffer_load_dwordx4 a[0:3], v2, s[20:23], s45 offen sc1
mm v[160:163],a[192:195],a[36:39],v[160:163]
mm v[160:163],a[224:227],a[52:55],v[160:163]
buffer_load_dwordx4 a[4:7], v3, s[20:23], s45 offen sc1
mm v[192:195],a[192:195],a[40:43],v[192:195]
mm v[192:195],a[224:227],a[56:59],v[192:195]
rt a[220:221],v13,16384
rt a[222:223],v13,20480
rt a[252:253],v13,24576
rt a[254:255],v13,28672
mm v[224:227],a[192:195],a[44:47],v[224:227]
mm v[224:227],a[224:227],a[60:63],v[224:227]
mm v[32:35],a[192:195],v[28:31],v[32:35]
mm v[32:35],a[224:227],v[28:31],v[32:35]
buffer_load_dwordx4 a[8:11], v4, s[20:23], s45 offen sc1
buffer_load_dwordx4 a[12:15], v5, s[20:23], s45 offen sc1
s_add_u32 s45, s45, 1024
mm v[132:135],a[196:199],a[32:35],v[132:135]
mm v[132:135],a[228:231],a[48:51],v[132:135]
s_waitcnt vmcnt(28) lgkmcnt(0)
s_barrier
mm v[164:167],a[196:199],a[36:39],v[164:167]
mm v[164:167],a[228:231],a[52:55],v[164:167]
mm v[196:199],a[196:199],a[40:43],v[196:199]
mm v[196:199],a[228:231],a[56:59],v[196:199]
mm v[228:231],a[196:199],a[44:47],v[228:231]
mm v[228:231],a[228:231],a[60:63],v[228:231]
rt a[192:193],v6,32768
rt a[194:195],v6,36864
rt a[224:225],v6,40960
rt a[226:227],v6,45056
mm v[36:39],a[196:199],v[28:31],v[36:39]
mm v[36:39],a[228:231],v[28:31],v[36:39]
mm v[136:139],a[200:203],a[32:35],v[136:139]
mm v[136:139],a[232:235],a[48:51],v[136:139]
buffer_load_dwordx4 a[16:19], v2, s[20:23], s45 offen sc1
mm v[168:171],a[200:203],a[36:39],v[168:171]
mm v[168:171],a[232:235],a[52:55],v[168:171]
mm v[200:203],a[200:203],a[40:43],v[200:203]
buffer_load_dwordx4 a[20:23], v3, s[20:23], s45 offen sc1
mm v[200:203],a[232:235],a[56:59],v[200:203]
mm v[232:235],a[200:203],a[44:47],v[232:235]
buffer_load_dwordx4 a[24:27], v4, s[20:23], s45 offen sc1
mm v[232:235],a[232:235],a[60:63],v[232:235]
rt a[196:197],v7,32768
rt a[198:199],v7,36864
rt a[228:229],v7,40960
rt a[230:231],v7,45056
mm v[140:143],a[204:207],a[32:35],v[140:143]
mm v[140:143],a[236:239],a[48:51],v[140:143]
mm v[172:175],a[204:207],a[36:39],v[172:175]
mm v[172:175],a[236:239],a[52:55],v[172:175]
mm v[204:207],a[204:207],a[40:43],v[204:207]
buffer_load_dwordx4 a[28:31], v5, s[20:23], s45 offen sc1
mm v[204:207],a[236:239],a[56:59],v[204:207]
mm v[236:239],a[204:207],a[44:47],v[236:239]
mm v[236:239],a[236:239],a[60:63],v[236:239]
rt a[200:201],v8,32768
rt a[202:203],v8,36864
rt a[232:233],v8,40960
rt a[234:235],v8,45056
mm v[144:147],a[208:211],a[32:35],v[144:147]
mm v[144:147],a[240:243],a[48:51],v[144:147]
mm v[176:179],a[208:211],a[36:39],v[176:179]
mm v[176:179],a[240:243],a[52:55],v[176:179]
s_add_u32 s45, s45, 1024
mm v[208:211],a[208:211],a[40:43],v[208:211]
rt a[204:205],v9,32768
mm v[208:211],a[240:243],a[56:59],v[208:211]
s_add_u32 m0, s47, 16384
mm v[240:243],a[208:211],a[44:47],v[240:243]
rt a[206:207],v9,36864
mm v[240:243],a[240:243],a[60:63],v[240:243]
rt a[236:237],v9,40960
rt a[238:239],v9,45056
mm v[148:151],a[212:215],a[32:35],v[148:151]
mm v[148:151],a[244:247],a[48:51],v[148:151]
mm v[180:183],a[212:215],a[36:39],v[180:183]
buffer_load_dwordx4 v20, s[12:15], s46 offen offset:0 lds
mm v[180:183],a[244:247],a[52:55],v[180:183]
mm v[212:215],a[212:215],a[40:43],v[212:215]
rt a[208:209],v10,32768
mm v[212:215],a[244:247],a[56:59],v[212:215]
buffer_load_dwordx4 v21, s[12:15], s46 offen offset:1024 lds
mm v[244:247],a[212:215],a[44:47],v[244:247]
mm v[244:247],a[244:247],a[60:63],v[244:247]
rt a[210:211],v10,36864
rt a[240:241],v10,40960
rt a[242:243],v10,45056
mm v[152:155],a[216:219],a[32:35],v[152:155]
mm v[152:155],a[248:251],a[48:51],v[152:155]
mm v[184:187],a[216:219],a[36:39],v[184:187]
rt a[212:213],v11,32768
mm v[184:187],a[248:251],a[52:55],v[184:187]
buffer_load_dwordx4 v22, s[12:15], s46 offen offset:2048 lds
mm v[216:219],a[216:219],a[40:43],v[216:219]
mm v[216:219],a[248:251],a[56:59],v[216:219]
mm v[248:251],a[216:219],a[44:47],v[248:251]
rt a[214:215],v11,36864
mm v[248:251],a[248:251],a[60:63],v[248:251]
rt a[244:245],v11,40960
rt a[246:247],v11,45056
mm v[156:159],a[220:223],a[32:35],v[156:159]
mm v[156:159],a[252:255],a[48:51],v[156:159]
buffer_load_dwordx4 v23, s[12:15], s46 offen offset:3072 lds
mm v[188:191],a[220:223],a[36:39],v[188:191]
mm v[188:191],a[252:255],a[52:55],v[188:191]
rt a[216:217],v12,32768
mm v[220:223],a[220:223],a[40:43],v[220:223]
rt a[218:219],v12,36864
mm v[220:223],a[252:255],a[56:59],v[220:223]
rt a[248:249],v12,40960
mm v[252:255],a[220:223],a[44:47],v[252:255]
s_add_u32 s46, s46, 458752
mm v[252:255],a[252:255],a[60:63],v[252:255]
rt a[250:251],v12,45056
s_waitcnt vmcnt(28) lgkmcnt(8)
mm v[128:131],a[192:195],a[64:67],v[128:131]
mm v[128:131],a[224:227],a[80:83],v[128:131]
buffer_load_dwordx4 a[32:35], v2, s[20:23], s45 offen sc1
mm v[160:163],a[192:195],a[68:71],v[160:163]
mm v[160:163],a[224:227],a[84:87],v[160:163]
buffer_load_dwordx4 a[36:39], v3, s[20:23], s45 offen sc1
mm v[192:195],a[192:195],a[72:75],v[192:195]
mm v[192:195],a[224:227],a[88:91],v[192:195]
rt a[220:221],v13,32768
rt a[222:223],v13,36864
rt a[252:253],v13,40960
rt a[254:255],v13,45056
mm v[224:227],a[192:195],a[76:79],v[224:227]
mm v[224:227],a[224:227],a[92:95],v[224:227]
mm v[32:35],a[192:195],v[28:31],v[32:35]
mm v[32:35],a[224:227],v[28:31],v[32:35]
buffer_load_dwordx4 a[40:43], v4, s[20:23], s45 offen sc1
buffer_load_dwordx4 a[44:47], v5, s[20:23], s45 offen sc1
s_add_u32 s45, s45, 1024
mm v[132:135],a[196:199],a[64:67],v[132:135]
mm v[132:135],a[228:231],a[80:83],v[132:135]
s_waitcnt vmcnt(28) lgkmcnt(0)
s_barrier
mm v[164:167],a[196:199],a[68:71],v[164:167]
mm v[164:167],a[228:231],a[84:87],v[164:167]
mm v[196:199],a[196:199],a[72:75],v[196:199]
mm v[196:199],a[228:231],a[88:91],v[196:199]
mm v[228:231],a[196:199],a[76:79],v[228:231]
mm v[228:231],a[228:231],a[92:95],v[228:231]
rt a[192:193],v6,49152
rt a[194:195],v6,53248
rt a[224:225],v6,57344
rt a[226:227],v6,61440
mm v[36:39],a[196:199],v[28:31],v[36:39]
mm v[36:39],a[228:231],v[28:31],v[36:39]
mm v[136:139],a[200:203],a[64:67],v[136:139]
mm v[136:139],a[232:235],a[80:83],v[136:139]
buffer_load_dwordx4 a[48:51], v2, s[20:23], s45 offen sc1
mm v[168:171],a[200:203],a[68:71],v[168:171]
mm v[168:171],a[232:235],a[84:87],v[168:171]
mm v[200:203],a[200:203],a[72:75],v[200:203]
buffer_load_dwordx4 a[52:55], v3, s[20:23], s45 offen sc1
mm v[200:203],a[232:235],a[88:91],v[200:203]
mm v[232:235],a[200:203],a[76:79],v[232:235]
buffer_load_dwordx4 a[56:59], v4, s[20:23], s45 offen sc1
mm v[232:235],a[232:235],a[92:95],v[232:235]
rt a[196:197],v7,49152
rt a[198:199],v7,53248
rt a[228:229],v7,57344
rt a[230:231],v7,61440
mm v[140:143],a[204:207],a[64:67],v[140:143]
mm v[140:143],a[236:239],a[80:83],v[140:143]
mm v[172:175],a[204:207],a[68:71],v[172:175]
mm v[172:175],a[236:239],a[84:87],v[172:175]
mm v[204:207],a[204:207],a[72:75],v[204:207]
buffer_load_dwordx4 a[60:63], v5, s[20:23], s45 offen sc1
mm v[204:207],a[236:239],a[88:91],v[204:207]
mm v[236:239],a[204:207],a[76:79],v[236:239]
mm v[236:239],a[236:239],a[92:95],v[236:239]
rt a[200:201],v8,49152
rt a[202:203],v8,53248
rt a[232:233],v8,57344
rt a[234:235],v8,61440
mm v[144:147],a[208:211],a[64:67],v[144:147]
mm v[144:147],a[240:243],a[80:83],v[144:147]
mm v[176:179],a[208:211],a[68:71],v[176:179]
mm v[176:179],a[240:243],a[84:87],v[176:179]
s_add_u32 s45, s45, 1024
mm v[208:211],a[208:211],a[72:75],v[208:211]
rt a[204:205],v9,49152
mm v[208:211],a[240:243],a[88:91],v[208:211]
s_add_u32 m0, s47, 32768
mm v[240:243],a[208:211],a[76:79],v[240:243]
rt a[206:207],v9,53248
mm v[240:243],a[240:243],a[92:95],v[240:243]
rt a[236:237],v9,57344
rt a[238:239],v9,61440
mm v[148:151],a[212:215],a[64:67],v[148:151]
mm v[148:151],a[244:247],a[80:83],v[148:151]
mm v[180:183],a[212:215],a[68:71],v[180:183]
buffer_load_dwordx4 v20, s[12:15], s46 offen offset:0 lds
mm v[180:183],a[244:247],a[84:87],v[180:183]
mm v[212:215],a[212:215],a[72:75],v[212:215]
rt a[208:209],v10,49152
mm v[212:215],a[244:247],a[88:91],v[212:215]
buffer_load_dwordx4 v21, s[12:15], s46 offen offset:1024 lds
mm v[244:247],a[212:215],a[76:79],v[244:247]
mm v[244:247],a[244:247],a[92:95],v[244:247]
rt a[210:211],v10,53248
rt a[240:241],v10,57344
rt a[242:243],v10,61440
mm v[152:155],a[216:219],a[64:67],v[152:155]
mm v[152:155],a[248:251],a[80:83],v[152:155]
mm v[184:187],a[216:219],a[68:71],v[184:187]
rt a[212:213],v11,49152
mm v[184:187],a[248:251],a[84:87],v[184:187]
buffer_load_dwordx4 v22, s[12:15], s46 offen offset:2048 lds
mm v[216:219],a[216:219],a[72:75],v[216:219]
mm v[216:219],a[248:251],a[88:91],v[216:219]
mm v[248:251],a[216:219],a[76:79],v[248:251]
rt a[214:215],v11,53248
mm v[248:251],a[248:251],a[92:95],v[248:251]
rt a[244:245],v11,57344
rt a[246:247],v11,61440
mm v[156:159],a[220:223],a[64:67],v[156:159]
mm v[156:159],a[252:255],a[80:83],v[156:159]
buffer_load_dwordx4 v23, s[12:15], s46 offen offset:3072 lds
mm v[188:191],a[220:223],a[68:71],v[188:191]
mm v[188:191],a[252:255],a[84:87],v[188:191]
rt a[216:217],v12,49152
mm v[220:223],a[220:223],a[72:75],v[220:223]
rt a[218:219],v12,53248
mm v[220:223],a[252:255],a[88:91],v[220:223]
rt a[248:249],v12,57344
mm v[252:255],a[220:223],a[76:79],v[252:255]
s_add_u32 s46, s46, 458752
mm v[252:255],a[252:255],a[92:95],v[252:255]
rt a[250:251],v12,61440
s_waitcnt vmcnt(28) lgkmcnt(8)
mm v[128:131],a[192:195],a[96:99],v[128:131]
mm v[128:131],a[224:227],a[112:115],v[128:131]
buffer_load_dwordx4 a[64:67], v2, s[20:23], s45 offen sc1
mm v[160:163],a[192:195],a[100:103],v[160:163]
mm v[160:163],a[224:227],a[116:119],v[160:163]
buffer_load_dwordx4 a[68:71], v3, s[20:23], s45 offen sc1
mm v[192:195],a[192:195],a[104:107],v[192:195]
mm v[192:195],a[224:227],a[120:123],v[192:195]
rt a[220:221],v13,49152
rt a[222:223],v13,53248
rt a[252:253],v13,57344
rt a[254:255],v13,61440
mm v[224:227],a[192:195],a[108:111],v[224:227]
mm v[224:227],a[224:227],a[124:127],v[224:227]
mm v[32:35],a[192:195],v[28:31],v[32:35]
mm v[32:35],a[224:227],v[28:31],v[32:35]
buffer_load_dwordx4 a[72:75], v4, s[20:23], s45 offen sc1
buffer_load_dwordx4 a[76:79], v5, s[20:23], s45 offen sc1
s_add_u32 s45, s45, 1024
mm v[132:135],a[196:199],a[96:99],v[132:135]
mm v[132:135],a[228:231],a[112:115],v[132:135]
s_waitcnt vmcnt(28) lgkmcnt(0)
s_barrier
mm v[164:167],a[196:199],a[100:103],v[164:167]
mm v[164:167],a[228:231],a[116:119],v[164:167]
mm v[196:199],a[196:199],a[104:107],v[196:199]
mm v[196:199],a[228:231],a[120:123],v[196:199]
mm v[228:231],a[196:199],a[108:111],v[228:231]
mm v[228:231],a[228:231],a[124:127],v[228:231]
rt a[192:193],v6,0
rt a[194:195],v6,4096
rt a[224:225],v6,8192
rt a[226:227],v6,12288
mm v[36:39],a[196:199],v[28:31],v[36:39]
mm v[36:39],a[228:231],v[28:31],v[36:39]
mm v[136:139],a[200:203],a[96:99],v[136:139]
mm v[136:139],a[232:235],a[112:115],v[136:139]
buffer_load_dwordx4 a[80:83], v2, s[20:23], s45 offen sc1
mm v[168:171],a[200:203],a[100:103],v[168:171]
mm v[168:171],a[232:235],a[116:119],v[168:171]
mm v[200:203],a[200:203],a[104:107],v[200:203]
buffer_load_dwordx4 a[84:87], v3, s[20:23], s45 offen sc1
mm v[200:203],a[232:235],a[120:123],v[200:203]
mm v[232:235],a[200:203],a[108:111],v[232:235]
buffer_load_dwordx4 a[88:91], v4, s[20:23], s45 offen sc1
mm v[232:235],a[232:235],a[124:127],v[232:235]
rt a[196:197],v7,0
rt a[198:199],v7,4096
rt a[228:229],v7,8192
rt a[230:231],v7,12288
mm v[140:143],a[204:207],a[96:99],v[140:143]
mm v[140:143],a[236:239],a[112:115],v[140:143]
mm v[172:175],a[204:207],a[100:103],v[172:175]
mm v[172:175],a[236:239],a[116:119],v[172:175]
mm v[204:207],a[204:207],a[104:107],v[204:207]
buffer_load_dwordx4 a[92:95], v5, s[20:23], s45 offen sc1
mm v[204:207],a[236:239],a[120:123],v[204:207]
mm v[236:239],a[204:207],a[108:111],v[236:239]
mm v[236:239],a[236:239],a[124:127],v[236:239]
rt a[200:201],v8,0
rt a[202:203],v8,4096
rt a[232:233],v8,8192
rt a[234:235],v8,12288
mm v[144:147],a[208:211],a[96:99],v[144:147]
mm v[144:147],a[240:243],a[112:115],v[144:147]
mm v[176:179],a[208:211],a[100:103],v[176:179]
mm v[176:179],a[240:243],a[116:119],v[176:179]
s_add_u32 s45, s45, 1024
mm v[208:211],a[208:211],a[104:107],v[208:211]
rt a[204:205],v9,0
mm v[208:211],a[240:243],a[120:123],v[208:211]
s_add_u32 m0, s47, 49152
mm v[240:243],a[208:211],a[108:111],v[240:243]
rt a[206:207],v9,4096
mm v[240:243],a[240:243],a[124:127],v[240:243]
rt a[236:237],v9,8192
rt a[238:239],v9,12288
mm v[148:151],a[212:215],a[96:99],v[148:151]
mm v[148:151],a[244:247],a[112:115],v[148:151]
mm v[180:183],a[212:215],a[100:103],v[180:183]
buffer_load_dwordx4 v20, s[12:15], s46 offen offset:0 lds
mm v[180:183],a[244:247],a[116:119],v[180:183]
mm v[212:215],a[212:215],a[104:107],v[212:215]
rt a[208:209],v10,0
mm v[212:215],a[244:247],a[120:123],v[212:215]
buffer_load_dwordx4 v21, s[12:15], s46 offen offset:1024 lds
mm v[244:247],a[212:215],a[108:111],v[244:247]
mm v[244:247],a[244:247],a[124:127],v[244:247]
rt a[210:211],v10,4096
rt a[240:241],v10,8192
rt a[242:243],v10,12288
mm v[152:155],a[216:219],a[96:99],v[152:155]
mm v[152:155],a[248:251],a[112:115],v[152:155]
mm v[184:187],a[216:219],a[100:103],v[184:187]
rt a[212:213],v11,0
mm v[184:187],a[248:251],a[116:119],v[184:187]
buffer_load_dwordx4 v22, s[12:15], s46 offen offset:2048 lds
mm v[216:219],a[216:219],a[104:107],v[216:219]
mm v[216:219],a[248:251],a[120:123],v[216:219]
mm v[248:251],a[216:219],a[108:111],v[248:251]
rt a[214:215],v11,4096
mm v[248:251],a[248:251],a[124:127],v[248:251]
rt a[244:245],v11,8192
rt a[246:247],v11,12288
mm v[156:159],a[220:223],a[96:99],v[156:159]
mm v[156:159],a[252:255],a[112:115],v[156:159]
buffer_load_dwordx4 v23, s[12:15], s46 offen offset:3072 lds
mm v[188:191],a[220:223],a[100:103],v[188:191]
mm v[188:191],a[252:255],a[116:119],v[188:191]
rt a[216:217],v12,0
mm v[220:223],a[220:223],a[104:107],v[220:223]
rt a[218:219],v12,4096
mm v[220:223],a[252:255],a[120:123],v[220:223]
rt a[248:249],v12,8192
mm v[252:255],a[220:223],a[108:111],v[252:255]
s_add_u32 s46, s46, 458752
mm v[252:255],a[252:255],a[124:127],v[252:255]
rt a[250:251],v12,12288
s_waitcnt vmcnt(28) lgkmcnt(8)
mm v[128:131],a[192:195],a[0:3],v[128:131]
mm v[128:131],a[224:227],a[16:19],v[128:131]
buffer_load_dwordx4 a[96:99], v2, s[20:23], s45 offen sc1
mm v[160:163],a[192:195],a[4:7],v[160:163]
mm v[160:163],a[224:227],a[20:23],v[160:163]
buffer_load_dwordx4 a[100:103], v3, s[20:23], s45 offen sc1
mm v[192:195],a[192:195],a[8:11],v[192:195]
mm v[192:195],a[224:227],a[24:27],v[192:195]
rt a[220:221],v13,0
rt a[222:223],v13,4096
rt a[252:253],v13,8192
rt a[254:255],v13,12288
mm v[224:227],a[192:195],a[12:15],v[224:227]
mm v[224:227],a[224:227],a[28:31],v[224:227]
mm v[32:35],a[192:195],v[28:31],v[32:35]
mm v[32:35],a[224:227],v[28:31],v[32:35]
buffer_load_dwordx4 a[104:107], v4, s[20:23], s45 offen sc1
buffer_load_dwordx4 a[108:111], v5, s[20:23], s45 offen sc1
s_add_u32 s45, s45, 1024
mm v[132:135],a[196:199],a[0:3],v[132:135]
mm v[132:135],a[228:231],a[16:19],v[132:135]
s_waitcnt vmcnt(28) lgkmcnt(0)
s_barrier
mm v[164:167],a[196:199],a[4:7],v[164:167]
mm v[164:167],a[228:231],a[20:23],v[164:167]
mm v[196:199],a[196:199],a[8:11],v[196:199]
mm v[196:199],a[228:231],a[24:27],v[196:199]
mm v[228:231],a[196:199],a[12:15],v[228:231]
mm v[228:231],a[228:231],a[28:31],v[228:231]
rt a[192:193],v6,16384
rt a[194:195],v6,20480
rt a[224:225],v6,24576
rt a[226:227],v6,28672
mm v[36:39],a[196:199],v[28:31],v[36:39]
mm v[36:39],a[228:231],v[28:31],v[36:39]
mm v[136:139],a[200:203],a[0:3],v[136:139]
mm v[136:139],a[232:235],a[16:19],v[136:139]
buffer_load_dwordx4 a[112:115], v2, s[20:23], s45 offen sc1
mm v[168:171],a[200:203],a[4:7],v[168:171]
mm v[168:171],a[232:235],a[20:23],v[168:171]
mm v[200:203],a[200:203],a[8:11],v[200:203]
buffer_load_dwordx4 a[116:119], v3, s[20:23], s45 offen sc1
mm v[200:203],a[232:235],a[24:27],v[200:203]
mm v[232:235],a[200:203],a[12:15],v[232:235]
buffer_load_dwordx4 a[120:123], v4, s[20:23], s45 offen sc1
mm v[232:235],a[232:235],a[28:31],v[232:235]
rt a[196:197],v7,16384
rt a[198:199],v7,20480
rt a[228:229],v7,24576
rt a[230:231],v7,28672
mm v[140:143],a[204:207],a[0:3],v[140:143]
mm v[140:143],a[236:239],a[16:19],v[140:143]
mm v[172:175],a[204:207],a[4:7],v[172:175]
mm v[172:175],a[236:239],a[20:23],v[172:175]
mm v[204:207],a[204:207],a[8:11],v[204:207]
buffer_load_dwordx4 a[124:127], v5, s[20:23], s45 offen sc1
mm v[204:207],a[236:239],a[24:27],v[204:207]
mm v[236:239],a[204:207],a[12:15],v[236:239]
mm v[236:239],a[236:239],a[28:31],v[236:239]
rt a[200:201],v8,16384
rt a[202:203],v8,20480
rt a[232:233],v8,24576
rt a[234:235],v8,28672
mm v[144:147],a[208:211],a[0:3],v[144:147]
mm v[144:147],a[240:243],a[16:19],v[144:147]
mm v[176:179],a[208:211],a[4:7],v[176:179]
mm v[176:179],a[240:243],a[20:23],v[176:179]
s_add_u32 s45, s45, 1024
mm v[208:211],a[208:211],a[8:11],v[208:211]
rt a[204:205],v9,16384
mm v[208:211],a[240:243],a[24:27],v[208:211]
s_add_u32 m0, s47, 0
mm v[240:243],a[208:211],a[12:15],v[240:243]
rt a[206:207],v9,20480
mm v[240:243],a[240:243],a[28:31],v[240:243]
rt a[236:237],v9,24576
rt a[238:239],v9,28672
mm v[148:151],a[212:215],a[0:3],v[148:151]
mm v[148:151],a[244:247],a[16:19],v[148:151]
mm v[180:183],a[212:215],a[4:7],v[180:183]
buffer_load_dwordx4 v20, s[12:15], s46 offen offset:0 lds
mm v[180:183],a[244:247],a[20:23],v[180:183]
mm v[212:215],a[212:215],a[8:11],v[212:215]
rt a[208:209],v10,16384
mm v[212:215],a[244:247],a[24:27],v[212:215]
buffer_load_dwordx4 v21, s[12:15], s46 offen offset:1024 lds
mm v[244:247],a[212:215],a[12:15],v[244:247]
mm v[244:247],a[244:247],a[28:31],v[244:247]
rt a[210:211],v10,20480
rt a[240:241],v10,24576
rt a[242:243],v10,28672
mm v[152:155],a[216:219],a[0:3],v[152:155]
mm v[152:155],a[248:251],a[16:19],v[152:155]
mm v[184:187],a[216:219],a[4:7],v[184:187]
rt a[212:213],v11,16384
mm v[184:187],a[248:251],a[20:23],v[184:187]
buffer_load_dwordx4 v22, s[12:15], s46 offen offset:2048 lds
mm v[216:219],a[216:219],a[8:11],v[216:219]
mm v[216:219],a[248:251],a[24:27],v[216:219]
mm v[248:251],a[216:219],a[12:15],v[248:251]
rt a[214:215],v11,20480
mm v[248:251],a[248:251],a[28:31],v[248:251]
rt a[244:245],v11,24576
rt a[246:247],v11,28672
mm v[156:159],a[220:223],a[0:3],v[156:159]
mm v[156:159],a[252:255],a[16:19],v[156:159]
buffer_load_dwordx4 v23, s[12:15], s46 offen offset:3072 lds
mm v[188:191],a[220:223],a[4:7],v[188:191]
mm v[188:191],a[252:255],a[20:23],v[188:191]
rt a[216:217],v12,16384
mm v[220:223],a[220:223],a[8:11],v[220:223]
rt a[218:219],v12,20480
mm v[220:223],a[252:255],a[24:27],v[220:223]
rt a[248:249],v12,24576
mm v[252:255],a[220:223],a[12:15],v[252:255]
s_add_u32 s46, s46, 458752
mm v[252:255],a[252:255],a[28:31],v[252:255]
rt a[250:251],v12,28672
s_waitcnt vmcnt(28) lgkmcnt(8)
mm v[128:131],a[192:195],a[32:35],v[128:131]
mm v[128:131],a[224:227],a[48:51],v[128:131]
buffer_load_dwordx4 a[0:3], v2, s[20:23], s45 offen sc1
mm v[160:163],a[192:195],a[36:39],v[160:163]
mm v[160:163],a[224:227],a[52:55],v[160:163]
buffer_load_dwordx4 a[4:7], v3, s[20:23], s45 offen sc1
mm v[192:195],a[192:195],a[40:43],v[192:195]
mm v[192:195],a[224:227],a[56:59],v[192:195]
rt a[220:221],v13,16384
rt a[222:223],v13,20480
rt a[252:253],v13,24576
rt a[254:255],v13,28672
mm v[224:227],a[192:195],a[44:47],v[224:227]
mm v[224:227],a[224:227],a[60:63],v[224:227]
mm v[32:35],a[192:195],v[28:31],v[32:35]
mm v[32:35],a[224:227],v[28:31],v[32:35]
buffer_load_dwordx4 a[8:11], v4, s[20:23], s45 offen sc1
buffer_load_dwordx4 a[12:15], v5, s[20:23], s45 offen sc1
s_add_u32 s45, s45, 1024
mm v[132:135],a[196:199],a[32:35],v[132:135]
mm v[132:135],a[228:231],a[48:51],v[132:135]
s_waitcnt vmcnt(28) lgkmcnt(0)
s_barrier
mm v[164:167],a[196:199],a[36:39],v[164:167]
mm v[164:167],a[228:231],a[52:55],v[164:167]
mm v[196:199],a[196:199],a[40:43],v[196:199]
mm v[196:199],a[228:231],a[56:59],v[196:199]
mm v[228:231],a[196:199],a[44:47],v[228:231]
mm v[228:231],a[228:231],a[60:63],v[228:231]
rt a[192:193],v6,32768
rt a[194:195],v6,36864
rt a[224:225],v6,40960
rt a[226:227],v6,45056
mm v[36:39],a[196:199],v[28:31],v[36:39]
mm v[36:39],a[228:231],v[28:31],v[36:39]
mm v[136:139],a[200:203],a[32:35],v[136:139]
mm v[136:139],a[232:235],a[48:51],v[136:139]
buffer_load_dwordx4 a[16:19], v2, s[20:23], s45 offen sc1
mm v[168:171],a[200:203],a[36:39],v[168:171]
mm v[168:171],a[232:235],a[52:55],v[168:171]
mm v[200:203],a[200:203],a[40:43],v[200:203]
buffer_load_dwordx4 a[20:23], v3, s[20:23], s45 offen sc1
mm v[200:203],a[232:235],a[56:59],v[200:203]
mm v[232:235],a[200:203],a[44:47],v[232:235]
buffer_load_dwordx4 a[24:27], v4, s[20:23], s45 offen sc1
mm v[232:235],a[232:235],a[60:63],v[232:235]
rt a[196:197],v7,32768
rt a[198:199],v7,36864
rt a[228:229],v7,40960
rt a[230:231],v7,45056
mm v[140:143],a[204:207],a[32:35],v[140:143]
mm v[140:143],a[236:239],a[48:51],v[140:143]
mm v[172:175],a[204:207],a[36:39],v[172:175]
mm v[172:175],a[236:239],a[52:55],v[172:175]
mm v[204:207],a[204:207],a[40:43],v[204:207]
buffer_load_dwordx4 a[28:31], v5, s[20:23], s45 offen sc1
mm v[204:207],a[236:239],a[56:59],v[204:207]
mm v[236:239],a[204:207],a[44:47],v[236:239]
mm v[236:239],a[236:239],a[60:63],v[236:239]
rt a[200:201],v8,32768
rt a[202:203],v8,36864
rt a[232:233],v8,40960
rt a[234:235],v8,45056
mm v[144:147],a[208:211],a[32:35],v[144:147]
mm v[144:147],a[240:243],a[48:51],v[144:147]
mm v[176:179],a[208:211],a[36:39],v[176:179]
mm v[176:179],a[240:243],a[52:55],v[176:179]
s_add_u32 s45, s45, 1024
mm v[208:211],a[208:211],a[40:43],v[208:211]
rt a[204:205],v9,32768
mm v[208:211],a[240:243],a[56:59],v[208:211]
s_add_u32 m0, s47, 16384
mm v[240:243],a[208:211],a[44:47],v[240:243]
rt a[206:207],v9,36864
mm v[240:243],a[240:243],a[60:63],v[240:243]
rt a[236:237],v9,40960
rt a[238:239],v9,45056
mm v[148:151],a[212:215],a[32:35],v[148:151]
mm v[148:151],a[244:247],a[48:51],v[148:151]
mm v[180:183],a[212:215],a[36:39],v[180:183]
buffer_load_dwordx4 v20, s[12:15], s46 offen offset:0 lds
mm v[180:183],a[244:247],a[52:55],v[180:183]
mm v[212:215],a[212:215],a[40:43],v[212:215]
rt a[208:209],v10,32768
mm v[212:215],a[244:247],a[56:59],v[212:215]
buffer_load_dwordx4 v21, s[12:15], s46 offen offset:1024 lds
mm v[244:247],a[212:215],a[44:47],v[244:247]
mm v[244:247],a[244:247],a[60:63],v[244:247]
rt a[210:211],v10,36864
rt a[240:241],v10,40960
rt a[242:243],v10,45056
mm v[152:155],a[216:219],a[32:35],v[152:155]
mm v[152:155],a[248:251],a[48:51],v[152:155]
mm v[184:187],a[216:219],a[36:39],v[184:187]
rt a[212:213],v11,32768
mm v[184:187],a[248:251],a[52:55],v[184:187]
buffer_load_dwordx4 v22, s[12:15], s46 offen offset:2048 lds
mm v[216:219],a[216:219],a[40:43],v[216:219]
mm v[216:219],a[248:251],a[56:59],v[216:219]
mm v[248:251],a[216:219],a[44:47],v[248:251]
rt a[214:215],v11,36864
mm v[248:251],a[248:251],a[60:63],v[248:251]
rt a[244:245],v11,40960
rt a[246:247],v11,45056
mm v[156:159],a[220:223],a[32:35],v[156:159]
mm v[156:159],a[252:255],a[48:51],v[156:159]
buffer_load_dwordx4 v23, s[12:15], s46 offen offset:3072 lds
mm v[188:191],a[220:223],a[36:39],v[188:191]
mm v[188:191],a[252:255],a[52:55],v[188:191]
rt a[216:217],v12,32768
mm v[220:223],a[220:223],a[40:43],v[220:223]
rt a[218:219],v12,36864
mm v[220:223],a[252:255],a[56:59],v[220:223]
rt a[248:249],v12,40960
mm v[252:255],a[220:223],a[44:47],v[252:255]
s_add_u32 s46, s46, 458752
mm v[252:255],a[252:255],a[60:63],v[252:255]
rt a[250:251],v12,45056
s_waitcnt vmcnt(28) lgkmcnt(8)
mm v[128:131],a[192:195],a[64:67],v[128:131]
mm v[128:131],a[224:227],a[80:83],v[128:131]
buffer_load_dwordx4 a[32:35], v2, s[20:23], s45 offen sc1
mm v[160:163],a[192:195],a[68:71],v[160:163]
mm v[160:163],a[224:227],a[84:87],v[160:163]
buffer_load_dwordx4 a[36:39], v3, s[20:23], s45 offen sc1
mm v[192:195],a[192:195],a[72:75],v[192:195]
mm v[192:195],a[224:227],a[88:91],v[192:195]
rt a[220:221],v13,32768
rt a[222:223],v13,36864
rt a[252:253],v13,40960
rt a[254:255],v13,45056
mm v[224:227],a[192:195],a[76:79],v[224:227]
mm v[224:227],a[224:227],a[92:95],v[224:227]
mm v[32:35],a[192:195],v[28:31],v[32:35]
mm v[32:35],a[224:227],v[28:31],v[32:35]
buffer_load_dwordx4 a[40:43], v4, s[20:23], s45 offen sc1
buffer_load_dwordx4 a[44:47], v5, s[20:23], s45 offen sc1
s_add_u32 s45, s45, 1024
mm v[132:135],a[196:199],a[64:67],v[132:135]
mm v[132:135],a[228:231],a[80:83],v[132:135]
s_waitcnt vmcnt(28) lgkmcnt(0)
s_barrier
mm v[164:167],a[196:199],a[68:71],v[164:167]
mm v[164:167],a[228:231],a[84:87],v[164:167]
mm v[196:199],a[196:199],a[72:75],v[196:199]
mm v[196:199],a[228:231],a[88:91],v[196:199]
mm v[228:231],a[196:199],a[76:79],v[228:231]
mm v[228:231],a[228:231],a[92:95],v[228:231]
rt a[192:193],v6,49152
rt a[194:195],v6,53248
rt a[224:225],v6,57344
rt a[226:227],v6,61440
mm v[36:39],a[196:199],v[28:31],v[36:39]
mm v[36:39],a[228:231],v[28:31],v[36:39]
mm v[136:139],a[200:203],a[64:67],v[136:139]
mm v[136:139],a[232:235],a[80:83],v[136:139]
buffer_load_dwordx4 a[48:51], v2, s[20:23], s45 offen sc1
mm v[168:171],a[200:203],a[68:71],v[168:171]
mm v[168:171],a[232:235],a[84:87],v[168:171]
mm v[200:203],a[200:203],a[72:75],v[200:203]
buffer_load_dwordx4 a[52:55], v3, s[20:23], s45 offen sc1
mm v[200:203],a[232:235],a[88:91],v[200:203]
mm v[232:235],a[200:203],a[76:79],v[232:235]
buffer_load_dwordx4 a[56:59], v4, s[20:23], s45 offen sc1
mm v[232:235],a[232:235],a[92:95],v[232:235]
rt a[196:197],v7,49152
rt a[198:199],v7,53248
rt a[228:229],v7,57344
rt a[230:231],v7,61440
mm v[140:143],a[204:207],a[64:67],v[140:143]
mm v[140:143],a[236:239],a[80:83],v[140:143]
mm v[172:175],a[204:207],a[68:71],v[172:175]
mm v[172:175],a[236:239],a[84:87],v[172:175]
mm v[204:207],a[204:207],a[72:75],v[204:207]
buffer_load_dwordx4 a[60:63], v5, s[20:23], s45 offen sc1
mm v[204:207],a[236:239],a[88:91],v[204:207]
mm v[236:239],a[204:207],a[76:79],v[236:239]
mm v[236:239],a[236:239],a[92:95],v[236:239]
rt a[200:201],v8,49152
rt a[202:203],v8,53248
rt a[232:233],v8,57344
rt a[234:235],v8,61440
mm v[144:147],a[208:211],a[64:67],v[144:147]
mm v[144:147],a[240:243],a[80:83],v[144:147]
mm v[176:179],a[208:211],a[68:71],v[176:179]
mm v[176:179],a[240:243],a[84:87],v[176:179]
s_add_u32 s45, s45, 1024
mm v[208:211],a[208:211],a[72:75],v[208:211]
rt a[204:205],v9,49152
mm v[208:211],a[240:243],a[88:91],v[208:211]
s_add_u32 m0, s47, 32768
mm v[240:243],a[208:211],a[76:79],v[240:243]
rt a[206:207],v9,53248
mm v[240:243],a[240:243],a[92:95],v[240:243]
rt a[236:237],v9,57344
rt a[238:239],v9,61440
mm v[148:151],a[212:215],a[64:67],v[148:151]
mm v[148:151],a[244:247],a[80:83],v[148:151]
mm v[180:183],a[212:215],a[68:71],v[180:183]
buffer_load_dwordx4 v20, s[12:15], s46 offen offset:0 lds
mm v[180:183],a[244:247],a[84:87],v[180:183]
mm v[212:215],a[212:215],a[72:75],v[212:215]
rt a[208:209],v10,49152
mm v[212:215],a[244:247],a[88:91],v[212:215]
buffer_load_dwordx4 v21, s[12:15], s46 offen offset:1024 lds
mm v[244:247],a[212:215],a[76:79],v[244:247]
mm v[244:247],a[244:247],a[92:95],v[244:247]
rt a[210:211],v10,53248
rt a[240:241],v10,57344
rt a[242:243],v10,61440
mm v[152:155],a[216:219],a[64:67],v[152:155]
mm v[152:155],a[248:251],a[80:83],v[152:155]
mm v[184:187],a[216:219],a[68:71],v[184:187]
rt a[212:213],v11,49152
mm v[184:187],a[248:251],a[84:87],v[184:187]
buffer_load_dwordx4 v22, s[12:15], s46 offen offset:2048 lds
mm v[216:219],a[216:219],a[72:75],v[216:219]
mm v[216:219],a[248:251],a[88:91],v[216:219]
mm v[248:251],a[216:219],a[76:79],v[248:251]
rt a[214:215],v11,53248
mm v[248:251],a[248:251],a[92:95],v[248:251]
rt a[244:245],v11,57344
rt a[246:247],v11,61440
mm v[156:159],a[220:223],a[64:67],v[156:159]
mm v[156:159],a[252:255],a[80:83],v[156:159]
buffer_load_dwordx4 v23, s[12:15], s46 offen offset:3072 lds
mm v[188:191],a[220:223],a[68:71],v[188:191]
mm v[188:191],a[252:255],a[84:87],v[188:191]
rt a[216:217],v12,49152
mm v[220:223],a[220:223],a[72:75],v[220:223]
rt a[218:219],v12,53248
mm v[220:223],a[252:255],a[88:91],v[220:223]
rt a[248:249],v12,57344
mm v[252:255],a[220:223],a[76:79],v[252:255]
s_add_u32 s46, s46, 458752
mm v[252:255],a[252:255],a[92:95],v[252:255]
rt a[250:251],v12,61440
s_waitcnt vmcnt(28) lgkmcnt(8)
mm v[128:131],a[192:195],a[96:99],v[128:131]
mm v[128:131],a[224:227],a[112:115],v[128:131]
buffer_load_dwordx4 a[64:67], v2, s[20:23], s45 offen sc1
mm v[160:163],a[192:195],a[100:103],v[160:163]
mm v[160:163],a[224:227],a[116:119],v[160:163]
buffer_load_dwordx4 a[68:71], v3, s[20:23], s45 offen sc1
mm v[192:195],a[192:195],a[104:107],v[192:195]
mm v[192:195],a[224:227],a[120:123],v[192:195]
rt a[220:221],v13,49152
rt a[222:223],v13,53248
rt a[252:253],v13,57344
rt a[254:255],v13,61440
mm v[224:227],a[192:195],a[108:111],v[224:227]
mm v[224:227],a[224:227],a[124:127],v[224:227]
mm v[32:35],a[192:195],v[28:31],v[32:35]
mm v[32:35],a[224:227],v[28:31],v[32:35]
buffer_load_dwordx4 a[72:75], v4, s[20:23], s45 offen sc1
buffer_load_dwordx4 a[76:79], v5, s[20:23], s45 offen sc1
s_add_u32 s45, s45, 1024
mm v[132:135],a[196:199],a[96:99],v[132:135]
mm v[132:135],a[228:231],a[112:115],v[132:135]
s_waitcnt vmcnt(28) lgkmcnt(0)
s_barrier
mm v[164:167],a[196:199],a[100:103],v[164:167]
mm v[164:167],a[228:231],a[116:119],v[164:167]
mm v[196:199],a[196:199],a[104:107],v[196:199]
mm v[196:199],a[228:231],a[120:123],v[196:199]
mm v[228:231],a[196:199],a[108:111],v[228:231]
mm v[228:231],a[228:231],a[124:127],v[228:231]
rt a[192:193],v6,0
rt a[194:195],v6,4096
rt a[224:225],v6,8192
rt a[226:227],v6,12288
mm v[36:39],a[196:199],v[28:31],v[36:39]
mm v[36:39],a[228:231],v[28:31],v[36:39]
mm v[136:139],a[200:203],a[96:99],v[136:139]
mm v[136:139],a[232:235],a[112:115],v[136:139]
buffer_load_dwordx4 a[80:83], v2, s[20:23], s45 offen sc1
mm v[168:171],a[200:203],a[100:103],v[168:171]
mm v[168:171],a[232:235],a[116:119],v[168:171]
mm v[200:203],a[200:203],a[104:107],v[200:203]
buffer_load_dwordx4 a[84:87], v3, s[20:23], s45 offen sc1
mm v[200:203],a[232:235],a[120:123],v[200:203]
mm v[232:235],a[200:203],a[108:111],v[232:235]
buffer_load_dwordx4 a[88:91], v4, s[20:23], s45 offen sc1
mm v[232:235],a[232:235],a[124:127],v[232:235]
rt a[196:197],v7,0
rt a[198:199],v7,4096
rt a[228:229],v7,8192
rt a[230:231],v7,12288
mm v[140:143],a[204:207],a[96:99],v[140:143]
mm v[140:143],a[236:239],a[112:115],v[140:143]
mm v[172:175],a[204:207],a[100:103],v[172:175]
mm v[172:175],a[236:239],a[116:119],v[172:175]
mm v[204:207],a[204:207],a[104:107],v[204:207]
buffer_load_dwordx4 a[92:95], v5, s[20:23], s45 offen sc1
mm v[204:207],a[236:239],a[120:123],v[204:207]
mm v[236:239],a[204:207],a[108:111],v[236:239]
mm v[236:239],a[236:239],a[124:127],v[236:239]
rt a[200:201],v8,0
rt a[202:203],v8,4096
rt a[232:233],v8,8192
rt a[234:235],v8,12288
mm v[144:147],a[208:211],a[96:99],v[144:147]
mm v[144:147],a[240:243],a[112:115],v[144:147]
mm v[176:179],a[208:211],a[100:103],v[176:179]
mm v[176:179],a[240:243],a[116:119],v[176:179]
s_add_u32 s45, s45, 1024
mm v[208:211],a[208:211],a[104:107],v[208:211]
rt a[204:205],v9,0
mm v[208:211],a[240:243],a[120:123],v[208:211]
s_add_u32 m0, s47, 49152
mm v[240:243],a[208:211],a[108:111],v[240:243]
rt a[206:207],v9,4096
mm v[240:243],a[240:243],a[124:127],v[240:243]
rt a[236:237],v9,8192
rt a[238:239],v9,12288
mm v[148:151],a[212:215],a[96:99],v[148:151]
mm v[148:151],a[244:247],a[112:115],v[148:151]
mm v[180:183],a[212:215],a[100:103],v[180:183]
buffer_load_dwordx4 v20, s[12:15], s46 offen offset:0 lds
mm v[180:183],a[244:247],a[116:119],v[180:183]
mm v[212:215],a[212:215],a[104:107],v[212:215]
rt a[208:209],v10,0
mm v[212:215],a[244:247],a[120:123],v[212:215]
buffer_load_dwordx4 v21, s[12:15], s46 offen offset:1024 lds
mm v[244:247],a[212:215],a[108:111],v[244:247]
mm v[244:247],a[244:247],a[124:127],v[244:247]
rt a[210:211],v10,4096
rt a[240:241],v10,8192
rt a[242:243],v10,12288
mm v[152:155],a[216:219],a[96:99],v[152:155]
mm v[152:155],a[248:251],a[112:115],v[152:155]
mm v[184:187],a[216:219],a[100:103],v[184:187]
rt a[212:213],v11,0
mm v[184:187],a[248:251],a[116:119],v[184:187]
buffer_load_dwordx4 v22, s[12:15], s46 offen offset:2048 lds
mm v[216:219],a[216:219],a[104:107],v[216:219]
mm v[216:219],a[248:251],a[120:123],v[216:219]
mm v[248:251],a[216:219],a[108:111],v[248:251]
rt a[214:215],v11,4096
mm v[248:251],a[248:251],a[124:127],v[248:251]
rt a[244:245],v11,8192
rt a[246:247],v11,12288
mm v[156:159],a[220:223],a[96:99],v[156:159]
mm v[156:159],a[252:255],a[112:115],v[156:159]
buffer_load_dwordx4 v23, s[12:15], s46 offen offset:3072 lds
mm v[188:191],a[220:223],a[100:103],v[188:191]
mm v[188:191],a[252:255],a[116:119],v[188:191]
rt a[216:217],v12,0
mm v[220:223],a[220:223],a[104:107],v[220:223]
rt a[218:219],v12,4096
mm v[220:223],a[252:255],a[120:123],v[220:223]
rt a[248:249],v12,8192
mm v[252:255],a[220:223],a[108:111],v[252:255]
s_add_u32 s46, s46, 458752
mm v[252:255],a[252:255],a[124:127],v[252:255]
rt a[250:251],v12,12288
s_waitcnt vmcnt(28) lgkmcnt(8)
mm v[128:131],a[192:195],a[0:3],v[128:131]
buffer_load_dwordx4 a[96:99], v2, s[20:23], s45 offen sc1
mm v[128:131],a[224:227],a[16:19],v[128:131]
mm v[160:163],a[192:195],a[4:7],v[160:163]
buffer_load_dwordx4 a[100:103], v3, s[20:23], s45 offen sc1
mm v[160:163],a[224:227],a[20:23],v[160:163]
rt a[220:221],v13,0
mm v[192:195],a[192:195],a[8:11],v[192:195]
buffer_load_dwordx4 a[104:107], v4, s[20:23], s45 offen sc1
mm v[192:195],a[224:227],a[24:27],v[192:195]
rt a[222:223],v13,4096
rt a[252:253],v13,8192
rt a[254:255],v13,12288
mm v[224:227],a[192:195],a[12:15],v[224:227]
mm v[224:227],a[224:227],a[28:31],v[224:227]
mm v[32:35],a[192:195],v[28:31],v[32:35]
buffer_load_dwordx4 a[108:111], v5, s[20:23], s45 offen sc1
mm v[32:35],a[224:227],v[28:31],v[32:35]
s_add_u32 s45, s45, 1024
mm v[132:135],a[196:199],a[0:3],v[132:135]
mm v[132:135],a[228:231],a[16:19],v[132:135]
s_waitcnt vmcnt(28) lgkmcnt(0)
s_barrier
mm v[164:167],a[196:199],a[4:7],v[164:167]
buffer_load_dwordx4 a[112:115], v2, s[20:23], s45 offen sc1
mm v[164:167],a[228:231],a[20:23],v[164:167]
rt a[192:193],v6,16384
mm v[196:199],a[196:199],a[8:11],v[196:199]
buffer_load_dwordx4 a[116:119], v3, s[20:23], s45 offen sc1
mm v[196:199],a[228:231],a[24:27],v[196:199]
mm v[228:231],a[196:199],a[12:15],v[228:231]
buffer_load_dwordx4 a[120:123], v4, s[20:23], s45 offen sc1
mm v[228:231],a[228:231],a[28:31],v[228:231]
rt a[194:195],v6,20480
rt a[224:225],v6,24576
rt a[226:227],v6,28672
mm v[36:39],a[196:199],v[28:31],v[36:39]
mm v[36:39],a[228:231],v[28:31],v[36:39]
mm v[136:139],a[200:203],a[0:3],v[136:139]
buffer_load_dwordx4 a[124:127], v5, s[20:23], s45 offen sc1
mm v[136:139],a[232:235],a[16:19],v[136:139]
s_add_u32 s45, s45, 1024
mm v[168:171],a[200:203],a[4:7],v[168:171]
rt a[196:197],v7,16384
mm v[168:171],a[232:235],a[20:23],v[168:171]
buffer_load_dwordx2 v[64:65], v14, s[24:27], s48 offen offset:0 sc1
mm v[200:203],a[200:203],a[8:11],v[200:203]
rt a[198:199],v7,20480
mm v[200:203],a[232:235],a[24:27],v[200:203]
buffer_load_dwordx2 v[66:67], v14, s[24:27], s48 offen offset:128 sc1
mm v[232:235],a[200:203],a[12:15],v[232:235]
mm v[232:235],a[232:235],a[28:31],v[232:235]
rt a[228:229],v7,24576
rt a[230:231],v7,28672
mm v[140:143],a[204:207],a[0:3],v[140:143]
buffer_load_dwordx2 v[68:69], v14, s[24:27], s48 offen offset:256 sc1
mm v[140:143],a[236:239],a[16:19],v[140:143]
mm v[172:175],a[204:207],a[4:7],v[172:175]
buffer_load_dwordx2 v[70:71], v14, s[24:27], s48 offen offset:384 sc1
mm v[172:175],a[236:239],a[20:23],v[172:175]
rt a[200:201],v8,16384
mm v[204:207],a[204:207],a[8:11],v[204:207]
rt a[202:203],v8,20480
mm v[204:207],a[236:239],a[24:27],v[204:207]
s_add_u32 s48, s48, 16384
mm v[236:239],a[204:207],a[12:15],v[236:239]
buffer_load_dwordx2 v[72:73], v14, s[24:27], s48 offen offset:0 sc1
mm v[236:239],a[236:239],a[28:31],v[236:239]
rt a[232:233],v8,24576
rt a[234:235],v8,28672
mm v[144:147],a[208:211],a[0:3],v[144:147]
mm v[144:147],a[240:243],a[16:19],v[144:147]
buffer_load_dwordx2 v[74:75], v14, s[24:27], s48 offen offset:128 sc1
mm v[176:179],a[208:211],a[4:7],v[176:179]
rt a[204:205],v9,16384
mm v[176:179],a[240:243],a[20:23],v[176:179]
buffer_load_dwordx2 v[76:77], v14, s[24:27], s48 offen offset:256 sc1
mm v[208:211],a[208:211],a[8:11],v[208:211]
rt a[206:207],v9,20480
mm v[208:211],a[240:243],a[24:27],v[208:211]
buffer_load_dwordx2 v[78:79], v14, s[24:27], s48 offen offset:384 sc1
mm v[240:243],a[208:211],a[12:15],v[240:243]
mm v[240:243],a[240:243],a[28:31],v[240:243]
rt a[236:237],v9,24576
rt a[238:239],v9,28672
mm v[148:151],a[212:215],a[0:3],v[148:151]
s_add_u32 s48, s48, 16384
mm v[148:151],a[244:247],a[16:19],v[148:151]
buffer_load_dwordx2 v[80:81], v14, s[24:27], s48 offen offset:0 sc1
mm v[180:183],a[212:215],a[4:7],v[180:183]
mm v[180:183],a[244:247],a[20:23],v[180:183]
rt a[208:209],v10,16384
rt a[210:211],v10,20480
mm v[212:215],a[212:215],a[8:11],v[212:215]
buffer_load_dwordx2 v[82:83], v14, s[24:27], s48 offen offset:128 sc1
mm v[212:215],a[244:247],a[24:27],v[212:215]
mm v[244:247],a[212:215],a[12:15],v[244:247]
buffer_load_dwordx2 v[84:85], v14, s[24:27], s48 offen offset:256 sc1
mm v[244:247],a[244:247],a[28:31],v[244:247]
rt a[240:241],v10,24576
rt a[242:243],v10,28672
mm v[152:155],a[216:219],a[0:3],v[152:155]
mm v[152:155],a[248:251],a[16:19],v[152:155]
buffer_load_dwordx2 v[86:87], v14, s[24:27], s48 offen offset:384 sc1
mm v[184:187],a[216:219],a[4:7],v[184:187]
rt a[212:213],v11,16384
mm v[184:187],a[248:251],a[20:23],v[184:187]
s_add_u32 s48, s48, 16384
mm v[216:219],a[216:219],a[8:11],v[216:219]
rt a[214:215],v11,20480
mm v[216:219],a[248:251],a[24:27],v[216:219]
buffer_load_dwordx2 v[88:89], v14, s[24:27], s48 offen offset:0 sc1
mm v[248:251],a[216:219],a[12:15],v[248:251]
rt a[244:245],v11,24576
mm v[248:251],a[248:251],a[28:31],v[248:251]
rt a[246:247],v11,28672
mm v[156:159],a[220:223],a[0:3],v[156:159]
buffer_load_dwordx2 v[90:91], v14, s[24:27], s48 offen offset:128 sc1
mm v[156:159],a[252:255],a[16:19],v[156:159]
buffer_load_dwordx2 v[92:93], v14, s[24:27], s48 offen offset:256 sc1
mm v[188:191],a[220:223],a[4:7],v[188:191]
mm v[188:191],a[252:255],a[20:23],v[188:191]
buffer_load_dwordx2 v[94:95], v14, s[24:27], s48 offen offset:384 sc1
mm v[220:223],a[220:223],a[8:11],v[220:223]
rt a[216:217],v12,16384
mm v[220:223],a[252:255],a[24:27],v[220:223]
rt a[218:219],v12,20480
mm v[252:255],a[220:223],a[12:15],v[252:255]
s_add_u32 s48, s48, 16384
mm v[252:255],a[252:255],a[28:31],v[252:255]
rt a[248:249],v12,24576
rt a[250:251],v12,28672
s_waitcnt vmcnt(40) lgkmcnt(8)
mm v[128:131],a[192:195],a[32:35],v[128:131]
mm v[128:131],a[224:227],a[48:51],v[128:131]
mm v[160:163],a[192:195],a[36:39],v[160:163]
rt a[220:221],v13,16384
mm v[160:163],a[224:227],a[52:55],v[160:163]
mm v[192:195],a[192:195],a[40:43],v[192:195]
rt a[222:223],v13,20480
mm v[192:195],a[224:227],a[56:59],v[192:195]
rt a[252:253],v13,24576
rt a[254:255],v13,28672
mm v[224:227],a[192:195],a[44:47],v[224:227]
mm v[224:227],a[224:227],a[60:63],v[224:227]
mm v[32:35],a[192:195],v[28:31],v[32:35]
mm v[32:35],a[224:227],v[28:31],v[32:35]
mm v[132:135],a[196:199],a[32:35],v[132:135]
mm v[132:135],a[228:231],a[48:51],v[132:135]
s_waitcnt vmcnt(36) lgkmcnt(0)
s_barrier
mm v[164:167],a[196:199],a[36:39],v[164:167]
mm v[164:167],a[228:231],a[52:55],v[164:167]
mm v[196:199],a[196:199],a[40:43],v[196:199]
rt a[192:193],v6,32768
mm v[196:199],a[228:231],a[56:59],v[196:199]
mm v[228:231],a[196:199],a[44:47],v[228:231]
rt a[194:195],v6,36864
mm v[228:231],a[228:231],a[60:63],v[228:231]
rt a[224:225],v6,40960
rt a[226:227],v6,45056
mm v[36:39],a[196:199],v[28:31],v[36:39]
mm v[36:39],a[228:231],v[28:31],v[36:39]
mm v[136:139],a[200:203],a[32:35],v[136:139]
mm v[136:139],a[232:235],a[48:51],v[136:139]
mm v[168:171],a[200:203],a[36:39],v[168:171]
rt a[196:197],v7,32768
mm v[168:171],a[232:235],a[52:55],v[168:171]
mm v[200:203],a[200:203],a[40:43],v[200:203]
rt a[198:199],v7,36864
mm v[200:203],a[232:235],a[56:59],v[200:203]
mm v[232:235],a[200:203],a[44:47],v[232:235]
rt a[228:229],v7,40960
mm v[232:235],a[232:235],a[60:63],v[232:235]
rt a[230:231],v7,45056
mm v[140:143],a[204:207],a[32:35],v[140:143]
mm v[140:143],a[236:239],a[48:51],v[140:143]
mm v[172:175],a[204:207],a[36:39],v[172:175]
rt a[200:201],v8,32768
mm v[172:175],a[236:239],a[52:55],v[172:175]
mm v[204:207],a[204:207],a[40:43],v[204:207]
rt a[202:203],v8,36864
mm v[204:207],a[236:239],a[56:59],v[204:207]
mm v[236:239],a[204:207],a[44:47],v[236:239]
rt a[232:233],v8,40960
mm v[236:239],a[236:239],a[60:63],v[236:239]
rt a[234:235],v8,45056
mm v[144:147],a[208:211],a[32:35],v[144:147]
mm v[144:147],a[240:243],a[48:51],v[144:147]
mm v[176:179],a[208:211],a[36:39],v[176:179]
rt a[204:205],v9,32768
mm v[176:179],a[240:243],a[52:55],v[176:179]
mm v[208:211],a[208:211],a[40:43],v[208:211]
rt a[206:207],v9,36864
mm v[208:211],a[240:243],a[56:59],v[208:211]
mm v[240:243],a[208:211],a[44:47],v[240:243]
rt a[236:237],v9,40960
mm v[240:243],a[240:243],a[60:63],v[240:243]
rt a[238:239],v9,45056
mm v[148:151],a[212:215],a[32:35],v[148:151]
mm v[148:151],a[244:247],a[48:51],v[148:151]
mm v[180:183],a[212:215],a[36:39],v[180:183]
rt a[208:209],v10,32768
mm v[180:183],a[244:247],a[52:55],v[180:183]
mm v[212:215],a[212:215],a[40:43],v[212:215]
rt a[210:211],v10,36864
mm v[212:215],a[244:247],a[56:59],v[212:215]
mm v[244:247],a[212:215],a[44:47],v[244:247]
rt a[240:241],v10,40960
mm v[244:247],a[244:247],a[60:63],v[244:247]
rt a[242:243],v10,45056
mm v[152:155],a[216:219],a[32:35],v[152:155]
mm v[152:155],a[248:251],a[48:51],v[152:155]
mm v[184:187],a[216:219],a[36:39],v[184:187]
rt a[212:213],v11,32768
mm v[184:187],a[248:251],a[52:55],v[184:187]
mm v[216:219],a[216:219],a[40:43],v[216:219]
rt a[214:215],v11,36864
mm v[216:219],a[248:251],a[56:59],v[216:219]
mm v[248:251],a[216:219],a[44:47],v[248:251]
rt a[244:245],v11,40960
mm v[248:251],a[248:251],a[60:63],v[248:251]
rt a[246:247],v11,45056
mm v[156:159],a[220:223],a[32:35],v[156:159]
mm v[156:159],a[252:255],a[48:51],v[156:159]
mm v[188:191],a[220:223],a[36:39],v[188:191]
rt a[216:217],v12,32768
mm v[188:191],a[252:255],a[52:55],v[188:191]
mm v[220:223],a[220:223],a[40:43],v[220:223]
rt a[218:219],v12,36864
mm v[220:223],a[252:255],a[56:59],v[220:223]
mm v[252:255],a[220:223],a[44:47],v[252:255]
rt a[248:249],v12,40960
mm v[252:255],a[252:255],a[60:63],v[252:255]
rt a[250:251],v12,45056
s_waitcnt vmcnt(0) lgkmcnt(8)
mm v[128:131],a[192:195],a[64:67],v[128:131]
rt a[220:221],v13,32768
mm v[128:131],a[224:227],a[80:83],v[128:131]
v_add_f32 v64, v64, v72
mm v[160:163],a[192:195],a[68:71],v[160:163]
v_add_f32 v80, v80, v88
mm v[160:163],a[224:227],a[84:87],v[160:163]
rt a[222:223],v13,36864
v_add_f32 v65, v65, v73
mm v[192:195],a[192:195],a[72:75],v[192:195]
rt a[252:253],v13,40960
mm v[192:195],a[224:227],a[88:91],v[192:195]
rt a[254:255],v13,45056
mm v[224:227],a[192:195],a[76:79],v[224:227]
v_add_f32 v81, v81, v89
mm v[224:227],a[224:227],a[92:95],v[224:227]
v_add_f32 v66, v66, v74
v_add_f32 v82, v82, v90
mm v[32:35],a[192:195],v[28:31],v[32:35]
v_add_f32 v67, v67, v75
mm v[32:35],a[224:227],v[28:31],v[32:35]
v_add_f32 v83, v83, v91
mm v[132:135],a[196:199],a[64:67],v[132:135]
v_add_f32 v68, v68, v76
mm v[132:135],a[228:231],a[80:83],v[132:135]
s_waitcnt vmcnt(24) lgkmcnt(0)
s_barrier
mm v[164:167],a[196:199],a[68:71],v[164:167]
v_add_f32 v84, v84, v92
mm v[164:167],a[228:231],a[84:87],v[164:167]
rt a[192:193],v6,49152
mm v[196:199],a[196:199],a[72:75],v[196:199]
v_add_f32 v69, v69, v77
mm v[196:199],a[228:231],a[88:91],v[196:199]
rt a[194:195],v6,53248
v_add_f32 v85, v85, v93
mm v[228:231],a[196:199],a[76:79],v[228:231]
v_add_f32 v70, v70, v78
mm v[228:231],a[228:231],a[92:95],v[228:231]
rt a[224:225],v6,57344
rt a[226:227],v6,61440
mm v[36:39],a[196:199],v[28:31],v[36:39]
v_add_f32 v86, v86, v94
mm v[36:39],a[228:231],v[28:31],v[36:39]
v_add_f32 v71, v71, v79
mm v[136:139],a[200:203],a[64:67],v[136:139]
v_add_f32 v87, v87, v95
mm v[136:139],a[232:235],a[80:83],v[136:139]
v_add_f32 v64, v64, v80
mm v[168:171],a[200:203],a[68:71],v[168:171]
rt a[196:197],v7,49152
v_add_f32 v65, v65, v81
mm v[168:171],a[232:235],a[84:87],v[168:171]
v_add_f32 v66, v66, v82
mm v[200:203],a[200:203],a[72:75],v[200:203]
rt a[198:199],v7,53248
mm v[200:203],a[232:235],a[88:91],v[200:203]
v_add_f32 v67, v67, v83
mm v[232:235],a[200:203],a[76:79],v[232:235]
rt a[228:229],v7,57344
v_add_f32 v68, v68, v84
mm v[232:235],a[232:235],a[92:95],v[232:235]
rt a[230:231],v7,61440
mm v[140:143],a[204:207],a[64:67],v[140:143]
v_add_f32 v69, v69, v85
mm v[140:143],a[236:239],a[80:83],v[140:143]
v_add_f32 v70, v70, v86
mm v[172:175],a[204:207],a[68:71],v[172:175]
v_add_f32 v71, v71, v87
rt a[200:201],v8,49152
mm v[172:175],a[236:239],a[84:87],v[172:175]
v_mov_b32 v72, v64
mm v[204:207],a[204:207],a[72:75],v[204:207]
rt a[202:203],v8,53248
mm v[204:207],a[236:239],a[88:91],v[204:207]
v_mov_b32 v73, v65
mm v[236:239],a[204:207],a[76:79],v[236:239]
v_mov_b32 v74, v66
rt a[232:233],v8,57344
mm v[236:239],a[236:239],a[92:95],v[236:239]
rt a[234:235],v8,61440
mm v[144:147],a[208:211],a[64:67],v[144:147]
v_mov_b32 v75, v67
mm v[144:147],a[240:243],a[80:83],v[144:147]
v_mov_b32 v76, v68
v_mov_b32 v77, v69
mm v[176:179],a[208:211],a[68:71],v[176:179]
rt a[204:205],v9,49152
mm v[176:179],a[240:243],a[84:87],v[176:179]
v_mov_b32 v78, v70
mm v[208:211],a[208:211],a[72:75],v[208:211]
v_mov_b32 v79, v71
mm v[208:211],a[240:243],a[88:91],v[208:211]
rt a[206:207],v9,53248
v_permlane16_swap_b32 v64, v72
mm v[240:243],a[208:211],a[76:79],v[240:243]
rt a[236:237],v9,57344
mm v[240:243],a[240:243],a[92:95],v[240:243]
rt a[238:239],v9,61440
mm v[148:151],a[212:215],a[64:67],v[148:151]
v_permlane16_swap_b32 v65, v73
mm v[148:151],a[244:247],a[80:83],v[148:151]
v_permlane16_swap_b32 v66, v74
v_permlane16_swap_b32 v67, v75
mm v[180:183],a[212:215],a[68:71],v[180:183]
rt a[208:209],v10,49152
mm v[180:183],a[244:247],a[84:87],v[180:183]
v_permlane16_swap_b32 v68, v76
mm v[212:215],a[212:215],a[72:75],v[212:215]
v_permlane16_swap_b32 v69, v77
mm v[212:215],a[244:247],a[88:91],v[212:215]
rt a[210:211],v10,53248
v_permlane16_swap_b32 v70, v78
mm v[244:247],a[212:215],a[76:79],v[244:247]
v_permlane16_swap_b32 v71, v79
mm v[244:247],a[244:247],a[92:95],v[244:247]
rt a[240:241],v10,57344
rt a[242:243],v10,61440
mm v[152:155],a[216:219],a[64:67],v[152:155]
v_add_f32 v64, v64, v72
mm v[152:155],a[248:251],a[80:83],v[152:155]
v_add_f32 v65, v65, v73
mm v[184:187],a[216:219],a[68:71],v[184:187]
v_add_f32 v66, v66, v74
mm v[184:187],a[248:251],a[84:87],v[184:187]
rt a[212:213],v11,49152
mm v[216:219],a[216:219],a[72:75],v[216:219]
v_add_f32 v67, v67, v75
rt a[214:215],v11,53248
mm v[216:219],a[248:251],a[88:91],v[216:219]
v_add_f32 v68, v68, v76
mm v[248:251],a[216:219],a[76:79],v[248:251]
v_add_f32 v69, v69, v77
mm v[248:251],a[248:251],a[92:95],v[248:251]
rt a[244:245],v11,57344
rt a[246:247],v11,61440
mm v[156:159],a[220:223],a[64:67],v[156:159]
v_add_f32 v70, v70, v78
mm v[156:159],a[252:255],a[80:83],v[156:159]
v_add_f32 v71, v71, v79
mm v[188:191],a[220:223],a[68:71],v[188:191]
v_mov_b32 v72, v64
mm v[188:191],a[252:255],a[84:87],v[188:191]
rt a[216:217],v12,49152
mm v[220:223],a[220:223],a[72:75],v[220:223]
v_mov_b32 v73, v65
v_mov_b32 v74, v66
v_mov_b32 v75, v67
mm v[220:223],a[252:255],a[88:91],v[220:223]
mm v[252:255],a[220:223],a[76:79],v[252:255]
rt a[218:219],v12,53248
mm v[252:255],a[252:255],a[92:95],v[252:255]
rt a[248:249],v12,57344
rt a[250:251],v12,61440
s_waitcnt vmcnt(16) lgkmcnt(8)
mm v[128:131],a[192:195],a[96:99],v[128:131]
mm v[128:131],a[224:227],a[112:115],v[128:131]
rt a[220:221],v13,49152
mm v[160:163],a[192:195],a[100:103],v[160:163]
v_mov_b32 v76, v68
mm v[160:163],a[224:227],a[116:119],v[160:163]
v_mov_b32 v77, v69
mm v[192:195],a[192:195],a[104:107],v[192:195]
rt a[222:223],v13,53248
mm v[192:195],a[224:227],a[120:123],v[192:195]
rt a[252:253],v13,57344
rt a[254:255],v13,61440
mm v[224:227],a[192:195],a[108:111],v[224:227]
mm v[224:227],a[224:227],a[124:127],v[224:227]
v_mov_b32 v78, v70
mm v[32:35],a[192:195],v[28:31],v[32:35]
v_mov_b32 v79, v71
mm v[32:35],a[224:227],v[28:31],v[32:35]
v_permlane32_swap_b32 v64, v72
mm v[132:135],a[196:199],a[96:99],v[132:135]
v_permlane32_swap_b32 v65, v73
mm v[132:135],a[228:231],a[112:115],v[132:135]
s_waitcnt lgkmcnt(0)
mm v[164:167],a[196:199],a[100:103],v[164:167]
v_permlane32_swap_b32 v66, v74
mm v[164:167],a[228:231],a[116:119],v[164:167]
v_permlane32_swap_b32 v67, v75
mm v[196:199],a[196:199],a[104:107],v[196:199]
v_permlane32_swap_b32 v68, v76
mm v[196:199],a[228:231],a[120:123],v[196:199]
v_permlane32_swap_b32 v69, v77
mm v[228:231],a[196:199],a[108:111],v[228:231]
v_permlane32_swap_b32 v70, v78
mm v[228:231],a[228:231],a[124:127],v[228:231]
v_permlane32_swap_b32 v71, v79
mm v[36:39],a[196:199],v[28:31],v[36:39]
v_add_f32 v64, v64, v72
mm v[36:39],a[228:231],v[28:31],v[36:39]
v_add_f32 v65, v65, v73
mm v[136:139],a[200:203],a[96:99],v[136:139]
v_add_f32 v66, v66, v74
mm v[136:139],a[232:235],a[112:115],v[136:139]
v_add_f32 v67, v67, v75
mm v[168:171],a[200:203],a[100:103],v[168:171]
mm v[168:171],a[232:235],a[116:119],v[168:171]
v_add_f32 v68, v68, v76
mm v[200:203],a[200:203],a[104:107],v[200:203]
v_add_f32 v69, v69, v77
mm v[200:203],a[232:235],a[120:123],v[200:203]
v_add_f32 v70, v70, v78
mm v[232:235],a[200:203],a[108:111],v[232:235]
v_add_f32 v71, v71, v79
mm v[232:235],a[232:235],a[124:127],v[232:235]
v_mul_f32 v96, 0xba800000, v64
mm v[140:143],a[204:207],a[96:99],v[140:143]
v_mul_f32 v98, 0xba800000, v66
mm v[140:143],a[236:239],a[112:115],v[140:143]
v_mul_f32 v100, 0xba800000, v68
mm v[172:175],a[204:207],a[100:103],v[172:175]
v_mul_f32 v102, 0xba800000, v70
mm v[172:175],a[236:239],a[116:119],v[172:175]
v_mul_f32 v104, 0x3a800000, v65
mm v[204:207],a[204:207],a[104:107],v[204:207]
v_mul_f32 v106, 0x3a800000, v67
mm v[204:207],a[236:239],a[120:123],v[204:207]
v_mul_f32 v108, 0x3a800000, v69
mm v[236:239],a[204:207],a[108:111],v[236:239]
v_mul_f32 v110, 0x3a800000, v71
mm v[236:239],a[236:239],a[124:127],v[236:239]
v_fma_f32 v104, -v96, v96, v104
mm v[144:147],a[208:211],a[96:99],v[144:147]
v_fma_f32 v106, -v98, v98, v106
mm v[144:147],a[240:243],a[112:115],v[144:147]
v_fma_f32 v108, -v100, v100, v108
mm v[176:179],a[208:211],a[100:103],v[176:179]
v_fma_f32 v110, -v102, v102, v110
mm v[176:179],a[240:243],a[116:119],v[176:179]
mm v[208:211],a[208:211],a[104:107],v[208:211]
v_max_f32 v104, 0, v104
mm v[208:211],a[240:243],a[120:123],v[208:211]
v_max_f32 v106, 0, v106
mm v[240:243],a[208:211],a[108:111],v[240:243]
v_max_f32 v108, 0, v108
mm v[240:243],a[240:243],a[124:127],v[240:243]
v_max_f32 v110, 0, v110
mm v[148:151],a[212:215],a[96:99],v[148:151]
mm v[148:151],a[244:247],a[112:115],v[148:151]
v_add_f32 v104, 0x3727c5ac, v104
mm v[180:183],a[212:215],a[100:103],v[180:183]
v_add_f32 v106, 0x3727c5ac, v106
mm v[180:183],a[244:247],a[116:119],v[180:183]
v_add_f32 v108, 0x3727c5ac, v108
mm v[212:215],a[212:215],a[104:107],v[212:215]
v_add_f32 v110, 0x3727c5ac, v110
mm v[212:215],a[244:247],a[120:123],v[212:215]
mm v[244:247],a[212:215],a[108:111],v[244:247]
v_rsq_f32 v97, v104
mm v[244:247],a[244:247],a[124:127],v[244:247]
v_rsq_f32 v99, v106
mm v[152:155],a[216:219],a[96:99],v[152:155]
v_rsq_f32 v101, v108
mm v[152:155],a[248:251],a[112:115],v[152:155]
mm v[184:187],a[216:219],a[100:103],v[184:187]
v_rsq_f32 v103, v110
mm v[184:187],a[248:251],a[116:119],v[184:187]
mm v[216:219],a[216:219],a[104:107],v[216:219]
v_sqrt_f32 v104, v104
mm v[216:219],a[248:251],a[120:123],v[216:219]
mm v[248:251],a[216:219],a[108:111],v[248:251]
v_sqrt_f32 v106, v106
mm v[248:251],a[248:251],a[124:127],v[248:251]
mm v[156:159],a[220:223],a[96:99],v[156:159]
v_sqrt_f32 v108, v108
mm v[156:159],a[252:255],a[112:115],v[156:159]
mm v[188:191],a[220:223],a[100:103],v[188:191]
v_sqrt_f32 v110, v110
mm v[188:191],a[252:255],a[116:119],v[188:191]
mm v[220:223],a[220:223],a[104:107],v[220:223]
v_mul_f32 v97, 0xbfb8aa3b, v97
v_mul_f32 v99, 0xbfb8aa3b, v99
v_mul_f32 v101, 0xbfb8aa3b, v101
v_mul_f32 v103, 0xbfb8aa3b, v103
mm v[220:223],a[252:255],a[120:123],v[220:223]
mm v[252:255],a[220:223],a[108:111],v[252:255]
mm v[252:255],a[252:255],a[124:127],v[252:255]
s_nop 4
ds_write_b128 v112, v[32:35]
ds_write_b128 v112, v[36:39] offset:1024
v_pk_fma_f32 v[128:129], v[32:33], v[96:97], v[128:129] op_sel_hi:[1,0,1]
v_pk_fma_f32 v[130:131], v[34:35], v[96:97], v[130:131] op_sel_hi:[1,0,1]
v_pk_fma_f32 v[132:133], v[36:37], v[96:97], v[132:133] op_sel_hi:[1,0,1]
v_pk_fma_f32 v[134:135], v[38:39], v[96:97], v[134:135] op_sel_hi:[1,0,1]
v_pk_mul_f32 v[64:65], v[128:129], v[96:97] op_sel:[0,1]
v_pk_mul_f32 v[66:67], v[130:131], v[96:97] op_sel:[0,1]
v_pk_mul_f32 v[68:69], v[132:133], v[96:97] op_sel:[0,1]
v_pk_mul_f32 v[70:71], v[134:135], v[96:97] op_sel:[0,1]
v_exp_f32 v64, v64
v_exp_f32 v65, v65
v_exp_f32 v66, v66
v_exp_f32 v67, v67
v_exp_f32 v68, v68
v_exp_f32 v69, v69
v_exp_f32 v70, v70
v_exp_f32 v71, v71
v_pk_fma_f32 v[64:65], v[64:65], v[104:105], v[104:105] op_sel_hi:[1,0,0]
v_pk_fma_f32 v[66:67], v[66:67], v[104:105], v[104:105] op_sel_hi:[1,0,0]
v_pk_fma_f32 v[68:69], v[68:69], v[104:105], v[104:105] op_sel_hi:[1,0,0]
v_pk_fma_f32 v[70:71], v[70:71], v[104:105], v[104:105] op_sel_hi:[1,0,0]
v_rcp_f32 v64, v64
v_rcp_f32 v65, v65
v_rcp_f32 v66, v66
v_rcp_f32 v67, v67
v_rcp_f32 v68, v68
v_rcp_f32 v69, v69
v_rcp_f32 v70, v70
v_rcp_f32 v71, v71
v_pk_mul_f32 v[64:65], v[64:65], v[128:129]
v_pk_mul_f32 v[66:67], v[66:67], v[130:131]
v_pk_mul_f32 v[68:69], v[68:69], v[132:133]
v_pk_mul_f32 v[70:71], v[70:71], v[134:135]
cv v128,v64,v65
cv v129,v66,v67
cv v130,v68,v69
cv v131,v70,v71
buffer_store_dwordx4 v[128:131], v24, s[8:11], s54 offen sc1
s_waitcnt lgkmcnt(0)
s_barrier
ds_read_b128 v[40:43], v113
ds_read_b128 v[44:47], v113 offset:1024
ds_read_b128 v[48:51], v114
ds_read_b128 v[52:55], v114 offset:1024
ds_read_b128 v[56:59], v115
ds_read_b128 v[60:63], v115 offset:1024
v_pk_fma_f32 v[160:161], v[32:33], v[98:99], v[160:161] op_sel_hi:[1,0,1]
v_pk_fma_f32 v[162:163], v[34:35], v[98:99], v[162:163] op_sel_hi:[1,0,1]
v_pk_fma_f32 v[164:165], v[36:37], v[98:99], v[164:165] op_sel_hi:[1,0,1]
v_pk_fma_f32 v[166:167], v[38:39], v[98:99], v[166:167] op_sel_hi:[1,0,1]
v_pk_mul_f32 v[72:73], v[160:161], v[98:99] op_sel:[0,1]
s_and_b32 s34, s2, 4
s_lshl_b32 s34, s34, 1
s_bfe_u32 s4, s2, 0x30003
s_add_u32 s34, s34, s4
s_and_b32 s35, s2, 2
s_lshl_b32 s35, s35, 1
s_lshr_b32 s4, s2, 6
s_add_u32 s35, s35, s4
s_lshl_b32 s35, s35, 1
s_and_b32 s4, s2, 1
s_add_u32 s35, s35, s4
s_mov_b32 s12, s80
s_and_b32 s13, s81, 0xffff
s_mov_b32 s14, 7340032
s_mov_b32 s15, 0x20000
v_lshrrev_b32 v18, 4, v0
v_pk_mul_f32 v[74:75], v[162:163], v[98:99] op_sel:[0,1]
v_pk_mul_f32 v[76:77], v[164:165], v[98:99] op_sel:[0,1]
v_pk_mul_f32 v[78:79], v[166:167], v[98:99] op_sel:[0,1]
v_exp_f32 v72, v72
v_exp_f32 v73, v73
v_lshlrev_b32 v19, 11, v18
v_exp_f32 v74, v74
v_exp_f32 v75, v75
v_exp_f32 v76, v76
v_exp_f32 v77, v77
v_exp_f32 v78, v78
v_lshlrev_b32 v18, 1, v18
v_exp_f32 v79, v79
v_pk_fma_f32 v[72:73], v[72:73], v[106:107], v[106:107] op_sel_hi:[1,0,0]
v_pk_fma_f32 v[74:75], v[74:75], v[106:107], v[106:107] op_sel_hi:[1,0,0]
v_pk_fma_f32 v[76:77], v[76:77], v[106:107], v[106:107] op_sel_hi:[1,0,0]
v_pk_fma_f32 v[78:79], v[78:79], v[106:107], v[106:107] op_sel_hi:[1,0,0]
v_and_b32 v20, 15, v0
v_rcp_f32 v72, v72
v_rcp_f32 v73, v73
v_rcp_f32 v74, v74
v_rcp_f32 v75, v75
v_rcp_f32 v76, v76
v_xor_b32 v18, v18, v20
v_rcp_f32 v77, v77
v_rcp_f32 v78, v78
v_rcp_f32 v79, v79
v_pk_mul_f32 v[72:73], v[72:73], v[160:161]
v_pk_mul_f32 v[74:75], v[74:75], v[162:163]
v_xor_b32 v20, 8, v18
v_pk_mul_f32 v[76:77], v[76:77], v[164:165]
v_pk_mul_f32 v[78:79], v[78:79], v[166:167]
cv v160,v72,v73
cv v161,v74,v75
cv v162,v76,v77
v_lshl_add_u32 v10, v18, 4, v19
cv v163,v78,v79
buffer_store_dwordx4 v[160:163], v25, s[8:11], s54 offen sc1
v_pk_fma_f32 v[192:193], v[32:33], v[100:101], v[192:193] op_sel_hi:[1,0,1]
v_pk_fma_f32 v[194:195], v[34:35], v[100:101], v[194:195] op_sel_hi:[1,0,1]
v_pk_fma_f32 v[196:197], v[36:37], v[100:101], v[196:197] op_sel_hi:[1,0,1]
v_lshl_add_u32 v11, v20, 4, v19
v_pk_fma_f32 v[198:199], v[38:39], v[100:101], v[198:199] op_sel_hi:[1,0,1]
v_pk_mul_f32 v[64:65], v[192:193], v[100:101] op_sel:[0,1]
v_pk_mul_f32 v[66:67], v[194:195], v[100:101] op_sel:[0,1]
v_pk_mul_f32 v[68:69], v[196:197], v[100:101] op_sel:[0,1]
v_pk_mul_f32 v[70:71], v[198:199], v[100:101] op_sel:[0,1]
v_add_u32 v11, 7168, v11
v_exp_f32 v64, v64
v_exp_f32 v65, v65
v_exp_f32 v66, v66
v_exp_f32 v67, v67
v_exp_f32 v68, v68
v_lshl_add_u32 v12, v18, 4, v19
v_exp_f32 v69, v69
v_exp_f32 v70, v70
v_exp_f32 v71, v71
v_pk_fma_f32 v[64:65], v[64:65], v[108:109], v[108:109] op_sel_hi:[1,0,0]
v_pk_fma_f32 v[66:67], v[66:67], v[108:109], v[108:109] op_sel_hi:[1,0,0]
v_add_u32 v12, 14336, v12
v_pk_fma_f32 v[68:69], v[68:69], v[108:109], v[108:109] op_sel_hi:[1,0,0]
v_pk_fma_f32 v[70:71], v[70:71], v[108:109], v[108:109] op_sel_hi:[1,0,0]
v_rcp_f32 v64, v64
v_rcp_f32 v65, v65
v_rcp_f32 v66, v66
v_lshl_add_u32 v13, v20, 4, v19
v_rcp_f32 v67, v67
v_rcp_f32 v68, v68
v_rcp_f32 v69, v69
v_rcp_f32 v70, v70
v_rcp_f32 v71, v71
v_add_u32 v13, 21504, v13
v_pk_mul_f32 v[64:65], v[64:65], v[192:193]
v_pk_mul_f32 v[66:67], v[66:67], v[194:195]
v_pk_mul_f32 v[68:69], v[68:69], v[196:197]
v_pk_mul_f32 v[70:71], v[70:71], v[198:199]
cv v192,v64,v65
s_and_b32 s6, s35, 1
s_lshl_b32 s6, s6, 2
s_add_u32 s7, s6, s3
s_mul_i32 s37, s7, 917504
s_lshr_b32 s4, s35, 1
s_lshl_b32 s4, s4, 8
s_add_u32 s37, s37, s4
s_add_u32 s39, s37, 32768
s_lshl_b32 s38, s3, 15
s_mul_i32 s36, s34, 917504
s_mul_i32 s4, s7, 14336
s_add_u32 s36, s36, s4
v_lshrrev_b32 v20, 4, v0
cv v193,v66,v67
cv v194,v68,v69
cv v195,v70,v71
buffer_store_dwordx4 v[192:195], v26, s[8:11], s54 offen sc1
v_pk_fma_f32 v[224:225], v[32:33], v[102:103], v[224:225] op_sel_hi:[1,0,1]
v_bfe_u32 v21, v0, 2, 2
v_pk_fma_f32 v[226:227], v[34:35], v[102:103], v[226:227] op_sel_hi:[1,0,1]
v_pk_fma_f32 v[228:229], v[36:37], v[102:103], v[228:229] op_sel_hi:[1,0,1]
v_pk_fma_f32 v[230:231], v[38:39], v[102:103], v[230:231] op_sel_hi:[1,0,1]
v_pk_mul_f32 v[72:73], v[224:225], v[102:103] op_sel:[0,1]
v_pk_mul_f32 v[74:75], v[226:227], v[102:103] op_sel:[0,1]
v_lshl_add_u32 v18, v20, 2, v21
v_pk_mul_f32 v[76:77], v[228:229], v[102:103] op_sel:[0,1]
v_pk_mul_f32 v[78:79], v[230:231], v[102:103] op_sel:[0,1]
v_exp_f32 v72, v72
v_exp_f32 v73, v73
v_exp_f32 v74, v74
v_and_b32 v19, 7, v18
v_exp_f32 v75, v75
v_exp_f32 v76, v76
v_exp_f32 v77, v77
v_exp_f32 v78, v78
v_exp_f32 v79, v79
v_xor_b32 v19, s6, v19
v_pk_fma_f32 v[72:73], v[72:73], v[110:111], v[110:111] op_sel_hi:[1,0,0]
v_pk_fma_f32 v[74:75], v[74:75], v[110:111], v[110:111] op_sel_hi:[1,0,0]
v_pk_fma_f32 v[76:77], v[76:77], v[110:111], v[110:111] op_sel_hi:[1,0,0]
v_pk_fma_f32 v[78:79], v[78:79], v[110:111], v[110:111] op_sel_hi:[1,0,0]
v_rcp_f32 v72, v72
v_lshlrev_b32 v18, 8, v18
v_rcp_f32 v73, v73
v_rcp_f32 v74, v74
v_rcp_f32 v75, v75
v_rcp_f32 v76, v76
v_rcp_f32 v77, v77
v_and_b32 v20, 3, v0
v_rcp_f32 v78, v78
v_rcp_f32 v79, v79
v_pk_mul_f32 v[72:73], v[72:73], v[224:225]
v_pk_mul_f32 v[74:75], v[74:75], v[226:227]
v_pk_mul_f32 v[76:77], v[76:77], v[228:229]
v_lshl_add_u32 v18, v20, 3, v18
v_pk_mul_f32 v[78:79], v[78:79], v[230:231]
cv v224,v72,v73
cv v225,v74,v75
cv v226,v76,v77
cv v227,v78,v79
v_lshl_add_u32 v18, v19, 5, v18
buffer_store_dwordx4 v[224:227], v27, s[8:11], s54 offen sc1
s_waitcnt lgkmcnt(0)
v_pk_fma_f32 v[136:137], v[40:41], v[96:97], v[136:137] op_sel_hi:[1,0,1]
v_pk_fma_f32 v[138:139], v[42:43], v[96:97], v[138:139] op_sel_hi:[1,0,1]
v_pk_fma_f32 v[140:141], v[44:45], v[96:97], v[140:141] op_sel_hi:[1,0,1]
v_add_u32 v18, s38, v18
v_pk_fma_f32 v[142:143], v[46:47], v[96:97], v[142:143] op_sel_hi:[1,0,1]
v_pk_mul_f32 v[72:73], v[136:137], v[96:97] op_sel:[0,1]
v_pk_mul_f32 v[74:75], v[138:139], v[96:97] op_sel:[0,1]
v_pk_mul_f32 v[76:77], v[140:141], v[96:97] op_sel:[0,1]
v_pk_mul_f32 v[78:79], v[142:143], v[96:97] op_sel:[0,1]
v_xor_b32 v116, 0, v18
v_exp_f32 v72, v72
v_exp_f32 v73, v73
v_exp_f32 v74, v74
v_exp_f32 v75, v75
v_exp_f32 v76, v76
v_xor_b32 v117, 32, v18
v_exp_f32 v77, v77
v_exp_f32 v78, v78
v_exp_f32 v79, v79
v_pk_fma_f32 v[72:73], v[72:73], v[104:105], v[104:105] op_sel_hi:[1,0,0]
v_pk_fma_f32 v[74:75], v[74:75], v[104:105], v[104:105] op_sel_hi:[1,0,0]
v_xor_b32 v118, 64, v18
v_pk_fma_f32 v[76:77], v[76:77], v[104:105], v[104:105] op_sel_hi:[1,0,0]
v_pk_fma_f32 v[78:79], v[78:79], v[104:105], v[104:105] op_sel_hi:[1,0,0]
v_rcp_f32 v72, v72
v_rcp_f32 v73, v73
v_rcp_f32 v74, v74
v_xor_b32 v119, 96, v18
v_rcp_f32 v75, v75
v_rcp_f32 v76, v76
v_rcp_f32 v77, v77
v_rcp_f32 v78, v78
v_xor_b32 v120, 128, v18
v_rcp_f32 v79, v79
v_pk_mul_f32 v[72:73], v[72:73], v[136:137]
v_pk_mul_f32 v[74:75], v[74:75], v[138:139]
v_pk_mul_f32 v[76:77], v[76:77], v[140:141]
v_pk_mul_f32 v[78:79], v[78:79], v[142:143]
v_xor_b32 v121, 160, v18
cv v136,v72,v73
cv v137,v74,v75
cv v138,v76,v77
cv v139,v78,v79
buffer_store_dwordx4 v[136:139], v24, s[8:11], s55 offen sc1
v_xor_b32 v122, 192, v18
v_pk_fma_f32 v[168:169], v[40:41], v[98:99], v[168:169] op_sel_hi:[1,0,1]
v_pk_fma_f32 v[170:171], v[42:43], v[98:99], v[170:171] op_sel_hi:[1,0,1]
v_pk_fma_f32 v[172:173], v[44:45], v[98:99], v[172:173] op_sel_hi:[1,0,1]
v_pk_fma_f32 v[174:175], v[46:47], v[98:99], v[174:175] op_sel_hi:[1,0,1]
v_pk_mul_f32 v[64:65], v[168:169], v[98:99] op_sel:[0,1]
v_xor_b32 v123, 224, v18
v_pk_mul_f32 v[66:67], v[170:171], v[98:99] op_sel:[0,1]
v_pk_mul_f32 v[68:69], v[172:173], v[98:99] op_sel:[0,1]
v_pk_mul_f32 v[70:71], v[174:175], v[98:99] op_sel:[0,1]
v_exp_f32 v64, v64
v_exp_f32 v65, v65
s_add_u32 s8, s86, 67108864
s_addc_u32 s9, s87, 0
s_and_b32 s9, s9, 0xffff
s_mov_b32 s10, 14680064
s_mov_b32 s11, 0x20000
s_add_u32 s20, s86, 58720256
s_addc_u32 s21, s87, 0
s_and_b32 s21, s21, 0xffff
s_mov_b32 s22, 4194304
s_mov_b32 s23, 0x20000
s_lshl_b32 s5, s3, 1
s_lshl_b32 s4, s34, 3
s_add_u32 s4, s4, s5
s_lshl_b32 s4, s4, 15
s_lshl_b32 s40, s35, 11
s_add_u32 s40, s4, s40
s_add_u32 s4, s5, 0
s_and_b32 s4, s4, 7
s_mul_i32 s4, s4, 114688
v_add_u32 v2, s4, v1
v_exp_f32 v66, v66
v_exp_f32 v67, v67
v_exp_f32 v68, v68
v_exp_f32 v69, v69
v_exp_f32 v70, v70
s_add_u32 s4, s5, 1
s_and_b32 s4, s4, 7
s_mul_i32 s4, s4, 114688
v_add_u32 v3, s4, v1
v_exp_f32 v71, v71
v_pk_fma_f32 v[64:65], v[64:65], v[106:107], v[106:107] op_sel_hi:[1,0,0]
v_pk_fma_f32 v[66:67], v[66:67], v[106:107], v[106:107] op_sel_hi:[1,0,0]
v_pk_fma_f32 v[68:69], v[68:69], v[106:107], v[106:107] op_sel_hi:[1,0,0]
v_pk_fma_f32 v[70:71], v[70:71], v[106:107], v[106:107] op_sel_hi:[1,0,0]
s_add_u32 s4, s5, 2
s_and_b32 s4, s4, 7
s_mul_i32 s4, s4, 114688
v_add_u32 v4, s4, v1
v_rcp_f32 v64, v64
v_rcp_f32 v65, v65
v_rcp_f32 v66, v66
v_rcp_f32 v67, v67
v_rcp_f32 v68, v68
s_add_u32 s4, s5, 3
s_and_b32 s4, s4, 7
s_mul_i32 s4, s4, 114688
v_add_u32 v5, s4, v1
v_rcp_f32 v69, v69
v_rcp_f32 v70, v70
v_rcp_f32 v71, v71
v_pk_mul_f32 v[64:65], v[64:65], v[168:169]
v_pk_mul_f32 v[66:67], v[66:67], v[170:171]
s_add_u32 s4, s5, 4
s_and_b32 s4, s4, 7
s_mul_i32 s4, s4, 114688
v_add_u32 v6, s4, v1
v_pk_mul_f32 v[68:69], v[68:69], v[172:173]
v_pk_mul_f32 v[70:71], v[70:71], v[174:175]
cv v168,v64,v65
cv v169,v66,v67
cv v170,v68,v69
s_add_u32 s4, s5, 5
s_and_b32 s4, s4, 7
s_mul_i32 s4, s4, 114688
v_add_u32 v7, s4, v1
cv v171,v70,v71
buffer_store_dwordx4 v[168:171], v25, s[8:11], s55 offen sc1
v_pk_fma_f32 v[200:201], v[40:41], v[100:101], v[200:201] op_sel_hi:[1,0,1]
v_pk_fma_f32 v[202:203], v[42:43], v[100:101], v[202:203] op_sel_hi:[1,0,1]
v_pk_fma_f32 v[204:205], v[44:45], v[100:101], v[204:205] op_sel_hi:[1,0,1]
s_add_u32 s4, s5, 6
s_and_b32 s4, s4, 7
s_mul_i32 s4, s4, 114688
v_add_u32 v8, s4, v1
v_pk_fma_f32 v[206:207], v[46:47], v[100:101], v[206:207] op_sel_hi:[1,0,1]
v_pk_mul_f32 v[72:73], v[200:201], v[100:101] op_sel:[0,1]
v_pk_mul_f32 v[74:75], v[202:203], v[100:101] op_sel:[0,1]
v_pk_mul_f32 v[76:77], v[204:205], v[100:101] op_sel:[0,1]
v_pk_mul_f32 v[78:79], v[206:207], v[100:101] op_sel:[0,1]
s_add_u32 s4, s5, 7
s_and_b32 s4, s4, 7
s_mul_i32 s4, s4, 114688
v_add_u32 v9, s4, v1
v_exp_f32 v72, v72
v_exp_f32 v73, v73
v_exp_f32 v74, v74
v_exp_f32 v75, v75
v_exp_f32 v76, v76
s_add_u32 m0, s38, 0
s_nop 0
buffer_load_dwordx4 v10, s[12:15], s37 offen offset:0 lds
v_exp_f32 v77, v77
v_exp_f32 v78, v78
v_exp_f32 v79, v79
v_pk_fma_f32 v[72:73], v[72:73], v[108:109], v[108:109] op_sel_hi:[1,0,0]
v_pk_fma_f32 v[74:75], v[74:75], v[108:109], v[108:109] op_sel_hi:[1,0,0]
buffer_load_dwordx4 v11, s[12:15], s37 offen offset:1024 lds
v_pk_fma_f32 v[76:77], v[76:77], v[108:109], v[108:109] op_sel_hi:[1,0,0]
v_pk_fma_f32 v[78:79], v[78:79], v[108:109], v[108:109] op_sel_hi:[1,0,0]
v_rcp_f32 v72, v72
v_rcp_f32 v73, v73
v_rcp_f32 v74, v74
buffer_load_dwordx4 v12, s[12:15], s37 offen offset:2048 lds
v_rcp_f32 v75, v75
v_rcp_f32 v76, v76
v_rcp_f32 v77, v77
v_rcp_f32 v78, v78
v_rcp_f32 v79, v79
buffer_load_dwordx4 v13, s[12:15], s37 offen offset:3072 lds
v_pk_mul_f32 v[72:73], v[72:73], v[200:201]
v_pk_mul_f32 v[74:75], v[74:75], v[202:203]
v_pk_mul_f32 v[76:77], v[76:77], v[204:205]
v_pk_mul_f32 v[78:79], v[78:79], v[206:207]
cv v200,v72,v73
s_add_u32 s37, s37, 65536
s_add_u32 m0, s38, 4096
s_nop 0
buffer_load_dwordx4 v10, s[12:15], s39 offen offset:0 lds
cv v201,v74,v75
cv v202,v76,v77
cv v203,v78,v79
buffer_store_dwordx4 v[200:203], v26, s[8:11], s55 offen sc1
v_pk_fma_f32 v[232:233], v[40:41], v[102:103], v[232:233] op_sel_hi:[1,0,1]
buffer_load_dwordx4 v11, s[12:15], s39 offen offset:1024 lds
v_pk_fma_f32 v[234:235], v[42:43], v[102:103], v[234:235] op_sel_hi:[1,0,1]
v_pk_fma_f32 v[236:237], v[44:45], v[102:103], v[236:237] op_sel_hi:[1,0,1]
v_pk_fma_f32 v[238:239], v[46:47], v[102:103], v[238:239] op_sel_hi:[1,0,1]
v_pk_mul_f32 v[64:65], v[232:233], v[102:103] op_sel:[0,1]
v_pk_mul_f32 v[66:67], v[234:235], v[102:103] op_sel:[0,1]
buffer_load_dwordx4 v12, s[12:15], s39 offen offset:2048 lds
v_pk_mul_f32 v[68:69], v[236:237], v[102:103] op_sel:[0,1]
v_pk_mul_f32 v[70:71], v[238:239], v[102:103] op_sel:[0,1]
v_exp_f32 v64, v64
v_exp_f32 v65, v65
v_exp_f32 v66, v66
buffer_load_dwordx4 v13, s[12:15], s39 offen offset:3072 lds
v_exp_f32 v67, v67
v_exp_f32 v68, v68
v_exp_f32 v69, v69
v_exp_f32 v70, v70
v_exp_f32 v71, v71
s_add_u32 s39, s39, 65536
s_add_u32 m0, s38, 8192
s_nop 0
buffer_load_dwordx4 v10, s[12:15], s37 offen offset:0 lds
v_pk_fma_f32 v[64:65], v[64:65], v[110:111], v[110:111] op_sel_hi:[1,0,0]
v_pk_fma_f32 v[66:67], v[66:67], v[110:111], v[110:111] op_sel_hi:[1,0,0]
v_pk_fma_f32 v[68:69], v[68:69], v[110:111], v[110:111] op_sel_hi:[1,0,0]
v_pk_fma_f32 v[70:71], v[70:71], v[110:111], v[110:111] op_sel_hi:[1,0,0]
v_rcp_f32 v64, v64
buffer_load_dwordx4 v11, s[12:15], s37 offen offset:1024 lds
v_rcp_f32 v65, v65
v_rcp_f32 v66, v66
v_rcp_f32 v67, v67
v_rcp_f32 v68, v68
v_rcp_f32 v69, v69
buffer_load_dwordx4 v12, s[12:15], s37 offen offset:2048 lds
v_rcp_f32 v70, v70
v_rcp_f32 v71, v71
v_pk_mul_f32 v[64:65], v[64:65], v[232:233]
v_pk_mul_f32 v[66:67], v[66:67], v[234:235]
v_pk_mul_f32 v[68:69], v[68:69], v[236:237]
buffer_load_dwordx4 v13, s[12:15], s37 offen offset:3072 lds
v_pk_mul_f32 v[70:71], v[70:71], v[238:239]
cv v232,v64,v65
cv v233,v66,v67
cv v234,v68,v69
cv v235,v70,v71
s_add_u32 s37, s37, 65536
s_add_u32 m0, s38, 12288
s_nop 0
buffer_load_dwordx4 v10, s[12:15], s39 offen offset:0 lds
buffer_store_dwordx4 v[232:235], v27, s[8:11], s55 offen sc1
v_pk_fma_f32 v[144:145], v[48:49], v[96:97], v[144:145] op_sel_hi:[1,0,1]
v_pk_fma_f32 v[146:147], v[50:51], v[96:97], v[146:147] op_sel_hi:[1,0,1]
v_pk_fma_f32 v[148:149], v[52:53], v[96:97], v[148:149] op_sel_hi:[1,0,1]
v_pk_fma_f32 v[150:151], v[54:55], v[96:97], v[150:151] op_sel_hi:[1,0,1]
buffer_load_dwordx4 v11, s[12:15], s39 offen offset:1024 lds
v_pk_mul_f32 v[64:65], v[144:145], v[96:97] op_sel:[0,1]
v_pk_mul_f32 v[66:67], v[146:147], v[96:97] op_sel:[0,1]
v_pk_mul_f32 v[68:69], v[148:149], v[96:97] op_sel:[0,1]
v_pk_mul_f32 v[70:71], v[150:151], v[96:97] op_sel:[0,1]
v_exp_f32 v64, v64
buffer_load_dwordx4 v12, s[12:15], s39 offen offset:2048 lds
v_exp_f32 v65, v65
v_exp_f32 v66, v66
v_exp_f32 v67, v67
v_exp_f32 v68, v68
v_exp_f32 v69, v69
buffer_load_dwordx4 v13, s[12:15], s39 offen offset:3072 lds
v_exp_f32 v70, v70
v_exp_f32 v71, v71
v_pk_fma_f32 v[64:65], v[64:65], v[104:105], v[104:105] op_sel_hi:[1,0,0]
v_pk_fma_f32 v[66:67], v[66:67], v[104:105], v[104:105] op_sel_hi:[1,0,0]
s_add_u32 s39, s39, 65536
v_pk_fma_f32 v[68:69], v[68:69], v[104:105], v[104:105] op_sel_hi:[1,0,0]
v_pk_fma_f32 v[70:71], v[70:71], v[104:105], v[104:105] op_sel_hi:[1,0,0]
v_rcp_f32 v64, v64
v_rcp_f32 v65, v65
v_rcp_f32 v66, v66
v_rcp_f32 v67, v67
v_rcp_f32 v68, v68
v_rcp_f32 v69, v69
v_rcp_f32 v70, v70
v_rcp_f32 v71, v71
v_pk_mul_f32 v[64:65], v[64:65], v[144:145]
v_pk_mul_f32 v[66:67], v[66:67], v[146:147]
v_pk_mul_f32 v[68:69], v[68:69], v[148:149]
v_pk_mul_f32 v[70:71], v[70:71], v[150:151]
cv v144,v64,v65
cv v145,v66,v67
cv v146,v68,v69
cv v147,v70,v71
buffer_store_dwordx4 v[144:147], v24, s[8:11], s56 offen sc1
v_pk_fma_f32 v[176:177], v[48:49], v[98:99], v[176:177] op_sel_hi:[1,0,1]
v_pk_fma_f32 v[178:179], v[50:51], v[98:99], v[178:179] op_sel_hi:[1,0,1]
v_pk_fma_f32 v[180:181], v[52:53], v[98:99], v[180:181] op_sel_hi:[1,0,1]
v_pk_fma_f32 v[182:183], v[54:55], v[98:99], v[182:183] op_sel_hi:[1,0,1]
v_pk_mul_f32 v[72:73], v[176:177], v[98:99] op_sel:[0,1]
v_pk_mul_f32 v[74:75], v[178:179], v[98:99] op_sel:[0,1]
v_pk_mul_f32 v[76:77], v[180:181], v[98:99] op_sel:[0,1]
v_pk_mul_f32 v[78:79], v[182:183], v[98:99] op_sel:[0,1]
v_exp_f32 v72, v72
v_exp_f32 v73, v73
v_exp_f32 v74, v74
v_exp_f32 v75, v75
v_exp_f32 v76, v76
v_exp_f32 v77, v77
v_exp_f32 v78, v78
v_exp_f32 v79, v79
v_pk_fma_f32 v[72:73], v[72:73], v[106:107], v[106:107] op_sel_hi:[1,0,0]
v_pk_fma_f32 v[74:75], v[74:75], v[106:107], v[106:107] op_sel_hi:[1,0,0]
v_pk_fma_f32 v[76:77], v[76:77], v[106:107], v[106:107] op_sel_hi:[1,0,0]
v_pk_fma_f32 v[78:79], v[78:79], v[106:107], v[106:107] op_sel_hi:[1,0,0]
v_rcp_f32 v72, v72
v_rcp_f32 v73, v73
v_rcp_f32 v74, v74
v_rcp_f32 v75, v75
v_rcp_f32 v76, v76
v_rcp_f32 v77, v77
v_rcp_f32 v78, v78
v_rcp_f32 v79, v79
v_pk_mul_f32 v[72:73], v[72:73], v[176:177]
v_pk_mul_f32 v[74:75], v[74:75], v[178:179]
v_pk_mul_f32 v[76:77], v[76:77], v[180:181]
v_pk_mul_f32 v[78:79], v[78:79], v[182:183]
cv v176,v72,v73
cv v177,v74,v75
cv v178,v76,v77
cv v179,v78,v79
buffer_store_dwordx4 v[176:179], v25, s[8:11], s56 offen sc1
v_pk_fma_f32 v[208:209], v[48:49], v[100:101], v[208:209] op_sel_hi:[1,0,1]
v_pk_fma_f32 v[210:211], v[50:51], v[100:101], v[210:211] op_sel_hi:[1,0,1]
v_pk_fma_f32 v[212:213], v[52:53], v[100:101], v[212:213] op_sel_hi:[1,0,1]
v_pk_fma_f32 v[214:215], v[54:55], v[100:101], v[214:215] op_sel_hi:[1,0,1]
v_pk_mul_f32 v[64:65], v[208:209], v[100:101] op_sel:[0,1]
v_pk_mul_f32 v[66:67], v[210:211], v[100:101] op_sel:[0,1]
v_pk_mul_f32 v[68:69], v[212:213], v[100:101] op_sel:[0,1]
v_pk_mul_f32 v[70:71], v[214:215], v[100:101] op_sel:[0,1]
v_exp_f32 v64, v64
v_exp_f32 v65, v65
v_exp_f32 v66, v66
v_exp_f32 v67, v67
v_exp_f32 v68, v68
v_exp_f32 v69, v69
v_exp_f32 v70, v70
v_exp_f32 v71, v71
v_pk_fma_f32 v[64:65], v[64:65], v[108:109], v[108:109] op_sel_hi:[1,0,0]
v_pk_fma_f32 v[66:67], v[66:67], v[108:109], v[108:109] op_sel_hi:[1,0,0]
v_pk_fma_f32 v[68:69], v[68:69], v[108:109], v[108:109] op_sel_hi:[1,0,0]
v_pk_fma_f32 v[70:71], v[70:71], v[108:109], v[108:109] op_sel_hi:[1,0,0]
v_rcp_f32 v64, v64
v_rcp_f32 v65, v65
v_rcp_f32 v66, v66
v_rcp_f32 v67, v67
v_rcp_f32 v68, v68
v_rcp_f32 v69, v69
v_rcp_f32 v70, v70
v_rcp_f32 v71, v71
v_pk_mul_f32 v[64:65], v[64:65], v[208:209]
v_pk_mul_f32 v[66:67], v[66:67], v[210:211]
v_pk_mul_f32 v[68:69], v[68:69], v[212:213]
v_pk_mul_f32 v[70:71], v[70:71], v[214:215]
cv v208,v64,v65
cv v209,v66,v67
cv v210,v68,v69
cv v211,v70,v71
buffer_store_dwordx4 v[208:211], v26, s[8:11], s56 offen sc1
v_pk_fma_f32 v[240:241], v[48:49], v[102:103], v[240:241] op_sel_hi:[1,0,1]
v_pk_fma_f32 v[242:243], v[50:51], v[102:103], v[242:243] op_sel_hi:[1,0,1]
v_pk_fma_f32 v[244:245], v[52:53], v[102:103], v[244:245] op_sel_hi:[1,0,1]
v_pk_fma_f32 v[246:247], v[54:55], v[102:103], v[246:247] op_sel_hi:[1,0,1]
v_pk_mul_f32 v[72:73], v[240:241], v[102:103] op_sel:[0,1]
v_pk_mul_f32 v[74:75], v[242:243], v[102:103] op_sel:[0,1]
v_pk_mul_f32 v[76:77], v[244:245], v[102:103] op_sel:[0,1]
v_pk_mul_f32 v[78:79], v[246:247], v[102:103] op_sel:[0,1]
v_exp_f32 v72, v72
v_exp_f32 v73, v73
v_exp_f32 v74, v74
v_exp_f32 v75, v75
v_exp_f32 v76, v76
v_exp_f32 v77, v77
v_exp_f32 v78, v78
v_exp_f32 v79, v79
v_pk_fma_f32 v[72:73], v[72:73], v[110:111], v[110:111] op_sel_hi:[1,0,0]
v_pk_fma_f32 v[74:75], v[74:75], v[110:111], v[110:111] op_sel_hi:[1,0,0]
v_pk_fma_f32 v[76:77], v[76:77], v[110:111], v[110:111] op_sel_hi:[1,0,0]
v_pk_fma_f32 v[78:79], v[78:79], v[110:111], v[110:111] op_sel_hi:[1,0,0]
v_rcp_f32 v72, v72
v_rcp_f32 v73, v73
v_rcp_f32 v74, v74
v_rcp_f32 v75, v75
v_rcp_f32 v76, v76
v_rcp_f32 v77, v77
v_rcp_f32 v78, v78
v_rcp_f32 v79, v79
v_pk_mul_f32 v[72:73], v[72:73], v[240:241]
v_pk_mul_f32 v[74:75], v[74:75], v[242:243]
v_pk_mul_f32 v[76:77], v[76:77], v[244:245]
v_pk_mul_f32 v[78:79], v[78:79], v[246:247]
cv v240,v72,v73
cv v241,v74,v75
cv v242,v76,v77
cv v243,v78,v79
buffer_store_dwordx4 v[240:243], v27, s[8:11], s56 offen sc1
v_pk_fma_f32 v[152:153], v[56:57], v[96:97], v[152:153] op_sel_hi:[1,0,1]
v_pk_fma_f32 v[154:155], v[58:59], v[96:97], v[154:155] op_sel_hi:[1,0,1]
v_pk_fma_f32 v[156:157], v[60:61], v[96:97], v[156:157] op_sel_hi:[1,0,1]
v_pk_fma_f32 v[158:159], v[62:63], v[96:97], v[158:159] op_sel_hi:[1,0,1]
v_pk_mul_f32 v[72:73], v[152:153], v[96:97] op_sel:[0,1]
v_pk_mul_f32 v[74:75], v[154:155], v[96:97] op_sel:[0,1]
v_pk_mul_f32 v[76:77], v[156:157], v[96:97] op_sel:[0,1]
v_pk_mul_f32 v[78:79], v[158:159], v[96:97] op_sel:[0,1]
v_exp_f32 v72, v72
v_exp_f32 v73, v73
v_exp_f32 v74, v74
v_exp_f32 v75, v75
v_exp_f32 v76, v76
v_exp_f32 v77, v77
v_exp_f32 v78, v78
v_exp_f32 v79, v79
v_pk_fma_f32 v[72:73], v[72:73], v[104:105], v[104:105] op_sel_hi:[1,0,0]
v_pk_fma_f32 v[74:75], v[74:75], v[104:105], v[104:105] op_sel_hi:[1,0,0]
v_pk_fma_f32 v[76:77], v[76:77], v[104:105], v[104:105] op_sel_hi:[1,0,0]
v_pk_fma_f32 v[78:79], v[78:79], v[104:105], v[104:105] op_sel_hi:[1,0,0]
v_rcp_f32 v72, v72
v_rcp_f32 v73, v73
v_rcp_f32 v74, v74
v_rcp_f32 v75, v75
v_rcp_f32 v76, v76
v_rcp_f32 v77, v77
v_rcp_f32 v78, v78
v_rcp_f32 v79, v79
v_pk_mul_f32 v[72:73], v[72:73], v[152:153]
v_pk_mul_f32 v[74:75], v[74:75], v[154:155]
v_pk_mul_f32 v[76:77], v[76:77], v[156:157]
v_pk_mul_f32 v[78:79], v[78:79], v[158:159]
cv v152,v72,v73
cv v153,v74,v75
cv v154,v76,v77
cv v155,v78,v79
buffer_store_dwordx4 v[152:155], v24, s[8:11], s57 offen sc1
v_pk_fma_f32 v[184:185], v[56:57], v[98:99], v[184:185] op_sel_hi:[1,0,1]
v_pk_fma_f32 v[186:187], v[58:59], v[98:99], v[186:187] op_sel_hi:[1,0,1]
v_pk_fma_f32 v[188:189], v[60:61], v[98:99], v[188:189] op_sel_hi:[1,0,1]
v_pk_fma_f32 v[190:191], v[62:63], v[98:99], v[190:191] op_sel_hi:[1,0,1]
v_pk_mul_f32 v[64:65], v[184:185], v[98:99] op_sel:[0,1]
v_pk_mul_f32 v[66:67], v[186:187], v[98:99] op_sel:[0,1]
v_pk_mul_f32 v[68:69], v[188:189], v[98:99] op_sel:[0,1]
v_pk_mul_f32 v[70:71], v[190:191], v[98:99] op_sel:[0,1]
v_exp_f32 v64, v64
v_exp_f32 v65, v65
v_exp_f32 v66, v66
v_exp_f32 v67, v67
v_exp_f32 v68, v68
v_exp_f32 v69, v69
v_exp_f32 v70, v70
v_exp_f32 v71, v71
v_pk_fma_f32 v[64:65], v[64:65], v[106:107], v[106:107] op_sel_hi:[1,0,0]
v_pk_fma_f32 v[66:67], v[66:67], v[106:107], v[106:107] op_sel_hi:[1,0,0]
v_pk_fma_f32 v[68:69], v[68:69], v[106:107], v[106:107] op_sel_hi:[1,0,0]
v_pk_fma_f32 v[70:71], v[70:71], v[106:107], v[106:107] op_sel_hi:[1,0,0]
v_rcp_f32 v64, v64
v_rcp_f32 v65, v65
v_rcp_f32 v66, v66
v_rcp_f32 v67, v67
v_rcp_f32 v68, v68
v_rcp_f32 v69, v69
v_rcp_f32 v70, v70
v_rcp_f32 v71, v71
v_pk_mul_f32 v[64:65], v[64:65], v[184:185]
v_pk_mul_f32 v[66:67], v[66:67], v[186:187]
v_pk_mul_f32 v[68:69], v[68:69], v[188:189]
v_pk_mul_f32 v[70:71], v[70:71], v[190:191]
cv v184,v64,v65
cv v185,v66,v67
cv v186,v68,v69
cv v187,v70,v71
buffer_store_dwordx4 v[184:187], v25, s[8:11], s57 offen sc1
v_pk_fma_f32 v[216:217], v[56:57], v[100:101], v[216:217] op_sel_hi:[1,0,1]
v_pk_fma_f32 v[218:219], v[58:59], v[100:101], v[218:219] op_sel_hi:[1,0,1]
v_pk_fma_f32 v[220:221], v[60:61], v[100:101], v[220:221] op_sel_hi:[1,0,1]
v_pk_fma_f32 v[222:223], v[62:63], v[100:101], v[222:223] op_sel_hi:[1,0,1]
v_pk_mul_f32 v[72:73], v[216:217], v[100:101] op_sel:[0,1]
v_pk_mul_f32 v[74:75], v[218:219], v[100:101] op_sel:[0,1]
v_pk_mul_f32 v[76:77], v[220:221], v[100:101] op_sel:[0,1]
v_pk_mul_f32 v[78:79], v[222:223], v[100:101] op_sel:[0,1]
v_exp_f32 v72, v72
v_exp_f32 v73, v73
v_exp_f32 v74, v74
v_exp_f32 v75, v75
v_exp_f32 v76, v76
v_exp_f32 v77, v77
v_exp_f32 v78, v78
v_exp_f32 v79, v79
v_pk_fma_f32 v[72:73], v[72:73], v[108:109], v[108:109] op_sel_hi:[1,0,0]
v_pk_fma_f32 v[74:75], v[74:75], v[108:109], v[108:109] op_sel_hi:[1,0,0]
v_pk_fma_f32 v[76:77], v[76:77], v[108:109], v[108:109] op_sel_hi:[1,0,0]
v_pk_fma_f32 v[78:79], v[78:79], v[108:109], v[108:109] op_sel_hi:[1,0,0]
v_rcp_f32 v72, v72
v_rcp_f32 v73, v73
v_rcp_f32 v74, v74
v_rcp_f32 v75, v75
v_rcp_f32 v76, v76
v_rcp_f32 v77, v77
v_rcp_f32 v78, v78
v_rcp_f32 v79, v79
v_pk_mul_f32 v[72:73], v[72:73], v[216:217]
v_pk_mul_f32 v[74:75], v[74:75], v[218:219]
v_pk_mul_f32 v[76:77], v[76:77], v[220:221]
v_pk_mul_f32 v[78:79], v[78:79], v[222:223]
cv v216,v72,v73
cv v217,v74,v75
cv v218,v76,v77
cv v219,v78,v79
buffer_store_dwordx4 v[216:219], v26, s[8:11], s57 offen sc1
v_pk_fma_f32 v[248:249], v[56:57], v[102:103], v[248:249] op_sel_hi:[1,0,1]
v_pk_fma_f32 v[250:251], v[58:59], v[102:103], v[250:251] op_sel_hi:[1,0,1]
v_pk_fma_f32 v[252:253], v[60:61], v[102:103], v[252:253] op_sel_hi:[1,0,1]
v_pk_fma_f32 v[254:255], v[62:63], v[102:103], v[254:255] op_sel_hi:[1,0,1]
v_pk_mul_f32 v[64:65], v[248:249], v[102:103] op_sel:[0,1]
v_pk_mul_f32 v[66:67], v[250:251], v[102:103] op_sel:[0,1]
v_pk_mul_f32 v[68:69], v[252:253], v[102:103] op_sel:[0,1]
v_pk_mul_f32 v[70:71], v[254:255], v[102:103] op_sel:[0,1]
v_exp_f32 v64, v64
v_exp_f32 v65, v65
v_exp_f32 v66, v66
v_exp_f32 v67, v67
v_exp_f32 v68, v68
v_exp_f32 v69, v69
v_exp_f32 v70, v70
v_exp_f32 v71, v71
v_pk_fma_f32 v[64:65], v[64:65], v[110:111], v[110:111] op_sel_hi:[1,0,0]
v_pk_fma_f32 v[66:67], v[66:67], v[110:111], v[110:111] op_sel_hi:[1,0,0]
v_pk_fma_f32 v[68:69], v[68:69], v[110:111], v[110:111] op_sel_hi:[1,0,0]
v_pk_fma_f32 v[70:71], v[70:71], v[110:111], v[110:111] op_sel_hi:[1,0,0]
v_rcp_f32 v64, v64
v_rcp_f32 v65, v65
v_rcp_f32 v66, v66
v_rcp_f32 v67, v67
v_rcp_f32 v68, v68
v_rcp_f32 v69, v69
v_rcp_f32 v70, v70
v_rcp_f32 v71, v71
v_pk_mul_f32 v[64:65], v[64:65], v[248:249]
v_pk_mul_f32 v[66:67], v[66:67], v[250:251]
v_pk_mul_f32 v[68:69], v[68:69], v[252:253]
v_pk_mul_f32 v[70:71], v[70:71], v[254:255]
cv v248,v64,v65
cv v249,v66,v67
cv v250,v68,v69
cv v251,v70,v71
buffer_store_dwordx4 v[248:251], v27, s[8:11], s57 offen sc1
s_waitcnt vmcnt(0)
s_barrier
s_lshl_b32 s4, s2, 7
s_cmp_lg_u32 s3, 0
s_cbranch_scc1 L_sg12
v_mov_b32 v18, 1
s_mov_b64 exec, 1
buffer_store_dword v18, off, s[28:31], s4 offset:16 sc1
s_mov_b64 exec, -1
L_sg12:
s_branch L_p5_done
L_p5_skip:
s_and_b32 s34, s2, 4
s_lshl_b32 s34, s34, 1
s_bfe_u32 s4, s2, 0x30003
s_add_u32 s34, s34, s4
s_and_b32 s35, s2, 2
s_lshl_b32 s35, s35, 1
s_lshr_b32 s4, s2, 6
s_add_u32 s35, s35, s4
s_lshl_b32 s35, s35, 1
s_and_b32 s4, s2, 1
s_add_u32 s35, s35, s4
s_mov_b32 s12, s80
s_and_b32 s13, s81, 0xffff
s_mov_b32 s14, 7340032
s_mov_b32 s15, 0x20000
v_lshrrev_b32 v18, 4, v0
v_lshlrev_b32 v19, 11, v18
v_lshlrev_b32 v18, 1, v18
v_and_b32 v20, 15, v0
v_xor_b32 v18, v18, v20
v_xor_b32 v20, 8, v18
v_lshl_add_u32 v10, v18, 4, v19
v_lshl_add_u32 v11, v20, 4, v19
v_add_u32 v11, 7168, v11
v_lshl_add_u32 v12, v18, 4, v19
v_add_u32 v12, 14336, v12
v_lshl_add_u32 v13, v20, 4, v19
v_add_u32 v13, 21504, v13
s_and_b32 s6, s35, 1
s_lshl_b32 s6, s6, 2
s_add_u32 s7, s6, s3
s_mul_i32 s37, s7, 917504
s_lshr_b32 s4, s35, 1
s_lshl_b32 s4, s4, 8
s_add_u32 s37, s37, s4
s_add_u32 s39, s37, 32768
s_lshl_b32 s38, s3, 15
s_mul_i32 s36, s34, 917504
s_mul_i32 s4, s7, 14336
s_add_u32 s36, s36, s4
v_lshrrev_b32 v20, 4, v0
v_bfe_u32 v21, v0, 2, 2
v_lshl_add_u32 v18, v20, 2, v21
v_and_b32 v19, 7, v18
v_xor_b32 v19, s6, v19
v_lshlrev_b32 v18, 8, v18
v_and_b32 v20, 3, v0
v_lshl_add_u32 v18, v20, 3, v18
v_lshl_add_u32 v18, v19, 5, v18
v_add_u32 v18, s38, v18
v_xor_b32 v116, 0, v18
v_xor_b32 v117, 32, v18
v_xor_b32 v118, 64, v18
v_xor_b32 v119, 96, v18
v_xor_b32 v120, 128, v18
v_xor_b32 v121, 160, v18
v_xor_b32 v122, 192, v18
v_xor_b32 v123, 224, v18
s_add_u32 s8, s86, 67108864
s_addc_u32 s9, s87, 0
s_and_b32 s9, s9, 0xffff
s_mov_b32 s10, 14680064
s_mov_b32 s11, 0x20000
s_add_u32 s20, s86, 58720256
s_addc_u32 s21, s87, 0
s_and_b32 s21, s21, 0xffff
s_mov_b32 s22, 4194304
s_mov_b32 s23, 0x20000
s_lshl_b32 s5, s3, 1
s_lshl_b32 s4, s34, 3
s_add_u32 s4, s4, s5
s_lshl_b32 s4, s4, 15
s_lshl_b32 s40, s35, 11
s_add_u32 s40, s4, s40
s_add_u32 s4, s5, 0
s_and_b32 s4, s4, 7
s_mul_i32 s4, s4, 114688
v_add_u32 v2, s4, v1
s_add_u32 s4, s5, 1
s_and_b32 s4, s4, 7
s_mul_i32 s4, s4, 114688
v_add_u32 v3, s4, v1
s_add_u32 s4, s5, 2
s_and_b32 s4, s4, 7
s_mul_i32 s4, s4, 114688
v_add_u32 v4, s4, v1
s_add_u32 s4, s5, 3
s_and_b32 s4, s4, 7
s_mul_i32 s4, s4, 114688
v_add_u32 v5, s4, v1
s_add_u32 s4, s5, 4
s_and_b32 s4, s4, 7
s_mul_i32 s4, s4, 114688
v_add_u32 v6, s4, v1
s_add_u32 s4, s5, 5
s_and_b32 s4, s4, 7
s_mul_i32 s4, s4, 114688
v_add_u32 v7, s4, v1
s_add_u32 s4, s5, 6
s_and_b32 s4, s4, 7
s_mul_i32 s4, s4, 114688
v_add_u32 v8, s4, v1
s_add_u32 s4, s5, 7
s_and_b32 s4, s4, 7
s_mul_i32 s4, s4, 114688
v_add_u32 v9, s4, v1
s_add_u32 m0, s38, 0
s_nop 0
buffer_load_dwordx4 v10, s[12:15], s37 offen offset:0 lds
buffer_load_dwordx4 v11, s[12:15], s37 offen offset:1024 lds
buffer_load_dwordx4 v12, s[12:15], s37 offen offset:2048 lds
buffer_load_dwordx4 v13, s[12:15], s37 offen offset:3072 lds
s_add_u32 s37, s37, 65536
s_add_u32 m0, s38, 4096
s_nop 0
buffer_load_dwordx4 v10, s[12:15], s39 offen offset:0 lds
buffer_load_dwordx4 v11, s[12:15], s39 offen offset:1024 lds
buffer_load_dwordx4 v12, s[12:15], s39 offen offset:2048 lds
buffer_load_dwordx4 v13, s[12:15], s39 offen offset:3072 lds
s_add_u32 s39, s39, 65536
s_add_u32 m0, s38, 8192
s_nop 0
buffer_load_dwordx4 v10, s[12:15], s37 offen offset:0 lds
buffer_load_dwordx4 v11, s[12:15], s37 offen offset:1024 lds
buffer_load_dwordx4 v12, s[12:15], s37 offen offset:2048 lds
buffer_load_dwordx4 v13, s[12:15], s37 offen offset:3072 lds
s_add_u32 s37, s37, 65536
s_add_u32 m0, s38, 12288
s_nop 0
buffer_load_dwordx4 v10, s[12:15], s39 offen offset:0 lds
buffer_load_dwordx4 v11, s[12:15], s39 offen offset:1024 lds
buffer_load_dwordx4 v12, s[12:15], s39 offen offset:2048 lds
buffer_load_dwordx4 v13, s[12:15], s39 offen offset:3072 lds
s_add_u32 s39, s39, 65536
L_p5_done:
s_and_b32 s4, s35, 1
s_lshl_b32 s4, s4, 2
s_add_u32 s4, s4, s3
s_lshr_b32 s4, s4, 1
s_lshr_b32 s5, s34, 3
s_lshl_b32 s5, s5, 2
s_add_u32 s4, s4, s5
s_bfe_u32 s5, s34, 0x20001
s_lshl_b32 s5, s5, 3
s_add_u32 s4, s4, s5
s_lshl_b32 s5, s4, 7
s_add_u32 s5, s5, 16
v_min_u32 v19, 6, v0
v_lshlrev_b32 v19, 12, v19
buffer_load_dword v18, v19, s[28:31], s5 offen sc1
s_add_u32 m0, s38, 16384
s_nop 0
buffer_load_dwordx4 v10, s[12:15], s37 offen offset:0 lds
buffer_load_dwordx4 v11, s[12:15], s37 offen offset:1024 lds
buffer_load_dwordx4 v12, s[12:15], s37 offen offset:2048 lds
buffer_load_dwordx4 v13, s[12:15], s37 offen offset:3072 lds
s_add_u32 s37, s37, 65536
s_add_u32 m0, s38, 20480
s_nop 0
buffer_load_dwordx4 v10, s[12:15], s39 offen offset:0 lds
buffer_load_dwordx4 v11, s[12:15], s39 offen offset:1024 lds
buffer_load_dwordx4 v12, s[12:15], s39 offen offset:2048 lds
buffer_load_dwordx4 v13, s[12:15], s39 offen offset:3072 lds
s_add_u32 s39, s39, 65536
s_add_u32 m0, s38, 24576
s_nop 0
buffer_load_dwordx4 v10, s[12:15], s37 offen offset:0 lds
buffer_load_dwordx4 v11, s[12:15], s37 offen offset:1024 lds
buffer_load_dwordx4 v12, s[12:15], s37 offen offset:2048 lds
buffer_load_dwordx4 v13, s[12:15], s37 offen offset:3072 lds
s_add_u32 s37, s37, 65536
s_add_u32 m0, s38, 28672
s_nop 0
buffer_load_dwordx4 v10, s[12:15], s39 offen offset:0 lds
buffer_load_dwordx4 v11, s[12:15], s39 offen offset:1024 lds
buffer_load_dwordx4 v12, s[12:15], s39 offen offset:2048 lds
buffer_load_dwordx4 v13, s[12:15], s39 offen offset:3072 lds
s_add_u32 s39, s39, 65536
v_mov_b32 v48, v116
v_mov_b32 v49, v117
v_mov_b32 v50, v118
v_mov_b32 v51, v119
v_mov_b32 v52, v120
v_mov_b32 v53, v121
v_mov_b32 v54, v122
v_mov_b32 v55, v123
s_waitcnt vmcnt(16)
rt v[64:65],v48,0
rt v[66:67],v48,4096
rt v[68:69],v49,0
rt v[70:71],v49,4096
rt v[72:73],v50,0
rt v[74:75],v50,4096
rt v[76:77],v51,0
rt v[78:79],v51,4096
rt v[80:81],v52,0
rt v[82:83],v52,4096
rt v[84:85],v53,0
rt v[86:87],v53,4096
rt v[88:89],v54,0
rt v[90:91],v54,4096
rt v[92:93],v55,0
rt v[94:95],v55,4096
s_mov_b32 s7, 0x100000
s_branch L_spc13
L_sp13:
buffer_load_dword v18, v19, s[28:31], s5 offen sc1
s_waitcnt vmcnt(0)
L_spc13:
v_cmp_gt_u32 vcc, 1, v18
s_sub_u32 s7, s7, 1
s_cbranch_vccz L_spd13
s_cmp_lg_u32 s7, 0
s_cbranch_scc1 L_sp13
L_spd13:
buffer_load_dwordx4 a[136:139], v4, s[8:11], s36 offen offset:0 sc1
buffer_load_dwordx4 a[140:143], v5, s[8:11], s36 offen offset:0 sc1
buffer_load_dwordx4 a[144:147], v6, s[8:11], s36 offen offset:0 sc1
buffer_load_dwordx4 a[148:151], v7, s[8:11], s36 offen offset:0 sc1
buffer_load_dwordx4 a[152:155], v8, s[8:11], s36 offen offset:0 sc1
buffer_load_dwordx4 a[156:159], v9, s[8:11], s36 offen offset:0 sc1
buffer_load_dwordx4 a[128:131], v2, s[8:11], s36 offen offset:0 sc1
buffer_load_dwordx4 a[132:135], v3, s[8:11], s36 offen offset:0 sc1
buffer_load_dwordx4 a[168:171], v4, s[8:11], s36 offen offset:1024 sc1
buffer_load_dwordx4 a[172:175], v5, s[8:11], s36 offen offset:1024 sc1
buffer_load_dwordx4 a[176:179], v6, s[8:11], s36 offen offset:1024 sc1
buffer_load_dwordx4 a[180:183], v7, s[8:11], s36 offen offset:1024 sc1
buffer_load_dwordx4 a[184:187], v8, s[8:11], s36 offen offset:1024 sc1
buffer_load_dwordx4 a[188:191], v9, s[8:11], s36 offen offset:1024 sc1
buffer_load_dwordx4 a[160:163], v2, s[8:11], s36 offen offset:1024 sc1
buffer_load_dwordx4 a[164:167], v3, s[8:11], s36 offen offset:1024 sc1
s_waitcnt vmcnt(8) lgkmcnt(0)
mm v[160:163],v[64:67],a[136:139],0
buffer_load_dwordx4 a[200:203], v4, s[8:11], s36 offen offset:2048 sc1
mm v[164:167],v[68:71],a[136:139],0
buffer_load_dwordx4 a[204:207], v5, s[8:11], s36 offen offset:2048 sc1
mm v[168:171],v[72:75],a[136:139],0
mm v[172:175],v[76:79],a[136:139],0
buffer_load_dwordx4 a[208:211], v6, s[8:11], s36 offen offset:2048 sc1
mm a[32:35],v[80:83],a[136:139],0
rt v[96:97],v48,16384
mm a[36:39],v[84:87],a[136:139],0
buffer_load_dwordx4 a[212:215], v7, s[8:11], s36 offen offset:2048 sc1
mm a[40:43],v[88:91],a[136:139],0
mm a[44:47],v[92:95],a[136:139],0
buffer_load_dwordx4 a[216:219], v8, s[8:11], s36 offen offset:2048 sc1
rt v[98:99],v48,20480
mm v[176:179],v[64:67],a[140:143],0
buffer_load_dwordx4 a[220:223], v9, s[8:11], s36 offen offset:2048 sc1
mm v[180:183],v[68:71],a[140:143],0
mm v[184:187],v[72:75],a[140:143],0
buffer_load_dwordx4 a[192:195], v2, s[8:11], s36 offen offset:2048 sc1
rt v[100:101],v49,16384
mm v[188:191],v[76:79],a[140:143],0
mm a[48:51],v[80:83],a[140:143],0
buffer_load_dwordx4 a[196:199], v3, s[8:11], s36 offen offset:2048 sc1
mm a[52:55],v[84:87],a[140:143],0
rt v[102:103],v49,20480
mm a[56:59],v[88:91],a[140:143],0
buffer_load_dwordx4 a[232:235], v4, s[8:11], s36 offen offset:3072 sc1
mm a[60:63],v[92:95],a[140:143],0
mm v[192:195],v[64:67],a[144:147],0
buffer_load_dwordx4 a[236:239], v5, s[8:11], s36 offen offset:3072 sc1
rt v[104:105],v50,16384
mm v[196:199],v[68:71],a[144:147],0
buffer_load_dwordx4 a[240:243], v6, s[8:11], s36 offen offset:3072 sc1
mm v[200:203],v[72:75],a[144:147],0
mm v[204:207],v[76:79],a[144:147],0
buffer_load_dwordx4 a[244:247], v7, s[8:11], s36 offen offset:3072 sc1
rt v[106:107],v50,20480
mm a[64:67],v[80:83],a[144:147],0
mm a[68:71],v[84:87],a[144:147],0
buffer_load_dwordx4 a[248:251], v8, s[8:11], s36 offen offset:3072 sc1
mm a[72:75],v[88:91],a[144:147],0
rt v[108:109],v51,16384
mm a[76:79],v[92:95],a[144:147],0
buffer_load_dwordx4 a[252:255], v9, s[8:11], s36 offen offset:3072 sc1
mm v[208:211],v[64:67],a[148:151],0
mm v[212:215],v[68:71],a[148:151],0
buffer_load_dwordx4 a[224:227], v2, s[8:11], s36 offen offset:3072 sc1
rt v[110:111],v51,20480
mm v[216:219],v[72:75],a[148:151],0
buffer_load_dwordx4 a[228:231], v3, s[8:11], s36 offen offset:3072 sc1
mm v[220:223],v[76:79],a[148:151],0
mm a[80:83],v[80:83],a[148:151],0
rt v[112:113],v52,16384
s_add_u32 m0, s38, 0
mm a[84:87],v[84:87],a[148:151],0
mm a[88:91],v[88:91],a[148:151],0
buffer_load_dwordx4 v10, s[12:15], s37 offen offset:0 lds
mm a[92:95],v[92:95],a[148:151],0
rt v[114:115],v52,20480
mm v[224:227],v[64:67],a[152:155],0
buffer_load_dwordx4 v11, s[12:15], s37 offen offset:1024 lds
mm v[228:231],v[68:71],a[152:155],0
buffer_load_dwordx4 v12, s[12:15], s37 offen offset:2048 lds
mm v[232:235],v[72:75],a[152:155],0
rt v[116:117],v53,16384
mm v[236:239],v[76:79],a[152:155],0
buffer_load_dwordx4 v13, s[12:15], s37 offen offset:3072 lds
mm a[96:99],v[80:83],a[152:155],0
mm a[100:103],v[84:87],a[152:155],0
s_add_u32 s37, s37, 65536
rt v[118:119],v53,20480
mm a[104:107],v[88:91],a[152:155],0
mm a[108:111],v[92:95],a[152:155],0
s_add_u32 m0, s38, 4096
mm v[240:243],v[64:67],a[156:159],0
rt v[120:121],v54,16384
mm v[244:247],v[68:71],a[156:159],0
buffer_load_dwordx4 v10, s[12:15], s39 offen offset:0 lds
mm v[248:251],v[72:75],a[156:159],0
buffer_load_dwordx4 v11, s[12:15], s39 offen offset:1024 lds
mm v[252:255],v[76:79],a[156:159],0
rt v[122:123],v54,20480
mm a[112:115],v[80:83],a[156:159],0
buffer_load_dwordx4 v12, s[12:15], s39 offen offset:2048 lds
mm a[116:119],v[84:87],a[156:159],0
mm a[120:123],v[88:91],a[156:159],0
buffer_load_dwordx4 v13, s[12:15], s39 offen offset:3072 lds
rt v[124:125],v55,16384
mm a[124:127],v[92:95],a[156:159],0
mm v[128:131],v[64:67],a[128:131],0
s_add_u32 s39, s39, 65536
mm v[132:135],v[68:71],a[128:131],0
mm v[136:139],v[72:75],a[128:131],0
s_add_u32 s36, s36, 4096
rt v[126:127],v55,20480
mm v[140:143],v[76:79],a[128:131],0
mm a[0:3],v[80:83],a[128:131],0
buffer_load_dwordx4 a[136:139], v4, s[8:11], s36 offen offset:0 sc1
mm a[4:7],v[84:87],a[128:131],0
buffer_load_dwordx4 a[140:143], v5, s[8:11], s36 offen offset:0 sc1
mm a[8:11],v[88:91],a[128:131],0
buffer_load_dwordx4 a[144:147], v6, s[8:11], s36 offen offset:0 sc1
mm a[12:15],v[92:95],a[128:131],0
buffer_load_dwordx4 a[148:151], v7, s[8:11], s36 offen offset:0 sc1
mm v[144:147],v[64:67],a[132:135],0
rt v[64:65],v48,8192
rt v[66:67],v48,12288
buffer_load_dwordx4 a[152:155], v8, s[8:11], s36 offen offset:0 sc1
mm v[148:151],v[68:71],a[132:135],0
rt v[68:69],v49,8192
rt v[70:71],v49,12288
buffer_load_dwordx4 a[156:159], v9, s[8:11], s36 offen offset:0 sc1
mm v[152:155],v[72:75],a[132:135],0
rt v[72:73],v50,8192
rt v[74:75],v50,12288
buffer_load_dwordx4 a[128:131], v2, s[8:11], s36 offen offset:0 sc1
mm v[156:159],v[76:79],a[132:135],0
rt v[76:77],v51,8192
rt v[78:79],v51,12288
mm a[16:19],v[80:83],a[132:135],0
rt v[80:81],v52,8192
rt v[82:83],v52,12288
mm a[20:23],v[84:87],a[132:135],0
rt v[84:85],v53,8192
rt v[86:87],v53,12288
mm a[24:27],v[88:91],a[132:135],0
rt v[88:89],v54,8192
rt v[90:91],v54,12288
mm a[28:31],v[92:95],a[132:135],0
buffer_load_dwordx4 a[132:135], v3, s[8:11], s36 offen offset:0 sc1
rt v[92:93],v55,8192
rt v[94:95],v55,12288
s_add_u32 s36, s36, 1024
s_waitcnt vmcnt(24) lgkmcnt(12)
mm v[160:163],v[64:67],a[168:171],v[160:163]
mm v[160:163],v[96:99],a[200:203],v[160:163]
mm v[164:167],v[68:71],a[168:171],v[164:167]
mm v[164:167],v[100:103],a[200:203],v[164:167]
mm v[168:171],v[72:75],a[168:171],v[168:171]
mm v[168:171],v[104:107],a[200:203],v[168:171]
mm v[172:175],v[76:79],a[168:171],v[172:175]
mm v[172:175],v[108:111],a[200:203],v[172:175]
s_waitcnt lgkmcnt(0)
mm a[32:35],v[80:83],a[168:171],a[32:35]
mm a[32:35],v[112:115],a[200:203],a[32:35]
s_add_u32 m0, s38, 8192
mm a[36:39],v[84:87],a[168:171],a[36:39]
mm a[36:39],v[116:119],a[200:203],a[36:39]
mm a[40:43],v[88:91],a[168:171],a[40:43]
buffer_load_dwordx4 v10, s[12:15], s37 offen offset:0 lds
mm a[40:43],v[120:123],a[200:203],a[40:43]
mm a[44:47],v[92:95],a[168:171],a[44:47]
mm a[44:47],v[124:127],a[200:203],a[44:47]
buffer_load_dwordx4 v11, s[12:15], s37 offen offset:1024 lds
mm v[176:179],v[64:67],a[172:175],v[176:179]
mm v[176:179],v[96:99],a[204:207],v[176:179]
mm v[180:183],v[68:71],a[172:175],v[180:183]
mm v[180:183],v[100:103],a[204:207],v[180:183]
buffer_load_dwordx4 v12, s[12:15], s37 offen offset:2048 lds
mm v[184:187],v[72:75],a[172:175],v[184:187]
mm v[184:187],v[104:107],a[204:207],v[184:187]
mm v[188:191],v[76:79],a[172:175],v[188:191]
buffer_load_dwordx4 a[168:171], v4, s[8:11], s36 offen offset:0 sc1
mm v[188:191],v[108:111],a[204:207],v[188:191]
mm a[48:51],v[80:83],a[172:175],a[48:51]
mm a[48:51],v[112:115],a[204:207],a[48:51]
buffer_load_dwordx4 a[200:203], v4, s[8:11], s36 offen offset:1024 sc1
mm a[52:55],v[84:87],a[172:175],a[52:55]
mm a[52:55],v[116:119],a[204:207],a[52:55]
mm a[56:59],v[88:91],a[172:175],a[56:59]
mm a[56:59],v[120:123],a[204:207],a[56:59]
buffer_load_dwordx4 v13, s[12:15], s37 offen offset:3072 lds
s_add_u32 s37, s37, 65536
mm a[60:63],v[92:95],a[172:175],a[60:63]
s_add_u32 m0, s38, 12288
mm a[60:63],v[124:127],a[204:207],a[60:63]
mm v[192:195],v[64:67],a[176:179],v[192:195]
mm v[192:195],v[96:99],a[208:211],v[192:195]
buffer_load_dwordx4 v10, s[12:15], s39 offen offset:0 lds
mm v[196:199],v[68:71],a[176:179],v[196:199]
mm v[196:199],v[100:103],a[208:211],v[196:199]
mm v[200:203],v[72:75],a[176:179],v[200:203]
mm v[200:203],v[104:107],a[208:211],v[200:203]
buffer_load_dwordx4 a[172:175], v5, s[8:11], s36 offen offset:0 sc1
mm v[204:207],v[76:79],a[176:179],v[204:207]
mm v[204:207],v[108:111],a[208:211],v[204:207]
mm a[64:67],v[80:83],a[176:179],a[64:67]
buffer_load_dwordx4 a[204:207], v5, s[8:11], s36 offen offset:1024 sc1
mm a[64:67],v[112:115],a[208:211],a[64:67]
mm a[68:71],v[84:87],a[176:179],a[68:71]
mm a[68:71],v[116:119],a[208:211],a[68:71]
buffer_load_dwordx4 v11, s[12:15], s39 offen offset:1024 lds
mm a[72:75],v[88:91],a[176:179],a[72:75]
mm a[72:75],v[120:123],a[208:211],a[72:75]
mm a[76:79],v[92:95],a[176:179],a[76:79]
mm a[76:79],v[124:127],a[208:211],a[76:79]
buffer_load_dwordx4 v12, s[12:15], s39 offen offset:2048 lds
mm v[208:211],v[64:67],a[180:183],v[208:211]
mm v[208:211],v[96:99],a[212:215],v[208:211]
mm v[212:215],v[68:71],a[180:183],v[212:215]
buffer_load_dwordx4 v13, s[12:15], s39 offen offset:3072 lds
mm v[212:215],v[100:103],a[212:215],v[212:215]
s_add_u32 s39, s39, 65536
mm v[216:219],v[72:75],a[180:183],v[216:219]
mm v[216:219],v[104:107],a[212:215],v[216:219]
mm v[220:223],v[76:79],a[180:183],v[220:223]
buffer_load_dwordx4 a[176:179], v6, s[8:11], s36 offen offset:0 sc1
mm v[220:223],v[108:111],a[212:215],v[220:223]
mm a[80:83],v[80:83],a[180:183],a[80:83]
mm a[80:83],v[112:115],a[212:215],a[80:83]
mm a[84:87],v[84:87],a[180:183],a[84:87]
buffer_load_dwordx4 a[208:211], v6, s[8:11], s36 offen offset:1024 sc1
s_add_u32 m0, s38, 16384
mm a[84:87],v[116:119],a[212:215],a[84:87]
mm a[88:91],v[88:91],a[180:183],a[88:91]
mm a[88:91],v[120:123],a[212:215],a[88:91]
buffer_load_dwordx4 v10, s[12:15], s37 offen offset:0 lds
mm a[92:95],v[92:95],a[180:183],a[92:95]
mm a[92:95],v[124:127],a[212:215],a[92:95]
mm v[224:227],v[64:67],a[184:187],v[224:227]
mm v[224:227],v[96:99],a[216:219],v[224:227]
buffer_load_dwordx4 v11, s[12:15], s37 offen offset:1024 lds
mm v[228:231],v[68:71],a[184:187],v[228:231]
mm v[228:231],v[100:103],a[216:219],v[228:231]
mm v[232:235],v[72:75],a[184:187],v[232:235]
buffer_load_dwordx4 v12, s[12:15], s37 offen offset:2048 lds
mm v[232:235],v[104:107],a[216:219],v[232:235]
mm v[236:239],v[76:79],a[184:187],v[236:239]
mm v[236:239],v[108:111],a[216:219],v[236:239]
mm a[96:99],v[80:83],a[184:187],a[96:99]
buffer_load_dwordx4 a[180:183], v7, s[8:11], s36 offen offset:0 sc1
mm a[96:99],v[112:115],a[216:219],a[96:99]
mm a[100:103],v[84:87],a[184:187],a[100:103]
mm a[100:103],v[116:119],a[216:219],a[100:103]
buffer_load_dwordx4 a[212:215], v7, s[8:11], s36 offen offset:1024 sc1
mm a[104:107],v[88:91],a[184:187],a[104:107]
mm a[104:107],v[120:123],a[216:219],a[104:107]
mm a[108:111],v[92:95],a[184:187],a[108:111]
mm a[108:111],v[124:127],a[216:219],a[108:111]
buffer_load_dwordx4 v13, s[12:15], s37 offen offset:3072 lds
s_add_u32 s37, s37, 65536
mm v[240:243],v[64:67],a[188:191],v[240:243]
s_add_u32 m0, s38, 20480
mm v[240:243],v[96:99],a[220:223],v[240:243]
mm v[244:247],v[68:71],a[188:191],v[244:247]
mm v[244:247],v[100:103],a[220:223],v[244:247]
buffer_load_dwordx4 v10, s[12:15], s39 offen offset:0 lds
mm v[248:251],v[72:75],a[188:191],v[248:251]
mm v[248:251],v[104:107],a[220:223],v[248:251]
mm v[252:255],v[76:79],a[188:191],v[252:255]
buffer_load_dwordx4 a[184:187], v8, s[8:11], s36 offen offset:0 sc1
mm v[252:255],v[108:111],a[220:223],v[252:255]
mm a[112:115],v[80:83],a[188:191],a[112:115]
mm a[112:115],v[112:115],a[220:223],a[112:115]
mm a[116:119],v[84:87],a[188:191],a[116:119]
buffer_load_dwordx4 a[216:219], v8, s[8:11], s36 offen offset:1024 sc1
mm a[116:119],v[116:119],a[220:223],a[116:119]
mm a[120:123],v[88:91],a[188:191],a[120:123]
mm a[120:123],v[120:123],a[220:223],a[120:123]
buffer_load_dwordx4 v11, s[12:15], s39 offen offset:1024 lds
mm a[124:127],v[92:95],a[188:191],a[124:127]
mm a[124:127],v[124:127],a[220:223],a[124:127]
mm v[128:131],v[64:67],a[160:163],v[128:131]
mm v[128:131],v[96:99],a[192:195],v[128:131]
buffer_load_dwordx4 v12, s[12:15], s39 offen offset:2048 lds
mm v[132:135],v[68:71],a[160:163],v[132:135]
mm v[132:135],v[100:103],a[192:195],v[132:135]
mm v[136:139],v[72:75],a[160:163],v[136:139]
buffer_load_dwordx4 v13, s[12:15], s39 offen offset:3072 lds
s_add_u32 s39, s39, 65536
mm v[136:139],v[104:107],a[192:195],v[136:139]
mm v[140:143],v[76:79],a[160:163],v[140:143]
mm v[140:143],v[108:111],a[192:195],v[140:143]
mm a[0:3],v[80:83],a[160:163],a[0:3]
buffer_load_dwordx4 a[188:191], v9, s[8:11], s36 offen offset:0 sc1
mm a[0:3],v[112:115],a[192:195],a[0:3]
mm a[4:7],v[84:87],a[160:163],a[4:7]
buffer_load_dwordx4 a[220:223], v9, s[8:11], s36 offen offset:1024 sc1
mm a[4:7],v[116:119],a[192:195],a[4:7]
s_waitcnt vmcnt(36)
mm a[8:11],v[88:91],a[160:163],a[8:11]
mm a[8:11],v[120:123],a[192:195],a[8:11]
mm a[12:15],v[92:95],a[160:163],a[12:15]
mm a[12:15],v[124:127],a[192:195],a[12:15]
mm v[144:147],v[64:67],a[164:167],v[144:147]
buffer_load_dwordx4 a[160:163], v2, s[8:11], s36 offen offset:0 sc1
mm v[144:147],v[96:99],a[196:199],v[144:147]
rt v[64:65],v48,24576
rt v[66:67],v48,28672
rt v[96:97],v48,0
mm v[148:151],v[68:71],a[164:167],v[148:151]
rt v[98:99],v48,4096
mm v[148:151],v[100:103],a[196:199],v[148:151]
buffer_load_dwordx4 a[192:195], v2, s[8:11], s36 offen offset:1024 sc1
rt v[68:69],v49,24576
rt v[70:71],v49,28672
rt v[100:101],v49,0
mm v[152:155],v[72:75],a[164:167],v[152:155]
rt v[102:103],v49,4096
mm v[152:155],v[104:107],a[196:199],v[152:155]
rt v[72:73],v50,24576
rt v[74:75],v50,28672
rt v[104:105],v50,0
mm v[156:159],v[76:79],a[164:167],v[156:159]
rt v[106:107],v50,4096
mm v[156:159],v[108:111],a[196:199],v[156:159]
rt v[76:77],v51,24576
rt v[78:79],v51,28672
rt v[108:109],v51,0
mm a[16:19],v[80:83],a[164:167],a[16:19]
rt v[110:111],v51,4096
mm a[16:19],v[112:115],a[196:199],a[16:19]
rt v[80:81],v52,24576
rt v[82:83],v52,28672
rt v[112:113],v52,0
mm a[20:23],v[84:87],a[164:167],a[20:23]
rt v[114:115],v52,4096
mm a[20:23],v[116:119],a[196:199],a[20:23]
rt v[84:85],v53,24576
rt v[86:87],v53,28672
rt v[116:117],v53,0
mm a[24:27],v[88:91],a[164:167],a[24:27]
rt v[118:119],v53,4096
mm a[24:27],v[120:123],a[196:199],a[24:27]
rt v[88:89],v54,24576
rt v[90:91],v54,28672
rt v[120:121],v54,0
mm a[28:31],v[92:95],a[164:167],a[28:31]
rt v[122:123],v54,4096
mm a[28:31],v[124:127],a[196:199],a[28:31]
buffer_load_dwordx4 a[164:167], v3, s[8:11], s36 offen offset:0 sc1
buffer_load_dwordx4 a[196:199], v3, s[8:11], s36 offen offset:1024 sc1
rt v[92:93],v55,24576
rt v[94:95],v55,28672
rt v[124:125],v55,0
rt v[126:127],v55,4096
s_add_u32 s36, s36, 2048
s_waitcnt vmcnt(32) lgkmcnt(12)
mm v[160:163],v[64:67],a[232:235],v[160:163]
mm v[160:163],v[96:99],a[136:139],v[160:163]
mm v[164:167],v[68:71],a[232:235],v[164:167]
mm v[164:167],v[100:103],a[136:139],v[164:167]
mm v[168:171],v[72:75],a[232:235],v[168:171]
mm v[168:171],v[104:107],a[136:139],v[168:171]
mm v[172:175],v[76:79],a[232:235],v[172:175]
mm v[172:175],v[108:111],a[136:139],v[172:175]
s_waitcnt lgkmcnt(0)
mm a[32:35],v[80:83],a[232:235],a[32:35]
mm a[32:35],v[112:115],a[136:139],a[32:35]
s_add_u32 m0, s38, 24576
mm a[36:39],v[84:87],a[232:235],a[36:39]
mm a[36:39],v[116:119],a[136:139],a[36:39]
mm a[40:43],v[88:91],a[232:235],a[40:43]
buffer_load_dwordx4 v10, s[12:15], s37 offen offset:0 lds
mm a[40:43],v[120:123],a[136:139],a[40:43]
mm a[44:47],v[92:95],a[232:235],a[44:47]
mm a[44:47],v[124:127],a[136:139],a[44:47]
buffer_load_dwordx4 v11, s[12:15], s37 offen offset:1024 lds
mm v[176:179],v[64:67],a[236:239],v[176:179]
mm v[176:179],v[96:99],a[140:143],v[176:179]
mm v[180:183],v[68:71],a[236:239],v[180:183]
mm v[180:183],v[100:103],a[140:143],v[180:183]
buffer_load_dwordx4 v12, s[12:15], s37 offen offset:2048 lds
mm v[184:187],v[72:75],a[236:239],v[184:187]
mm v[184:187],v[104:107],a[140:143],v[184:187]
mm v[188:191],v[76:79],a[236:239],v[188:191]
buffer_load_dwordx4 a[232:235], v4, s[8:11], s36 offen offset:0 sc1
mm v[188:191],v[108:111],a[140:143],v[188:191]
mm a[48:51],v[80:83],a[236:239],a[48:51]
mm a[48:51],v[112:115],a[140:143],a[48:51]
buffer_load_dwordx4 a[136:139], v4, s[8:11], s36 offen offset:1024 sc1
mm a[52:55],v[84:87],a[236:239],a[52:55]
mm a[52:55],v[116:119],a[140:143],a[52:55]
mm a[56:59],v[88:91],a[236:239],a[56:59]
mm a[56:59],v[120:123],a[140:143],a[56:59]
buffer_load_dwordx4 v13, s[12:15], s37 offen offset:3072 lds
s_add_u32 s37, s37, 65536
mm a[60:63],v[92:95],a[236:239],a[60:63]
s_add_u32 m0, s38, 28672
mm a[60:63],v[124:127],a[140:143],a[60:63]
mm v[192:195],v[64:67],a[240:243],v[192:195]
mm v[192:195],v[96:99],a[144:147],v[192:195]
buffer_load_dwordx4 v10, s[12:15], s39 offen offset:0 lds
mm v[196:199],v[68:71],a[240:243],v[196:199]
mm v[196:199],v[100:103],a[144:147],v[196:199]
mm v[200:203],v[72:75],a[240:243],v[200:203]
mm v[200:203],v[104:107],a[144:147],v[200:203]
buffer_load_dwordx4 a[236:239], v5, s[8:11], s36 offen offset:0 sc1
mm v[204:207],v[76:79],a[240:243],v[204:207]
mm v[204:207],v[108:111],a[144:147],v[204:207]
mm a[64:67],v[80:83],a[240:243],a[64:67]
buffer_load_dwordx4 a[140:143], v5, s[8:11], s36 offen offset:1024 sc1
mm a[64:67],v[112:115],a[144:147],a[64:67]
mm a[68:71],v[84:87],a[240:243],a[68:71]
mm a[68:71],v[116:119],a[144:147],a[68:71]
buffer_load_dwordx4 v11, s[12:15], s39 offen offset:1024 lds
mm a[72:75],v[88:91],a[240:243],a[72:75]
mm a[72:75],v[120:123],a[144:147],a[72:75]
mm a[76:79],v[92:95],a[240:243],a[76:79]
mm a[76:79],v[124:127],a[144:147],a[76:79]
buffer_load_dwordx4 v12, s[12:15], s39 offen offset:2048 lds
mm v[208:211],v[64:67],a[244:247],v[208:211]
mm v[208:211],v[96:99],a[148:151],v[208:211]
mm v[212:215],v[68:71],a[244:247],v[212:215]
buffer_load_dwordx4 v13, s[12:15], s39 offen offset:3072 lds
mm v[212:215],v[100:103],a[148:151],v[212:215]
s_add_u32 s39, s39, 65536
mm v[216:219],v[72:75],a[244:247],v[216:219]
mm v[216:219],v[104:107],a[148:151],v[216:219]
mm v[220:223],v[76:79],a[244:247],v[220:223]
buffer_load_dwordx4 a[240:243], v6, s[8:11], s36 offen offset:0 sc1
mm v[220:223],v[108:111],a[148:151],v[220:223]
mm a[80:83],v[80:83],a[244:247],a[80:83]
mm a[80:83],v[112:115],a[148:151],a[80:83]
mm a[84:87],v[84:87],a[244:247],a[84:87]
buffer_load_dwordx4 a[144:147], v6, s[8:11], s36 offen offset:1024 sc1
s_add_u32 m0, s38, 0
mm a[84:87],v[116:119],a[148:151],a[84:87]
mm a[88:91],v[88:91],a[244:247],a[88:91]
mm a[88:91],v[120:123],a[148:151],a[88:91]
buffer_load_dwordx4 v10, s[12:15], s37 offen offset:0 lds
mm a[92:95],v[92:95],a[244:247],a[92:95]
mm a[92:95],v[124:127],a[148:151],a[92:95]
mm v[224:227],v[64:67],a[248:251],v[224:227]
mm v[224:227],v[96:99],a[152:155],v[224:227]
buffer_load_dwordx4 v11, s[12:15], s37 offen offset:1024 lds
mm v[228:231],v[68:71],a[248:251],v[228:231]
mm v[228:231],v[100:103],a[152:155],v[228:231]
mm v[232:235],v[72:75],a[248:251],v[232:235]
buffer_load_dwordx4 v12, s[12:15], s37 offen offset:2048 lds
mm v[232:235],v[104:107],a[152:155],v[232:235]
mm v[236:239],v[76:79],a[248:251],v[236:239]
mm v[236:239],v[108:111],a[152:155],v[236:239]
mm a[96:99],v[80:83],a[248:251],a[96:99]
buffer_load_dwordx4 a[244:247], v7, s[8:11], s36 offen offset:0 sc1
mm a[96:99],v[112:115],a[152:155],a[96:99]
mm a[100:103],v[84:87],a[248:251],a[100:103]
mm a[100:103],v[116:119],a[152:155],a[100:103]
buffer_load_dwordx4 a[148:151], v7, s[8:11], s36 offen offset:1024 sc1
mm a[104:107],v[88:91],a[248:251],a[104:107]
mm a[104:107],v[120:123],a[152:155],a[104:107]
mm a[108:111],v[92:95],a[248:251],a[108:111]
mm a[108:111],v[124:127],a[152:155],a[108:111]
buffer_load_dwordx4 v13, s[12:15], s37 offen offset:3072 lds
s_add_u32 s37, s37, 65536
mm v[240:243],v[64:67],a[252:255],v[240:243]
s_add_u32 m0, s38, 4096
mm v[240:243],v[96:99],a[156:159],v[240:243]
mm v[244:247],v[68:71],a[252:255],v[244:247]
mm v[244:247],v[100:103],a[156:159],v[244:247]
buffer_load_dwordx4 v10, s[12:15], s39 offen offset:0 lds
mm v[248:251],v[72:75],a[252:255],v[248:251]
mm v[248:251],v[104:107],a[156:159],v[248:251]
mm v[252:255],v[76:79],a[252:255],v[252:255]
buffer_load_dwordx4 a[248:251], v8, s[8:11], s36 offen offset:0 sc1
mm v[252:255],v[108:111],a[156:159],v[252:255]
mm a[112:115],v[80:83],a[252:255],a[112:115]
mm a[112:115],v[112:115],a[156:159],a[112:115]
mm a[116:119],v[84:87],a[252:255],a[116:119]
buffer_load_dwordx4 a[152:155], v8, s[8:11], s36 offen offset:1024 sc1
mm a[116:119],v[116:119],a[156:159],a[116:119]
mm a[120:123],v[88:91],a[252:255],a[120:123]
mm a[120:123],v[120:123],a[156:159],a[120:123]
buffer_load_dwordx4 v11, s[12:15], s39 offen offset:1024 lds
mm a[124:127],v[92:95],a[252:255],a[124:127]
mm a[124:127],v[124:127],a[156:159],a[124:127]
mm v[128:131],v[64:67],a[224:227],v[128:131]
mm v[128:131],v[96:99],a[128:131],v[128:131]
buffer_load_dwordx4 v12, s[12:15], s39 offen offset:2048 lds
mm v[132:135],v[68:71],a[224:227],v[132:135]
mm v[132:135],v[100:103],a[128:131],v[132:135]
mm v[136:139],v[72:75],a[224:227],v[136:139]
buffer_load_dwordx4 v13, s[12:15], s39 offen offset:3072 lds
s_add_u32 s39, s39, 65536
mm v[136:139],v[104:107],a[128:131],v[136:139]
mm v[140:143],v[76:79],a[224:227],v[140:143]
mm v[140:143],v[108:111],a[128:131],v[140:143]
mm a[0:3],v[80:83],a[224:227],a[0:3]
buffer_load_dwordx4 a[252:255], v9, s[8:11], s36 offen offset:0 sc1
mm a[0:3],v[112:115],a[128:131],a[0:3]
mm a[4:7],v[84:87],a[224:227],a[4:7]
buffer_load_dwordx4 a[156:159], v9, s[8:11], s36 offen offset:1024 sc1
mm a[4:7],v[116:119],a[128:131],a[4:7]
s_waitcnt vmcnt(34)
mm a[8:11],v[88:91],a[224:227],a[8:11]
mm a[8:11],v[120:123],a[128:131],a[8:11]
mm a[12:15],v[92:95],a[224:227],a[12:15]
mm a[12:15],v[124:127],a[128:131],a[12:15]
mm v[144:147],v[64:67],a[228:231],v[144:147]
buffer_load_dwordx4 a[224:227], v2, s[8:11], s36 offen offset:0 sc1
mm v[144:147],v[96:99],a[132:135],v[144:147]
rt v[64:65],v48,8192
rt v[66:67],v48,12288
rt v[96:97],v48,16384
mm v[148:151],v[68:71],a[228:231],v[148:151]
rt v[98:99],v48,20480
mm v[148:151],v[100:103],a[132:135],v[148:151]
buffer_load_dwordx4 a[128:131], v2, s[8:11], s36 offen offset:1024 sc1
rt v[68:69],v49,8192
rt v[70:71],v49,12288
rt v[100:101],v49,16384
mm v[152:155],v[72:75],a[228:231],v[152:155]
rt v[102:103],v49,20480
mm v[152:155],v[104:107],a[132:135],v[152:155]
rt v[72:73],v50,8192
rt v[74:75],v50,12288
rt v[104:105],v50,16384
mm v[156:159],v[76:79],a[228:231],v[156:159]
rt v[106:107],v50,20480
mm v[156:159],v[108:111],a[132:135],v[156:159]
rt v[76:77],v51,8192
rt v[78:79],v51,12288
rt v[108:109],v51,16384
mm a[16:19],v[80:83],a[228:231],a[16:19]
rt v[110:111],v51,20480
mm a[16:19],v[112:115],a[132:135],a[16:19]
rt v[80:81],v52,8192
rt v[82:83],v52,12288
rt v[112:113],v52,16384
mm a[20:23],v[84:87],a[228:231],a[20:23]
rt v[114:115],v52,20480
mm a[20:23],v[116:119],a[132:135],a[20:23]
rt v[84:85],v53,8192
rt v[86:87],v53,12288
rt v[116:117],v53,16384
mm a[24:27],v[88:91],a[228:231],a[24:27]
rt v[118:119],v53,20480
mm a[24:27],v[120:123],a[132:135],a[24:27]
rt v[88:89],v54,8192
rt v[90:91],v54,12288
rt v[120:121],v54,16384
mm a[28:31],v[92:95],a[228:231],a[28:31]
rt v[122:123],v54,20480
mm a[28:31],v[124:127],a[132:135],a[28:31]
buffer_load_dwordx4 a[228:231], v3, s[8:11], s36 offen offset:0 sc1
buffer_load_dwordx4 a[132:135], v3, s[8:11], s36 offen offset:1024 sc1
rt v[92:93],v55,8192
rt v[94:95],v55,12288
rt v[124:125],v55,16384
rt v[126:127],v55,20480
s_add_u32 s36, s36, 2048
s_waitcnt vmcnt(32) lgkmcnt(12)
mm v[160:163],v[64:67],a[168:171],v[160:163]
mm v[160:163],v[96:99],a[200:203],v[160:163]
mm v[164:167],v[68:71],a[168:171],v[164:167]
mm v[164:167],v[100:103],a[200:203],v[164:167]
mm v[168:171],v[72:75],a[168:171],v[168:171]
mm v[168:171],v[104:107],a[200:203],v[168:171]
mm v[172:175],v[76:79],a[168:171],v[172:175]
mm v[172:175],v[108:111],a[200:203],v[172:175]
s_waitcnt lgkmcnt(0)
mm a[32:35],v[80:83],a[168:171],a[32:35]
mm a[32:35],v[112:115],a[200:203],a[32:35]
s_add_u32 m0, s38, 8192
mm a[36:39],v[84:87],a[168:171],a[36:39]
mm a[36:39],v[116:119],a[200:203],a[36:39]
mm a[40:43],v[88:91],a[168:171],a[40:43]
buffer_load_dwordx4 v10, s[12:15], s37 offen offset:0 lds
mm a[40:43],v[120:123],a[200:203],a[40:43]
mm a[44:47],v[92:95],a[168:171],a[44:47]
mm a[44:47],v[124:127],a[200:203],a[44:47]
buffer_load_dwordx4 v11, s[12:15], s37 offen offset:1024 lds
mm v[176:179],v[64:67],a[172:175],v[176:179]
mm v[176:179],v[96:99],a[204:207],v[176:179]
mm v[180:183],v[68:71],a[172:175],v[180:183]
mm v[180:183],v[100:103],a[204:207],v[180:183]
buffer_load_dwordx4 v12, s[12:15], s37 offen offset:2048 lds
mm v[184:187],v[72:75],a[172:175],v[184:187]
mm v[184:187],v[104:107],a[204:207],v[184:187]
mm v[188:191],v[76:79],a[172:175],v[188:191]
buffer_load_dwordx4 a[168:171], v4, s[8:11], s36 offen offset:0 sc1
mm v[188:191],v[108:111],a[204:207],v[188:191]
mm a[48:51],v[80:83],a[172:175],a[48:51]
mm a[48:51],v[112:115],a[204:207],a[48:51]
buffer_load_dwordx4 a[200:203], v4, s[8:11], s36 offen offset:1024 sc1
mm a[52:55],v[84:87],a[172:175],a[52:55]
mm a[52:55],v[116:119],a[204:207],a[52:55]
mm a[56:59],v[88:91],a[172:175],a[56:59]
mm a[56:59],v[120:123],a[204:207],a[56:59]
buffer_load_dwordx4 v13, s[12:15], s37 offen offset:3072 lds
s_add_u32 s37, s37, 65536
mm a[60:63],v[92:95],a[172:175],a[60:63]
s_add_u32 m0, s38, 12288
mm a[60:63],v[124:127],a[204:207],a[60:63]
mm v[192:195],v[64:67],a[176:179],v[192:195]
mm v[192:195],v[96:99],a[208:211],v[192:195]
buffer_load_dwordx4 v10, s[12:15], s39 offen offset:0 lds
mm v[196:199],v[68:71],a[176:179],v[196:199]
mm v[196:199],v[100:103],a[208:211],v[196:199]
mm v[200:203],v[72:75],a[176:179],v[200:203]
mm v[200:203],v[104:107],a[208:211],v[200:203]
buffer_load_dwordx4 a[172:175], v5, s[8:11], s36 offen offset:0 sc1
mm v[204:207],v[76:79],a[176:179],v[204:207]
mm v[204:207],v[108:111],a[208:211],v[204:207]
mm a[64:67],v[80:83],a[176:179],a[64:67]
buffer_load_dwordx4 a[204:207], v5, s[8:11], s36 offen offset:1024 sc1
mm a[64:67],v[112:115],a[208:211],a[64:67]
mm a[68:71],v[84:87],a[176:179],a[68:71]
mm a[68:71],v[116:119],a[208:211],a[68:71]
buffer_load_dwordx4 v11, s[12:15], s39 offen offset:1024 lds
mm a[72:75],v[88:91],a[176:179],a[72:75]
mm a[72:75],v[120:123],a[208:211],a[72:75]
mm a[76:79],v[92:95],a[176:179],a[76:79]
mm a[76:79],v[124:127],a[208:211],a[76:79]
buffer_load_dwordx4 v12, s[12:15], s39 offen offset:2048 lds
mm v[208:211],v[64:67],a[180:183],v[208:211]
mm v[208:211],v[96:99],a[212:215],v[208:211]
mm v[212:215],v[68:71],a[180:183],v[212:215]
buffer_load_dwordx4 v13, s[12:15], s39 offen offset:3072 lds
mm v[212:215],v[100:103],a[212:215],v[212:215]
s_add_u32 s39, s39, 65536
mm v[216:219],v[72:75],a[180:183],v[216:219]
mm v[216:219],v[104:107],a[212:215],v[216:219]
mm v[220:223],v[76:79],a[180:183],v[220:223]
buffer_load_dwordx4 a[176:179], v6, s[8:11], s36 offen offset:0 sc1
mm v[220:223],v[108:111],a[212:215],v[220:223]
mm a[80:83],v[80:83],a[180:183],a[80:83]
mm a[80:83],v[112:115],a[212:215],a[80:83]
mm a[84:87],v[84:87],a[180:183],a[84:87]
buffer_load_dwordx4 a[208:211], v6, s[8:11], s36 offen offset:1024 sc1
s_add_u32 m0, s38, 16384
mm a[84:87],v[116:119],a[212:215],a[84:87]
mm a[88:91],v[88:91],a[180:183],a[88:91]
mm a[88:91],v[120:123],a[212:215],a[88:91]
buffer_load_dwordx4 v10, s[12:15], s37 offen offset:0 lds
mm a[92:95],v[92:95],a[180:183],a[92:95]
mm a[92:95],v[124:127],a[212:215],a[92:95]
mm v[224:227],v[64:67],a[184:187],v[224:227]
mm v[224:227],v[96:99],a[216:219],v[224:227]
buffer_load_dwordx4 v11, s[12:15], s37 offen offset:1024 lds
mm v[228:231],v[68:71],a[184:187],v[228:231]
mm v[228:231],v[100:103],a[216:219],v[228:231]
mm v[232:235],v[72:75],a[184:187],v[232:235]
buffer_load_dwordx4 v12, s[12:15], s37 offen offset:2048 lds
mm v[232:235],v[104:107],a[216:219],v[232:235]
mm v[236:239],v[76:79],a[184:187],v[236:239]
mm v[236:239],v[108:111],a[216:219],v[236:239]
mm a[96:99],v[80:83],a[184:187],a[96:99]
buffer_load_dwordx4 a[180:183], v7, s[8:11], s36 offen offset:0 sc1
mm a[96:99],v[112:115],a[216:219],a[96:99]
mm a[100:103],v[84:87],a[184:187],a[100:103]
mm a[100:103],v[116:119],a[216:219],a[100:103]
buffer_load_dwordx4 a[212:215], v7, s[8:11], s36 offen offset:1024 sc1
mm a[104:107],v[88:91],a[184:187],a[104:107]
mm a[104:107],v[120:123],a[216:219],a[104:107]
mm a[108:111],v[92:95],a[184:187],a[108:111]
mm a[108:111],v[124:127],a[216:219],a[108:111]
buffer_load_dwordx4 v13, s[12:15], s37 offen offset:3072 lds
s_add_u32 s37, s37, 65536
mm v[240:243],v[64:67],a[188:191],v[240:243]
s_add_u32 m0, s38, 20480
mm v[240:243],v[96:99],a[220:223],v[240:243]
mm v[244:247],v[68:71],a[188:191],v[244:247]
mm v[244:247],v[100:103],a[220:223],v[244:247]
buffer_load_dwordx4 v10, s[12:15], s39 offen offset:0 lds
mm v[248:251],v[72:75],a[188:191],v[248:251]
mm v[248:251],v[104:107],a[220:223],v[248:251]
mm v[252:255],v[76:79],a[188:191],v[252:255]
buffer_load_dwordx4 a[184:187], v8, s[8:11], s36 offen offset:0 sc1
mm v[252:255],v[108:111],a[220:223],v[252:255]
mm a[112:115],v[80:83],a[188:191],a[112:115]
mm a[112:115],v[112:115],a[220:223],a[112:115]
mm a[116:119],v[84:87],a[188:191],a[116:119]
buffer_load_dwordx4 a[216:219], v8, s[8:11], s36 offen offset:1024 sc1
mm a[116:119],v[116:119],a[220:223],a[116:119]
mm a[120:123],v[88:91],a[188:191],a[120:123]
mm a[120:123],v[120:123],a[220:223],a[120:123]
buffer_load_dwordx4 v11, s[12:15], s39 offen offset:1024 lds
mm a[124:127],v[92:95],a[188:191],a[124:127]
mm a[124:127],v[124:127],a[220:223],a[124:127]
mm v[128:131],v[64:67],a[160:163],v[128:131]
mm v[128:131],v[96:99],a[192:195],v[128:131]
buffer_load_dwordx4 v12, s[12:15], s39 offen offset:2048 lds
mm v[132:135],v[68:71],a[160:163],v[132:135]
mm v[132:135],v[100:103],a[192:195],v[132:135]
mm v[136:139],v[72:75],a[160:163],v[136:139]
buffer_load_dwordx4 v13, s[12:15], s39 offen offset:3072 lds
s_add_u32 s39, s39, 65536
mm v[136:139],v[104:107],a[192:195],v[136:139]
mm v[140:143],v[76:79],a[160:163],v[140:143]
mm v[140:143],v[108:111],a[192:195],v[140:143]
mm a[0:3],v[80:83],a[160:163],a[0:3]
buffer_load_dwordx4 a[188:191], v9, s[8:11], s36 offen offset:0 sc1
mm a[0:3],v[112:115],a[192:195],a[0:3]
mm a[4:7],v[84:87],a[160:163],a[4:7]
buffer_load_dwordx4 a[220:223], v9, s[8:11], s36 offen offset:1024 sc1
mm a[4:7],v[116:119],a[192:195],a[4:7]
s_waitcnt vmcnt(34)
mm a[8:11],v[88:91],a[160:163],a[8:11]
mm a[8:11],v[120:123],a[192:195],a[8:11]
mm a[12:15],v[92:95],a[160:163],a[12:15]
mm a[12:15],v[124:127],a[192:195],a[12:15]
mm v[144:147],v[64:67],a[164:167],v[144:147]
buffer_load_dwordx4 a[160:163], v2, s[8:11], s36 offen offset:0 sc1
mm v[144:147],v[96:99],a[196:199],v[144:147]
rt v[64:65],v48,24576
rt v[66:67],v48,28672
rt v[96:97],v48,0
mm v[148:151],v[68:71],a[164:167],v[148:151]
rt v[98:99],v48,4096
mm v[148:151],v[100:103],a[196:199],v[148:151]
buffer_load_dwordx4 a[192:195], v2, s[8:11], s36 offen offset:1024 sc1
rt v[68:69],v49,24576
rt v[70:71],v49,28672
rt v[100:101],v49,0
mm v[152:155],v[72:75],a[164:167],v[152:155]
rt v[102:103],v49,4096
mm v[152:155],v[104:107],a[196:199],v[152:155]
rt v[72:73],v50,24576
rt v[74:75],v50,28672
rt v[104:105],v50,0
mm v[156:159],v[76:79],a[164:167],v[156:159]
rt v[106:107],v50,4096
mm v[156:159],v[108:111],a[196:199],v[156:159]
rt v[76:77],v51,24576
rt v[78:79],v51,28672
rt v[108:109],v51,0
mm a[16:19],v[80:83],a[164:167],a[16:19]
rt v[110:111],v51,4096
mm a[16:19],v[112:115],a[196:199],a[16:19]
rt v[80:81],v52,24576
rt v[82:83],v52,28672
rt v[112:113],v52,0
mm a[20:23],v[84:87],a[164:167],a[20:23]
rt v[114:115],v52,4096
mm a[20:23],v[116:119],a[196:199],a[20:23]
rt v[84:85],v53,24576
rt v[86:87],v53,28672
rt v[116:117],v53,0
mm a[24:27],v[88:91],a[164:167],a[24:27]
rt v[118:119],v53,4096
mm a[24:27],v[120:123],a[196:199],a[24:27]
rt v[88:89],v54,24576
rt v[90:91],v54,28672
rt v[120:121],v54,0
mm a[28:31],v[92:95],a[164:167],a[28:31]
rt v[122:123],v54,4096
mm a[28:31],v[124:127],a[196:199],a[28:31]
buffer_load_dwordx4 a[164:167], v3, s[8:11], s36 offen offset:0 sc1
buffer_load_dwordx4 a[196:199], v3, s[8:11], s36 offen offset:1024 sc1
rt v[92:93],v55,24576
rt v[94:95],v55,28672
rt v[124:125],v55,0
rt v[126:127],v55,4096
s_add_u32 s36, s36, 2048
s_waitcnt vmcnt(32) lgkmcnt(12)
mm v[160:163],v[64:67],a[232:235],v[160:163]
mm v[160:163],v[96:99],a[136:139],v[160:163]
mm v[164:167],v[68:71],a[232:235],v[164:167]
mm v[164:167],v[100:103],a[136:139],v[164:167]
mm v[168:171],v[72:75],a[232:235],v[168:171]
mm v[168:171],v[104:107],a[136:139],v[168:171]
mm v[172:175],v[76:79],a[232:235],v[172:175]
mm v[172:175],v[108:111],a[136:139],v[172:175]
s_waitcnt lgkmcnt(0)
mm a[32:35],v[80:83],a[232:235],a[32:35]
mm a[32:35],v[112:115],a[136:139],a[32:35]
s_add_u32 m0, s38, 24576
mm a[36:39],v[84:87],a[232:235],a[36:39]
mm a[36:39],v[116:119],a[136:139],a[36:39]
mm a[40:43],v[88:91],a[232:235],a[40:43]
buffer_load_dwordx4 v10, s[12:15], s37 offen offset:0 lds
mm a[40:43],v[120:123],a[136:139],a[40:43]
mm a[44:47],v[92:95],a[232:235],a[44:47]
mm a[44:47],v[124:127],a[136:139],a[44:47]
buffer_load_dwordx4 v11, s[12:15], s37 offen offset:1024 lds
mm v[176:179],v[64:67],a[236:239],v[176:179]
mm v[176:179],v[96:99],a[140:143],v[176:179]
mm v[180:183],v[68:71],a[236:239],v[180:183]
mm v[180:183],v[100:103],a[140:143],v[180:183]
buffer_load_dwordx4 v12, s[12:15], s37 offen offset:2048 lds
mm v[184:187],v[72:75],a[236:239],v[184:187]
mm v[184:187],v[104:107],a[140:143],v[184:187]
mm v[188:191],v[76:79],a[236:239],v[188:191]
buffer_load_dwordx4 a[232:235], v4, s[8:11], s36 offen offset:0 sc1
mm v[188:191],v[108:111],a[140:143],v[188:191]
mm a[48:51],v[80:83],a[236:239],a[48:51]
mm a[48:51],v[112:115],a[140:143],a[48:51]
buffer_load_dwordx4 a[136:139], v4, s[8:11], s36 offen offset:1024 sc1
mm a[52:55],v[84:87],a[236:239],a[52:55]
mm a[52:55],v[116:119],a[140:143],a[52:55]
mm a[56:59],v[88:91],a[236:239],a[56:59]
mm a[56:59],v[120:123],a[140:143],a[56:59]
buffer_load_dwordx4 v13, s[12:15], s37 offen offset:3072 lds
s_add_u32 s37, s37, 65536
mm a[60:63],v[92:95],a[236:239],a[60:63]
s_add_u32 m0, s38, 28672
mm a[60:63],v[124:127],a[140:143],a[60:63]
mm v[192:195],v[64:67],a[240:243],v[192:195]
mm v[192:195],v[96:99],a[144:147],v[192:195]
buffer_load_dwordx4 v10, s[12:15], s39 offen offset:0 lds
mm v[196:199],v[68:71],a[240:243],v[196:199]
mm v[196:199],v[100:103],a[144:147],v[196:199]
mm v[200:203],v[72:75],a[240:243],v[200:203]
mm v[200:203],v[104:107],a[144:147],v[200:203]
buffer_load_dwordx4 a[236:239], v5, s[8:11], s36 offen offset:0 sc1
mm v[204:207],v[76:79],a[240:243],v[204:207]
mm v[204:207],v[108:111],a[144:147],v[204:207]
mm a[64:67],v[80:83],a[240:243],a[64:67]
buffer_load_dwordx4 a[140:143], v5, s[8:11], s36 offen offset:1024 sc1
mm a[64:67],v[112:115],a[144:147],a[64:67]
mm a[68:71],v[84:87],a[240:243],a[68:71]
mm a[68:71],v[116:119],a[144:147],a[68:71]
buffer_load_dwordx4 v11, s[12:15], s39 offen offset:1024 lds
mm a[72:75],v[88:91],a[240:243],a[72:75]
mm a[72:75],v[120:123],a[144:147],a[72:75]
mm a[76:79],v[92:95],a[240:243],a[76:79]
mm a[76:79],v[124:127],a[144:147],a[76:79]
buffer_load_dwordx4 v12, s[12:15], s39 offen offset:2048 lds
mm v[208:211],v[64:67],a[244:247],v[208:211]
mm v[208:211],v[96:99],a[148:151],v[208:211]
mm v[212:215],v[68:71],a[244:247],v[212:215]
buffer_load_dwordx4 v13, s[12:15], s39 offen offset:3072 lds
mm v[212:215],v[100:103],a[148:151],v[212:215]
s_add_u32 s39, s39, 65536
mm v[216:219],v[72:75],a[244:247],v[216:219]
mm v[216:219],v[104:107],a[148:151],v[216:219]
mm v[220:223],v[76:79],a[244:247],v[220:223]
buffer_load_dwordx4 a[240:243], v6, s[8:11], s36 offen offset:0 sc1
mm v[220:223],v[108:111],a[148:151],v[220:223]
mm a[80:83],v[80:83],a[244:247],a[80:83]
mm a[80:83],v[112:115],a[148:151],a[80:83]
mm a[84:87],v[84:87],a[244:247],a[84:87]
buffer_load_dwordx4 a[144:147], v6, s[8:11], s36 offen offset:1024 sc1
s_add_u32 m0, s38, 0
mm a[84:87],v[116:119],a[148:151],a[84:87]
mm a[88:91],v[88:91],a[244:247],a[88:91]
mm a[88:91],v[120:123],a[148:151],a[88:91]
buffer_load_dwordx4 v10, s[12:15], s37 offen offset:0 lds
mm a[92:95],v[92:95],a[244:247],a[92:95]
mm a[92:95],v[124:127],a[148:151],a[92:95]
mm v[224:227],v[64:67],a[248:251],v[224:227]
mm v[224:227],v[96:99],a[152:155],v[224:227]
buffer_load_dwordx4 v11, s[12:15], s37 offen offset:1024 lds
mm v[228:231],v[68:71],a[248:251],v[228:231]
mm v[228:231],v[100:103],a[152:155],v[228:231]
mm v[232:235],v[72:75],a[248:251],v[232:235]
buffer_load_dwordx4 v12, s[12:15], s37 offen offset:2048 lds
mm v[232:235],v[104:107],a[152:155],v[232:235]
mm v[236:239],v[76:79],a[248:251],v[236:239]
mm v[236:239],v[108:111],a[152:155],v[236:239]
mm a[96:99],v[80:83],a[248:251],a[96:99]
buffer_load_dwordx4 a[244:247], v7, s[8:11], s36 offen offset:0 sc1
mm a[96:99],v[112:115],a[152:155],a[96:99]
mm a[100:103],v[84:87],a[248:251],a[100:103]
mm a[100:103],v[116:119],a[152:155],a[100:103]
buffer_load_dwordx4 a[148:151], v7, s[8:11], s36 offen offset:1024 sc1
mm a[104:107],v[88:91],a[248:251],a[104:107]
mm a[104:107],v[120:123],a[152:155],a[104:107]
mm a[108:111],v[92:95],a[248:251],a[108:111]
mm a[108:111],v[124:127],a[152:155],a[108:111]
buffer_load_dwordx4 v13, s[12:15], s37 offen offset:3072 lds
s_add_u32 s37, s37, 65536
mm v[240:243],v[64:67],a[252:255],v[240:243]
s_add_u32 m0, s38, 4096
mm v[240:243],v[96:99],a[156:159],v[240:243]
mm v[244:247],v[68:71],a[252:255],v[244:247]
mm v[244:247],v[100:103],a[156:159],v[244:247]
buffer_load_dwordx4 v10, s[12:15], s39 offen offset:0 lds
mm v[248:251],v[72:75],a[252:255],v[248:251]
mm v[248:251],v[104:107],a[156:159],v[248:251]
mm v[252:255],v[76:79],a[252:255],v[252:255]
buffer_load_dwordx4 a[248:251], v8, s[8:11], s36 offen offset:0 sc1
mm v[252:255],v[108:111],a[156:159],v[252:255]
mm a[112:115],v[80:83],a[252:255],a[112:115]
mm a[112:115],v[112:115],a[156:159],a[112:115]
mm a[116:119],v[84:87],a[252:255],a[116:119]
buffer_load_dwordx4 a[152:155], v8, s[8:11], s36 offen offset:1024 sc1
mm a[116:119],v[116:119],a[156:159],a[116:119]
mm a[120:123],v[88:91],a[252:255],a[120:123]
mm a[120:123],v[120:123],a[156:159],a[120:123]
buffer_load_dwordx4 v11, s[12:15], s39 offen offset:1024 lds
mm a[124:127],v[92:95],a[252:255],a[124:127]
mm a[124:127],v[124:127],a[156:159],a[124:127]
mm v[128:131],v[64:67],a[224:227],v[128:131]
mm v[128:131],v[96:99],a[128:131],v[128:131]
buffer_load_dwordx4 v12, s[12:15], s39 offen offset:2048 lds
mm v[132:135],v[68:71],a[224:227],v[132:135]
mm v[132:135],v[100:103],a[128:131],v[132:135]
mm v[136:139],v[72:75],a[224:227],v[136:139]
buffer_load_dwordx4 v13, s[12:15], s39 offen offset:3072 lds
s_add_u32 s39, s39, 65536
mm v[136:139],v[104:107],a[128:131],v[136:139]
mm v[140:143],v[76:79],a[224:227],v[140:143]
mm v[140:143],v[108:111],a[128:131],v[140:143]
mm a[0:3],v[80:83],a[224:227],a[0:3]
buffer_load_dwordx4 a[252:255], v9, s[8:11], s36 offen offset:0 sc1
mm a[0:3],v[112:115],a[128:131],a[0:3]
mm a[4:7],v[84:87],a[224:227],a[4:7]
buffer_load_dwordx4 a[156:159], v9, s[8:11], s36 offen offset:1024 sc1
mm a[4:7],v[116:119],a[128:131],a[4:7]
s_waitcnt vmcnt(34)
mm a[8:11],v[88:91],a[224:227],a[8:11]
mm a[8:11],v[120:123],a[128:131],a[8:11]
mm a[12:15],v[92:95],a[224:227],a[12:15]
mm a[12:15],v[124:127],a[128:131],a[12:15]
mm v[144:147],v[64:67],a[228:231],v[144:147]
buffer_load_dwordx4 a[224:227], v2, s[8:11], s36 offen offset:0 sc1
mm v[144:147],v[96:99],a[132:135],v[144:147]
rt v[64:65],v48,8192
rt v[66:67],v48,12288
rt v[96:97],v48,16384
mm v[148:151],v[68:71],a[228:231],v[148:151]
rt v[98:99],v48,20480
mm v[148:151],v[100:103],a[132:135],v[148:151]
buffer_load_dwordx4 a[128:131], v2, s[8:11], s36 offen offset:1024 sc1
rt v[68:69],v49,8192
rt v[70:71],v49,12288
rt v[100:101],v49,16384
mm v[152:155],v[72:75],a[228:231],v[152:155]
rt v[102:103],v49,20480
mm v[152:155],v[104:107],a[132:135],v[152:155]
rt v[72:73],v50,8192
rt v[74:75],v50,12288
rt v[104:105],v50,16384
mm v[156:159],v[76:79],a[228:231],v[156:159]
rt v[106:107],v50,20480
mm v[156:159],v[108:111],a[132:135],v[156:159]
rt v[76:77],v51,8192
rt v[78:79],v51,12288
rt v[108:109],v51,16384
mm a[16:19],v[80:83],a[228:231],a[16:19]
rt v[110:111],v51,20480
mm a[16:19],v[112:115],a[132:135],a[16:19]
rt v[80:81],v52,8192
rt v[82:83],v52,12288
rt v[112:113],v52,16384
mm a[20:23],v[84:87],a[228:231],a[20:23]
rt v[114:115],v52,20480
mm a[20:23],v[116:119],a[132:135],a[20:23]
rt v[84:85],v53,8192
rt v[86:87],v53,12288
rt v[116:117],v53,16384
mm a[24:27],v[88:91],a[228:231],a[24:27]
rt v[118:119],v53,20480
mm a[24:27],v[120:123],a[132:135],a[24:27]
rt v[88:89],v54,8192
rt v[90:91],v54,12288
rt v[120:121],v54,16384
mm a[28:31],v[92:95],a[228:231],a[28:31]
rt v[122:123],v54,20480
mm a[28:31],v[124:127],a[132:135],a[28:31]
buffer_load_dwordx4 a[228:231], v3, s[8:11], s36 offen offset:0 sc1
buffer_load_dwordx4 a[132:135], v3, s[8:11], s36 offen offset:1024 sc1
rt v[92:93],v55,8192
rt v[94:95],v55,12288
rt v[124:125],v55,16384
rt v[126:127],v55,20480
s_add_u32 s36, s36, 2048
s_waitcnt vmcnt(32) lgkmcnt(12)
mm v[160:163],v[64:67],a[168:171],v[160:163]
mm v[160:163],v[96:99],a[200:203],v[160:163]
mm v[164:167],v[68:71],a[168:171],v[164:167]
mm v[164:167],v[100:103],a[200:203],v[164:167]
mm v[168:171],v[72:75],a[168:171],v[168:171]
mm v[168:171],v[104:107],a[200:203],v[168:171]
mm v[172:175],v[76:79],a[168:171],v[172:175]
mm v[172:175],v[108:111],a[200:203],v[172:175]
s_waitcnt lgkmcnt(0)
mm a[32:35],v[80:83],a[168:171],a[32:35]
mm a[32:35],v[112:115],a[200:203],a[32:35]
s_add_u32 m0, s38, 8192
mm a[36:39],v[84:87],a[168:171],a[36:39]
mm a[36:39],v[116:119],a[200:203],a[36:39]
mm a[40:43],v[88:91],a[168:171],a[40:43]
buffer_load_dwordx4 v10, s[12:15], s37 offen offset:0 lds
mm a[40:43],v[120:123],a[200:203],a[40:43]
mm a[44:47],v[92:95],a[168:171],a[44:47]
mm a[44:47],v[124:127],a[200:203],a[44:47]
buffer_load_dwordx4 v11, s[12:15], s37 offen offset:1024 lds
mm v[176:179],v[64:67],a[172:175],v[176:179]
mm v[176:179],v[96:99],a[204:207],v[176:179]
mm v[180:183],v[68:71],a[172:175],v[180:183]
mm v[180:183],v[100:103],a[204:207],v[180:183]
buffer_load_dwordx4 v12, s[12:15], s37 offen offset:2048 lds
mm v[184:187],v[72:75],a[172:175],v[184:187]
mm v[184:187],v[104:107],a[204:207],v[184:187]
mm v[188:191],v[76:79],a[172:175],v[188:191]
buffer_load_dwordx4 a[168:171], v4, s[8:11], s36 offen offset:0 sc1
mm v[188:191],v[108:111],a[204:207],v[188:191]
mm a[48:51],v[80:83],a[172:175],a[48:51]
mm a[48:51],v[112:115],a[204:207],a[48:51]
buffer_load_dwordx4 v13, s[12:15], s37 offen offset:3072 lds
mm a[52:55],v[84:87],a[172:175],a[52:55]
s_add_u32 s37, s37, 65536
s_add_u32 m0, s38, 12288
mm a[52:55],v[116:119],a[204:207],a[52:55]
mm a[56:59],v[88:91],a[172:175],a[56:59]
mm a[56:59],v[120:123],a[204:207],a[56:59]
mm a[60:63],v[92:95],a[172:175],a[60:63]
buffer_load_dwordx4 v10, s[12:15], s39 offen offset:0 lds
mm a[60:63],v[124:127],a[204:207],a[60:63]
mm v[192:195],v[64:67],a[176:179],v[192:195]
mm v[192:195],v[96:99],a[208:211],v[192:195]
buffer_load_dwordx4 a[172:175], v5, s[8:11], s36 offen offset:0 sc1
mm v[196:199],v[68:71],a[176:179],v[196:199]
mm v[196:199],v[100:103],a[208:211],v[196:199]
mm v[200:203],v[72:75],a[176:179],v[200:203]
mm v[200:203],v[104:107],a[208:211],v[200:203]
buffer_load_dwordx4 v11, s[12:15], s39 offen offset:1024 lds
mm v[204:207],v[76:79],a[176:179],v[204:207]
mm v[204:207],v[108:111],a[208:211],v[204:207]
mm a[64:67],v[80:83],a[176:179],a[64:67]
buffer_load_dwordx4 v12, s[12:15], s39 offen offset:2048 lds
mm a[64:67],v[112:115],a[208:211],a[64:67]
mm a[68:71],v[84:87],a[176:179],a[68:71]
mm a[68:71],v[116:119],a[208:211],a[68:71]
buffer_load_dwordx4 v13, s[12:15], s39 offen offset:3072 lds
mm a[72:75],v[88:91],a[176:179],a[72:75]
s_add_u32 s39, s39, 65536
mm a[72:75],v[120:123],a[208:211],a[72:75]
mm a[76:79],v[92:95],a[176:179],a[76:79]
mm a[76:79],v[124:127],a[208:211],a[76:79]
mm v[208:211],v[64:67],a[180:183],v[208:211]
buffer_load_dwordx4 a[176:179], v6, s[8:11], s36 offen offset:0 sc1
mm v[208:211],v[96:99],a[212:215],v[208:211]
mm v[212:215],v[68:71],a[180:183],v[212:215]
mm v[212:215],v[100:103],a[212:215],v[212:215]
mm v[216:219],v[72:75],a[180:183],v[216:219]
mm v[216:219],v[104:107],a[212:215],v[216:219]
mm v[220:223],v[76:79],a[180:183],v[220:223]
mm v[220:223],v[108:111],a[212:215],v[220:223]
mm a[80:83],v[80:83],a[180:183],a[80:83]
mm a[80:83],v[112:115],a[212:215],a[80:83]
mm a[84:87],v[84:87],a[180:183],a[84:87]
mm a[84:87],v[116:119],a[212:215],a[84:87]
mm a[88:91],v[88:91],a[180:183],a[88:91]
mm a[88:91],v[120:123],a[212:215],a[88:91]
mm a[92:95],v[92:95],a[180:183],a[92:95]
mm a[92:95],v[124:127],a[212:215],a[92:95]
mm v[224:227],v[64:67],a[184:187],v[224:227]
buffer_load_dwordx4 a[180:183], v7, s[8:11], s36 offen offset:0 sc1
mm v[224:227],v[96:99],a[216:219],v[224:227]
mm v[228:231],v[68:71],a[184:187],v[228:231]
mm v[228:231],v[100:103],a[216:219],v[228:231]
mm v[232:235],v[72:75],a[184:187],v[232:235]
mm v[232:235],v[104:107],a[216:219],v[232:235]
mm v[236:239],v[76:79],a[184:187],v[236:239]
mm v[236:239],v[108:111],a[216:219],v[236:239]
mm a[96:99],v[80:83],a[184:187],a[96:99]
mm a[96:99],v[112:115],a[216:219],a[96:99]
mm a[100:103],v[84:87],a[184:187],a[100:103]
mm a[100:103],v[116:119],a[216:219],a[100:103]
mm a[104:107],v[88:91],a[184:187],a[104:107]
mm a[104:107],v[120:123],a[216:219],a[104:107]
mm a[108:111],v[92:95],a[184:187],a[108:111]
mm a[108:111],v[124:127],a[216:219],a[108:111]
mm v[240:243],v[64:67],a[188:191],v[240:243]
buffer_load_dwordx4 a[184:187], v8, s[8:11], s36 offen offset:0 sc1
mm v[240:243],v[96:99],a[220:223],v[240:243]
mm v[244:247],v[68:71],a[188:191],v[244:247]
mm v[244:247],v[100:103],a[220:223],v[244:247]
mm v[248:251],v[72:75],a[188:191],v[248:251]
mm v[248:251],v[104:107],a[220:223],v[248:251]
mm v[252:255],v[76:79],a[188:191],v[252:255]
mm v[252:255],v[108:111],a[220:223],v[252:255]
mm a[112:115],v[80:83],a[188:191],a[112:115]
mm a[112:115],v[112:115],a[220:223],a[112:115]
mm a[116:119],v[84:87],a[188:191],a[116:119]
mm a[116:119],v[116:119],a[220:223],a[116:119]
mm a[120:123],v[88:91],a[188:191],a[120:123]
mm a[120:123],v[120:123],a[220:223],a[120:123]
mm a[124:127],v[92:95],a[188:191],a[124:127]
mm a[124:127],v[124:127],a[220:223],a[124:127]
mm v[128:131],v[64:67],a[160:163],v[128:131]
buffer_load_dwordx4 a[188:191], v9, s[8:11], s36 offen offset:0 sc1
mm v[128:131],v[96:99],a[192:195],v[128:131]
mm v[132:135],v[68:71],a[160:163],v[132:135]
mm v[132:135],v[100:103],a[192:195],v[132:135]
mm v[136:139],v[72:75],a[160:163],v[136:139]
mm v[136:139],v[104:107],a[192:195],v[136:139]
mm v[140:143],v[76:79],a[160:163],v[140:143]
mm v[140:143],v[108:111],a[192:195],v[140:143]
mm a[0:3],v[80:83],a[160:163],a[0:3]
mm a[0:3],v[112:115],a[192:195],a[0:3]
mm a[4:7],v[84:87],a[160:163],a[4:7]
mm a[4:7],v[116:119],a[192:195],a[4:7]
s_waitcnt vmcnt(4)
mm a[8:11],v[88:91],a[160:163],a[8:11]
rt v[32:33],v52,8192
rt v[34:35],v52,12288
mm a[8:11],v[120:123],a[192:195],a[8:11]
rt v[36:37],v53,8192
mm a[12:15],v[92:95],a[160:163],a[12:15]
rt v[38:39],v53,12288
rt v[40:41],v54,8192
mm a[12:15],v[124:127],a[192:195],a[12:15]
rt v[42:43],v54,12288
mm v[144:147],v[64:67],a[164:167],v[144:147]
buffer_load_dwordx4 a[160:163], v2, s[8:11], s36 offen offset:0 sc1
rt v[44:45],v55,8192
mm v[144:147],v[96:99],a[196:199],v[144:147]
rt v[46:47],v55,12288
rt v[64:65],v48,24576
rt v[66:67],v48,28672
rt v[96:97],v48,0
mm v[148:151],v[68:71],a[164:167],v[148:151]
rt v[98:99],v48,4096
mm v[148:151],v[100:103],a[196:199],v[148:151]
rt v[68:69],v49,24576
rt v[70:71],v49,28672
rt v[100:101],v49,0
mm v[152:155],v[72:75],a[164:167],v[152:155]
rt v[102:103],v49,4096
mm v[152:155],v[104:107],a[196:199],v[152:155]
rt v[72:73],v50,24576
rt v[74:75],v50,28672
rt v[104:105],v50,0
mm v[156:159],v[76:79],a[164:167],v[156:159]
rt v[106:107],v50,4096
mm v[156:159],v[108:111],a[196:199],v[156:159]
rt v[76:77],v51,24576
rt v[78:79],v51,28672
rt v[108:109],v51,0
mm a[16:19],v[80:83],a[164:167],a[16:19]
rt v[110:111],v51,4096
mm a[16:19],v[112:115],a[196:199],a[16:19]
rt v[80:81],v52,24576
rt v[82:83],v52,28672
rt v[112:113],v52,0
mm a[20:23],v[84:87],a[164:167],a[20:23]
rt v[114:115],v52,4096
mm a[20:23],v[116:119],a[196:199],a[20:23]
rt v[84:85],v53,24576
rt v[86:87],v53,28672
rt v[116:117],v53,0
mm a[24:27],v[88:91],a[164:167],a[24:27]
rt v[118:119],v53,4096
mm a[24:27],v[120:123],a[196:199],a[24:27]
rt v[88:89],v54,24576
rt v[90:91],v54,28672
rt v[120:121],v54,0
mm a[28:31],v[92:95],a[164:167],a[28:31]
rt v[122:123],v54,4096
mm a[28:31],v[124:127],a[196:199],a[28:31]
buffer_load_dwordx4 a[164:167], v3, s[8:11], s36 offen offset:0 sc1
rt v[92:93],v55,24576
rt v[94:95],v55,28672
rt v[124:125],v55,0
rt v[126:127],v55,4096
s_add_u32 s36, s36, 2048
s_waitcnt vmcnt(9) lgkmcnt(0)
mm a[32:35],v[80:83],a[232:235],a[32:35]
rt v[2:3],v48,8192
mm a[32:35],v[112:115],a[136:139],a[32:35]
s_add_u32 s4, s40, 32768
buffer_load_dwordx4 a[192:195], v1, s[20:23], s40 offen offset:0 sc1
mm a[32:35],v[32:35],a[168:171],a[32:35]
mm a[36:39],v[84:87],a[232:235],a[36:39]
buffer_load_dwordx4 a[196:199], v1, s[20:23], s40 offen offset:1024 sc1
mm a[36:39],v[116:119],a[136:139],a[36:39]
buffer_load_dwordx4 a[200:203], v1, s[20:23], s4 offen offset:0 sc1
mm a[36:39],v[36:39],a[168:171],a[36:39]
buffer_load_dwordx4 a[204:207], v1, s[20:23], s4 offen offset:1024 sc1
mm a[40:43],v[88:91],a[232:235],a[40:43]
mm a[40:43],v[120:123],a[136:139],a[40:43]
rt v[4:5],v48,12288
s_add_u32 s6, s3, 1
mm a[40:43],v[40:43],a[168:171],a[40:43]
s_and_b32 s6, s6, 3
mm a[44:47],v[92:95],a[232:235],a[44:47]
rt v[6:7],v49,8192
s_mul_i32 s6, s6, 24576
mm a[44:47],v[124:127],a[136:139],a[44:47]
rt v[8:9],v49,12288
rt v[10:11],v50,8192
rt v[12:13],v50,12288
rt v[14:15],v51,8192
rt v[16:17],v51,12288
mm a[44:47],v[44:47],a[168:171],a[44:47]
mm a[48:51],v[80:83],a[236:239],a[48:51]
mm a[48:51],v[112:115],a[140:143],a[48:51]
s_add_u32 s6, s6, 0
mm a[48:51],v[32:35],a[172:175],a[48:51]
v_add_u32 v19, s6, v1
mm a[52:55],v[84:87],a[236:239],a[52:55]
s_add_u32 s6, s3, 2
s_and_b32 s6, s6, 3
mm a[52:55],v[116:119],a[140:143],a[52:55]
s_mul_i32 s6, s6, 24576
mm a[52:55],v[36:39],a[172:175],a[52:55]
s_add_u32 s6, s6, 8192
v_add_u32 v28, s6, v1
mm a[56:59],v[88:91],a[236:239],a[56:59]
s_add_u32 s6, s3, 3
mm a[56:59],v[120:123],a[140:143],a[56:59]
s_and_b32 s6, s6, 3
s_mul_i32 s6, s6, 24576
mm a[56:59],v[40:43],a[172:175],a[56:59]
s_add_u32 s6, s6, 16384
mm a[60:63],v[92:95],a[236:239],a[60:63]
v_add_u32 v29, s6, v1
s_mul_i32 s6, s3, 24576
mm a[60:63],v[124:127],a[140:143],a[60:63]
v_add_u32 v18, s6, v1
s_add_u32 s6, s3, 1
s_and_b32 s6, s6, 3
s_lshl_b32 s6, s6, 14
s_add_u32 s6, s6, 98304
v_add_u32 v21, s6, v1
s_add_u32 s6, s3, 2
s_and_b32 s6, s6, 3
s_lshl_b32 s6, s6, 14
s_add_u32 s6, s6, 106496
v_add_u32 v22, s6, v1
s_add_u32 s6, s3, 0
s_and_b32 s6, s6, 3
s_lshl_b32 s6, s6, 14
s_add_u32 s6, s6, 98304
v_add_u32 v20, s6, v1
s_add_u32 s8, s86, 92274688
s_addc_u32 s9, s87, 0
s_and_b32 s9, s9, 0xffff
s_mov_b32 s10, 8388608
s_mov_b32 s11, 0x20000
s_xor_b32 s6, s2, 1
s_lshl_b32 s36, s6, 2
s_add_u32 s36, s36, s3
s_lshl_b32 s36, s36, 13
s_lshr_b32 s37, s36, 6
s_add_u32 s37, s37, 163840
mm a[60:63],v[44:47],a[172:175],a[60:63]
s_waitcnt vmcnt(8)
s_waitcnt lgkmcnt(0)
s_barrier
mm a[64:67],v[80:83],a[240:243],a[64:67]
mm a[64:67],v[112:115],a[144:147],a[64:67]
ds_write_b128 v19, a[32:35] offset:0
mm a[64:67],v[32:35],a[176:179],a[64:67]
mm a[68:71],v[84:87],a[240:243],a[68:71]
mm a[68:71],v[116:119],a[144:147],a[68:71]
ds_write_b128 v19, a[36:39] offset:1024
mm a[68:71],v[36:39],a[176:179],a[68:71]
mm a[72:75],v[88:91],a[240:243],a[72:75]
mm a[72:75],v[120:123],a[144:147],a[72:75]
ds_write_b128 v19, a[40:43] offset:2048
mm a[72:75],v[40:43],a[176:179],a[72:75]
mm a[76:79],v[92:95],a[240:243],a[76:79]
mm a[76:79],v[124:127],a[144:147],a[76:79]
ds_write_b128 v19, a[44:47] offset:3072
mm a[76:79],v[44:47],a[176:179],a[76:79]
mm a[80:83],v[80:83],a[244:247],a[80:83]
mm a[80:83],v[112:115],a[148:151],a[80:83]
ds_write_b128 v19, a[48:51] offset:4096
mm a[80:83],v[32:35],a[180:183],a[80:83]
mm a[84:87],v[84:87],a[244:247],a[84:87]
mm a[84:87],v[116:119],a[148:151],a[84:87]
ds_write_b128 v19, a[52:55] offset:5120
mm a[84:87],v[36:39],a[180:183],a[84:87]
mm a[88:91],v[88:91],a[244:247],a[88:91]
mm a[88:91],v[120:123],a[148:151],a[88:91]
mm a[88:91],v[40:43],a[180:183],a[88:91]
ds_write_b128 v19, a[56:59] offset:6144
mm a[92:95],v[92:95],a[244:247],a[92:95]
mm a[92:95],v[124:127],a[148:151],a[92:95]
mm a[92:95],v[44:47],a[180:183],a[92:95]
ds_write_b128 v19, a[60:63] offset:7168
s_waitcnt vmcnt(6)
mm a[96:99],v[80:83],a[248:251],a[96:99]
mm a[96:99],v[112:115],a[152:155],a[96:99]
mm a[96:99],v[32:35],a[184:187],a[96:99]
ds_write_b128 v28, a[64:67] offset:0
mm a[100:103],v[84:87],a[248:251],a[100:103]
mm a[100:103],v[116:119],a[152:155],a[100:103]
mm a[100:103],v[36:39],a[184:187],a[100:103]
ds_write_b128 v28, a[68:71] offset:1024
mm a[104:107],v[88:91],a[248:251],a[104:107]
mm a[104:107],v[120:123],a[152:155],a[104:107]
mm a[104:107],v[40:43],a[184:187],a[104:107]
ds_write_b128 v28, a[72:75] offset:2048
mm a[108:111],v[92:95],a[248:251],a[108:111]
mm a[108:111],v[124:127],a[152:155],a[108:111]
mm a[108:111],v[44:47],a[184:187],a[108:111]
ds_write_b128 v28, a[76:79] offset:3072
mm a[112:115],v[80:83],a[252:255],a[112:115]
mm a[112:115],v[112:115],a[156:159],a[112:115]
mm a[112:115],v[32:35],a[188:191],a[112:115]
mm a[116:119],v[84:87],a[252:255],a[116:119]
ds_write_b128 v28, a[80:83] offset:4096
mm a[116:119],v[116:119],a[156:159],a[116:119]
mm a[116:119],v[36:39],a[188:191],a[116:119]
mm a[120:123],v[88:91],a[252:255],a[120:123]
ds_write_b128 v28, a[84:87] offset:5120
mm a[120:123],v[120:123],a[156:159],a[120:123]
mm a[120:123],v[40:43],a[188:191],a[120:123]
mm a[124:127],v[92:95],a[252:255],a[124:127]
ds_write_b128 v28, a[88:91] offset:6144
mm a[124:127],v[124:127],a[156:159],a[124:127]
mm a[124:127],v[44:47],a[188:191],a[124:127]
s_waitcnt vmcnt(4)
mm a[0:3],v[80:83],a[224:227],a[0:3]
ds_write_b128 v28, a[92:95] offset:7168
mm a[0:3],v[112:115],a[128:131],a[0:3]
mm a[0:3],v[32:35],a[160:163],a[0:3]
mm a[4:7],v[84:87],a[224:227],a[4:7]
ds_write_b128 v29, a[96:99] offset:0
mm a[4:7],v[116:119],a[128:131],a[4:7]
mm a[4:7],v[36:39],a[160:163],a[4:7]
mm a[8:11],v[88:91],a[224:227],a[8:11]
ds_write_b128 v29, a[100:103] offset:1024
mm a[8:11],v[120:123],a[128:131],a[8:11]
mm a[8:11],v[40:43],a[160:163],a[8:11]
mm a[12:15],v[92:95],a[224:227],a[12:15]
mm a[12:15],v[124:127],a[128:131],a[12:15]
ds_write_b128 v29, a[104:107] offset:2048
mm a[12:15],v[44:47],a[160:163],a[12:15]
mm a[16:19],v[80:83],a[228:231],a[16:19]
mm a[16:19],v[112:115],a[132:135],a[16:19]
ds_write_b128 v29, a[108:111] offset:3072
mm a[16:19],v[32:35],a[164:167],a[16:19]
mm a[20:23],v[84:87],a[228:231],a[20:23]
mm a[20:23],v[116:119],a[132:135],a[20:23]
ds_write_b128 v29, a[112:115] offset:4096
mm a[20:23],v[36:39],a[164:167],a[20:23]
mm a[24:27],v[88:91],a[228:231],a[24:27]
mm a[24:27],v[120:123],a[132:135],a[24:27]
ds_write_b128 v29, a[116:119] offset:5120
mm a[24:27],v[40:43],a[164:167],a[24:27]
mm a[28:31],v[92:95],a[228:231],a[28:31]
mm a[28:31],v[124:127],a[132:135],a[28:31]
ds_write_b128 v29, a[120:123] offset:6144
mm a[28:31],v[44:47],a[164:167],a[28:31]
mm v[160:163],v[64:67],a[232:235],v[160:163]
mm v[160:163],v[96:99],a[136:139],v[160:163]
mm v[160:163],v[2:5],a[168:171],v[160:163]
ds_write_b128 v29, a[124:127] offset:7168
mm v[164:167],v[68:71],a[232:235],v[164:167]
mm v[164:167],v[100:103],a[136:139],v[164:167]
mm v[164:167],v[6:9],a[168:171],v[164:167]
mm v[168:171],v[72:75],a[232:235],v[168:171]
mm v[168:171],v[104:107],a[136:139],v[168:171]
s_waitcnt lgkmcnt(0)
s_barrier
mm v[168:171],v[10:13],a[168:171],v[168:171]
ds_read_b128 v[80:83], v18 offset:0
ds_read_b128 v[84:87], v18 offset:1024
ds_read_b128 v[88:91], v18 offset:2048
ds_read_b128 v[92:95], v18 offset:3072
mm v[172:175],v[76:79],a[232:235],v[172:175]
ds_read_b128 v[112:115], v18 offset:4096
ds_read_b128 v[116:119], v18 offset:5120
ds_read_b128 v[120:123], v18 offset:6144
mm v[172:175],v[108:111],a[136:139],v[172:175]
ds_read_b128 v[124:127], v18 offset:7168
ar v32,a0
ar v33,a1
ar v34,a2
mm v[172:175],v[14:17],a[168:171],v[172:175]
ar v35,a3
ar v36,a4
ar v37,a5
mm v[176:179],v[64:67],a[236:239],v[176:179]
ar v38,a6
ar v39,a7
ar v40,a8
ar v41,a9
mm v[176:179],v[96:99],a[140:143],v[176:179]
ar v42,a10
ar v43,a11
ar v44,a12
mm v[176:179],v[2:5],a[172:175],v[176:179]
ar v45,a13
ar v46,a14
ar v47,a15
mm v[180:183],v[68:71],a[236:239],v[180:183]
ar v48,a16
ar v49,a17
ar v50,a18
ar v51,a19
mm v[180:183],v[100:103],a[140:143],v[180:183]
ar v52,a20
ar v53,a21
ar v54,a22
mm v[180:183],v[6:9],a[172:175],v[180:183]
ar v55,a23
ar v56,a24
ar v57,a25
ar v58,a26
mm v[184:187],v[72:75],a[236:239],v[184:187]
ar v59,a27
ar v60,a28
ar v61,a29
mm v[184:187],v[104:107],a[140:143],v[184:187]
ar v62,a30
ar v63,a31
s_waitcnt lgkmcnt(4)
mm v[184:187],v[10:13],a[172:175],v[184:187]
v_add_f32 v32, v32, v80
v_add_f32 v33, v33, v81
v_add_f32 v34, v34, v82
v_add_f32 v35, v35, v83
mm v[188:191],v[76:79],a[236:239],v[188:191]
v_add_f32 v36, v36, v84
v_add_f32 v37, v37, v85
v_add_f32 v38, v38, v86
mm v[188:191],v[108:111],a[140:143],v[188:191]
v_add_f32 v39, v39, v87
v_add_f32 v40, v40, v88
v_add_f32 v41, v41, v89
v_add_f32 v42, v42, v90
mm v[188:191],v[14:17],a[172:175],v[188:191]
v_add_f32 v43, v43, v91
v_add_f32 v44, v44, v92
v_add_f32 v45, v45, v93
mm v[192:195],v[64:67],a[240:243],v[192:195]
v_add_f32 v46, v46, v94
v_add_f32 v47, v47, v95
ds_read_b128 v[80:83], v18 offset:8192
mm v[192:195],v[96:99],a[144:147],v[192:195]
ds_read_b128 v[84:87], v18 offset:9216
ds_read_b128 v[88:91], v18 offset:10240
ds_read_b128 v[92:95], v18 offset:11264
s_waitcnt lgkmcnt(4)
mm v[192:195],v[2:5],a[176:179],v[192:195]
v_add_f32 v48, v48, v112
v_add_f32 v49, v49, v113
v_add_f32 v50, v50, v114
mm v[196:199],v[68:71],a[240:243],v[196:199]
v_add_f32 v51, v51, v115
v_add_f32 v52, v52, v116
v_add_f32 v53, v53, v117
v_add_f32 v54, v54, v118
mm v[196:199],v[100:103],a[144:147],v[196:199]
v_add_f32 v55, v55, v119
v_add_f32 v56, v56, v120
v_add_f32 v57, v57, v121
mm v[196:199],v[6:9],a[176:179],v[196:199]
v_add_f32 v58, v58, v122
v_add_f32 v59, v59, v123
v_add_f32 v60, v60, v124
mm v[200:203],v[72:75],a[240:243],v[200:203]
v_add_f32 v61, v61, v125
v_add_f32 v62, v62, v126
v_add_f32 v63, v63, v127
ds_read_b128 v[112:115], v18 offset:12288
mm v[200:203],v[104:107],a[144:147],v[200:203]
ds_read_b128 v[116:119], v18 offset:13312
ds_read_b128 v[120:123], v18 offset:14336
ds_read_b128 v[124:127], v18 offset:15360
mm v[200:203],v[10:13],a[176:179],v[200:203]
s_waitcnt lgkmcnt(4)
v_add_f32 v32, v32, v80
v_add_f32 v33, v33, v81
v_add_f32 v34, v34, v82
mm v[204:207],v[76:79],a[240:243],v[204:207]
v_add_f32 v35, v35, v83
v_add_f32 v36, v36, v84
v_add_f32 v37, v37, v85
mm v[204:207],v[108:111],a[144:147],v[204:207]
v_add_f32 v38, v38, v86
v_add_f32 v39, v39, v87
v_add_f32 v40, v40, v88
mm v[204:207],v[14:17],a[176:179],v[204:207]
v_add_f32 v41, v41, v89
v_add_f32 v42, v42, v90
v_add_f32 v43, v43, v91
v_add_f32 v44, v44, v92
mm v[208:211],v[64:67],a[244:247],v[208:211]
v_add_f32 v45, v45, v93
v_add_f32 v46, v46, v94
v_add_f32 v47, v47, v95
mm v[208:211],v[96:99],a[148:151],v[208:211]
ds_read_b128 v[80:83], v18 offset:16384
ds_read_b128 v[84:87], v18 offset:17408
ds_read_b128 v[88:91], v18 offset:18432
ds_read_b128 v[92:95], v18 offset:19456
mm v[208:211],v[2:5],a[180:183],v[208:211]
s_waitcnt lgkmcnt(4)
v_add_f32 v48, v48, v112
v_add_f32 v49, v49, v113
mm v[212:215],v[68:71],a[244:247],v[212:215]
v_add_f32 v50, v50, v114
v_add_f32 v51, v51, v115
v_add_f32 v52, v52, v116
mm v[212:215],v[100:103],a[148:151],v[212:215]
v_add_f32 v53, v53, v117
v_add_f32 v54, v54, v118
v_add_f32 v55, v55, v119
v_add_f32 v56, v56, v120
mm v[212:215],v[6:9],a[180:183],v[212:215]
v_add_f32 v57, v57, v121
v_add_f32 v58, v58, v122
v_add_f32 v59, v59, v123
mm v[216:219],v[72:75],a[244:247],v[216:219]
v_add_f32 v60, v60, v124
v_add_f32 v61, v61, v125
v_add_f32 v62, v62, v126
v_add_f32 v63, v63, v127
mm v[216:219],v[104:107],a[148:151],v[216:219]
ds_read_b128 v[112:115], v18 offset:20480
ds_read_b128 v[116:119], v18 offset:21504
ds_read_b128 v[120:123], v18 offset:22528
mm v[216:219],v[10:13],a[180:183],v[216:219]
ds_read_b128 v[124:127], v18 offset:23552
s_waitcnt lgkmcnt(4)
v_add_f32 v32, v32, v80
mm v[220:223],v[76:79],a[244:247],v[220:223]
v_add_f32 v33, v33, v81
v_add_f32 v34, v34, v82
v_add_f32 v35, v35, v83
v_add_f32 v36, v36, v84
mm v[220:223],v[108:111],a[148:151],v[220:223]
v_add_f32 v37, v37, v85
v_add_f32 v38, v38, v86
v_add_f32 v39, v39, v87
mm v[220:223],v[14:17],a[180:183],v[220:223]
v_add_f32 v40, v40, v88
v_add_f32 v41, v41, v89
v_add_f32 v42, v42, v90
v_add_f32 v43, v43, v91
mm v[224:227],v[64:67],a[248:251],v[224:227]
v_add_f32 v44, v44, v92
v_add_f32 v45, v45, v93
v_add_f32 v46, v46, v94
mm v[224:227],v[96:99],a[152:155],v[224:227]
v_add_f32 v47, v47, v95
cv v32,v32,v33
cv v33,v34,v35
mm v[224:227],v[2:5],a[184:187],v[224:227]
cv v34,v36,v37
cv v35,v38,v39
buffer_store_dwordx4 v[32:35], v1, s[8:11], s36 offen offset:0 sc1
cv v40,v40,v41
mm v[228:231],v[68:71],a[248:251],v[228:231]
cv v41,v42,v43
cv v42,v44,v45
cv v43,v46,v47
mm v[228:231],v[100:103],a[152:155],v[228:231]
buffer_store_dwordx4 v[40:43], v1, s[8:11], s36 offen offset:1024 sc1
s_waitcnt lgkmcnt(0)
ds_write_b128 v21, v[160:163] offset:0
v_add_f32 v48, v48, v112
v_add_f32 v49, v49, v113
mm v[228:231],v[6:9],a[184:187],v[228:231]
v_add_f32 v50, v50, v114
v_add_f32 v51, v51, v115
v_add_f32 v52, v52, v116
mm v[232:235],v[72:75],a[248:251],v[232:235]
v_add_f32 v53, v53, v117
v_add_f32 v54, v54, v118
v_add_f32 v55, v55, v119
ds_write_b128 v21, v[164:167] offset:1024
mm v[232:235],v[104:107],a[152:155],v[232:235]
v_add_f32 v56, v56, v120
v_add_f32 v57, v57, v121
v_add_f32 v58, v58, v122
v_add_f32 v59, v59, v123
mm v[232:235],v[10:13],a[184:187],v[232:235]
v_add_f32 v60, v60, v124
v_add_f32 v61, v61, v125
v_add_f32 v62, v62, v126
mm v[236:239],v[76:79],a[248:251],v[236:239]
v_add_f32 v63, v63, v127
cv v48,v48,v49
ds_write_b128 v21, v[168:171] offset:2048
cv v49,v50,v51
cv v50,v52,v53
mm v[236:239],v[108:111],a[152:155],v[236:239]
cv v51,v54,v55
buffer_store_dwordx4 v[48:51], v1, s[8:11], s36 offen offset:2048 sc1
cv v56,v56,v57
mm v[236:239],v[14:17],a[184:187],v[236:239]
cv v57,v58,v59
cv v58,v60,v61
cv v59,v62,v63
mm v[240:243],v[64:67],a[252:255],v[240:243]
buffer_store_dwordx4 v[56:59], v1, s[8:11], s36 offen offset:3072 sc1
ds_write_b128 v21, v[172:175] offset:3072
mm v[240:243],v[96:99],a[156:159],v[240:243]
mm v[240:243],v[2:5],a[188:191],v[240:243]
mm v[244:247],v[68:71],a[252:255],v[244:247]
ds_write_b128 v21, v[176:179] offset:4096
mm v[244:247],v[100:103],a[156:159],v[244:247]
mm v[244:247],v[6:9],a[188:191],v[244:247]
mm v[248:251],v[72:75],a[252:255],v[248:251]
ds_write_b128 v21, v[180:183] offset:5120
mm v[248:251],v[104:107],a[156:159],v[248:251]
mm v[248:251],v[10:13],a[188:191],v[248:251]
ds_write_b128 v21, v[184:187] offset:6144
mm v[252:255],v[76:79],a[252:255],v[252:255]
mm v[252:255],v[108:111],a[156:159],v[252:255]
mm v[252:255],v[14:17],a[188:191],v[252:255]
ds_write_b128 v21, v[188:191] offset:7168
mm v[128:131],v[64:67],a[224:227],v[128:131]
mm v[128:131],v[96:99],a[128:131],v[128:131]
mm v[128:131],v[2:5],a[160:163],v[128:131]
ds_write_b128 v22, v[192:195] offset:0
mm v[132:135],v[68:71],a[224:227],v[132:135]
mm v[132:135],v[100:103],a[128:131],v[132:135]
mm v[132:135],v[6:9],a[160:163],v[132:135]
ds_write_b128 v22, v[196:199] offset:1024
mm v[136:139],v[72:75],a[224:227],v[136:139]
mm v[136:139],v[104:107],a[128:131],v[136:139]
mm v[136:139],v[10:13],a[160:163],v[136:139]
ds_write_b128 v22, v[200:203] offset:2048
mm v[140:143],v[76:79],a[224:227],v[140:143]
mm v[140:143],v[108:111],a[128:131],v[140:143]
ds_write_b128 v22, v[204:207] offset:3072
mm v[140:143],v[14:17],a[160:163],v[140:143]
mm v[144:147],v[64:67],a[228:231],v[144:147]
mm v[144:147],v[96:99],a[132:135],v[144:147]
ds_write_b128 v22, v[208:211] offset:4096
mm v[144:147],v[2:5],a[164:167],v[144:147]
mm v[148:151],v[68:71],a[228:231],v[148:151]
mm v[148:151],v[100:103],a[132:135],v[148:151]
ds_write_b128 v22, v[212:215] offset:5120
mm v[148:151],v[6:9],a[164:167],v[148:151]
mm v[152:155],v[72:75],a[228:231],v[152:155]
mm v[152:155],v[104:107],a[132:135],v[152:155]
ds_write_b128 v22, v[216:219] offset:6144
mm v[152:155],v[10:13],a[164:167],v[152:155]
mm v[156:159],v[76:79],a[228:231],v[156:159]
mm v[156:159],v[108:111],a[132:135],v[156:159]
ds_write_b128 v22, v[220:223] offset:7168
mm v[156:159],v[14:17],a[164:167],v[156:159]
s_barrier
s_waitcnt vmcnt(4)
ar v96,a192
ar v97,a193
ar v98,a194
ar v99,a195
ar v100,a196
ds_write_b128 v29, v[224:227] offset:0
ar v101,a197
ar v102,a198
ar v103,a199
ar v104,a200
ar v105,a201
ds_write_b128 v29, v[228:231] offset:1024
ar v106,a202
ar v107,a203
ar v108,a204
ar v109,a205
ar v110,a206
ds_write_b128 v29, v[232:235] offset:2048
ar v111,a207
v_lshlrev_b32 v64, 16, v96
v_and_b32 v65, 0xffff0000, v96
v_lshlrev_b32 v66, 16, v97
ds_write_b128 v29, v[236:239] offset:3072
v_and_b32 v67, 0xffff0000, v97
v_lshlrev_b32 v68, 16, v98
v_and_b32 v69, 0xffff0000, v98
v_lshlrev_b32 v70, 16, v99
v_and_b32 v71, 0xffff0000, v99
ds_write_b128 v29, v[240:243] offset:4096
v_lshlrev_b32 v72, 16, v100
v_and_b32 v73, 0xffff0000, v100
v_lshlrev_b32 v74, 16, v101
v_and_b32 v75, 0xffff0000, v101
v_lshlrev_b32 v76, 16, v102
ds_write_b128 v29, v[244:247] offset:5120
v_and_b32 v77, 0xffff0000, v102
v_lshlrev_b32 v78, 16, v103
v_and_b32 v79, 0xffff0000, v103
v_lshlrev_b32 v80, 16, v104
v_and_b32 v81, 0xffff0000, v104
ds_write_b128 v29, v[248:251] offset:6144
v_lshlrev_b32 v82, 16, v105
v_and_b32 v83, 0xffff0000, v105
v_lshlrev_b32 v84, 16, v106
v_and_b32 v85, 0xffff0000, v106
ds_write_b128 v29, v[252:255] offset:7168
v_lshlrev_b32 v86, 16, v107
v_and_b32 v87, 0xffff0000, v107
v_lshlrev_b32 v88, 16, v108
v_and_b32 v89, 0xffff0000, v108
v_lshlrev_b32 v90, 16, v109
v_and_b32 v91, 0xffff0000, v109
v_lshlrev_b32 v92, 16, v110
v_and_b32 v93, 0xffff0000, v110
v_lshlrev_b32 v94, 16, v111
v_and_b32 v95, 0xffff0000, v111
v_pk_add_f32 v[128:129], v[128:129], v[64:65]
v_pk_add_f32 v[130:131], v[130:131], v[66:67]
v_pk_add_f32 v[132:133], v[132:133], v[68:69]
v_pk_add_f32 v[134:135], v[134:135], v[70:71]
v_pk_add_f32 v[136:137], v[136:137], v[72:73]
v_pk_add_f32 v[138:139], v[138:139], v[74:75]
v_pk_add_f32 v[140:141], v[140:141], v[76:77]
v_pk_add_f32 v[142:143], v[142:143], v[78:79]
v_pk_add_f32 v[144:145], v[144:145], v[80:81]
v_pk_add_f32 v[146:147], v[146:147], v[82:83]
v_pk_add_f32 v[148:149], v[148:149], v[84:85]
v_pk_add_f32 v[150:151], v[150:151], v[86:87]
v_pk_add_f32 v[152:153], v[152:153], v[88:89]
v_pk_add_f32 v[154:155], v[154:155], v[90:91]
v_pk_add_f32 v[156:157], v[156:157], v[92:93]
v_pk_add_f32 v[158:159], v[158:159], v[94:95]
v_mov_b32 v30, 1
s_waitcnt vmcnt(0)
s_mov_b64 exec, 1
buffer_store_dword v30, off, s[28:31], s37 sc1
s_mov_b64 exec, -1
s_xor_b32 s36, s36, 32768
s_xor_b32 s37, s37, 512
s_waitcnt lgkmcnt(0)
s_barrier
buffer_load_dword v31, off, s[28:31], s37 sc1
ds_read_b128 v[160:163], v20 offset:0
ds_read_b128 v[164:167], v20 offset:1024
ds_read_b128 v[168:171], v20 offset:2048
ds_read_b128 v[172:175], v20 offset:3072
ds_read_b128 v[176:179], v20 offset:4096
ds_read_b128 v[180:183], v20 offset:5120
ds_read_b128 v[184:187], v20 offset:6144
ds_read_b128 v[188:191], v20 offset:7168
ds_read_b128 v[192:195], v20 offset:8192
ds_read_b128 v[196:199], v20 offset:9216
ds_read_b128 v[200:203], v20 offset:10240
ds_read_b128 v[204:207], v20 offset:11264
ds_read_b128 v[208:211], v20 offset:12288
ds_read_b128 v[212:215], v20 offset:13312
ds_read_b128 v[216:219], v20 offset:14336
s_waitcnt lgkmcnt(7)
ds_read_b128 v[220:223], v20 offset:15360
ds_read_b128 v[224:227], v18 offset:16384
ds_read_b128 v[228:231], v18 offset:17408
ds_read_b128 v[232:235], v18 offset:18432
ds_read_b128 v[236:239], v18 offset:19456
ds_read_b128 v[240:243], v18 offset:20480
ds_read_b128 v[244:247], v18 offset:21504
ds_read_b128 v[248:251], v18 offset:22528
v_pk_add_f32 v[128:129], v[128:129], v[160:161]
v_pk_add_f32 v[130:131], v[130:131], v[162:163]
v_pk_add_f32 v[132:133], v[132:133], v[164:165]
v_pk_add_f32 v[134:135], v[134:135], v[166:167]
v_pk_add_f32 v[136:137], v[136:137], v[168:169]
v_pk_add_f32 v[138:139], v[138:139], v[170:171]
v_pk_add_f32 v[140:141], v[140:141], v[172:173]
v_pk_add_f32 v[142:143], v[142:143], v[174:175]
v_pk_add_f32 v[144:145], v[144:145], v[176:177]
v_pk_add_f32 v[146:147], v[146:147], v[178:179]
v_pk_add_f32 v[148:149], v[148:149], v[180:181]
v_pk_add_f32 v[150:151], v[150:151], v[182:183]
v_pk_add_f32 v[152:153], v[152:153], v[184:185]
v_pk_add_f32 v[154:155], v[154:155], v[186:187]
v_pk_add_f32 v[156:157], v[156:157], v[188:189]
v_pk_add_f32 v[158:159], v[158:159], v[190:191]
s_waitcnt lgkmcnt(7)
ds_read_b128 v[252:255], v18 offset:23552
s_waitcnt vmcnt(0)
s_mov_b32 s7, 0x100000
s_branch L_spc14
L_sp14:
buffer_load_dword v31, off, s[28:31], s37 sc1
s_waitcnt vmcnt(0)
L_spc14:
v_readfirstlane_b32 s6, v31
s_sub_u32 s7, s7, 1
s_cmp_ge_u32 s6, 1
s_cbranch_scc1 L_spd14
s_sleep 1
s_cmp_lg_u32 s7, 0
s_cbranch_scc1 L_sp14
L_spd14:
buffer_load_dwordx4 v[96:99], v1, s[8:11], s36 offen offset:0 sc1
buffer_load_dwordx4 v[100:103], v1, s[8:11], s36 offen offset:1024 sc1
buffer_load_dwordx4 v[104:107], v1, s[8:11], s36 offen offset:2048 sc1
buffer_load_dwordx4 v[108:111], v1, s[8:11], s36 offen offset:3072 sc1
v_pk_add_f32 v[128:129], v[128:129], v[192:193]
v_pk_add_f32 v[130:131], v[130:131], v[194:195]
v_pk_add_f32 v[132:133], v[132:133], v[196:197]
v_pk_add_f32 v[134:135], v[134:135], v[198:199]
v_pk_add_f32 v[136:137], v[136:137], v[200:201]
v_pk_add_f32 v[138:139], v[138:139], v[202:203]
v_pk_add_f32 v[140:141], v[140:141], v[204:205]
v_pk_add_f32 v[142:143], v[142:143], v[206:207]
v_pk_add_f32 v[144:145], v[144:145], v[208:209]
v_pk_add_f32 v[146:147], v[146:147], v[210:211]
v_pk_add_f32 v[148:149], v[148:149], v[212:213]
v_pk_add_f32 v[150:151], v[150:151], v[214:215]
v_pk_add_f32 v[152:153], v[152:153], v[216:217]
v_pk_add_f32 v[154:155], v[154:155], v[218:219]
v_pk_add_f32 v[156:157], v[156:157], v[220:221]
v_pk_add_f32 v[158:159], v[158:159], v[222:223]
s_waitcnt lgkmcnt(0)
v_pk_add_f32 v[128:129], v[128:129], v[224:225]
v_pk_add_f32 v[130:131], v[130:131], v[226:227]
v_pk_add_f32 v[132:133], v[132:133], v[228:229]
v_pk_add_f32 v[134:135], v[134:135], v[230:231]
v_pk_add_f32 v[136:137], v[136:137], v[232:233]
v_pk_add_f32 v[138:139], v[138:139], v[234:235]
v_pk_add_f32 v[140:141], v[140:141], v[236:237]
v_pk_add_f32 v[142:143], v[142:143], v[238:239]
v_pk_add_f32 v[144:145], v[144:145], v[240:241]
v_pk_add_f32 v[146:147], v[146:147], v[242:243]
v_pk_add_f32 v[148:149], v[148:149], v[244:245]
v_pk_add_f32 v[150:151], v[150:151], v[246:247]
v_pk_add_f32 v[152:153], v[152:153], v[248:249]
v_pk_add_f32 v[154:155], v[154:155], v[250:251]
v_pk_add_f32 v[156:157], v[156:157], v[252:253]
v_pk_add_f32 v[158:159], v[158:159], v[254:255]
s_mov_b32 s24, s82
s_and_b32 s25, s83, 0xffff
s_mov_b32 s26, 4194304
s_mov_b32 s27, 0x20000
s_lshl_b32 s4, s3, 14
s_add_u32 s4, s4, 98304
v_and_b32 v19, 15, v0
v_mul_u32_u24 v19, 144, v19
v_lshrrev_b32 v28, 4, v0
v_lshl_add_u32 v19, v28, 3, v19
v_add_u32 v19, s4, v19
v_lshrrev_b32 v28, 3, v0
v_and_b32 v29, 7, v0
v_mul_u32_u24 v23, 144, v28
v_lshl_add_u32 v23, v29, 4, v23
v_add_u32 v23, s4, v23
v_lshlrev_b32 v28, 11, v28
v_lshl_add_u32 v28, v29, 4, v28
s_lshl_b32 s4, s34, 7
s_lshl_b32 s5, s3, 5
s_add_u32 s4, s4, s5
s_lshl_b32 s4, s4, 11
s_lshl_b32 s5, s35, 7
s_add_u32 s4, s4, s5
s_waitcnt vmcnt(0)
v_lshlrev_b32 v64, 16, v96
v_and_b32 v65, 0xffff0000, v96
v_lshlrev_b32 v66, 16, v97
v_and_b32 v67, 0xffff0000, v97
v_lshlrev_b32 v68, 16, v98
v_and_b32 v69, 0xffff0000, v98
v_lshlrev_b32 v70, 16, v99
v_and_b32 v71, 0xffff0000, v99
v_lshlrev_b32 v72, 16, v100
v_and_b32 v73, 0xffff0000, v100
v_lshlrev_b32 v74, 16, v101
v_and_b32 v75, 0xffff0000, v101
v_lshlrev_b32 v76, 16, v102
v_and_b32 v77, 0xffff0000, v102
v_lshlrev_b32 v78, 16, v103
v_and_b32 v79, 0xffff0000, v103
v_lshlrev_b32 v80, 16, v104
v_and_b32 v81, 0xffff0000, v104
v_lshlrev_b32 v82, 16, v105
v_and_b32 v83, 0xffff0000, v105
v_lshlrev_b32 v84, 16, v106
v_and_b32 v85, 0xffff0000, v106
v_lshlrev_b32 v86, 16, v107
v_and_b32 v87, 0xffff0000, v107
v_lshlrev_b32 v88, 16, v108
v_and_b32 v89, 0xffff0000, v108
v_lshlrev_b32 v90, 16, v109
v_and_b32 v91, 0xffff0000, v109
v_lshlrev_b32 v92, 16, v110
v_and_b32 v93, 0xffff0000, v110
v_lshlrev_b32 v94, 16, v111
v_and_b32 v95, 0xffff0000, v111
v_pk_add_f32 v[128:129], v[128:129], v[64:65]
v_pk_add_f32 v[130:131], v[130:131], v[66:67]
v_pk_add_f32 v[132:133], v[132:133], v[68:69]
v_pk_add_f32 v[134:135], v[134:135], v[70:71]
v_pk_add_f32 v[136:137], v[136:137], v[72:73]
v_pk_add_f32 v[138:139], v[138:139], v[74:75]
v_pk_add_f32 v[140:141], v[140:141], v[76:77]
v_pk_add_f32 v[142:143], v[142:143], v[78:79]
v_pk_add_f32 v[144:145], v[144:145], v[80:81]
v_pk_add_f32 v[146:147], v[146:147], v[82:83]
v_pk_add_f32 v[148:149], v[148:149], v[84:85]
v_pk_add_f32 v[150:151], v[150:151], v[86:87]
v_pk_add_f32 v[152:153], v[152:153], v[88:89]
v_pk_add_f32 v[154:155], v[154:155], v[90:91]
v_pk_add_f32 v[156:157], v[156:157], v[92:93]
v_pk_add_f32 v[158:159], v[158:159], v[94:95]
cv v64,v128,v129
cv v65,v130,v131
cv v66,v132,v133
cv v67,v134,v135
cv v68,v136,v137
cv v69,v138,v139
cv v70,v140,v141
cv v71,v142,v143
cv v72,v144,v145
cv v73,v146,v147
cv v74,v148,v149
cv v75,v150,v151
cv v76,v152,v153
cv v77,v154,v155
cv v78,v156,v157
cv v79,v158,v159
ds_write_b64 v19, v[64:65] offset:0
ds_write_b64 v19, v[66:67] offset:32
ds_write_b64 v19, v[68:69] offset:64
ds_write_b64 v19, v[70:71] offset:96
ds_write_b64 v19, v[72:73] offset:2304
ds_write_b64 v19, v[74:75] offset:2336
ds_write_b64 v19, v[76:77] offset:2368
ds_write_b64 v19, v[78:79] offset:2400
s_waitcnt lgkmcnt(0)
ds_read_b128 v[96:99], v23 offset:0
ds_read_b128 v[100:103], v23 offset:1152
ds_read_b128 v[104:107], v23 offset:2304
ds_read_b128 v[108:111], v23 offset:3456
s_waitcnt lgkmcnt(3)
buffer_store_dwordx4 v[96:99], v28, s[24:27], s4 offen
s_add_u32 s4, s4, 16384
s_waitcnt lgkmcnt(2)
buffer_store_dwordx4 v[100:103], v28, s[24:27], s4 offen
s_add_u32 s4, s4, 16384
s_waitcnt lgkmcnt(1)
buffer_store_dwordx4 v[104:107], v28, s[24:27], s4 offen
s_add_u32 s4, s4, 16384
s_waitcnt lgkmcnt(0)
buffer_store_dwordx4 v[108:111], v28, s[24:27], s4 offen
L_end:
s_endpgm
.section .rodata,"a"
.p2align 6
.amdhsa_kernel sequential_preLN__compressed_kv_cla__dense_activation_silu__prompt_kernel
  .amdhsa_next_free_vgpr 512
  .amdhsa_next_free_sgpr 102
  .amdhsa_accum_offset 256
  .amdhsa_group_segment_fixed_size 0
  .amdhsa_kernarg_size 96
  .amdhsa_user_sgpr_count 2
  .amdhsa_user_sgpr_kernarg_segment_ptr 1
  .amdhsa_system_sgpr_workgroup_id_x 1
  .amdhsa_float_denorm_mode_32 3
.end_amdhsa_kernel
```
